```python
import torch

def _softmax(x, axis=-1):
    return torch.softmax(x, dim=axis)

def _gelu(x):
    return torch.nn.functional.gelu(x, approximate='tanh')

def _silu(x):
    return torch.nn.functional.silu(x)

def _sigmoid(x):
    return torch.sigmoid(x)

def _layernorm(x, axis=-1, eps=1e-05):
    m = x.mean(dim=axis, keepdim=True)
    v = x.var(dim=axis, keepdim=True, unbiased=False)
    return (x - m) / torch.sqrt(v + eps)

def _scatter_add(tgt, idx, src, axis=0):
    return tgt.clone().index_add_(axis, idx, src)

def _segment_sum(src, seg, n):
    out = torch.zeros((n,) + src.shape[1:], dtype=src.dtype)
    return out.index_add_(0, seg, src)

def _pad(x, pw):
    flat = tuple((v for pair in reversed(pw) for v in pair))
    return torch.nn.functional.pad(x, flat)
kernel_name = 'interleave_layers__memory_aug_recurrent_mem_tr__glu_gated_geglu__prompt'

def setup_inputs():

    _w = lambda a: (lambda t: t.to(torch.bfloat16) if t.is_floating_point() else t)(torch.as_tensor(a))

    def _A_setup():
        B, S, Dm = (1, 2048, 512)
        H, Dh = (32, 128)
        M, seg = (8, 32)
        seg = min(seg, S)
        S = S // seg * seg
        return {'x': _w((lambda *s: torch.randn(*s, dtype=torch.bfloat16) * 0.05)(B, S, Dm)), 'mem0': _w((lambda *s: torch.randn(*s, dtype=torch.bfloat16) * 0.4)(B, M, Dm)), 'Wq': _w((lambda *s: torch.randn(*s, dtype=torch.bfloat16) * 0.8)(Dm, H, Dh) * Dm ** (-0.5)), 'Wk': _w((lambda *s: torch.randn(*s, dtype=torch.bfloat16) * 0.8)(Dm, H, Dh) * Dm ** (-0.5)), 'Wv': _w((lambda *s: torch.randn(*s, dtype=torch.bfloat16) * 0.4)(Dm, H, Dh) * Dm ** (-0.5)), 'Wo': _w((lambda *s: torch.randn(*s, dtype=torch.bfloat16) * 0.4)(H, Dh, Dm) * (H * Dh) ** (-0.5)), 'seg_len': seg}
    _A_in = _A_setup()

    def _B_setup():
        B, S, Dm, Df = (1, 2048, 512, 1792)
        return {'x': _w((lambda *s: torch.randn(*s, dtype=torch.bfloat16) * 0.05)(B, S, Dm)), 'w_gate': _w((lambda *s: torch.randn(*s, dtype=torch.bfloat16) * 0.4)(Dm, Df) * Dm ** (-0.5)), 'w_up': _w((lambda *s: torch.randn(*s, dtype=torch.bfloat16) * 0.4)(Dm, Df) * Dm ** (-0.5)), 'w_down': _w((lambda *s: torch.randn(*s, dtype=torch.bfloat16) * 0.4)(Df, Dm) * Df ** (-0.5))}
    _B_in = _B_setup()
    return {'A_x': _A_in['x'], 'A_mem0': _A_in['mem0'], 'A_Wq': _A_in['Wq'], 'A_Wk': _A_in['Wk'], 'A_Wv': _A_in['Wv'], 'A_Wo': _A_in['Wo'], 'A_seg_len': _A_in['seg_len'], 'B_x': _B_in['x'], 'B_w_gate': _B_in['w_gate'], 'B_w_up': _B_in['w_up'], 'B_w_down': _B_in['w_down']}

def reference(A_x, A_mem0, A_Wq, A_Wk, A_Wv, A_Wo, A_seg_len, B_x, B_w_gate, B_w_up, B_w_down):

    def _A_ref(x, mem0, Wq, Wk, Wv, Wo, seg_len):
        B, S, Dm = x.shape
        H, Dh = (Wq.shape[1], Wq.shape[2])
        M = mem0.shape[1]
        scale = Dh ** (-0.5)
        n_seg = S // seg_len
        L = M + seg_len
        idx = torch.arange(L)
        mask = (idx[:, None] < M) | (idx[:, None] >= idx[None, :])
        mem = mem0
        outs = []
        for s in range(n_seg):
            xs = x[:, s * seg_len:(s + 1) * seg_len, :].clone()
            h = torch.concatenate([mem, xs], axis=1)
            q = torch.einsum('btd,dhe->bhte', h, Wq)
            k = torch.einsum('btd,dhe->bhte', h, Wk)
            v = torch.einsum('btd,dhe->bhte', h, Wv)
            scores = torch.einsum('bhqe,bhke->bhqk', q, k) * scale
            scores = torch.where(mask[None, None], scores, -1000000000.0)
            p = _softmax(scores, axis=-1)
            o = torch.einsum('bhqk,bhke->bhqe', p, v)
            o = torch.einsum('bhte,hed->btd', o, Wo)
            mem = o[:, :M, :].clone()
            outs.append(o[:, M:, :])
        return torch.concatenate(outs, axis=1)

    def _B_ref(x, w_gate, w_up, w_down):
        g = torch.einsum('bsd,df->bsf', x, w_gate)
        u = torch.einsum('bsd,df->bsf', x, w_up)
        h = _gelu(g) * u
        return torch.einsum('bsf,fd->bsd', h, w_down)
    x = A_x
    x = x + _A_ref(_layernorm(x, axis=-1), A_mem0, A_Wq, A_Wk, A_Wv, A_Wo, A_seg_len)
    x = x + _B_ref(_layernorm(x, axis=-1), B_w_gate, B_w_up, B_w_down)
    x = x + _A_ref(_layernorm(x, axis=-1), A_mem0, A_Wq, A_Wk, A_Wv, A_Wo, A_seg_len)
    x = x + _B_ref(_layernorm(x, axis=-1), B_w_gate, B_w_up, B_w_down)
    return x
```

```asm
; @launch kernel=mega_kernel grid=(256,1,1) block=(256,1,1) lds=163840
.amdgcn_target "amdgcn-amd-amdhsa--gfx950"
.text
.globl mega_kernel
.p2align 8
.type mega_kernel,@function
mega_kernel:
  s_cmp_ge_u32 s2, 256
  s_cbranch_scc1 mega_kernel_end
  s_load_dwordx2 s[4:5], s[0:1], 104
  s_load_dwordx2 s[92:93], s[0:1], 96
  s_waitcnt lgkmcnt(0)
  s_mov_b32 s6, 268435456
  s_mov_b32 s7, 0x00020000
  s_mov_b32 s94, 256
  s_mov_b32 s95, 0x00020000
  v_lshrrev_b32 v3, 6, v0
  v_and_b32 v2, 63, v0
  v_readfirstlane_b32 s3, v3
  v_lshlrev_b32 v1, 4, v2
  s_getreg_b32 s99, hwreg(HW_REG_XCC_ID)
  s_and_b32 s99, s99, 7
  s_cmp_lg_u32 s3, 0
  s_cbranch_scc1 tick_1
  s_lshl_b32 s40, s99, 2
  s_add_u32 s40, s40, 128
  s_cmp_eq_u32 s99, 0
  s_cselect_b32 s40, 0, s40
  v_mov_b32 v4, 1
  v_mov_b32 v5, 0
  s_mov_b64 exec, 1
  buffer_atomic_add v4, off, s[92:95], s40 sc0 sc1
  s_waitcnt vmcnt(0)
  ds_write_b32 v5, v4
  s_mov_b64 exec, -1
  s_waitcnt lgkmcnt(0)
tick_1:
  s_barrier
  v_mov_b32 v5, 0
  ds_read_b32 v4, v5
  s_waitcnt lgkmcnt(0)
  v_readfirstlane_b32 s41, v4
  s_barrier
  s_lshl_b32 s96, s99, 5
  s_add_u32 s96, s96, s41
  s_cmp_lt_u32 s41, 32
  s_cbranch_scc1 slotok_2
  s_mov_b32 s42, 0
surp_3:
  s_add_u32 s42, s42, 1
  s_cmp_gt_u32 s42, 131072
  s_cbranch_scc1 mega_kernel_end
  v_and_b32 v3, 7, v2
  v_lshlrev_b32 v3, 2, v3
  v_cmp_ne_u32 vcc, 0, v3
  v_add_u32 v4, 128, v3
  s_nop 0
  v_cndmask_b32 v3, 0, v4, vcc
  buffer_load_dword v4, v3, s[92:95], 0 offen sc1
  s_waitcnt vmcnt(0)
  v_readlane_b32 s80, v4, 0
  v_readlane_b32 s81, v4, 1
  v_readlane_b32 s82, v4, 2
  v_readlane_b32 s83, v4, 3
  v_readlane_b32 s84, v4, 4
  v_readlane_b32 s85, v4, 5
  v_readlane_b32 s86, v4, 6
  v_readlane_b32 s87, v4, 7
  s_add_u32 s88, s80, s81
  s_add_u32 s88, s88, s82
  s_add_u32 s88, s88, s83
  s_add_u32 s88, s88, s84
  s_add_u32 s88, s88, s85
  s_add_u32 s88, s88, s86
  s_add_u32 s88, s88, s87
  s_cmp_lt_u32 s88, 256
  s_cbranch_scc1 surp_3
  s_sub_u32 s43, s41, 32
  s_max_u32 s89, s80, 32
  s_sub_u32 s89, s89, 32
  s_cmp_gt_u32 s99, 0
  s_cselect_b32 s89, s89, 0
  s_add_u32 s43, s43, s89
  s_max_u32 s89, s81, 32
  s_sub_u32 s89, s89, 32
  s_cmp_gt_u32 s99, 1
  s_cselect_b32 s89, s89, 0
  s_add_u32 s43, s43, s89
  s_max_u32 s89, s82, 32
  s_sub_u32 s89, s89, 32
  s_cmp_gt_u32 s99, 2
  s_cselect_b32 s89, s89, 0
  s_add_u32 s43, s43, s89
  s_max_u32 s89, s83, 32
  s_sub_u32 s89, s89, 32
  s_cmp_gt_u32 s99, 3
  s_cselect_b32 s89, s89, 0
  s_add_u32 s43, s43, s89
  s_max_u32 s89, s84, 32
  s_sub_u32 s89, s89, 32
  s_cmp_gt_u32 s99, 4
  s_cselect_b32 s89, s89, 0
  s_add_u32 s43, s43, s89
  s_max_u32 s89, s85, 32
  s_sub_u32 s89, s89, 32
  s_cmp_gt_u32 s99, 5
  s_cselect_b32 s89, s89, 0
  s_add_u32 s43, s43, s89
  s_max_u32 s89, s86, 32
  s_sub_u32 s89, s89, 32
  s_cmp_gt_u32 s99, 6
  s_cselect_b32 s89, s89, 0
  s_add_u32 s43, s43, s89
  s_max_u32 s89, s87, 32
  s_sub_u32 s89, s89, 32
  s_cmp_gt_u32 s99, 7
  s_cselect_b32 s89, s89, 0
  s_add_u32 s43, s43, s89
  s_min_u32 s89, s80, 32
  s_sub_u32 s90, 32, s89
  s_cmp_lt_u32 s43, s90
  s_cbranch_scc0 hole_4
  s_add_u32 s96, s89, s43
  s_add_u32 s96, s96, 0
  s_branch slotok_2
hole_4:
  s_sub_u32 s43, s43, s90
  s_min_u32 s89, s81, 32
  s_sub_u32 s90, 32, s89
  s_cmp_lt_u32 s43, s90
  s_cbranch_scc0 hole_5
  s_add_u32 s96, s89, s43
  s_add_u32 s96, s96, 32
  s_branch slotok_2
hole_5:
  s_sub_u32 s43, s43, s90
  s_min_u32 s89, s82, 32
  s_sub_u32 s90, 32, s89
  s_cmp_lt_u32 s43, s90
  s_cbranch_scc0 hole_6
  s_add_u32 s96, s89, s43
  s_add_u32 s96, s96, 64
  s_branch slotok_2
hole_6:
  s_sub_u32 s43, s43, s90
  s_min_u32 s89, s83, 32
  s_sub_u32 s90, 32, s89
  s_cmp_lt_u32 s43, s90
  s_cbranch_scc0 hole_7
  s_add_u32 s96, s89, s43
  s_add_u32 s96, s96, 96
  s_branch slotok_2
hole_7:
  s_sub_u32 s43, s43, s90
  s_min_u32 s89, s84, 32
  s_sub_u32 s90, 32, s89
  s_cmp_lt_u32 s43, s90
  s_cbranch_scc0 hole_8
  s_add_u32 s96, s89, s43
  s_add_u32 s96, s96, 128
  s_branch slotok_2
hole_8:
  s_sub_u32 s43, s43, s90
  s_min_u32 s89, s85, 32
  s_sub_u32 s90, 32, s89
  s_cmp_lt_u32 s43, s90
  s_cbranch_scc0 hole_9
  s_add_u32 s96, s89, s43
  s_add_u32 s96, s96, 160
  s_branch slotok_2
hole_9:
  s_sub_u32 s43, s43, s90
  s_min_u32 s89, s86, 32
  s_sub_u32 s90, 32, s89
  s_cmp_lt_u32 s43, s90
  s_cbranch_scc0 hole_10
  s_add_u32 s96, s89, s43
  s_add_u32 s96, s96, 192
  s_branch slotok_2
hole_10:
  s_sub_u32 s43, s43, s90
  s_min_u32 s89, s87, 32
  s_sub_u32 s90, 32, s89
  s_cmp_lt_u32 s43, s90
  s_cbranch_scc0 hole_11
  s_add_u32 s96, s89, s43
  s_add_u32 s96, s96, 224
  s_branch slotok_2
hole_11:
  s_sub_u32 s43, s43, s90
  s_branch mega_kernel_end
slotok_2:
  s_cmp_lt_u32 s96, 32
  s_cbranch_scc1 r_team_12
  s_mov_b32 s44, 2
  s_sub_u32 s45, s96, 32
  s_cmp_lt_u32 s96, 64
  s_cbranch_scc1 r_proj_13
  s_and_b32 s40, s96, 31
  s_lshr_b32 s41, s96, 5
  s_cmp_ge_u32 s41, 4
  s_cbranch_scc1 mx4_21
  s_sub_u32 s41, s41, 2
  s_mul_i32 s42, s41, 70
  s_add_u32 s42, s42, 48
  s_lshl_b32 s43, s41, 1
  s_add_u32 s43, s43, 158
  s_cmp_lt_u32 s40, 30
  s_cselect_b32 s42, s42, s43
  s_add_u32 s98, s42, s40
  s_branch mxd_22
mx4_21:
  s_sub_u32 s41, s41, 4
  s_lshr_b32 s42, s41, 1
  s_mul_i32 s42, s42, 70
  s_add_u32 s42, s42, 48
  s_and_b32 s43, s41, 1
  s_lshl_b32 s47, s43, 4
  s_add_u32 s47, s47, s42
  s_add_u32 s47, s47, 38
  s_lshl_b32 s48, s43, 2
  s_add_u32 s48, s48, s42
  s_add_u32 s48, s48, 14
  s_mul_i32 s49, s41, 12
  s_sub_u32 s49, s49, 20
  s_cmp_lt_u32 s40, 20
  s_cselect_b32 s49, s48, s49
  s_cmp_lt_u32 s40, 16
  s_cselect_b32 s49, s47, s49
  s_add_u32 s98, s49, s40
mxd_22:
  s_mov_b32 s44, 0
  s_mov_b32 s45, s98
  s_cmp_lt_u32 s98, 48
  s_cbranch_scc1 r_proj_13
  s_sub_u32 s98, s98, 48
  s_mov_b32 s97, 0
  s_cmp_lt_u32 s98, 64
  s_cbranch_scc1 r_init_14
  s_cmp_lt_u32 s98, 70
  s_cbranch_scc1 r_group_15
  s_sub_u32 s98, s98, 70
  s_mov_b32 s97, 1
  s_mov_b32 s44, 1
  s_mov_b32 s45, s98
  s_cmp_lt_u32 s98, 30
  s_cbranch_scc1 r_proj_13
  s_add_u32 s45, s98, 2
  s_cmp_lt_u32 s98, 46
  s_cbranch_scc1 r_proj_13
  s_mov_b32 s44, 2
  s_sub_u32 s45, s98, 14
  s_cmp_lt_u32 s98, 62
  s_cbranch_scc1 r_proj_13
  s_mov_b32 s44, 1
  s_sub_u32 s45, s98, 40
  s_sub_u32 s40, s98, 70
  s_cmp_lt_u32 s40, 2
  s_cbranch_scc0 r_group_15
r_proj_13:
  s_cmp_eq_u32 s44, 3
  s_cbranch_scc1 r_group_15
  s_lshr_b32 s43, s45, 4
  s_and_b32 s42, s45, 15
  s_lshl_b32 s40, s43, 3
  s_add_u32 s40, s40, 16
  s_load_dwordx2 s[8:9], s[0:1], s40
  s_waitcnt lgkmcnt(0)
  s_mov_b32 s10, 4194304
  s_mov_b32 s11, 0x00020000
  s_lshl_b32 s24, s42, 9
  s_lshl_b32 s40, s3, 7
  s_add_u32 s24, s24, s40
  s_add_u32 s25, s24, 64
  s_cmp_eq_u32 s43, 2
  s_cbranch_scc1 pv_23
  s_waitcnt vmcnt(0)
  v_lshrrev_b32 v3, 2, v2
  s_mov_b32 s31, 8192
  v_mul_lo_u32 v6, v3, s31
  v_and_b32 v3, 3, v2
  v_lshl_add_u32 v6, v3, 4, v6
  v_bfe_u32 v4, v2, 2, 2
  v_lshrrev_b32 v5, 5, v2
  v_lshl_add_u32 v4, v5, 3, v4
  v_lshlrev_b32 v7, 6, v4
  v_bfe_u32 v4, v2, 4, 1
  v_lshl_add_u32 v7, v4, 5, v7
  v_and_b32 v4, 1, v2
  v_lshl_add_u32 v7, v4, 4, v7
  v_bfe_u32 v4, v2, 1, 1
  v_lshl_add_u32 v7, v4, 3, v7
  s_lshl_b32 s31, s3, 15
  v_add_u32 v7, s31, v7
  v_mov_b32 v14, 1
  s_lshl_b32 s36, s3, 15
  s_add_u32 m0, s36, 0
  s_nop 0
  buffer_load_dwordx4 v6, s[8:11], s24 offen lds
  s_add_u32 s24, s24, 131072
  s_add_u32 m0, m0, 1024
  s_nop 0
  buffer_load_dwordx4 v6, s[8:11], s25 offen lds
  s_add_u32 s25, s25, 131072
  s_add_u32 m0, m0, 1024
  s_nop 0
  buffer_load_dwordx4 v6, s[8:11], s24 offen lds
  s_add_u32 s24, s24, 131072
  s_add_u32 m0, m0, 1024
  s_nop 0
  buffer_load_dwordx4 v6, s[8:11], s25 offen lds
  s_add_u32 s25, s25, 131072
  s_add_u32 m0, m0, 1024
  s_nop 0
  buffer_load_dwordx4 v6, s[8:11], s24 offen lds
  s_add_u32 s24, s24, 131072
  s_add_u32 m0, m0, 1024
  s_nop 0
  buffer_load_dwordx4 v6, s[8:11], s25 offen lds
  s_add_u32 s25, s25, 131072
  s_add_u32 m0, m0, 1024
  s_nop 0
  buffer_load_dwordx4 v6, s[8:11], s24 offen lds
  s_add_u32 s24, s24, 131072
  s_add_u32 m0, m0, 1024
  s_nop 0
  buffer_load_dwordx4 v6, s[8:11], s25 offen lds
  s_add_u32 s25, s25, 131072
  s_add_u32 m0, m0, 1024
  s_nop 0
  buffer_load_dwordx4 v6, s[8:11], s24 offen lds
  s_add_u32 s24, s24, 131072
  s_add_u32 m0, m0, 1024
  s_nop 0
  buffer_load_dwordx4 v6, s[8:11], s25 offen lds
  s_add_u32 s25, s25, 131072
  s_add_u32 m0, m0, 1024
  s_nop 0
  buffer_load_dwordx4 v6, s[8:11], s24 offen lds
  s_add_u32 s24, s24, 131072
  s_add_u32 m0, m0, 1024
  s_nop 0
  buffer_load_dwordx4 v6, s[8:11], s25 offen lds
  s_add_u32 s25, s25, 131072
  s_add_u32 m0, m0, 1024
  s_nop 0
  buffer_load_dwordx4 v6, s[8:11], s24 offen lds
  s_add_u32 s24, s24, 131072
  s_add_u32 m0, m0, 1024
  s_nop 0
  buffer_load_dwordx4 v6, s[8:11], s25 offen lds
  s_add_u32 s25, s25, 131072
  s_add_u32 m0, m0, 1024
  s_nop 0
  buffer_load_dwordx4 v6, s[8:11], s24 offen lds
  s_add_u32 s24, s24, 131072
  s_add_u32 m0, m0, 1024
  s_nop 0
  buffer_load_dwordx4 v6, s[8:11], s25 offen lds
  s_add_u32 s25, s25, 131072
  s_lshl_b32 s36, s3, 15
  s_add_u32 m0, s36, 16384
  s_nop 0
  buffer_load_dwordx4 v6, s[8:11], s24 offen lds
  s_add_u32 s24, s24, 131072
  s_add_u32 m0, m0, 1024
  s_nop 0
  buffer_load_dwordx4 v6, s[8:11], s25 offen lds
  s_add_u32 s25, s25, 131072
  s_add_u32 m0, m0, 1024
  s_nop 0
  buffer_load_dwordx4 v6, s[8:11], s24 offen lds
  s_add_u32 s24, s24, 131072
  s_add_u32 m0, m0, 1024
  s_nop 0
  buffer_load_dwordx4 v6, s[8:11], s25 offen lds
  s_add_u32 s25, s25, 131072
  s_add_u32 m0, m0, 1024
  s_nop 0
  buffer_load_dwordx4 v6, s[8:11], s24 offen lds
  s_add_u32 s24, s24, 131072
  s_add_u32 m0, m0, 1024
  s_nop 0
  buffer_load_dwordx4 v6, s[8:11], s25 offen lds
  s_add_u32 s25, s25, 131072
  s_add_u32 m0, m0, 1024
  s_nop 0
  buffer_load_dwordx4 v6, s[8:11], s24 offen lds
  s_add_u32 s24, s24, 131072
  s_add_u32 m0, m0, 1024
  s_nop 0
  buffer_load_dwordx4 v6, s[8:11], s25 offen lds
  s_add_u32 s25, s25, 131072
  s_add_u32 m0, m0, 1024
  s_nop 0
  buffer_load_dwordx4 v6, s[8:11], s24 offen lds
  s_add_u32 s24, s24, 131072
  s_add_u32 m0, m0, 1024
  s_nop 0
  buffer_load_dwordx4 v6, s[8:11], s25 offen lds
  s_add_u32 s25, s25, 131072
  s_add_u32 m0, m0, 1024
  s_nop 0
  buffer_load_dwordx4 v6, s[8:11], s24 offen lds
  s_add_u32 s24, s24, 131072
  s_add_u32 m0, m0, 1024
  s_nop 0
  buffer_load_dwordx4 v6, s[8:11], s25 offen lds
  s_add_u32 s25, s25, 131072
  s_add_u32 m0, m0, 1024
  s_nop 0
  buffer_load_dwordx4 v6, s[8:11], s24 offen lds
  s_add_u32 s24, s24, 131072
  s_add_u32 m0, m0, 1024
  s_nop 0
  buffer_load_dwordx4 v6, s[8:11], s25 offen lds
  s_add_u32 s25, s25, 131072
  s_add_u32 m0, m0, 1024
  s_nop 0
  buffer_load_dwordx4 v6, s[8:11], s24 offen lds
  s_add_u32 s24, s24, 131072
  s_add_u32 m0, m0, 1024
  s_nop 0
  buffer_load_dwordx4 v6, s[8:11], s25 offen lds
  s_add_u32 s25, s25, 131072
  s_waitcnt vmcnt(16)
  ds_read_b64_tr_b16 a[0:1], v7 offset:0
  ds_read_b64_tr_b16 a[2:3], v7 offset:256
  ds_read_b64_tr_b16 a[128:129], v7 offset:1024
  ds_read_b64_tr_b16 a[130:131], v7 offset:1280
  ds_read_b64_tr_b16 a[4:5], v7 offset:2048
  ds_read_b64_tr_b16 a[6:7], v7 offset:2304
  ds_read_b64_tr_b16 a[132:133], v7 offset:3072
  ds_read_b64_tr_b16 a[134:135], v7 offset:3328
  ds_read_b64_tr_b16 a[8:9], v7 offset:4096
  ds_read_b64_tr_b16 a[10:11], v7 offset:4352
  ds_read_b64_tr_b16 a[136:137], v7 offset:5120
  ds_read_b64_tr_b16 a[138:139], v7 offset:5376
  ds_read_b64_tr_b16 a[12:13], v7 offset:6144
  ds_read_b64_tr_b16 a[14:15], v7 offset:6400
  ds_read_b64_tr_b16 a[140:141], v7 offset:7168
  ds_read_b64_tr_b16 a[142:143], v7 offset:7424
  ds_read_b64_tr_b16 a[16:17], v7 offset:8192
  ds_read_b64_tr_b16 a[18:19], v7 offset:8448
  ds_read_b64_tr_b16 a[144:145], v7 offset:9216
  ds_read_b64_tr_b16 a[146:147], v7 offset:9472
  ds_read_b64_tr_b16 a[20:21], v7 offset:10240
  ds_read_b64_tr_b16 a[22:23], v7 offset:10496
  ds_read_b64_tr_b16 a[148:149], v7 offset:11264
  ds_read_b64_tr_b16 a[150:151], v7 offset:11520
  ds_read_b64_tr_b16 a[24:25], v7 offset:12288
  ds_read_b64_tr_b16 a[26:27], v7 offset:12544
  ds_read_b64_tr_b16 a[152:153], v7 offset:13312
  ds_read_b64_tr_b16 a[154:155], v7 offset:13568
  ds_read_b64_tr_b16 a[28:29], v7 offset:14336
  ds_read_b64_tr_b16 a[30:31], v7 offset:14592
  ds_read_b64_tr_b16 a[156:157], v7 offset:15360
  ds_read_b64_tr_b16 a[158:159], v7 offset:15616
  s_waitcnt lgkmcnt(0)
  s_lshl_b32 s36, s3, 15
  s_add_u32 m0, s36, 0
  s_nop 0
  buffer_load_dwordx4 v6, s[8:11], s24 offen lds
  s_add_u32 s24, s24, 131072
  s_add_u32 m0, m0, 1024
  s_nop 0
  buffer_load_dwordx4 v6, s[8:11], s25 offen lds
  s_add_u32 s25, s25, 131072
  s_add_u32 m0, m0, 1024
  s_nop 0
  buffer_load_dwordx4 v6, s[8:11], s24 offen lds
  s_add_u32 s24, s24, 131072
  s_add_u32 m0, m0, 1024
  s_nop 0
  buffer_load_dwordx4 v6, s[8:11], s25 offen lds
  s_add_u32 s25, s25, 131072
  s_add_u32 m0, m0, 1024
  s_nop 0
  buffer_load_dwordx4 v6, s[8:11], s24 offen lds
  s_add_u32 s24, s24, 131072
  s_add_u32 m0, m0, 1024
  s_nop 0
  buffer_load_dwordx4 v6, s[8:11], s25 offen lds
  s_add_u32 s25, s25, 131072
  s_add_u32 m0, m0, 1024
  s_nop 0
  buffer_load_dwordx4 v6, s[8:11], s24 offen lds
  s_add_u32 s24, s24, 131072
  s_add_u32 m0, m0, 1024
  s_nop 0
  buffer_load_dwordx4 v6, s[8:11], s25 offen lds
  s_add_u32 s25, s25, 131072
  s_add_u32 m0, m0, 1024
  s_nop 0
  buffer_load_dwordx4 v6, s[8:11], s24 offen lds
  s_add_u32 s24, s24, 131072
  s_add_u32 m0, m0, 1024
  s_nop 0
  buffer_load_dwordx4 v6, s[8:11], s25 offen lds
  s_add_u32 s25, s25, 131072
  s_add_u32 m0, m0, 1024
  s_nop 0
  buffer_load_dwordx4 v6, s[8:11], s24 offen lds
  s_add_u32 s24, s24, 131072
  s_add_u32 m0, m0, 1024
  s_nop 0
  buffer_load_dwordx4 v6, s[8:11], s25 offen lds
  s_add_u32 s25, s25, 131072
  s_add_u32 m0, m0, 1024
  s_nop 0
  buffer_load_dwordx4 v6, s[8:11], s24 offen lds
  s_add_u32 s24, s24, 131072
  s_add_u32 m0, m0, 1024
  s_nop 0
  buffer_load_dwordx4 v6, s[8:11], s25 offen lds
  s_add_u32 s25, s25, 131072
  s_add_u32 m0, m0, 1024
  s_nop 0
  buffer_load_dwordx4 v6, s[8:11], s24 offen lds
  s_add_u32 s24, s24, 131072
  s_add_u32 m0, m0, 1024
  s_nop 0
  buffer_load_dwordx4 v6, s[8:11], s25 offen lds
  s_add_u32 s25, s25, 131072
  s_waitcnt vmcnt(16)
  ds_read_b64_tr_b16 a[32:33], v7 offset:16384
  ds_read_b64_tr_b16 a[34:35], v7 offset:16640
  ds_read_b64_tr_b16 a[160:161], v7 offset:17408
  ds_read_b64_tr_b16 a[162:163], v7 offset:17664
  ds_read_b64_tr_b16 a[36:37], v7 offset:18432
  ds_read_b64_tr_b16 a[38:39], v7 offset:18688
  ds_read_b64_tr_b16 a[164:165], v7 offset:19456
  ds_read_b64_tr_b16 a[166:167], v7 offset:19712
  ds_read_b64_tr_b16 a[40:41], v7 offset:20480
  ds_read_b64_tr_b16 a[42:43], v7 offset:20736
  ds_read_b64_tr_b16 a[168:169], v7 offset:21504
  ds_read_b64_tr_b16 a[170:171], v7 offset:21760
  ds_read_b64_tr_b16 a[44:45], v7 offset:22528
  ds_read_b64_tr_b16 a[46:47], v7 offset:22784
  ds_read_b64_tr_b16 a[172:173], v7 offset:23552
  ds_read_b64_tr_b16 a[174:175], v7 offset:23808
  ds_read_b64_tr_b16 a[48:49], v7 offset:24576
  ds_read_b64_tr_b16 a[50:51], v7 offset:24832
  ds_read_b64_tr_b16 a[176:177], v7 offset:25600
  ds_read_b64_tr_b16 a[178:179], v7 offset:25856
  ds_read_b64_tr_b16 a[52:53], v7 offset:26624
  ds_read_b64_tr_b16 a[54:55], v7 offset:26880
  ds_read_b64_tr_b16 a[180:181], v7 offset:27648
  ds_read_b64_tr_b16 a[182:183], v7 offset:27904
  ds_read_b64_tr_b16 a[56:57], v7 offset:28672
  ds_read_b64_tr_b16 a[58:59], v7 offset:28928
  ds_read_b64_tr_b16 a[184:185], v7 offset:29696
  ds_read_b64_tr_b16 a[186:187], v7 offset:29952
  ds_read_b64_tr_b16 a[60:61], v7 offset:30720
  ds_read_b64_tr_b16 a[62:63], v7 offset:30976
  ds_read_b64_tr_b16 a[188:189], v7 offset:31744
  ds_read_b64_tr_b16 a[190:191], v7 offset:32000
  s_waitcnt lgkmcnt(0)
  s_lshl_b32 s36, s3, 15
  s_add_u32 m0, s36, 16384
  s_nop 0
  buffer_load_dwordx4 v6, s[8:11], s24 offen lds
  s_add_u32 s24, s24, 131072
  s_add_u32 m0, m0, 1024
  s_nop 0
  buffer_load_dwordx4 v6, s[8:11], s25 offen lds
  s_add_u32 s25, s25, 131072
  s_add_u32 m0, m0, 1024
  s_nop 0
  buffer_load_dwordx4 v6, s[8:11], s24 offen lds
  s_add_u32 s24, s24, 131072
  s_add_u32 m0, m0, 1024
  s_nop 0
  buffer_load_dwordx4 v6, s[8:11], s25 offen lds
  s_add_u32 s25, s25, 131072
  s_add_u32 m0, m0, 1024
  s_nop 0
  buffer_load_dwordx4 v6, s[8:11], s24 offen lds
  s_add_u32 s24, s24, 131072
  s_add_u32 m0, m0, 1024
  s_nop 0
  buffer_load_dwordx4 v6, s[8:11], s25 offen lds
  s_add_u32 s25, s25, 131072
  s_add_u32 m0, m0, 1024
  s_nop 0
  buffer_load_dwordx4 v6, s[8:11], s24 offen lds
  s_add_u32 s24, s24, 131072
  s_add_u32 m0, m0, 1024
  s_nop 0
  buffer_load_dwordx4 v6, s[8:11], s25 offen lds
  s_add_u32 s25, s25, 131072
  s_add_u32 m0, m0, 1024
  s_nop 0
  buffer_load_dwordx4 v6, s[8:11], s24 offen lds
  s_add_u32 s24, s24, 131072
  s_add_u32 m0, m0, 1024
  s_nop 0
  buffer_load_dwordx4 v6, s[8:11], s25 offen lds
  s_add_u32 s25, s25, 131072
  s_add_u32 m0, m0, 1024
  s_nop 0
  buffer_load_dwordx4 v6, s[8:11], s24 offen lds
  s_add_u32 s24, s24, 131072
  s_add_u32 m0, m0, 1024
  s_nop 0
  buffer_load_dwordx4 v6, s[8:11], s25 offen lds
  s_add_u32 s25, s25, 131072
  s_add_u32 m0, m0, 1024
  s_nop 0
  buffer_load_dwordx4 v6, s[8:11], s24 offen lds
  s_add_u32 s24, s24, 131072
  s_add_u32 m0, m0, 1024
  s_nop 0
  buffer_load_dwordx4 v6, s[8:11], s25 offen lds
  s_add_u32 s25, s25, 131072
  s_add_u32 m0, m0, 1024
  s_nop 0
  buffer_load_dwordx4 v6, s[8:11], s24 offen lds
  s_add_u32 s24, s24, 131072
  s_add_u32 m0, m0, 1024
  s_nop 0
  buffer_load_dwordx4 v6, s[8:11], s25 offen lds
  s_add_u32 s25, s25, 131072
  s_waitcnt vmcnt(16)
  ds_read_b64_tr_b16 a[64:65], v7 offset:0
  ds_read_b64_tr_b16 a[66:67], v7 offset:256
  ds_read_b64_tr_b16 a[192:193], v7 offset:1024
  ds_read_b64_tr_b16 a[194:195], v7 offset:1280
  ds_read_b64_tr_b16 a[68:69], v7 offset:2048
  ds_read_b64_tr_b16 a[70:71], v7 offset:2304
  ds_read_b64_tr_b16 a[196:197], v7 offset:3072
  ds_read_b64_tr_b16 a[198:199], v7 offset:3328
  ds_read_b64_tr_b16 a[72:73], v7 offset:4096
  ds_read_b64_tr_b16 a[74:75], v7 offset:4352
  ds_read_b64_tr_b16 a[200:201], v7 offset:5120
  ds_read_b64_tr_b16 a[202:203], v7 offset:5376
  ds_read_b64_tr_b16 a[76:77], v7 offset:6144
  ds_read_b64_tr_b16 a[78:79], v7 offset:6400
  ds_read_b64_tr_b16 a[204:205], v7 offset:7168
  ds_read_b64_tr_b16 a[206:207], v7 offset:7424
  ds_read_b64_tr_b16 a[80:81], v7 offset:8192
  ds_read_b64_tr_b16 a[82:83], v7 offset:8448
  ds_read_b64_tr_b16 a[208:209], v7 offset:9216
  ds_read_b64_tr_b16 a[210:211], v7 offset:9472
  ds_read_b64_tr_b16 a[84:85], v7 offset:10240
  ds_read_b64_tr_b16 a[86:87], v7 offset:10496
  ds_read_b64_tr_b16 a[212:213], v7 offset:11264
  ds_read_b64_tr_b16 a[214:215], v7 offset:11520
  ds_read_b64_tr_b16 a[88:89], v7 offset:12288
  ds_read_b64_tr_b16 a[90:91], v7 offset:12544
  ds_read_b64_tr_b16 a[216:217], v7 offset:13312
  ds_read_b64_tr_b16 a[218:219], v7 offset:13568
  ds_read_b64_tr_b16 a[92:93], v7 offset:14336
  ds_read_b64_tr_b16 a[94:95], v7 offset:14592
  ds_read_b64_tr_b16 a[220:221], v7 offset:15360
  ds_read_b64_tr_b16 a[222:223], v7 offset:15616
  s_waitcnt lgkmcnt(0)
  s_waitcnt vmcnt(0)
  ds_read_b64_tr_b16 a[96:97], v7 offset:16384
  ds_read_b64_tr_b16 a[98:99], v7 offset:16640
  ds_read_b64_tr_b16 a[224:225], v7 offset:17408
  ds_read_b64_tr_b16 a[226:227], v7 offset:17664
  ds_read_b64_tr_b16 a[100:101], v7 offset:18432
  ds_read_b64_tr_b16 a[102:103], v7 offset:18688
  ds_read_b64_tr_b16 a[228:229], v7 offset:19456
  ds_read_b64_tr_b16 a[230:231], v7 offset:19712
  ds_read_b64_tr_b16 a[104:105], v7 offset:20480
  ds_read_b64_tr_b16 a[106:107], v7 offset:20736
  ds_read_b64_tr_b16 a[232:233], v7 offset:21504
  ds_read_b64_tr_b16 a[234:235], v7 offset:21760
  ds_read_b64_tr_b16 a[108:109], v7 offset:22528
  ds_read_b64_tr_b16 a[110:111], v7 offset:22784
  ds_read_b64_tr_b16 a[236:237], v7 offset:23552
  ds_read_b64_tr_b16 a[238:239], v7 offset:23808
  ds_read_b64_tr_b16 a[112:113], v7 offset:24576
  ds_read_b64_tr_b16 a[114:115], v7 offset:24832
  ds_read_b64_tr_b16 a[240:241], v7 offset:25600
  ds_read_b64_tr_b16 a[242:243], v7 offset:25856
  ds_read_b64_tr_b16 a[116:117], v7 offset:26624
  ds_read_b64_tr_b16 a[118:119], v7 offset:26880
  ds_read_b64_tr_b16 a[244:245], v7 offset:27648
  ds_read_b64_tr_b16 a[246:247], v7 offset:27904
  ds_read_b64_tr_b16 a[120:121], v7 offset:28672
  ds_read_b64_tr_b16 a[122:123], v7 offset:28928
  ds_read_b64_tr_b16 a[248:249], v7 offset:29696
  ds_read_b64_tr_b16 a[250:251], v7 offset:29952
  ds_read_b64_tr_b16 a[124:125], v7 offset:30720
  ds_read_b64_tr_b16 a[126:127], v7 offset:30976
  ds_read_b64_tr_b16 a[252:253], v7 offset:31744
  ds_read_b64_tr_b16 a[254:255], v7 offset:32000
  s_waitcnt lgkmcnt(0)
  v_mov_b32 v8, v1
  v_mov_b32 v9, v1
  v_and_b32 v3, 1, v2
  v_lshlrev_b32 v3, 7, v3
  s_mov_b32 s89, 0
wi_24:
  buffer_load_dword v4, v3, s[92:95], 0 offen offset:64 sc1
  s_waitcnt vmcnt(0)
  v_readlane_b32 s80, v4, 0
  v_readlane_b32 s81, v4, 1
  s_nop 0
  s_add_u32 s80, s80, s81
  s_cmp_ge_u32 s80, 64
  s_cbranch_scc1 wid_25
  s_sleep 8
  s_add_u32 s89, s89, 1
  s_cmp_lt_u32 s89, 131072
  s_cbranch_scc1 wi_24
  s_branch mega_kernel_end
wid_25:
  s_lshl_b32 s41, s44, 3
pagain_26:
  s_mov_b32 s50, 328448
  s_cmp_eq_u32 s41, 0
  s_cbranch_scc1 pgo_29
  s_mov_b32 s50, 721423
  s_cmp_eq_u32 s41, 1
  s_cbranch_scc1 pgo_29
  s_mov_b32 s50, 328449
  s_cmp_eq_u32 s41, 8
  s_cbranch_scc1 pgo_29
  s_mov_b32 s50, 721424
  s_cmp_eq_u32 s41, 9
  s_cbranch_scc1 pgo_29
  s_mov_b32 s50, 1769765
  s_cmp_eq_u32 s41, 10
  s_cbranch_scc1 pgo_29
  s_mov_b32 s50, 328450
  s_cmp_eq_u32 s41, 16
  s_cbranch_scc1 pgo_29
  s_branch pfin_28
pgo_29:
  s_mov_b32 s26, 4194304
  s_lshl_b32 s27, s42, 14
  s_lshl_b32 s40, s3, 12
  s_add_u32 s27, s27, s40
  s_lshl_b32 s40, s43, 25
  s_add_u32 s27, s27, s40
  s_add_u32 s27, s27, 37748736
  s_mov_b32 s28, 1
  s_mov_b32 s29, 917504
  s_lshl_b32 s30, s43, 6
  s_lshl_b32 s40, s42, 2
  s_add_u32 s30, s30, s40
  s_add_u32 s30, s30, 0
  s_and_b32 s51, s50, 255
  s_lshl_b32 s40, s51, 15
  s_add_u32 s26, s26, s40
  s_lshl_b32 s40, s51, 18
  s_add_u32 s27, s27, s40
  s_lshl_b32 s40, s51, 10
  s_add_u32 s30, s30, s40
  s_bfe_u32 s51, s50, 0x80008
  s_lshl_b32 s47, s51, 15
  s_lshl_b32 s48, s51, 18
  s_lshl_b32 s49, s51, 10
  s_lshr_b32 s28, s50, 16
  s_lshl_b32 s31, s3, 10
  v_add_u32 v11, s31, v1
  s_mov_b32 s36, s31
  v_min_u32 v12, 0, v2
  v_lshlrev_b32 v12, 2, v12
  v_and_b32 v8, 0x7fff, v8
  v_mov_b32 v36, 163584
  v_mov_b32 v38, 0
  ds_write_b32 v36, v38
  ds_write_b32 v36, v38 offset:4
  ds_write_b32 v36, v38 offset:8
  s_waitcnt lgkmcnt(0)
  v_mov_b32 v38, 1
  v_mov_b32 v37, 163584
  s_mov_b32 s38, 1
  s_barrier
  s_mov_b32 s37, s26
  s_mov_b32 m0, s36
  s_nop 0
  buffer_load_dwordx4 v11, s[4:7], s37 offen sc1 lds
  s_add_u32 m0, m0, 4096
  s_add_u32 s37, s37, 4096
  buffer_load_dwordx4 v11, s[4:7], s37 offen sc1 lds
  s_add_u32 m0, m0, 4096
  s_add_u32 s37, s37, 4096
  buffer_load_dwordx4 v11, s[4:7], s37 offen sc1 lds
  s_add_u32 m0, m0, 4096
  s_add_u32 s37, s37, 4096
  buffer_load_dwordx4 v11, s[4:7], s37 offen sc1 lds
  s_add_u32 m0, m0, 4096
  s_add_u32 s37, s37, 4096
  buffer_load_dwordx4 v11, s[4:7], s37 offen sc1 lds
  s_add_u32 m0, m0, 4096
  s_add_u32 s37, s37, 4096
  buffer_load_dwordx4 v11, s[4:7], s37 offen sc1 lds
  s_add_u32 m0, m0, 4096
  s_add_u32 s37, s37, 4096
  buffer_load_dwordx4 v11, s[4:7], s37 offen sc1 lds
  s_add_u32 m0, m0, 4096
  s_add_u32 s37, s37, 4096
  buffer_load_dwordx4 v11, s[4:7], s37 offen sc1 lds
  s_add_u32 s26, s26, s47
  s_xor_b32 s36, s36, 32768
  s_mov_b32 s34, 0
  s_waitcnt vmcnt(0)
gtop_30:
  s_waitcnt vmcnt(2)
  s_barrier
  ds_read_b128 v[96:99], v8 offset:0
  ds_read_b128 v[100:103], v8 offset:1024
  ds_read_b128 v[104:107], v8 offset:2048
  ds_read_b128 v[108:111], v8 offset:3072
  ds_read_b128 v[112:115], v8 offset:4096
  ds_read_b128 v[116:119], v8 offset:5120
  ds_read_b128 v[120:123], v8 offset:6144
  s_sub_u32 s28, s28, 1
  s_cmp_eq_u32 s28, 0
  s_cselect_b32 s37, 2146435072, s26
  s_mov_b32 m0, s36
  ds_read_b128 v[124:127], v8 offset:7168
  s_waitcnt lgkmcnt(7)
  v_mfma_f32_32x32x16_bf16 v[40:55], a[0:3], v[96:99], 0
  ds_read_b128 v[96:99], v8 offset:8192
  s_waitcnt lgkmcnt(7)
  v_mfma_f32_32x32x16_bf16 v[40:55], a[4:7], v[100:103], v[40:55]
  ds_read_b128 v[100:103], v8 offset:9216
  s_waitcnt lgkmcnt(7)
  v_mfma_f32_32x32x16_bf16 v[40:55], a[8:11], v[104:107], v[40:55]
  buffer_load_dwordx4 v11, s[4:7], s37 offen sc1 lds
  s_add_u32 m0, m0, 4096
  s_add_u32 s37, s37, 4096
  ds_read_b128 v[104:107], v8 offset:10240
  s_waitcnt lgkmcnt(7)
  v_mfma_f32_32x32x16_bf16 v[40:55], a[12:15], v[108:111], v[40:55]
  ds_read_b128 v[108:111], v8 offset:11264
  s_waitcnt lgkmcnt(7)
  v_mfma_f32_32x32x16_bf16 v[40:55], a[16:19], v[112:115], v[40:55]
  ds_read_b128 v[112:115], v8 offset:12288
  s_waitcnt lgkmcnt(7)
  v_mfma_f32_32x32x16_bf16 v[40:55], a[20:23], v[116:119], v[40:55]
  buffer_load_dwordx4 v11, s[4:7], s37 offen sc1 lds
  s_add_u32 m0, m0, 4096
  s_add_u32 s37, s37, 4096
  ds_read_b128 v[116:119], v8 offset:13312
  s_waitcnt lgkmcnt(7)
  v_mfma_f32_32x32x16_bf16 v[40:55], a[24:27], v[120:123], v[40:55]
  ds_read_b128 v[120:123], v8 offset:14336
  s_waitcnt lgkmcnt(7)
  v_mfma_f32_32x32x16_bf16 v[40:55], a[28:31], v[124:127], v[40:55]
  ds_read_b128 v[124:127], v8 offset:15360
  s_waitcnt lgkmcnt(7)
  v_mfma_f32_32x32x16_bf16 v[40:55], a[32:35], v[96:99], v[40:55]
  buffer_load_dwordx4 v11, s[4:7], s37 offen sc1 lds
  s_add_u32 m0, m0, 4096
  s_add_u32 s37, s37, 4096
  ds_read_b128 v[96:99], v8 offset:16384
  s_waitcnt lgkmcnt(7)
  v_mfma_f32_32x32x16_bf16 v[40:55], a[36:39], v[100:103], v[40:55]
  ds_read_b128 v[100:103], v8 offset:17408
  s_waitcnt lgkmcnt(7)
  v_mfma_f32_32x32x16_bf16 v[40:55], a[40:43], v[104:107], v[40:55]
  ds_read_b128 v[104:107], v8 offset:18432
  s_waitcnt lgkmcnt(7)
  v_mfma_f32_32x32x16_bf16 v[40:55], a[44:47], v[108:111], v[40:55]
  buffer_load_dwordx4 v11, s[4:7], s37 offen sc1 lds
  s_add_u32 m0, m0, 4096
  s_add_u32 s37, s37, 4096
  ds_read_b128 v[108:111], v8 offset:19456
  s_waitcnt lgkmcnt(7)
  v_mfma_f32_32x32x16_bf16 v[40:55], a[48:51], v[112:115], v[40:55]
  ds_read_b128 v[112:115], v8 offset:20480
  s_waitcnt lgkmcnt(7)
  v_mfma_f32_32x32x16_bf16 v[40:55], a[52:55], v[116:119], v[40:55]
  ds_read_b128 v[116:119], v8 offset:21504
  s_waitcnt lgkmcnt(7)
  v_mfma_f32_32x32x16_bf16 v[40:55], a[56:59], v[120:123], v[40:55]
  buffer_load_dwordx4 v11, s[4:7], s37 offen sc1 lds
  s_add_u32 m0, m0, 4096
  s_add_u32 s37, s37, 4096
  ds_read_b128 v[120:123], v8 offset:22528
  s_waitcnt lgkmcnt(7)
  v_mfma_f32_32x32x16_bf16 v[40:55], a[60:63], v[124:127], v[40:55]
  ds_read_b128 v[124:127], v8 offset:23552
  s_waitcnt lgkmcnt(7)
  v_mfma_f32_32x32x16_bf16 v[40:55], a[64:67], v[96:99], v[40:55]
  ds_read_b128 v[96:99], v8 offset:24576
  s_waitcnt lgkmcnt(7)
  v_mfma_f32_32x32x16_bf16 v[40:55], a[68:71], v[100:103], v[40:55]
  buffer_load_dwordx4 v11, s[4:7], s37 offen sc1 lds
  s_add_u32 m0, m0, 4096
  s_add_u32 s37, s37, 4096
  ds_read_b128 v[100:103], v8 offset:25600
  s_waitcnt lgkmcnt(7)
  v_mfma_f32_32x32x16_bf16 v[40:55], a[72:75], v[104:107], v[40:55]
  s_waitcnt vmcnt(6)
  v_mov_b32 v38, s34
  s_mov_b64 exec, 1
  ds_add_rtn_u32 v39, v37, v38
  s_mov_b64 exec, -1
  ds_read_b128 v[104:107], v8 offset:26624
  s_waitcnt lgkmcnt(7)
  v_mfma_f32_32x32x16_bf16 v[40:55], a[76:79], v[108:111], v[40:55]
  ds_read_b128 v[108:111], v8 offset:27648
  s_waitcnt lgkmcnt(7)
  v_mfma_f32_32x32x16_bf16 v[40:55], a[80:83], v[112:115], v[40:55]
  buffer_load_dwordx4 v11, s[4:7], s37 offen sc1 lds
  s_add_u32 m0, m0, 4096
  s_add_u32 s37, s37, 4096
  ds_read_b128 v[112:115], v8 offset:28672
  s_waitcnt lgkmcnt(7)
  v_mfma_f32_32x32x16_bf16 v[40:55], a[84:87], v[116:119], v[40:55]
  ds_read_b128 v[116:119], v8 offset:29696
  s_waitcnt lgkmcnt(7)
  v_mfma_f32_32x32x16_bf16 v[40:55], a[88:91], v[120:123], v[40:55]
  ds_read_b128 v[120:123], v8 offset:30720
  s_waitcnt lgkmcnt(7)
  v_mfma_f32_32x32x16_bf16 v[40:55], a[92:95], v[124:127], v[40:55]
  buffer_load_dwordx4 v11, s[4:7], s37 offen sc1 lds
  s_add_u32 m0, m0, 4096
  s_add_u32 s37, s37, 4096
  ds_read_b128 v[124:127], v8 offset:31744
  s_waitcnt lgkmcnt(7)
  v_mfma_f32_32x32x16_bf16 v[40:55], a[96:99], v[96:99], v[40:55]
  ds_read_b128 v[96:99], v8 offset:0
  s_waitcnt lgkmcnt(7)
  v_mfma_f32_32x32x16_bf16 v[40:55], a[100:103], v[100:103], v[40:55]
  ds_read_b128 v[100:103], v8 offset:1024
  s_waitcnt lgkmcnt(7)
  v_mfma_f32_32x32x16_bf16 v[40:55], a[104:107], v[104:107], v[40:55]
  ds_read_b128 v[104:107], v8 offset:2048
  s_waitcnt lgkmcnt(7)
  v_mfma_f32_32x32x16_bf16 v[40:55], a[108:111], v[108:111], v[40:55]
  ds_read_b128 v[108:111], v8 offset:3072
  s_waitcnt lgkmcnt(7)
  v_mfma_f32_32x32x16_bf16 v[40:55], a[112:115], v[112:115], v[40:55]
  v_readfirstlane_b32 s31, v39
  s_lshl_b32 s32, s34, 3
  v_xor_b32 v37, s32, v37
  v_mov_b32 v38, 1
  s_and_b32 s31, s31, 3
  s_add_u32 s31, s31, s34
  s_cmp_eq_u32 s31, 4
  s_cselect_b32 s31, s30, 2146435072
  s_mov_b64 exec, 1
  buffer_store_dword v14, off, s[4:7], s31 sc1
  s_mov_b64 exec, -1
  s_mul_i32 s32, s34, s49
  s_add_u32 s30, s30, s32
  s_mov_b32 s34, 0
  ds_read_b128 v[112:115], v8 offset:4096
  s_waitcnt lgkmcnt(7)
  v_mfma_f32_32x32x16_bf16 v[40:55], a[116:119], v[116:119], v[40:55]
  ds_read_b128 v[116:119], v8 offset:5120
  s_waitcnt lgkmcnt(7)
  v_mfma_f32_32x32x16_bf16 v[40:55], a[120:123], v[120:123], v[40:55]
  ds_read_b128 v[120:123], v8 offset:6144
  s_waitcnt lgkmcnt(7)
  v_mfma_f32_32x32x16_bf16 v[40:55], a[124:127], v[124:127], v[40:55]
  ds_read_b128 v[124:127], v8 offset:7168
  s_waitcnt lgkmcnt(7)
  v_mfma_f32_32x32x16_bf16 v[56:71], a[128:131], v[96:99], 0
  ds_read_b128 v[96:99], v8 offset:8192
  s_waitcnt lgkmcnt(7)
  v_mfma_f32_32x32x16_bf16 v[56:71], a[132:135], v[100:103], v[56:71]
  ds_read_b128 v[100:103], v8 offset:9216
  s_waitcnt lgkmcnt(7)
  v_mfma_f32_32x32x16_bf16 v[56:71], a[136:139], v[104:107], v[56:71]
  ds_read_b128 v[104:107], v8 offset:10240
  s_waitcnt lgkmcnt(7)
  v_mfma_f32_32x32x16_bf16 v[56:71], a[140:143], v[108:111], v[56:71]
  v_cvt_pk_bf16_f32 v72, v40, v41
  v_cvt_pk_bf16_f32 v73, v42, v43
  ds_read_b128 v[108:111], v8 offset:11264
  s_waitcnt lgkmcnt(7)
  v_mfma_f32_32x32x16_bf16 v[56:71], a[144:147], v[112:115], v[56:71]
  v_cvt_pk_bf16_f32 v74, v44, v45
  v_cvt_pk_bf16_f32 v75, v46, v47
  ds_read_b128 v[112:115], v8 offset:12288
  s_waitcnt lgkmcnt(7)
  v_mfma_f32_32x32x16_bf16 v[56:71], a[148:151], v[116:119], v[56:71]
  buffer_store_dwordx4 v[72:75], v9, s[4:7], s27 offen offset:0 sc1
  v_cvt_pk_bf16_f32 v76, v48, v49
  ds_read_b128 v[116:119], v8 offset:13312
  s_waitcnt lgkmcnt(7)
  v_mfma_f32_32x32x16_bf16 v[56:71], a[152:155], v[120:123], v[56:71]
  v_cvt_pk_bf16_f32 v77, v50, v51
  v_cvt_pk_bf16_f32 v78, v52, v53
  ds_read_b128 v[120:123], v8 offset:14336
  s_waitcnt lgkmcnt(7)
  v_mfma_f32_32x32x16_bf16 v[56:71], a[156:159], v[124:127], v[56:71]
  v_cvt_pk_bf16_f32 v79, v54, v55
  buffer_store_dwordx4 v[76:79], v9, s[4:7], s27 offen offset:1024 sc1
  ds_read_b128 v[124:127], v8 offset:15360
  s_waitcnt lgkmcnt(7)
  v_mfma_f32_32x32x16_bf16 v[56:71], a[160:163], v[96:99], v[56:71]
  ds_read_b128 v[96:99], v8 offset:16384
  s_waitcnt lgkmcnt(7)
  v_mfma_f32_32x32x16_bf16 v[56:71], a[164:167], v[100:103], v[56:71]
  ds_read_b128 v[100:103], v8 offset:17408
  s_waitcnt lgkmcnt(7)
  v_mfma_f32_32x32x16_bf16 v[56:71], a[168:171], v[104:107], v[56:71]
  ds_read_b128 v[104:107], v8 offset:18432
  s_waitcnt lgkmcnt(7)
  v_mfma_f32_32x32x16_bf16 v[56:71], a[172:175], v[108:111], v[56:71]
  ds_read_b128 v[108:111], v8 offset:19456
  s_waitcnt lgkmcnt(7)
  v_mfma_f32_32x32x16_bf16 v[56:71], a[176:179], v[112:115], v[56:71]
  ds_read_b128 v[112:115], v8 offset:20480
  s_waitcnt lgkmcnt(7)
  v_mfma_f32_32x32x16_bf16 v[56:71], a[180:183], v[116:119], v[56:71]
  ds_read_b128 v[116:119], v8 offset:21504
  s_waitcnt lgkmcnt(7)
  v_mfma_f32_32x32x16_bf16 v[56:71], a[184:187], v[120:123], v[56:71]
  ds_read_b128 v[120:123], v8 offset:22528
  s_waitcnt lgkmcnt(7)
  v_mfma_f32_32x32x16_bf16 v[56:71], a[188:191], v[124:127], v[56:71]
  ds_read_b128 v[124:127], v8 offset:23552
  s_waitcnt lgkmcnt(7)
  v_mfma_f32_32x32x16_bf16 v[56:71], a[192:195], v[96:99], v[56:71]
  ds_read_b128 v[96:99], v8 offset:24576
  s_waitcnt lgkmcnt(7)
  v_mfma_f32_32x32x16_bf16 v[56:71], a[196:199], v[100:103], v[56:71]
  ds_read_b128 v[100:103], v8 offset:25600
  s_waitcnt lgkmcnt(7)
  v_mfma_f32_32x32x16_bf16 v[56:71], a[200:203], v[104:107], v[56:71]
  ds_read_b128 v[104:107], v8 offset:26624
  s_waitcnt lgkmcnt(7)
  v_mfma_f32_32x32x16_bf16 v[56:71], a[204:207], v[108:111], v[56:71]
  ds_read_b128 v[108:111], v8 offset:27648
  s_waitcnt lgkmcnt(7)
  v_mfma_f32_32x32x16_bf16 v[56:71], a[208:211], v[112:115], v[56:71]
  ds_read_b128 v[112:115], v8 offset:28672
  s_waitcnt lgkmcnt(7)
  v_mfma_f32_32x32x16_bf16 v[56:71], a[212:215], v[116:119], v[56:71]
  ds_read_b128 v[116:119], v8 offset:29696
  s_waitcnt lgkmcnt(7)
  v_mfma_f32_32x32x16_bf16 v[56:71], a[216:219], v[120:123], v[56:71]
  ds_read_b128 v[120:123], v8 offset:30720
  s_waitcnt lgkmcnt(7)
  v_mfma_f32_32x32x16_bf16 v[56:71], a[220:223], v[124:127], v[56:71]
  ds_read_b128 v[124:127], v8 offset:31744
  s_waitcnt lgkmcnt(7)
  v_mfma_f32_32x32x16_bf16 v[56:71], a[224:227], v[96:99], v[56:71]
  s_waitcnt lgkmcnt(6)
  v_mfma_f32_32x32x16_bf16 v[56:71], a[228:231], v[100:103], v[56:71]
  s_waitcnt lgkmcnt(5)
  v_mfma_f32_32x32x16_bf16 v[56:71], a[232:235], v[104:107], v[56:71]
  s_waitcnt lgkmcnt(4)
  v_mfma_f32_32x32x16_bf16 v[56:71], a[236:239], v[108:111], v[56:71]
  s_waitcnt lgkmcnt(3)
  v_mfma_f32_32x32x16_bf16 v[56:71], a[240:243], v[112:115], v[56:71]
  s_waitcnt lgkmcnt(2)
  v_mfma_f32_32x32x16_bf16 v[56:71], a[244:247], v[116:119], v[56:71]
  s_waitcnt lgkmcnt(1)
  v_mfma_f32_32x32x16_bf16 v[56:71], a[248:251], v[120:123], v[56:71]
  s_waitcnt lgkmcnt(0)
  v_mfma_f32_32x32x16_bf16 v[56:71], a[252:255], v[124:127], v[56:71]
  v_xor_b32 v8, 32768, v8
  s_nop 10
  v_cvt_pk_bf16_f32 v80, v56, v57
  v_cvt_pk_bf16_f32 v81, v58, v59
  v_cvt_pk_bf16_f32 v82, v60, v61
  v_cvt_pk_bf16_f32 v83, v62, v63
  buffer_store_dwordx4 v[80:83], v9, s[4:7], s27 offen offset:2048 sc1
  v_cvt_pk_bf16_f32 v84, v64, v65
  v_cvt_pk_bf16_f32 v85, v66, v67
  v_cvt_pk_bf16_f32 v86, v68, v69
  v_cvt_pk_bf16_f32 v87, v70, v71
  buffer_store_dwordx4 v[84:87], v9, s[4:7], s27 offen offset:3072 sc1
  s_add_u32 s27, s27, s48
  s_mov_b32 s34, 1
  s_cmp_eq_u32 s28, 0
  s_cbranch_scc1 glast_31
  s_add_u32 s26, s26, s47
  s_xor_b32 s36, s36, 32768
  s_branch gtop_30
glast_31:
  s_waitcnt vmcnt(0)
  s_mov_b64 exec, 1
  ds_add_rtn_u32 v39, v37, v38
  s_waitcnt lgkmcnt(0)
  v_readfirstlane_b32 s31, v39
  s_mov_b64 exec, -1
  v_xor_b32 v37, 8, v37
  s_and_b32 s31, s31, 3
  s_cmp_lg_u32 s31, 3
  s_cbranch_scc1 agg_32
  s_mov_b64 exec, 1
  buffer_store_dword v14, off, s[4:7], s30 sc1
  s_mov_b64 exec, -1
agg_32:
  s_add_u32 s30, s30, s49
  s_mov_b32 s34, 0
  s_barrier
  s_add_u32 s41, s41, 1
  s_branch pagain_26
pfin_28:
  s_cmp_eq_u32 s44, 0
  s_cbranch_scc1 pl2_27
  s_cmp_lt_u32 s96, 64
  s_cbranch_scc1 r_team_12
  s_branch r_group_15
pl2_27:
  s_mov_b32 s26, 8388608
  s_lshl_b32 s27, s42, 14
  s_lshl_b32 s40, s3, 12
  s_add_u32 s27, s27, s40
  s_lshl_b32 s40, s43, 25
  s_add_u32 s27, s27, s40
  s_add_u32 s27, s27, 54525952
  s_mov_b32 s28, 64
  s_mov_b32 s29, 917504
  s_lshl_b32 s30, s43, 6
  s_lshl_b32 s40, s42, 2
  s_add_u32 s30, s30, s40
  s_add_u32 s30, s30, 65536
  s_lshl_b32 s31, s3, 10
  v_add_u32 v11, s31, v1
  s_mov_b32 s36, s31
  v_min_u32 v12, 3, v2
  v_lshlrev_b32 v12, 2, v12
  v_and_b32 v8, 0x7fff, v8
  v_mov_b32 v36, 163584
  v_mov_b32 v38, 0
  ds_write_b32 v36, v38
  ds_write_b32 v36, v38 offset:4
  ds_write_b32 v36, v38 offset:8
  s_waitcnt lgkmcnt(0)
  v_mov_b32 v38, 1
  v_mov_b32 v37, 163584
  s_mov_b32 s38, 1
  s_barrier
  s_cmp_lg_u32 s3, 0
  s_cbranch_scc1 wro_33
  s_mov_b32 s35, 0
poll_35:
  buffer_load_dword v13, v12, s[4:7], s29 offen sc1
  s_waitcnt vmcnt(0)
  v_cmp_ne_u32 vcc, 0, v13
  s_nop 0
  s_cmp_eq_u64 vcc, exec
  s_cbranch_scc1 polld_36
  s_sleep 8
  s_add_u32 s35, s35, 1
  s_cmp_lt_u32 s35, 131072
  s_cbranch_scc1 poll_35
  s_branch mega_kernel_end
polld_36:
  v_mov_b32 v13, s38
  ds_write_b32 v36, v13 offset:4
  s_waitcnt lgkmcnt(0)
  s_branch wrd_34
wro_33:
  s_mov_b32 s35, 0
wrl_37:
  ds_read_b32 v13, v36 offset:4
  s_add_u32 s35, s35, 1
  s_cmp_gt_u32 s35, 2097152
  s_cbranch_scc1 mega_kernel_end
  s_waitcnt lgkmcnt(0)
  v_readfirstlane_b32 s31, v13
  s_nop 0
  s_cmp_ge_u32 s31, s38
  s_cbranch_scc1 wrd_34
  s_sleep 1
  s_branch wrl_37
wrd_34:
  s_mov_b32 s37, s26
  s_mov_b32 m0, s36
  s_nop 0
  buffer_load_dwordx4 v11, s[4:7], s37 offen sc1 lds
  s_add_u32 m0, m0, 4096
  s_add_u32 s37, s37, 4096
  buffer_load_dwordx4 v11, s[4:7], s37 offen sc1 lds
  s_add_u32 m0, m0, 4096
  s_add_u32 s37, s37, 4096
  buffer_load_dwordx4 v11, s[4:7], s37 offen sc1 lds
  s_add_u32 m0, m0, 4096
  s_add_u32 s37, s37, 4096
  buffer_load_dwordx4 v11, s[4:7], s37 offen sc1 lds
  s_add_u32 m0, m0, 4096
  s_add_u32 s37, s37, 4096
  buffer_load_dwordx4 v11, s[4:7], s37 offen sc1 lds
  s_add_u32 m0, m0, 4096
  s_add_u32 s37, s37, 4096
  buffer_load_dwordx4 v11, s[4:7], s37 offen sc1 lds
  s_add_u32 m0, m0, 4096
  s_add_u32 s37, s37, 4096
  buffer_load_dwordx4 v11, s[4:7], s37 offen sc1 lds
  s_add_u32 m0, m0, 4096
  s_add_u32 s37, s37, 4096
  buffer_load_dwordx4 v11, s[4:7], s37 offen sc1 lds
  s_add_u32 s26, s26, 32768
  s_xor_b32 s36, s36, 32768
  s_add_u32 s29, s29, 1024
  s_add_u32 s38, s38, 1
  s_mov_b32 s34, 0
  s_waitcnt vmcnt(0)
gtop_38:
  s_waitcnt vmcnt(2)
  s_barrier
  ds_read_b128 v[96:99], v8 offset:0
  ds_read_b128 v[100:103], v8 offset:1024
  ds_read_b128 v[104:107], v8 offset:2048
  ds_read_b128 v[108:111], v8 offset:3072
  ds_read_b128 v[112:115], v8 offset:4096
  ds_read_b128 v[116:119], v8 offset:5120
  ds_read_b128 v[120:123], v8 offset:6144
  s_sub_u32 s28, s28, 1
  v_mov_b32 v13, 0
  buffer_load_dword v13, v12, s[4:7], s29 offen sc1
  s_cmp_eq_u32 s28, 0
  s_cselect_b32 s33, 2, 0
  ds_read_b128 v[124:127], v8 offset:7168
  s_waitcnt lgkmcnt(7)
  v_mfma_f32_32x32x16_bf16 v[40:55], a[0:3], v[96:99], 0
  ds_read_b128 v[96:99], v8 offset:8192
  s_waitcnt lgkmcnt(7)
  v_mfma_f32_32x32x16_bf16 v[40:55], a[4:7], v[100:103], v[40:55]
  ds_read_b128 v[100:103], v8 offset:9216
  s_waitcnt lgkmcnt(7)
  v_mfma_f32_32x32x16_bf16 v[40:55], a[8:11], v[104:107], v[40:55]
  ds_read_b128 v[104:107], v8 offset:10240
  s_waitcnt lgkmcnt(7)
  v_mfma_f32_32x32x16_bf16 v[40:55], a[12:15], v[108:111], v[40:55]
  ds_read_b128 v[108:111], v8 offset:11264
  s_waitcnt lgkmcnt(7)
  v_mfma_f32_32x32x16_bf16 v[40:55], a[16:19], v[112:115], v[40:55]
  ds_read_b128 v[112:115], v8 offset:12288
  s_waitcnt lgkmcnt(7)
  v_mfma_f32_32x32x16_bf16 v[40:55], a[20:23], v[116:119], v[40:55]
  ds_read_b128 v[116:119], v8 offset:13312
  s_waitcnt lgkmcnt(7)
  v_mfma_f32_32x32x16_bf16 v[40:55], a[24:27], v[120:123], v[40:55]
  buffer_load_dword v13, v12, s[4:7], s29 offen sc1
  ds_read_b128 v[120:123], v8 offset:14336
  s_waitcnt lgkmcnt(7)
  v_mfma_f32_32x32x16_bf16 v[40:55], a[28:31], v[124:127], v[40:55]
  ds_read_b128 v[124:127], v8 offset:15360
  s_waitcnt lgkmcnt(7)
  v_mfma_f32_32x32x16_bf16 v[40:55], a[32:35], v[96:99], v[40:55]
  ds_read_b128 v[96:99], v8 offset:16384
  s_waitcnt lgkmcnt(7)
  v_mfma_f32_32x32x16_bf16 v[40:55], a[36:39], v[100:103], v[40:55]
  ds_read_b128 v[100:103], v8 offset:17408
  s_waitcnt lgkmcnt(7)
  v_mfma_f32_32x32x16_bf16 v[40:55], a[40:43], v[104:107], v[40:55]
  ds_read_b128 v[104:107], v8 offset:18432
  s_waitcnt lgkmcnt(7)
  v_mfma_f32_32x32x16_bf16 v[40:55], a[44:47], v[108:111], v[40:55]
  ds_read_b128 v[108:111], v8 offset:19456
  s_waitcnt lgkmcnt(7)
  v_mfma_f32_32x32x16_bf16 v[40:55], a[48:51], v[112:115], v[40:55]
  ds_read_b128 v[112:115], v8 offset:20480
  s_waitcnt lgkmcnt(7)
  v_mfma_f32_32x32x16_bf16 v[40:55], a[52:55], v[116:119], v[40:55]
  ds_read_b128 v[116:119], v8 offset:21504
  s_waitcnt lgkmcnt(7)
  v_mfma_f32_32x32x16_bf16 v[40:55], a[56:59], v[120:123], v[40:55]
  ds_read_b128 v[120:123], v8 offset:22528
  s_waitcnt lgkmcnt(7)
  v_mfma_f32_32x32x16_bf16 v[40:55], a[60:63], v[124:127], v[40:55]
  ds_read_b128 v[124:127], v8 offset:23552
  s_waitcnt lgkmcnt(7)
  v_mfma_f32_32x32x16_bf16 v[40:55], a[64:67], v[96:99], v[40:55]
  ds_read_b128 v[96:99], v8 offset:24576
  s_waitcnt lgkmcnt(7)
  v_mfma_f32_32x32x16_bf16 v[40:55], a[68:71], v[100:103], v[40:55]
  ds_read_b128 v[100:103], v8 offset:25600
  s_waitcnt lgkmcnt(7)
  v_mfma_f32_32x32x16_bf16 v[40:55], a[72:75], v[104:107], v[40:55]
  v_cmp_ne_u32 vcc, 0, v13
  s_nop 0
  s_cmp_eq_u64 vcc, exec
  s_cselect_b32 s31, s33, 1
  s_cmp_eq_u32 s31, 0
  s_cselect_b32 s37, s26, 2146435072
  s_cselect_b32 m0, s36, 65536
  s_cselect_b32 s33, 1, s33
  s_waitcnt vmcnt(2)
  v_mov_b32 v38, s34
  s_mov_b64 exec, 1
  ds_add_rtn_u32 v39, v37, v38
  s_mov_b64 exec, -1
  ds_read_b128 v[104:107], v8 offset:26624
  s_waitcnt lgkmcnt(7)
  v_mfma_f32_32x32x16_bf16 v[40:55], a[76:79], v[108:111], v[40:55]
  buffer_load_dwordx4 v11, s[4:7], s37 offen sc1 lds
  s_add_u32 m0, m0, 4096
  s_add_u32 s37, s37, 4096
  ds_read_b128 v[108:111], v8 offset:27648
  s_waitcnt lgkmcnt(7)
  v_mfma_f32_32x32x16_bf16 v[40:55], a[80:83], v[112:115], v[40:55]
  ds_read_b128 v[112:115], v8 offset:28672
  s_waitcnt lgkmcnt(7)
  v_mfma_f32_32x32x16_bf16 v[40:55], a[84:87], v[116:119], v[40:55]
  buffer_load_dwordx4 v11, s[4:7], s37 offen sc1 lds
  s_add_u32 m0, m0, 4096
  s_add_u32 s37, s37, 4096
  ds_read_b128 v[116:119], v8 offset:29696
  s_waitcnt lgkmcnt(7)
  v_mfma_f32_32x32x16_bf16 v[40:55], a[88:91], v[120:123], v[40:55]
  ds_read_b128 v[120:123], v8 offset:30720
  s_waitcnt lgkmcnt(7)
  v_mfma_f32_32x32x16_bf16 v[40:55], a[92:95], v[124:127], v[40:55]
  buffer_load_dwordx4 v11, s[4:7], s37 offen sc1 lds
  s_add_u32 m0, m0, 4096
  s_add_u32 s37, s37, 4096
  ds_read_b128 v[124:127], v8 offset:31744
  s_waitcnt lgkmcnt(7)
  v_mfma_f32_32x32x16_bf16 v[40:55], a[96:99], v[96:99], v[40:55]
  ds_read_b128 v[96:99], v8 offset:0
  s_waitcnt lgkmcnt(7)
  v_mfma_f32_32x32x16_bf16 v[40:55], a[100:103], v[100:103], v[40:55]
  buffer_load_dwordx4 v11, s[4:7], s37 offen sc1 lds
  s_add_u32 m0, m0, 4096
  s_add_u32 s37, s37, 4096
  ds_read_b128 v[100:103], v8 offset:1024
  s_waitcnt lgkmcnt(7)
  v_mfma_f32_32x32x16_bf16 v[40:55], a[104:107], v[104:107], v[40:55]
  ds_read_b128 v[104:107], v8 offset:2048
  s_waitcnt lgkmcnt(7)
  v_mfma_f32_32x32x16_bf16 v[40:55], a[108:111], v[108:111], v[40:55]
  buffer_load_dwordx4 v11, s[4:7], s37 offen sc1 lds
  s_add_u32 m0, m0, 4096
  s_add_u32 s37, s37, 4096
  ds_read_b128 v[108:111], v8 offset:3072
  s_waitcnt lgkmcnt(7)
  v_mfma_f32_32x32x16_bf16 v[40:55], a[112:115], v[112:115], v[40:55]
  v_readfirstlane_b32 s31, v39
  s_lshl_b32 s32, s34, 3
  v_xor_b32 v37, s32, v37
  v_mov_b32 v38, 1
  s_and_b32 s31, s31, 3
  s_add_u32 s31, s31, s34
  s_cmp_eq_u32 s31, 4
  s_cselect_b32 s31, s30, 2146435072
  s_mov_b64 exec, 1
  buffer_store_dword v14, off, s[4:7], s31 sc1
  s_mov_b64 exec, -1
  s_mul_i32 s32, s34, 1024
  s_add_u32 s30, s30, s32
  s_mov_b32 s34, 0
  ds_read_b128 v[112:115], v8 offset:4096
  s_waitcnt lgkmcnt(7)
  v_mfma_f32_32x32x16_bf16 v[40:55], a[116:119], v[116:119], v[40:55]
  buffer_load_dwordx4 v11, s[4:7], s37 offen sc1 lds
  s_add_u32 m0, m0, 4096
  s_add_u32 s37, s37, 4096
  ds_read_b128 v[116:119], v8 offset:5120
  s_waitcnt lgkmcnt(7)
  v_mfma_f32_32x32x16_bf16 v[40:55], a[120:123], v[120:123], v[40:55]
  ds_read_b128 v[120:123], v8 offset:6144
  s_waitcnt lgkmcnt(7)
  v_mfma_f32_32x32x16_bf16 v[40:55], a[124:127], v[124:127], v[40:55]
  buffer_load_dwordx4 v11, s[4:7], s37 offen sc1 lds
  s_add_u32 m0, m0, 4096
  s_add_u32 s37, s37, 4096
  ds_read_b128 v[124:127], v8 offset:7168
  s_waitcnt lgkmcnt(7)
  v_mfma_f32_32x32x16_bf16 v[56:71], a[128:131], v[96:99], 0
  ds_read_b128 v[96:99], v8 offset:8192
  s_waitcnt lgkmcnt(7)
  v_mfma_f32_32x32x16_bf16 v[56:71], a[132:135], v[100:103], v[56:71]
  buffer_load_dwordx4 v11, s[4:7], s37 offen sc1 lds
  s_add_u32 m0, m0, 4096
  s_add_u32 s37, s37, 4096
  ds_read_b128 v[100:103], v8 offset:9216
  s_waitcnt lgkmcnt(7)
  v_mfma_f32_32x32x16_bf16 v[56:71], a[136:139], v[104:107], v[56:71]
  ds_read_b128 v[104:107], v8 offset:10240
  s_waitcnt lgkmcnt(7)
  v_mfma_f32_32x32x16_bf16 v[56:71], a[140:143], v[108:111], v[56:71]
  v_cvt_pk_bf16_f32 v72, v40, v41
  v_cvt_pk_bf16_f32 v73, v42, v43
  ds_read_b128 v[108:111], v8 offset:11264
  s_waitcnt lgkmcnt(7)
  v_mfma_f32_32x32x16_bf16 v[56:71], a[144:147], v[112:115], v[56:71]
  v_cvt_pk_bf16_f32 v74, v44, v45
  v_cvt_pk_bf16_f32 v75, v46, v47
  ds_read_b128 v[112:115], v8 offset:12288
  s_waitcnt lgkmcnt(7)
  v_mfma_f32_32x32x16_bf16 v[56:71], a[148:151], v[116:119], v[56:71]
  buffer_store_dwordx4 v[72:75], v9, s[4:7], s27 offen offset:0 sc1
  v_cvt_pk_bf16_f32 v76, v48, v49
  ds_read_b128 v[116:119], v8 offset:13312
  s_waitcnt lgkmcnt(7)
  v_mfma_f32_32x32x16_bf16 v[56:71], a[152:155], v[120:123], v[56:71]
  v_cvt_pk_bf16_f32 v77, v50, v51
  v_cvt_pk_bf16_f32 v78, v52, v53
  ds_read_b128 v[120:123], v8 offset:14336
  s_waitcnt lgkmcnt(7)
  v_mfma_f32_32x32x16_bf16 v[56:71], a[156:159], v[124:127], v[56:71]
  v_cvt_pk_bf16_f32 v79, v54, v55
  buffer_store_dwordx4 v[76:79], v9, s[4:7], s27 offen offset:1024 sc1
  ds_read_b128 v[124:127], v8 offset:15360
  s_waitcnt lgkmcnt(7)
  v_mfma_f32_32x32x16_bf16 v[56:71], a[160:163], v[96:99], v[56:71]
  ds_read_b128 v[96:99], v8 offset:16384
  s_waitcnt lgkmcnt(7)
  v_mfma_f32_32x32x16_bf16 v[56:71], a[164:167], v[100:103], v[56:71]
  ds_read_b128 v[100:103], v8 offset:17408
  s_waitcnt lgkmcnt(7)
  v_mfma_f32_32x32x16_bf16 v[56:71], a[168:171], v[104:107], v[56:71]
  ds_read_b128 v[104:107], v8 offset:18432
  s_waitcnt lgkmcnt(7)
  v_mfma_f32_32x32x16_bf16 v[56:71], a[172:175], v[108:111], v[56:71]
  ds_read_b128 v[108:111], v8 offset:19456
  s_waitcnt lgkmcnt(7)
  v_mfma_f32_32x32x16_bf16 v[56:71], a[176:179], v[112:115], v[56:71]
  buffer_load_dword v13, v12, s[4:7], s29 offen sc1
  ds_read_b128 v[112:115], v8 offset:20480
  s_waitcnt lgkmcnt(7)
  v_mfma_f32_32x32x16_bf16 v[56:71], a[180:183], v[116:119], v[56:71]
  ds_read_b128 v[116:119], v8 offset:21504
  s_waitcnt lgkmcnt(7)
  v_mfma_f32_32x32x16_bf16 v[56:71], a[184:187], v[120:123], v[56:71]
  ds_read_b128 v[120:123], v8 offset:22528
  s_waitcnt lgkmcnt(7)
  v_mfma_f32_32x32x16_bf16 v[56:71], a[188:191], v[124:127], v[56:71]
  ds_read_b128 v[124:127], v8 offset:23552
  s_waitcnt lgkmcnt(7)
  v_mfma_f32_32x32x16_bf16 v[56:71], a[192:195], v[96:99], v[56:71]
  ds_read_b128 v[96:99], v8 offset:24576
  s_waitcnt lgkmcnt(7)
  v_mfma_f32_32x32x16_bf16 v[56:71], a[196:199], v[100:103], v[56:71]
  ds_read_b128 v[100:103], v8 offset:25600
  s_waitcnt lgkmcnt(7)
  v_mfma_f32_32x32x16_bf16 v[56:71], a[200:203], v[104:107], v[56:71]
  ds_read_b128 v[104:107], v8 offset:26624
  s_waitcnt lgkmcnt(7)
  v_mfma_f32_32x32x16_bf16 v[56:71], a[204:207], v[108:111], v[56:71]
  ds_read_b128 v[108:111], v8 offset:27648
  s_waitcnt lgkmcnt(7)
  v_mfma_f32_32x32x16_bf16 v[56:71], a[208:211], v[112:115], v[56:71]
  ds_read_b128 v[112:115], v8 offset:28672
  s_waitcnt lgkmcnt(7)
  v_mfma_f32_32x32x16_bf16 v[56:71], a[212:215], v[116:119], v[56:71]
  ds_read_b128 v[116:119], v8 offset:29696
  s_waitcnt lgkmcnt(7)
  v_mfma_f32_32x32x16_bf16 v[56:71], a[216:219], v[120:123], v[56:71]
  ds_read_b128 v[120:123], v8 offset:30720
  s_waitcnt lgkmcnt(7)
  v_mfma_f32_32x32x16_bf16 v[56:71], a[220:223], v[124:127], v[56:71]
  ds_read_b128 v[124:127], v8 offset:31744
  s_waitcnt lgkmcnt(7)
  v_mfma_f32_32x32x16_bf16 v[56:71], a[224:227], v[96:99], v[56:71]
  s_waitcnt lgkmcnt(6)
  v_mfma_f32_32x32x16_bf16 v[56:71], a[228:231], v[100:103], v[56:71]
  s_waitcnt lgkmcnt(5)
  v_mfma_f32_32x32x16_bf16 v[56:71], a[232:235], v[104:107], v[56:71]
  buffer_load_dword v13, v12, s[4:7], s29 offen sc1
  s_waitcnt lgkmcnt(4)
  v_mfma_f32_32x32x16_bf16 v[56:71], a[236:239], v[108:111], v[56:71]
  s_waitcnt lgkmcnt(3)
  v_mfma_f32_32x32x16_bf16 v[56:71], a[240:243], v[112:115], v[56:71]
  s_waitcnt lgkmcnt(2)
  v_mfma_f32_32x32x16_bf16 v[56:71], a[244:247], v[116:119], v[56:71]
  s_waitcnt lgkmcnt(1)
  v_mfma_f32_32x32x16_bf16 v[56:71], a[248:251], v[120:123], v[56:71]
  s_waitcnt lgkmcnt(0)
  v_mfma_f32_32x32x16_bf16 v[56:71], a[252:255], v[124:127], v[56:71]
  v_xor_b32 v8, 32768, v8
  s_nop 10
  v_cvt_pk_bf16_f32 v80, v56, v57
  v_cvt_pk_bf16_f32 v81, v58, v59
  v_cvt_pk_bf16_f32 v82, v60, v61
  v_cvt_pk_bf16_f32 v83, v62, v63
  buffer_store_dwordx4 v[80:83], v9, s[4:7], s27 offen offset:2048 sc1
  v_cvt_pk_bf16_f32 v84, v64, v65
  v_cvt_pk_bf16_f32 v85, v66, v67
  v_cvt_pk_bf16_f32 v86, v68, v69
  v_cvt_pk_bf16_f32 v87, v70, v71
  buffer_store_dwordx4 v[84:87], v9, s[4:7], s27 offen offset:3072 sc1
  s_add_u32 s27, s27, 262144
  s_mov_b32 s34, 1
  s_cmp_eq_u32 s28, 0
  s_cbranch_scc1 glast_39
  s_cmp_eq_u32 s33, 0
  s_cbranch_scc1 gblk_40
  s_cmp_lg_u32 s3, 0
  s_cbranch_scc1 post_41
  v_mov_b32 v39, s38
  ds_write_b32 v36, v39 offset:4
  s_waitcnt lgkmcnt(0)
post_41:
  s_add_u32 s26, s26, 32768
  s_xor_b32 s36, s36, 32768
  s_add_u32 s29, s29, 1024
  s_add_u32 s38, s38, 1
  s_branch gtop_38
gblk_40:
  s_waitcnt vmcnt(2)
  v_cmp_ne_u32 vcc, 0, v13
  s_nop 0
  s_cmp_eq_u64 vcc, exec
  s_cbranch_scc0 gblk2_42
  s_cmp_lg_u32 s3, 0
  s_cbranch_scc1 post_43
  v_mov_b32 v39, s38
  ds_write_b32 v36, v39 offset:4
  s_waitcnt lgkmcnt(0)
post_43:
  s_mov_b32 s37, s26
  s_mov_b32 m0, s36
  s_nop 0
  buffer_load_dwordx4 v11, s[4:7], s37 offen sc1 lds
  s_add_u32 m0, m0, 4096
  s_add_u32 s37, s37, 4096
  buffer_load_dwordx4 v11, s[4:7], s37 offen sc1 lds
  s_add_u32 m0, m0, 4096
  s_add_u32 s37, s37, 4096
  buffer_load_dwordx4 v11, s[4:7], s37 offen sc1 lds
  s_add_u32 m0, m0, 4096
  s_add_u32 s37, s37, 4096
  buffer_load_dwordx4 v11, s[4:7], s37 offen sc1 lds
  s_add_u32 m0, m0, 4096
  s_add_u32 s37, s37, 4096
  buffer_load_dwordx4 v11, s[4:7], s37 offen sc1 lds
  s_add_u32 m0, m0, 4096
  s_add_u32 s37, s37, 4096
  buffer_load_dwordx4 v11, s[4:7], s37 offen sc1 lds
  s_add_u32 m0, m0, 4096
  s_add_u32 s37, s37, 4096
  buffer_load_dwordx4 v11, s[4:7], s37 offen sc1 lds
  s_add_u32 m0, m0, 4096
  s_add_u32 s37, s37, 4096
  buffer_load_dwordx4 v11, s[4:7], s37 offen sc1 lds
  s_add_u32 s26, s26, 32768
  s_xor_b32 s36, s36, 32768
  s_add_u32 s29, s29, 1024
  s_add_u32 s38, s38, 1
  s_waitcnt vmcnt(8)
  s_mov_b64 exec, 1
  ds_add_rtn_u32 v39, v37, v38
  s_waitcnt lgkmcnt(0)
  v_readfirstlane_b32 s31, v39
  s_mov_b64 exec, -1
  v_xor_b32 v37, 8, v37
  s_and_b32 s31, s31, 3
  s_cmp_lg_u32 s31, 3
  s_cbranch_scc1 agg_44
  s_mov_b64 exec, 1
  buffer_store_dword v14, off, s[4:7], s30 sc1
  s_mov_b64 exec, -1
  s_waitcnt vmcnt(1)
  s_branch aggj_45
agg_44:
  s_waitcnt vmcnt(0)
aggj_45:
  s_add_u32 s30, s30, 1024
  s_mov_b32 s34, 0
  s_branch gtop_38
gblk2_42:
  s_waitcnt vmcnt(0)
  s_mov_b64 exec, 1
  ds_add_rtn_u32 v39, v37, v38
  s_waitcnt lgkmcnt(0)
  v_readfirstlane_b32 s31, v39
  s_mov_b64 exec, -1
  v_xor_b32 v37, 8, v37
  s_and_b32 s31, s31, 3
  s_cmp_lg_u32 s31, 3
  s_cbranch_scc1 agg_46
  s_mov_b64 exec, 1
  buffer_store_dword v14, off, s[4:7], s30 sc1
  s_mov_b64 exec, -1
agg_46:
  s_add_u32 s30, s30, 1024
  s_mov_b32 s34, 0
  s_cmp_lg_u32 s3, 0
  s_cbranch_scc1 wro_47
  s_mov_b32 s35, 0
poll_49:
  buffer_load_dword v13, v12, s[4:7], s29 offen sc1
  s_waitcnt vmcnt(0)
  v_cmp_ne_u32 vcc, 0, v13
  s_nop 0
  s_cmp_eq_u64 vcc, exec
  s_cbranch_scc1 polld_50
  s_sleep 2
  s_add_u32 s35, s35, 1
  s_cmp_lt_u32 s35, 131072
  s_cbranch_scc1 poll_49
  s_branch mega_kernel_end
polld_50:
  v_mov_b32 v13, s38
  ds_write_b32 v36, v13 offset:4
  s_waitcnt lgkmcnt(0)
  s_branch wrd_48
wro_47:
  s_mov_b32 s35, 0
wrl_51:
  ds_read_b32 v13, v36 offset:4
  s_add_u32 s35, s35, 1
  s_cmp_gt_u32 s35, 2097152
  s_cbranch_scc1 mega_kernel_end
  s_waitcnt lgkmcnt(0)
  v_readfirstlane_b32 s31, v13
  s_nop 0
  s_cmp_ge_u32 s31, s38
  s_cbranch_scc1 wrd_48
  s_sleep 1
  s_branch wrl_51
wrd_48:
  s_mov_b32 s37, s26
  s_mov_b32 m0, s36
  s_nop 0
  buffer_load_dwordx4 v11, s[4:7], s37 offen sc1 lds
  s_add_u32 m0, m0, 4096
  s_add_u32 s37, s37, 4096
  buffer_load_dwordx4 v11, s[4:7], s37 offen sc1 lds
  s_add_u32 m0, m0, 4096
  s_add_u32 s37, s37, 4096
  buffer_load_dwordx4 v11, s[4:7], s37 offen sc1 lds
  s_add_u32 m0, m0, 4096
  s_add_u32 s37, s37, 4096
  buffer_load_dwordx4 v11, s[4:7], s37 offen sc1 lds
  s_add_u32 m0, m0, 4096
  s_add_u32 s37, s37, 4096
  buffer_load_dwordx4 v11, s[4:7], s37 offen sc1 lds
  s_add_u32 m0, m0, 4096
  s_add_u32 s37, s37, 4096
  buffer_load_dwordx4 v11, s[4:7], s37 offen sc1 lds
  s_add_u32 m0, m0, 4096
  s_add_u32 s37, s37, 4096
  buffer_load_dwordx4 v11, s[4:7], s37 offen sc1 lds
  s_add_u32 m0, m0, 4096
  s_add_u32 s37, s37, 4096
  buffer_load_dwordx4 v11, s[4:7], s37 offen sc1 lds
  s_add_u32 s26, s26, 32768
  s_xor_b32 s36, s36, 32768
  s_add_u32 s29, s29, 1024
  s_add_u32 s38, s38, 1
  s_waitcnt vmcnt(0)
  s_branch gtop_38
glast_39:
  s_waitcnt vmcnt(0)
  s_mov_b64 exec, 1
  ds_add_rtn_u32 v39, v37, v38
  s_waitcnt lgkmcnt(0)
  v_readfirstlane_b32 s31, v39
  s_mov_b64 exec, -1
  v_xor_b32 v37, 8, v37
  s_and_b32 s31, s31, 3
  s_cmp_lg_u32 s31, 3
  s_cbranch_scc1 agg_52
  s_mov_b64 exec, 1
  buffer_store_dword v14, off, s[4:7], s30 sc1
  s_mov_b64 exec, -1
agg_52:
  s_add_u32 s30, s30, 1024
  s_mov_b32 s34, 0
  s_branch mega_kernel_end
pv_23:
  s_waitcnt vmcnt(0)
  v_lshrrev_b32 v3, 2, v2
  s_mov_b32 s31, 8192
  v_mul_lo_u32 v6, v3, s31
  v_and_b32 v3, 3, v2
  v_lshl_add_u32 v6, v3, 4, v6
  v_bfe_u32 v4, v2, 2, 2
  v_lshrrev_b32 v5, 5, v2
  v_lshl_add_u32 v4, v5, 3, v4
  v_lshlrev_b32 v7, 6, v4
  v_bfe_u32 v4, v2, 4, 1
  v_lshl_add_u32 v7, v4, 5, v7
  v_lshl_add_u32 v7, v3, 3, v7
  s_lshl_b32 s31, s3, 15
  v_add_u32 v7, s31, v7
  v_mov_b32 v14, 1
  s_lshl_b32 s36, s3, 15
  s_add_u32 m0, s36, 0
  s_nop 0
  buffer_load_dwordx4 v6, s[8:11], s24 offen lds
  s_add_u32 s24, s24, 131072
  s_add_u32 m0, m0, 1024
  s_nop 0
  buffer_load_dwordx4 v6, s[8:11], s25 offen lds
  s_add_u32 s25, s25, 131072
  s_add_u32 m0, m0, 1024
  s_nop 0
  buffer_load_dwordx4 v6, s[8:11], s24 offen lds
  s_add_u32 s24, s24, 131072
  s_add_u32 m0, m0, 1024
  s_nop 0
  buffer_load_dwordx4 v6, s[8:11], s25 offen lds
  s_add_u32 s25, s25, 131072
  s_add_u32 m0, m0, 1024
  s_nop 0
  buffer_load_dwordx4 v6, s[8:11], s24 offen lds
  s_add_u32 s24, s24, 131072
  s_add_u32 m0, m0, 1024
  s_nop 0
  buffer_load_dwordx4 v6, s[8:11], s25 offen lds
  s_add_u32 s25, s25, 131072
  s_add_u32 m0, m0, 1024
  s_nop 0
  buffer_load_dwordx4 v6, s[8:11], s24 offen lds
  s_add_u32 s24, s24, 131072
  s_add_u32 m0, m0, 1024
  s_nop 0
  buffer_load_dwordx4 v6, s[8:11], s25 offen lds
  s_add_u32 s25, s25, 131072
  s_add_u32 m0, m0, 1024
  s_nop 0
  buffer_load_dwordx4 v6, s[8:11], s24 offen lds
  s_add_u32 s24, s24, 131072
  s_add_u32 m0, m0, 1024
  s_nop 0
  buffer_load_dwordx4 v6, s[8:11], s25 offen lds
  s_add_u32 s25, s25, 131072
  s_add_u32 m0, m0, 1024
  s_nop 0
  buffer_load_dwordx4 v6, s[8:11], s24 offen lds
  s_add_u32 s24, s24, 131072
  s_add_u32 m0, m0, 1024
  s_nop 0
  buffer_load_dwordx4 v6, s[8:11], s25 offen lds
  s_add_u32 s25, s25, 131072
  s_add_u32 m0, m0, 1024
  s_nop 0
  buffer_load_dwordx4 v6, s[8:11], s24 offen lds
  s_add_u32 s24, s24, 131072
  s_add_u32 m0, m0, 1024
  s_nop 0
  buffer_load_dwordx4 v6, s[8:11], s25 offen lds
  s_add_u32 s25, s25, 131072
  s_add_u32 m0, m0, 1024
  s_nop 0
  buffer_load_dwordx4 v6, s[8:11], s24 offen lds
  s_add_u32 s24, s24, 131072
  s_add_u32 m0, m0, 1024
  s_nop 0
  buffer_load_dwordx4 v6, s[8:11], s25 offen lds
  s_add_u32 s25, s25, 131072
  s_lshl_b32 s36, s3, 15
  s_add_u32 m0, s36, 16384
  s_nop 0
  buffer_load_dwordx4 v6, s[8:11], s24 offen lds
  s_add_u32 s24, s24, 131072
  s_add_u32 m0, m0, 1024
  s_nop 0
  buffer_load_dwordx4 v6, s[8:11], s25 offen lds
  s_add_u32 s25, s25, 131072
  s_add_u32 m0, m0, 1024
  s_nop 0
  buffer_load_dwordx4 v6, s[8:11], s24 offen lds
  s_add_u32 s24, s24, 131072
  s_add_u32 m0, m0, 1024
  s_nop 0
  buffer_load_dwordx4 v6, s[8:11], s25 offen lds
  s_add_u32 s25, s25, 131072
  s_add_u32 m0, m0, 1024
  s_nop 0
  buffer_load_dwordx4 v6, s[8:11], s24 offen lds
  s_add_u32 s24, s24, 131072
  s_add_u32 m0, m0, 1024
  s_nop 0
  buffer_load_dwordx4 v6, s[8:11], s25 offen lds
  s_add_u32 s25, s25, 131072
  s_add_u32 m0, m0, 1024
  s_nop 0
  buffer_load_dwordx4 v6, s[8:11], s24 offen lds
  s_add_u32 s24, s24, 131072
  s_add_u32 m0, m0, 1024
  s_nop 0
  buffer_load_dwordx4 v6, s[8:11], s25 offen lds
  s_add_u32 s25, s25, 131072
  s_add_u32 m0, m0, 1024
  s_nop 0
  buffer_load_dwordx4 v6, s[8:11], s24 offen lds
  s_add_u32 s24, s24, 131072
  s_add_u32 m0, m0, 1024
  s_nop 0
  buffer_load_dwordx4 v6, s[8:11], s25 offen lds
  s_add_u32 s25, s25, 131072
  s_add_u32 m0, m0, 1024
  s_nop 0
  buffer_load_dwordx4 v6, s[8:11], s24 offen lds
  s_add_u32 s24, s24, 131072
  s_add_u32 m0, m0, 1024
  s_nop 0
  buffer_load_dwordx4 v6, s[8:11], s25 offen lds
  s_add_u32 s25, s25, 131072
  s_add_u32 m0, m0, 1024
  s_nop 0
  buffer_load_dwordx4 v6, s[8:11], s24 offen lds
  s_add_u32 s24, s24, 131072
  s_add_u32 m0, m0, 1024
  s_nop 0
  buffer_load_dwordx4 v6, s[8:11], s25 offen lds
  s_add_u32 s25, s25, 131072
  s_add_u32 m0, m0, 1024
  s_nop 0
  buffer_load_dwordx4 v6, s[8:11], s24 offen lds
  s_add_u32 s24, s24, 131072
  s_add_u32 m0, m0, 1024
  s_nop 0
  buffer_load_dwordx4 v6, s[8:11], s25 offen lds
  s_add_u32 s25, s25, 131072
  s_waitcnt vmcnt(16)
  ds_read_b64_tr_b16 a[0:1], v7 offset:0
  ds_read_b64_tr_b16 a[2:3], v7 offset:256
  ds_read_b64_tr_b16 a[128:129], v7 offset:1024
  ds_read_b64_tr_b16 a[130:131], v7 offset:1280
  ds_read_b64_tr_b16 a[4:5], v7 offset:2048
  ds_read_b64_tr_b16 a[6:7], v7 offset:2304
  ds_read_b64_tr_b16 a[132:133], v7 offset:3072
  ds_read_b64_tr_b16 a[134:135], v7 offset:3328
  ds_read_b64_tr_b16 a[8:9], v7 offset:4096
  ds_read_b64_tr_b16 a[10:11], v7 offset:4352
  ds_read_b64_tr_b16 a[136:137], v7 offset:5120
  ds_read_b64_tr_b16 a[138:139], v7 offset:5376
  ds_read_b64_tr_b16 a[12:13], v7 offset:6144
  ds_read_b64_tr_b16 a[14:15], v7 offset:6400
  ds_read_b64_tr_b16 a[140:141], v7 offset:7168
  ds_read_b64_tr_b16 a[142:143], v7 offset:7424
  ds_read_b64_tr_b16 a[16:17], v7 offset:8192
  ds_read_b64_tr_b16 a[18:19], v7 offset:8448
  ds_read_b64_tr_b16 a[144:145], v7 offset:9216
  ds_read_b64_tr_b16 a[146:147], v7 offset:9472
  ds_read_b64_tr_b16 a[20:21], v7 offset:10240
  ds_read_b64_tr_b16 a[22:23], v7 offset:10496
  ds_read_b64_tr_b16 a[148:149], v7 offset:11264
  ds_read_b64_tr_b16 a[150:151], v7 offset:11520
  ds_read_b64_tr_b16 a[24:25], v7 offset:12288
  ds_read_b64_tr_b16 a[26:27], v7 offset:12544
  ds_read_b64_tr_b16 a[152:153], v7 offset:13312
  ds_read_b64_tr_b16 a[154:155], v7 offset:13568
  ds_read_b64_tr_b16 a[28:29], v7 offset:14336
  ds_read_b64_tr_b16 a[30:31], v7 offset:14592
  ds_read_b64_tr_b16 a[156:157], v7 offset:15360
  ds_read_b64_tr_b16 a[158:159], v7 offset:15616
  s_waitcnt lgkmcnt(0)
  s_lshl_b32 s36, s3, 15
  s_add_u32 m0, s36, 0
  s_nop 0
  buffer_load_dwordx4 v6, s[8:11], s24 offen lds
  s_add_u32 s24, s24, 131072
  s_add_u32 m0, m0, 1024
  s_nop 0
  buffer_load_dwordx4 v6, s[8:11], s25 offen lds
  s_add_u32 s25, s25, 131072
  s_add_u32 m0, m0, 1024
  s_nop 0
  buffer_load_dwordx4 v6, s[8:11], s24 offen lds
  s_add_u32 s24, s24, 131072
  s_add_u32 m0, m0, 1024
  s_nop 0
  buffer_load_dwordx4 v6, s[8:11], s25 offen lds
  s_add_u32 s25, s25, 131072
  s_add_u32 m0, m0, 1024
  s_nop 0
  buffer_load_dwordx4 v6, s[8:11], s24 offen lds
  s_add_u32 s24, s24, 131072
  s_add_u32 m0, m0, 1024
  s_nop 0
  buffer_load_dwordx4 v6, s[8:11], s25 offen lds
  s_add_u32 s25, s25, 131072
  s_add_u32 m0, m0, 1024
  s_nop 0
  buffer_load_dwordx4 v6, s[8:11], s24 offen lds
  s_add_u32 s24, s24, 131072
  s_add_u32 m0, m0, 1024
  s_nop 0
  buffer_load_dwordx4 v6, s[8:11], s25 offen lds
  s_add_u32 s25, s25, 131072
  s_add_u32 m0, m0, 1024
  s_nop 0
  buffer_load_dwordx4 v6, s[8:11], s24 offen lds
  s_add_u32 s24, s24, 131072
  s_add_u32 m0, m0, 1024
  s_nop 0
  buffer_load_dwordx4 v6, s[8:11], s25 offen lds
  s_add_u32 s25, s25, 131072
  s_add_u32 m0, m0, 1024
  s_nop 0
  buffer_load_dwordx4 v6, s[8:11], s24 offen lds
  s_add_u32 s24, s24, 131072
  s_add_u32 m0, m0, 1024
  s_nop 0
  buffer_load_dwordx4 v6, s[8:11], s25 offen lds
  s_add_u32 s25, s25, 131072
  s_add_u32 m0, m0, 1024
  s_nop 0
  buffer_load_dwordx4 v6, s[8:11], s24 offen lds
  s_add_u32 s24, s24, 131072
  s_add_u32 m0, m0, 1024
  s_nop 0
  buffer_load_dwordx4 v6, s[8:11], s25 offen lds
  s_add_u32 s25, s25, 131072
  s_add_u32 m0, m0, 1024
  s_nop 0
  buffer_load_dwordx4 v6, s[8:11], s24 offen lds
  s_add_u32 s24, s24, 131072
  s_add_u32 m0, m0, 1024
  s_nop 0
  buffer_load_dwordx4 v6, s[8:11], s25 offen lds
  s_add_u32 s25, s25, 131072
  s_waitcnt vmcnt(16)
  ds_read_b64_tr_b16 a[32:33], v7 offset:16384
  ds_read_b64_tr_b16 a[34:35], v7 offset:16640
  ds_read_b64_tr_b16 a[160:161], v7 offset:17408
  ds_read_b64_tr_b16 a[162:163], v7 offset:17664
  ds_read_b64_tr_b16 a[36:37], v7 offset:18432
  ds_read_b64_tr_b16 a[38:39], v7 offset:18688
  ds_read_b64_tr_b16 a[164:165], v7 offset:19456
  ds_read_b64_tr_b16 a[166:167], v7 offset:19712
  ds_read_b64_tr_b16 a[40:41], v7 offset:20480
  ds_read_b64_tr_b16 a[42:43], v7 offset:20736
  ds_read_b64_tr_b16 a[168:169], v7 offset:21504
  ds_read_b64_tr_b16 a[170:171], v7 offset:21760
  ds_read_b64_tr_b16 a[44:45], v7 offset:22528
  ds_read_b64_tr_b16 a[46:47], v7 offset:22784
  ds_read_b64_tr_b16 a[172:173], v7 offset:23552
  ds_read_b64_tr_b16 a[174:175], v7 offset:23808
  ds_read_b64_tr_b16 a[48:49], v7 offset:24576
  ds_read_b64_tr_b16 a[50:51], v7 offset:24832
  ds_read_b64_tr_b16 a[176:177], v7 offset:25600
  ds_read_b64_tr_b16 a[178:179], v7 offset:25856
  ds_read_b64_tr_b16 a[52:53], v7 offset:26624
  ds_read_b64_tr_b16 a[54:55], v7 offset:26880
  ds_read_b64_tr_b16 a[180:181], v7 offset:27648
  ds_read_b64_tr_b16 a[182:183], v7 offset:27904
  ds_read_b64_tr_b16 a[56:57], v7 offset:28672
  ds_read_b64_tr_b16 a[58:59], v7 offset:28928
  ds_read_b64_tr_b16 a[184:185], v7 offset:29696
  ds_read_b64_tr_b16 a[186:187], v7 offset:29952
  ds_read_b64_tr_b16 a[60:61], v7 offset:30720
  ds_read_b64_tr_b16 a[62:63], v7 offset:30976
  ds_read_b64_tr_b16 a[188:189], v7 offset:31744
  ds_read_b64_tr_b16 a[190:191], v7 offset:32000
  s_waitcnt lgkmcnt(0)
  s_lshl_b32 s36, s3, 15
  s_add_u32 m0, s36, 16384
  s_nop 0
  buffer_load_dwordx4 v6, s[8:11], s24 offen lds
  s_add_u32 s24, s24, 131072
  s_add_u32 m0, m0, 1024
  s_nop 0
  buffer_load_dwordx4 v6, s[8:11], s25 offen lds
  s_add_u32 s25, s25, 131072
  s_add_u32 m0, m0, 1024
  s_nop 0
  buffer_load_dwordx4 v6, s[8:11], s24 offen lds
  s_add_u32 s24, s24, 131072
  s_add_u32 m0, m0, 1024
  s_nop 0
  buffer_load_dwordx4 v6, s[8:11], s25 offen lds
  s_add_u32 s25, s25, 131072
  s_add_u32 m0, m0, 1024
  s_nop 0
  buffer_load_dwordx4 v6, s[8:11], s24 offen lds
  s_add_u32 s24, s24, 131072
  s_add_u32 m0, m0, 1024
  s_nop 0
  buffer_load_dwordx4 v6, s[8:11], s25 offen lds
  s_add_u32 s25, s25, 131072
  s_add_u32 m0, m0, 1024
  s_nop 0
  buffer_load_dwordx4 v6, s[8:11], s24 offen lds
  s_add_u32 s24, s24, 131072
  s_add_u32 m0, m0, 1024
  s_nop 0
  buffer_load_dwordx4 v6, s[8:11], s25 offen lds
  s_add_u32 s25, s25, 131072
  s_add_u32 m0, m0, 1024
  s_nop 0
  buffer_load_dwordx4 v6, s[8:11], s24 offen lds
  s_add_u32 s24, s24, 131072
  s_add_u32 m0, m0, 1024
  s_nop 0
  buffer_load_dwordx4 v6, s[8:11], s25 offen lds
  s_add_u32 s25, s25, 131072
  s_add_u32 m0, m0, 1024
  s_nop 0
  buffer_load_dwordx4 v6, s[8:11], s24 offen lds
  s_add_u32 s24, s24, 131072
  s_add_u32 m0, m0, 1024
  s_nop 0
  buffer_load_dwordx4 v6, s[8:11], s25 offen lds
  s_add_u32 s25, s25, 131072
  s_add_u32 m0, m0, 1024
  s_nop 0
  buffer_load_dwordx4 v6, s[8:11], s24 offen lds
  s_add_u32 s24, s24, 131072
  s_add_u32 m0, m0, 1024
  s_nop 0
  buffer_load_dwordx4 v6, s[8:11], s25 offen lds
  s_add_u32 s25, s25, 131072
  s_add_u32 m0, m0, 1024
  s_nop 0
  buffer_load_dwordx4 v6, s[8:11], s24 offen lds
  s_add_u32 s24, s24, 131072
  s_add_u32 m0, m0, 1024
  s_nop 0
  buffer_load_dwordx4 v6, s[8:11], s25 offen lds
  s_add_u32 s25, s25, 131072
  s_waitcnt vmcnt(16)
  ds_read_b64_tr_b16 a[64:65], v7 offset:0
  ds_read_b64_tr_b16 a[66:67], v7 offset:256
  ds_read_b64_tr_b16 a[192:193], v7 offset:1024
  ds_read_b64_tr_b16 a[194:195], v7 offset:1280
  ds_read_b64_tr_b16 a[68:69], v7 offset:2048
  ds_read_b64_tr_b16 a[70:71], v7 offset:2304
  ds_read_b64_tr_b16 a[196:197], v7 offset:3072
  ds_read_b64_tr_b16 a[198:199], v7 offset:3328
  ds_read_b64_tr_b16 a[72:73], v7 offset:4096
  ds_read_b64_tr_b16 a[74:75], v7 offset:4352
  ds_read_b64_tr_b16 a[200:201], v7 offset:5120
  ds_read_b64_tr_b16 a[202:203], v7 offset:5376
  ds_read_b64_tr_b16 a[76:77], v7 offset:6144
  ds_read_b64_tr_b16 a[78:79], v7 offset:6400
  ds_read_b64_tr_b16 a[204:205], v7 offset:7168
  ds_read_b64_tr_b16 a[206:207], v7 offset:7424
  ds_read_b64_tr_b16 a[80:81], v7 offset:8192
  ds_read_b64_tr_b16 a[82:83], v7 offset:8448
  ds_read_b64_tr_b16 a[208:209], v7 offset:9216
  ds_read_b64_tr_b16 a[210:211], v7 offset:9472
  ds_read_b64_tr_b16 a[84:85], v7 offset:10240
  ds_read_b64_tr_b16 a[86:87], v7 offset:10496
  ds_read_b64_tr_b16 a[212:213], v7 offset:11264
  ds_read_b64_tr_b16 a[214:215], v7 offset:11520
  ds_read_b64_tr_b16 a[88:89], v7 offset:12288
  ds_read_b64_tr_b16 a[90:91], v7 offset:12544
  ds_read_b64_tr_b16 a[216:217], v7 offset:13312
  ds_read_b64_tr_b16 a[218:219], v7 offset:13568
  ds_read_b64_tr_b16 a[92:93], v7 offset:14336
  ds_read_b64_tr_b16 a[94:95], v7 offset:14592
  ds_read_b64_tr_b16 a[220:221], v7 offset:15360
  ds_read_b64_tr_b16 a[222:223], v7 offset:15616
  s_waitcnt lgkmcnt(0)
  s_waitcnt vmcnt(0)
  ds_read_b64_tr_b16 a[96:97], v7 offset:16384
  ds_read_b64_tr_b16 a[98:99], v7 offset:16640
  ds_read_b64_tr_b16 a[224:225], v7 offset:17408
  ds_read_b64_tr_b16 a[226:227], v7 offset:17664
  ds_read_b64_tr_b16 a[100:101], v7 offset:18432
  ds_read_b64_tr_b16 a[102:103], v7 offset:18688
  ds_read_b64_tr_b16 a[228:229], v7 offset:19456
  ds_read_b64_tr_b16 a[230:231], v7 offset:19712
  ds_read_b64_tr_b16 a[104:105], v7 offset:20480
  ds_read_b64_tr_b16 a[106:107], v7 offset:20736
  ds_read_b64_tr_b16 a[232:233], v7 offset:21504
  ds_read_b64_tr_b16 a[234:235], v7 offset:21760
  ds_read_b64_tr_b16 a[108:109], v7 offset:22528
  ds_read_b64_tr_b16 a[110:111], v7 offset:22784
  ds_read_b64_tr_b16 a[236:237], v7 offset:23552
  ds_read_b64_tr_b16 a[238:239], v7 offset:23808
  ds_read_b64_tr_b16 a[112:113], v7 offset:24576
  ds_read_b64_tr_b16 a[114:115], v7 offset:24832
  ds_read_b64_tr_b16 a[240:241], v7 offset:25600
  ds_read_b64_tr_b16 a[242:243], v7 offset:25856
  ds_read_b64_tr_b16 a[116:117], v7 offset:26624
  ds_read_b64_tr_b16 a[118:119], v7 offset:26880
  ds_read_b64_tr_b16 a[244:245], v7 offset:27648
  ds_read_b64_tr_b16 a[246:247], v7 offset:27904
  ds_read_b64_tr_b16 a[120:121], v7 offset:28672
  ds_read_b64_tr_b16 a[122:123], v7 offset:28928
  ds_read_b64_tr_b16 a[248:249], v7 offset:29696
  ds_read_b64_tr_b16 a[250:251], v7 offset:29952
  ds_read_b64_tr_b16 a[124:125], v7 offset:30720
  ds_read_b64_tr_b16 a[126:127], v7 offset:30976
  ds_read_b64_tr_b16 a[252:253], v7 offset:31744
  ds_read_b64_tr_b16 a[254:255], v7 offset:32000
  s_waitcnt lgkmcnt(0)
  v_and_b32 v3, 0x33, v2
  v_bfe_u32 v4, v2, 2, 1
  v_lshl_or_b32 v3, v4, 3, v3
  v_bfe_u32 v4, v2, 3, 1
  v_lshl_or_b32 v3, v4, 2, v3
  v_lshlrev_b32 v8, 4, v3
  v_and_b32 v3, 31, v2
  v_lshlrev_b32 v9, 4, v3
  v_lshrrev_b32 v4, 5, v2
  v_lshl_add_u32 v9, v4, 11, v9
  v_add_u32 v10, 4096, v9
  v_and_b32 v3, 1, v2
  v_lshlrev_b32 v3, 7, v3
  s_mov_b32 s89, 0
wi_53:
  buffer_load_dword v4, v3, s[92:95], 0 offen offset:64 sc1
  s_waitcnt vmcnt(0)
  v_readlane_b32 s80, v4, 0
  v_readlane_b32 s81, v4, 1
  s_nop 0
  s_add_u32 s80, s80, s81
  s_cmp_ge_u32 s80, 64
  s_cbranch_scc1 wid_54
  s_sleep 8
  s_add_u32 s89, s89, 1
  s_cmp_lt_u32 s89, 131072
  s_cbranch_scc1 wi_53
  s_branch mega_kernel_end
wid_54:
  s_lshl_b32 s41, s44, 3
pagain_55:
  s_mov_b32 s50, 1049344
  s_cmp_eq_u32 s41, 0
  s_cbranch_scc1 pgo_58
  s_mov_b32 s50, 1049345
  s_cmp_eq_u32 s41, 8
  s_cbranch_scc1 pgo_58
  s_mov_b32 s50, 524848
  s_cmp_eq_u32 s41, 9
  s_cbranch_scc1 pgo_58
  s_mov_b32 s50, 1049346
  s_cmp_eq_u32 s41, 16
  s_cbranch_scc1 pgo_58
  s_mov_b32 s50, 524849
  s_cmp_eq_u32 s41, 17
  s_cbranch_scc1 pgo_58
  s_branch pfin_57
pgo_58:
  s_mov_b32 s26, 4194304
  s_lshl_b32 s27, s42, 14
  s_lshr_b32 s40, s3, 1
  s_lshl_b32 s40, s40, 13
  s_add_u32 s27, s27, s40
  s_and_b32 s40, s3, 1
  s_lshl_b32 s40, s40, 10
  s_add_u32 s27, s27, s40
  s_add_u32 s27, s27, 104857600
  s_mov_b32 s28, 1
  s_mov_b32 s29, 917504
  s_lshl_b32 s30, s43, 6
  s_lshl_b32 s40, s42, 2
  s_add_u32 s30, s30, s40
  s_add_u32 s30, s30, 0
  s_and_b32 s51, s50, 255
  s_lshl_b32 s40, s51, 15
  s_add_u32 s26, s26, s40
  s_lshl_b32 s40, s51, 18
  s_add_u32 s27, s27, s40
  s_lshl_b32 s40, s51, 10
  s_add_u32 s30, s30, s40
  s_bfe_u32 s51, s50, 0x80008
  s_lshl_b32 s47, s51, 15
  s_lshl_b32 s48, s51, 18
  s_lshl_b32 s49, s51, 10
  s_lshr_b32 s28, s50, 16
  s_lshl_b32 s31, s3, 10
  v_add_u32 v11, s31, v1
  s_mov_b32 s36, s31
  v_min_u32 v12, 0, v2
  v_lshlrev_b32 v12, 2, v12
  v_and_b32 v8, 0x7fff, v8
  v_mov_b32 v36, 163584
  v_mov_b32 v38, 0
  ds_write_b32 v36, v38
  ds_write_b32 v36, v38 offset:4
  ds_write_b32 v36, v38 offset:8
  s_waitcnt lgkmcnt(0)
  v_mov_b32 v38, 1
  v_mov_b32 v37, 163584
  s_mov_b32 s38, 1
  s_barrier
  s_mov_b32 s37, s26
  s_mov_b32 m0, s36
  s_nop 0
  buffer_load_dwordx4 v11, s[4:7], s37 offen sc1 lds
  s_add_u32 m0, m0, 4096
  s_add_u32 s37, s37, 4096
  buffer_load_dwordx4 v11, s[4:7], s37 offen sc1 lds
  s_add_u32 m0, m0, 4096
  s_add_u32 s37, s37, 4096
  buffer_load_dwordx4 v11, s[4:7], s37 offen sc1 lds
  s_add_u32 m0, m0, 4096
  s_add_u32 s37, s37, 4096
  buffer_load_dwordx4 v11, s[4:7], s37 offen sc1 lds
  s_add_u32 m0, m0, 4096
  s_add_u32 s37, s37, 4096
  buffer_load_dwordx4 v11, s[4:7], s37 offen sc1 lds
  s_add_u32 m0, m0, 4096
  s_add_u32 s37, s37, 4096
  buffer_load_dwordx4 v11, s[4:7], s37 offen sc1 lds
  s_add_u32 m0, m0, 4096
  s_add_u32 s37, s37, 4096
  buffer_load_dwordx4 v11, s[4:7], s37 offen sc1 lds
  s_add_u32 m0, m0, 4096
  s_add_u32 s37, s37, 4096
  buffer_load_dwordx4 v11, s[4:7], s37 offen sc1 lds
  s_add_u32 s26, s26, s47
  s_xor_b32 s36, s36, 32768
  s_mov_b32 s34, 0
  s_waitcnt vmcnt(0)
gtop_59:
  s_waitcnt vmcnt(2)
  s_barrier
  ds_read_b128 v[96:99], v8 offset:0
  ds_read_b128 v[100:103], v8 offset:1024
  ds_read_b128 v[104:107], v8 offset:2048
  ds_read_b128 v[108:111], v8 offset:3072
  ds_read_b128 v[112:115], v8 offset:4096
  ds_read_b128 v[116:119], v8 offset:5120
  ds_read_b128 v[120:123], v8 offset:6144
  s_sub_u32 s28, s28, 1
  s_cmp_eq_u32 s28, 0
  s_cselect_b32 s37, 2146435072, s26
  s_mov_b32 m0, s36
  ds_read_b128 v[124:127], v8 offset:7168
  s_waitcnt lgkmcnt(7)
  v_mfma_f32_32x32x16_bf16 v[40:55], v[96:99], a[0:3], 0
  ds_read_b128 v[96:99], v8 offset:8192
  s_waitcnt lgkmcnt(7)
  v_mfma_f32_32x32x16_bf16 v[40:55], v[100:103], a[4:7], v[40:55]
  ds_read_b128 v[100:103], v8 offset:9216
  s_waitcnt lgkmcnt(7)
  v_mfma_f32_32x32x16_bf16 v[40:55], v[104:107], a[8:11], v[40:55]
  buffer_load_dwordx4 v11, s[4:7], s37 offen sc1 lds
  s_add_u32 m0, m0, 4096
  s_add_u32 s37, s37, 4096
  ds_read_b128 v[104:107], v8 offset:10240
  s_waitcnt lgkmcnt(7)
  v_mfma_f32_32x32x16_bf16 v[40:55], v[108:111], a[12:15], v[40:55]
  ds_read_b128 v[108:111], v8 offset:11264
  s_waitcnt lgkmcnt(7)
  v_mfma_f32_32x32x16_bf16 v[40:55], v[112:115], a[16:19], v[40:55]
  ds_read_b128 v[112:115], v8 offset:12288
  s_waitcnt lgkmcnt(7)
  v_mfma_f32_32x32x16_bf16 v[40:55], v[116:119], a[20:23], v[40:55]
  buffer_load_dwordx4 v11, s[4:7], s37 offen sc1 lds
  s_add_u32 m0, m0, 4096
  s_add_u32 s37, s37, 4096
  ds_read_b128 v[116:119], v8 offset:13312
  s_waitcnt lgkmcnt(7)
  v_mfma_f32_32x32x16_bf16 v[40:55], v[120:123], a[24:27], v[40:55]
  ds_read_b128 v[120:123], v8 offset:14336
  s_waitcnt lgkmcnt(7)
  v_mfma_f32_32x32x16_bf16 v[40:55], v[124:127], a[28:31], v[40:55]
  ds_read_b128 v[124:127], v8 offset:15360
  s_waitcnt lgkmcnt(7)
  v_mfma_f32_32x32x16_bf16 v[40:55], v[96:99], a[32:35], v[40:55]
  buffer_load_dwordx4 v11, s[4:7], s37 offen sc1 lds
  s_add_u32 m0, m0, 4096
  s_add_u32 s37, s37, 4096
  ds_read_b128 v[96:99], v8 offset:16384
  s_waitcnt lgkmcnt(7)
  v_mfma_f32_32x32x16_bf16 v[40:55], v[100:103], a[36:39], v[40:55]
  ds_read_b128 v[100:103], v8 offset:17408
  s_waitcnt lgkmcnt(7)
  v_mfma_f32_32x32x16_bf16 v[40:55], v[104:107], a[40:43], v[40:55]
  ds_read_b128 v[104:107], v8 offset:18432
  s_waitcnt lgkmcnt(7)
  v_mfma_f32_32x32x16_bf16 v[40:55], v[108:111], a[44:47], v[40:55]
  buffer_load_dwordx4 v11, s[4:7], s37 offen sc1 lds
  s_add_u32 m0, m0, 4096
  s_add_u32 s37, s37, 4096
  ds_read_b128 v[108:111], v8 offset:19456
  s_waitcnt lgkmcnt(7)
  v_mfma_f32_32x32x16_bf16 v[40:55], v[112:115], a[48:51], v[40:55]
  ds_read_b128 v[112:115], v8 offset:20480
  s_waitcnt lgkmcnt(7)
  v_mfma_f32_32x32x16_bf16 v[40:55], v[116:119], a[52:55], v[40:55]
  ds_read_b128 v[116:119], v8 offset:21504
  s_waitcnt lgkmcnt(7)
  v_mfma_f32_32x32x16_bf16 v[40:55], v[120:123], a[56:59], v[40:55]
  buffer_load_dwordx4 v11, s[4:7], s37 offen sc1 lds
  s_add_u32 m0, m0, 4096
  s_add_u32 s37, s37, 4096
  ds_read_b128 v[120:123], v8 offset:22528
  s_waitcnt lgkmcnt(7)
  v_mfma_f32_32x32x16_bf16 v[40:55], v[124:127], a[60:63], v[40:55]
  ds_read_b128 v[124:127], v8 offset:23552
  s_waitcnt lgkmcnt(7)
  v_mfma_f32_32x32x16_bf16 v[40:55], v[96:99], a[64:67], v[40:55]
  ds_read_b128 v[96:99], v8 offset:24576
  s_waitcnt lgkmcnt(7)
  v_mfma_f32_32x32x16_bf16 v[40:55], v[100:103], a[68:71], v[40:55]
  buffer_load_dwordx4 v11, s[4:7], s37 offen sc1 lds
  s_add_u32 m0, m0, 4096
  s_add_u32 s37, s37, 4096
  ds_read_b128 v[100:103], v8 offset:25600
  s_waitcnt lgkmcnt(7)
  v_mfma_f32_32x32x16_bf16 v[40:55], v[104:107], a[72:75], v[40:55]
  s_waitcnt vmcnt(6)
  v_mov_b32 v38, s34
  s_mov_b64 exec, 1
  ds_add_rtn_u32 v39, v37, v38
  s_mov_b64 exec, -1
  ds_read_b128 v[104:107], v8 offset:26624
  s_waitcnt lgkmcnt(7)
  v_mfma_f32_32x32x16_bf16 v[40:55], v[108:111], a[76:79], v[40:55]
  ds_read_b128 v[108:111], v8 offset:27648
  s_waitcnt lgkmcnt(7)
  v_mfma_f32_32x32x16_bf16 v[40:55], v[112:115], a[80:83], v[40:55]
  buffer_load_dwordx4 v11, s[4:7], s37 offen sc1 lds
  s_add_u32 m0, m0, 4096
  s_add_u32 s37, s37, 4096
  ds_read_b128 v[112:115], v8 offset:28672
  s_waitcnt lgkmcnt(7)
  v_mfma_f32_32x32x16_bf16 v[40:55], v[116:119], a[84:87], v[40:55]
  ds_read_b128 v[116:119], v8 offset:29696
  s_waitcnt lgkmcnt(7)
  v_mfma_f32_32x32x16_bf16 v[40:55], v[120:123], a[88:91], v[40:55]
  ds_read_b128 v[120:123], v8 offset:30720
  s_waitcnt lgkmcnt(7)
  v_mfma_f32_32x32x16_bf16 v[40:55], v[124:127], a[92:95], v[40:55]
  buffer_load_dwordx4 v11, s[4:7], s37 offen sc1 lds
  s_add_u32 m0, m0, 4096
  s_add_u32 s37, s37, 4096
  ds_read_b128 v[124:127], v8 offset:31744
  s_waitcnt lgkmcnt(7)
  v_mfma_f32_32x32x16_bf16 v[40:55], v[96:99], a[96:99], v[40:55]
  ds_read_b128 v[96:99], v8 offset:0
  s_waitcnt lgkmcnt(7)
  v_mfma_f32_32x32x16_bf16 v[40:55], v[100:103], a[100:103], v[40:55]
  ds_read_b128 v[100:103], v8 offset:1024
  s_waitcnt lgkmcnt(7)
  v_mfma_f32_32x32x16_bf16 v[40:55], v[104:107], a[104:107], v[40:55]
  ds_read_b128 v[104:107], v8 offset:2048
  s_waitcnt lgkmcnt(7)
  v_mfma_f32_32x32x16_bf16 v[40:55], v[108:111], a[108:111], v[40:55]
  ds_read_b128 v[108:111], v8 offset:3072
  s_waitcnt lgkmcnt(7)
  v_mfma_f32_32x32x16_bf16 v[40:55], v[112:115], a[112:115], v[40:55]
  v_readfirstlane_b32 s31, v39
  s_lshl_b32 s32, s34, 3
  v_xor_b32 v37, s32, v37
  v_mov_b32 v38, 1
  s_and_b32 s31, s31, 3
  s_add_u32 s31, s31, s34
  s_cmp_eq_u32 s31, 4
  s_cselect_b32 s31, s30, 2146435072
  s_mov_b64 exec, 1
  buffer_store_dword v14, off, s[4:7], s31 sc1
  s_mov_b64 exec, -1
  s_mul_i32 s32, s34, s49
  s_add_u32 s30, s30, s32
  s_mov_b32 s34, 0
  ds_read_b128 v[112:115], v8 offset:4096
  s_waitcnt lgkmcnt(7)
  v_mfma_f32_32x32x16_bf16 v[40:55], v[116:119], a[116:119], v[40:55]
  ds_read_b128 v[116:119], v8 offset:5120
  s_waitcnt lgkmcnt(7)
  v_mfma_f32_32x32x16_bf16 v[40:55], v[120:123], a[120:123], v[40:55]
  ds_read_b128 v[120:123], v8 offset:6144
  s_waitcnt lgkmcnt(7)
  v_mfma_f32_32x32x16_bf16 v[40:55], v[124:127], a[124:127], v[40:55]
  ds_read_b128 v[124:127], v8 offset:7168
  s_waitcnt lgkmcnt(7)
  v_mfma_f32_32x32x16_bf16 v[56:71], v[96:99], a[128:131], 0
  ds_read_b128 v[96:99], v8 offset:8192
  s_waitcnt lgkmcnt(7)
  v_mfma_f32_32x32x16_bf16 v[56:71], v[100:103], a[132:135], v[56:71]
  ds_read_b128 v[100:103], v8 offset:9216
  s_waitcnt lgkmcnt(7)
  v_mfma_f32_32x32x16_bf16 v[56:71], v[104:107], a[136:139], v[56:71]
  ds_read_b128 v[104:107], v8 offset:10240
  s_waitcnt lgkmcnt(7)
  v_mfma_f32_32x32x16_bf16 v[56:71], v[108:111], a[140:143], v[56:71]
  v_cvt_pk_bf16_f32 v72, v40, v41
  v_cvt_pk_bf16_f32 v73, v42, v43
  ds_read_b128 v[108:111], v8 offset:11264
  s_waitcnt lgkmcnt(7)
  v_mfma_f32_32x32x16_bf16 v[56:71], v[112:115], a[144:147], v[56:71]
  v_cvt_pk_bf16_f32 v74, v44, v45
  v_cvt_pk_bf16_f32 v75, v46, v47
  ds_read_b128 v[112:115], v8 offset:12288
  s_waitcnt lgkmcnt(7)
  v_mfma_f32_32x32x16_bf16 v[56:71], v[116:119], a[148:151], v[56:71]
  buffer_store_dwordx4 v[72:75], v9, s[4:7], s27 offen offset:0 sc1
  v_cvt_pk_bf16_f32 v76, v48, v49
  ds_read_b128 v[116:119], v8 offset:13312
  s_waitcnt lgkmcnt(7)
  v_mfma_f32_32x32x16_bf16 v[56:71], v[120:123], a[152:155], v[56:71]
  v_cvt_pk_bf16_f32 v77, v50, v51
  v_cvt_pk_bf16_f32 v78, v52, v53
  ds_read_b128 v[120:123], v8 offset:14336
  s_waitcnt lgkmcnt(7)
  v_mfma_f32_32x32x16_bf16 v[56:71], v[124:127], a[156:159], v[56:71]
  v_cvt_pk_bf16_f32 v79, v54, v55
  buffer_store_dwordx4 v[76:79], v10, s[4:7], s27 offen offset:0 sc1
  ds_read_b128 v[124:127], v8 offset:15360
  s_waitcnt lgkmcnt(7)
  v_mfma_f32_32x32x16_bf16 v[56:71], v[96:99], a[160:163], v[56:71]
  ds_read_b128 v[96:99], v8 offset:16384
  s_waitcnt lgkmcnt(7)
  v_mfma_f32_32x32x16_bf16 v[56:71], v[100:103], a[164:167], v[56:71]
  ds_read_b128 v[100:103], v8 offset:17408
  s_waitcnt lgkmcnt(7)
  v_mfma_f32_32x32x16_bf16 v[56:71], v[104:107], a[168:171], v[56:71]
  ds_read_b128 v[104:107], v8 offset:18432
  s_waitcnt lgkmcnt(7)
  v_mfma_f32_32x32x16_bf16 v[56:71], v[108:111], a[172:175], v[56:71]
  ds_read_b128 v[108:111], v8 offset:19456
  s_waitcnt lgkmcnt(7)
  v_mfma_f32_32x32x16_bf16 v[56:71], v[112:115], a[176:179], v[56:71]
  ds_read_b128 v[112:115], v8 offset:20480
  s_waitcnt lgkmcnt(7)
  v_mfma_f32_32x32x16_bf16 v[56:71], v[116:119], a[180:183], v[56:71]
  ds_read_b128 v[116:119], v8 offset:21504
  s_waitcnt lgkmcnt(7)
  v_mfma_f32_32x32x16_bf16 v[56:71], v[120:123], a[184:187], v[56:71]
  ds_read_b128 v[120:123], v8 offset:22528
  s_waitcnt lgkmcnt(7)
  v_mfma_f32_32x32x16_bf16 v[56:71], v[124:127], a[188:191], v[56:71]
  ds_read_b128 v[124:127], v8 offset:23552
  s_waitcnt lgkmcnt(7)
  v_mfma_f32_32x32x16_bf16 v[56:71], v[96:99], a[192:195], v[56:71]
  ds_read_b128 v[96:99], v8 offset:24576
  s_waitcnt lgkmcnt(7)
  v_mfma_f32_32x32x16_bf16 v[56:71], v[100:103], a[196:199], v[56:71]
  ds_read_b128 v[100:103], v8 offset:25600
  s_waitcnt lgkmcnt(7)
  v_mfma_f32_32x32x16_bf16 v[56:71], v[104:107], a[200:203], v[56:71]
  ds_read_b128 v[104:107], v8 offset:26624
  s_waitcnt lgkmcnt(7)
  v_mfma_f32_32x32x16_bf16 v[56:71], v[108:111], a[204:207], v[56:71]
  ds_read_b128 v[108:111], v8 offset:27648
  s_waitcnt lgkmcnt(7)
  v_mfma_f32_32x32x16_bf16 v[56:71], v[112:115], a[208:211], v[56:71]
  ds_read_b128 v[112:115], v8 offset:28672
  s_waitcnt lgkmcnt(7)
  v_mfma_f32_32x32x16_bf16 v[56:71], v[116:119], a[212:215], v[56:71]
  ds_read_b128 v[116:119], v8 offset:29696
  s_waitcnt lgkmcnt(7)
  v_mfma_f32_32x32x16_bf16 v[56:71], v[120:123], a[216:219], v[56:71]
  ds_read_b128 v[120:123], v8 offset:30720
  s_waitcnt lgkmcnt(7)
  v_mfma_f32_32x32x16_bf16 v[56:71], v[124:127], a[220:223], v[56:71]
  ds_read_b128 v[124:127], v8 offset:31744
  s_waitcnt lgkmcnt(7)
  v_mfma_f32_32x32x16_bf16 v[56:71], v[96:99], a[224:227], v[56:71]
  s_waitcnt lgkmcnt(6)
  v_mfma_f32_32x32x16_bf16 v[56:71], v[100:103], a[228:231], v[56:71]
  s_waitcnt lgkmcnt(5)
  v_mfma_f32_32x32x16_bf16 v[56:71], v[104:107], a[232:235], v[56:71]
  s_waitcnt lgkmcnt(4)
  v_mfma_f32_32x32x16_bf16 v[56:71], v[108:111], a[236:239], v[56:71]
  s_waitcnt lgkmcnt(3)
  v_mfma_f32_32x32x16_bf16 v[56:71], v[112:115], a[240:243], v[56:71]
  s_waitcnt lgkmcnt(2)
  v_mfma_f32_32x32x16_bf16 v[56:71], v[116:119], a[244:247], v[56:71]
  s_waitcnt lgkmcnt(1)
  v_mfma_f32_32x32x16_bf16 v[56:71], v[120:123], a[248:251], v[56:71]
  s_waitcnt lgkmcnt(0)
  v_mfma_f32_32x32x16_bf16 v[56:71], v[124:127], a[252:255], v[56:71]
  v_xor_b32 v8, 32768, v8
  s_nop 10
  v_cvt_pk_bf16_f32 v80, v56, v57
  v_cvt_pk_bf16_f32 v81, v58, v59
  v_cvt_pk_bf16_f32 v82, v60, v61
  v_cvt_pk_bf16_f32 v83, v62, v63
  buffer_store_dwordx4 v[80:83], v9, s[4:7], s27 offen offset:512 sc1
  v_cvt_pk_bf16_f32 v84, v64, v65
  v_cvt_pk_bf16_f32 v85, v66, v67
  v_cvt_pk_bf16_f32 v86, v68, v69
  v_cvt_pk_bf16_f32 v87, v70, v71
  buffer_store_dwordx4 v[84:87], v10, s[4:7], s27 offen offset:512 sc1
  s_add_u32 s27, s27, s48
  s_mov_b32 s34, 1
  s_cmp_eq_u32 s28, 0
  s_cbranch_scc1 glast_60
  s_add_u32 s26, s26, s47
  s_xor_b32 s36, s36, 32768
  s_branch gtop_59
glast_60:
  s_waitcnt vmcnt(0)
  s_mov_b64 exec, 1
  ds_add_rtn_u32 v39, v37, v38
  s_waitcnt lgkmcnt(0)
  v_readfirstlane_b32 s31, v39
  s_mov_b64 exec, -1
  v_xor_b32 v37, 8, v37
  s_and_b32 s31, s31, 3
  s_cmp_lg_u32 s31, 3
  s_cbranch_scc1 agg_61
  s_mov_b64 exec, 1
  buffer_store_dword v14, off, s[4:7], s30 sc1
  s_mov_b64 exec, -1
agg_61:
  s_add_u32 s30, s30, s49
  s_mov_b32 s34, 0
  s_barrier
  s_add_u32 s41, s41, 1
  s_branch pagain_55
pfin_57:
  s_cmp_eq_u32 s44, 0
  s_cbranch_scc1 pl2_56
  s_cmp_lt_u32 s96, 64
  s_cbranch_scc1 r_team_12
  s_branch r_group_15
pl2_56:
  s_mov_b32 s26, 8388608
  s_lshl_b32 s27, s42, 14
  s_lshr_b32 s40, s3, 1
  s_lshl_b32 s40, s40, 13
  s_add_u32 s27, s27, s40
  s_and_b32 s40, s3, 1
  s_lshl_b32 s40, s40, 10
  s_add_u32 s27, s27, s40
  s_add_u32 s27, s27, 121634816
  s_mov_b32 s28, 64
  s_mov_b32 s29, 917504
  s_lshl_b32 s30, s43, 6
  s_lshl_b32 s40, s42, 2
  s_add_u32 s30, s30, s40
  s_add_u32 s30, s30, 65536
  s_lshl_b32 s31, s3, 10
  v_add_u32 v11, s31, v1
  s_mov_b32 s36, s31
  v_min_u32 v12, 3, v2
  v_lshlrev_b32 v12, 2, v12
  v_and_b32 v8, 0x7fff, v8
  v_mov_b32 v36, 163584
  v_mov_b32 v38, 0
  ds_write_b32 v36, v38
  ds_write_b32 v36, v38 offset:4
  ds_write_b32 v36, v38 offset:8
  s_waitcnt lgkmcnt(0)
  v_mov_b32 v38, 1
  v_mov_b32 v37, 163584
  s_mov_b32 s38, 1
  s_barrier
  s_cmp_lg_u32 s3, 0
  s_cbranch_scc1 wro_62
  s_mov_b32 s35, 0
poll_64:
  buffer_load_dword v13, v12, s[4:7], s29 offen sc1
  s_waitcnt vmcnt(0)
  v_cmp_ne_u32 vcc, 0, v13
  s_nop 0
  s_cmp_eq_u64 vcc, exec
  s_cbranch_scc1 polld_65
  s_sleep 8
  s_add_u32 s35, s35, 1
  s_cmp_lt_u32 s35, 131072
  s_cbranch_scc1 poll_64
  s_branch mega_kernel_end
polld_65:
  v_mov_b32 v13, s38
  ds_write_b32 v36, v13 offset:4
  s_waitcnt lgkmcnt(0)
  s_branch wrd_63
wro_62:
  s_mov_b32 s35, 0
wrl_66:
  ds_read_b32 v13, v36 offset:4
  s_add_u32 s35, s35, 1
  s_cmp_gt_u32 s35, 2097152
  s_cbranch_scc1 mega_kernel_end
  s_waitcnt lgkmcnt(0)
  v_readfirstlane_b32 s31, v13
  s_nop 0
  s_cmp_ge_u32 s31, s38
  s_cbranch_scc1 wrd_63
  s_sleep 1
  s_branch wrl_66
wrd_63:
  s_mov_b32 s37, s26
  s_mov_b32 m0, s36
  s_nop 0
  buffer_load_dwordx4 v11, s[4:7], s37 offen sc1 lds
  s_add_u32 m0, m0, 4096
  s_add_u32 s37, s37, 4096
  buffer_load_dwordx4 v11, s[4:7], s37 offen sc1 lds
  s_add_u32 m0, m0, 4096
  s_add_u32 s37, s37, 4096
  buffer_load_dwordx4 v11, s[4:7], s37 offen sc1 lds
  s_add_u32 m0, m0, 4096
  s_add_u32 s37, s37, 4096
  buffer_load_dwordx4 v11, s[4:7], s37 offen sc1 lds
  s_add_u32 m0, m0, 4096
  s_add_u32 s37, s37, 4096
  buffer_load_dwordx4 v11, s[4:7], s37 offen sc1 lds
  s_add_u32 m0, m0, 4096
  s_add_u32 s37, s37, 4096
  buffer_load_dwordx4 v11, s[4:7], s37 offen sc1 lds
  s_add_u32 m0, m0, 4096
  s_add_u32 s37, s37, 4096
  buffer_load_dwordx4 v11, s[4:7], s37 offen sc1 lds
  s_add_u32 m0, m0, 4096
  s_add_u32 s37, s37, 4096
  buffer_load_dwordx4 v11, s[4:7], s37 offen sc1 lds
  s_add_u32 s26, s26, 32768
  s_xor_b32 s36, s36, 32768
  s_add_u32 s29, s29, 1024
  s_add_u32 s38, s38, 1
  s_mov_b32 s34, 0
  s_waitcnt vmcnt(0)
gtop_67:
  s_waitcnt vmcnt(2)
  s_barrier
  ds_read_b128 v[96:99], v8 offset:0
  ds_read_b128 v[100:103], v8 offset:1024
  ds_read_b128 v[104:107], v8 offset:2048
  ds_read_b128 v[108:111], v8 offset:3072
  ds_read_b128 v[112:115], v8 offset:4096
  ds_read_b128 v[116:119], v8 offset:5120
  ds_read_b128 v[120:123], v8 offset:6144
  s_sub_u32 s28, s28, 1
  v_mov_b32 v13, 0
  buffer_load_dword v13, v12, s[4:7], s29 offen sc1
  s_cmp_eq_u32 s28, 0
  s_cselect_b32 s33, 2, 0
  ds_read_b128 v[124:127], v8 offset:7168
  s_waitcnt lgkmcnt(7)
  v_mfma_f32_32x32x16_bf16 v[40:55], v[96:99], a[0:3], 0
  ds_read_b128 v[96:99], v8 offset:8192
  s_waitcnt lgkmcnt(7)
  v_mfma_f32_32x32x16_bf16 v[40:55], v[100:103], a[4:7], v[40:55]
  ds_read_b128 v[100:103], v8 offset:9216
  s_waitcnt lgkmcnt(7)
  v_mfma_f32_32x32x16_bf16 v[40:55], v[104:107], a[8:11], v[40:55]
  ds_read_b128 v[104:107], v8 offset:10240
  s_waitcnt lgkmcnt(7)
  v_mfma_f32_32x32x16_bf16 v[40:55], v[108:111], a[12:15], v[40:55]
  ds_read_b128 v[108:111], v8 offset:11264
  s_waitcnt lgkmcnt(7)
  v_mfma_f32_32x32x16_bf16 v[40:55], v[112:115], a[16:19], v[40:55]
  ds_read_b128 v[112:115], v8 offset:12288
  s_waitcnt lgkmcnt(7)
  v_mfma_f32_32x32x16_bf16 v[40:55], v[116:119], a[20:23], v[40:55]
  ds_read_b128 v[116:119], v8 offset:13312
  s_waitcnt lgkmcnt(7)
  v_mfma_f32_32x32x16_bf16 v[40:55], v[120:123], a[24:27], v[40:55]
  buffer_load_dword v13, v12, s[4:7], s29 offen sc1
  ds_read_b128 v[120:123], v8 offset:14336
  s_waitcnt lgkmcnt(7)
  v_mfma_f32_32x32x16_bf16 v[40:55], v[124:127], a[28:31], v[40:55]
  ds_read_b128 v[124:127], v8 offset:15360
  s_waitcnt lgkmcnt(7)
  v_mfma_f32_32x32x16_bf16 v[40:55], v[96:99], a[32:35], v[40:55]
  ds_read_b128 v[96:99], v8 offset:16384
  s_waitcnt lgkmcnt(7)
  v_mfma_f32_32x32x16_bf16 v[40:55], v[100:103], a[36:39], v[40:55]
  ds_read_b128 v[100:103], v8 offset:17408
  s_waitcnt lgkmcnt(7)
  v_mfma_f32_32x32x16_bf16 v[40:55], v[104:107], a[40:43], v[40:55]
  ds_read_b128 v[104:107], v8 offset:18432
  s_waitcnt lgkmcnt(7)
  v_mfma_f32_32x32x16_bf16 v[40:55], v[108:111], a[44:47], v[40:55]
  ds_read_b128 v[108:111], v8 offset:19456
  s_waitcnt lgkmcnt(7)
  v_mfma_f32_32x32x16_bf16 v[40:55], v[112:115], a[48:51], v[40:55]
  ds_read_b128 v[112:115], v8 offset:20480
  s_waitcnt lgkmcnt(7)
  v_mfma_f32_32x32x16_bf16 v[40:55], v[116:119], a[52:55], v[40:55]
  ds_read_b128 v[116:119], v8 offset:21504
  s_waitcnt lgkmcnt(7)
  v_mfma_f32_32x32x16_bf16 v[40:55], v[120:123], a[56:59], v[40:55]
  ds_read_b128 v[120:123], v8 offset:22528
  s_waitcnt lgkmcnt(7)
  v_mfma_f32_32x32x16_bf16 v[40:55], v[124:127], a[60:63], v[40:55]
  ds_read_b128 v[124:127], v8 offset:23552
  s_waitcnt lgkmcnt(7)
  v_mfma_f32_32x32x16_bf16 v[40:55], v[96:99], a[64:67], v[40:55]
  ds_read_b128 v[96:99], v8 offset:24576
  s_waitcnt lgkmcnt(7)
  v_mfma_f32_32x32x16_bf16 v[40:55], v[100:103], a[68:71], v[40:55]
  ds_read_b128 v[100:103], v8 offset:25600
  s_waitcnt lgkmcnt(7)
  v_mfma_f32_32x32x16_bf16 v[40:55], v[104:107], a[72:75], v[40:55]
  v_cmp_ne_u32 vcc, 0, v13
  s_nop 0
  s_cmp_eq_u64 vcc, exec
  s_cselect_b32 s31, s33, 1
  s_cmp_eq_u32 s31, 0
  s_cselect_b32 s37, s26, 2146435072
  s_cselect_b32 m0, s36, 65536
  s_cselect_b32 s33, 1, s33
  s_waitcnt vmcnt(2)
  v_mov_b32 v38, s34
  s_mov_b64 exec, 1
  ds_add_rtn_u32 v39, v37, v38
  s_mov_b64 exec, -1
  ds_read_b128 v[104:107], v8 offset:26624
  s_waitcnt lgkmcnt(7)
  v_mfma_f32_32x32x16_bf16 v[40:55], v[108:111], a[76:79], v[40:55]
  buffer_load_dwordx4 v11, s[4:7], s37 offen sc1 lds
  s_add_u32 m0, m0, 4096
  s_add_u32 s37, s37, 4096
  ds_read_b128 v[108:111], v8 offset:27648
  s_waitcnt lgkmcnt(7)
  v_mfma_f32_32x32x16_bf16 v[40:55], v[112:115], a[80:83], v[40:55]
  ds_read_b128 v[112:115], v8 offset:28672
  s_waitcnt lgkmcnt(7)
  v_mfma_f32_32x32x16_bf16 v[40:55], v[116:119], a[84:87], v[40:55]
  buffer_load_dwordx4 v11, s[4:7], s37 offen sc1 lds
  s_add_u32 m0, m0, 4096
  s_add_u32 s37, s37, 4096
  ds_read_b128 v[116:119], v8 offset:29696
  s_waitcnt lgkmcnt(7)
  v_mfma_f32_32x32x16_bf16 v[40:55], v[120:123], a[88:91], v[40:55]
  ds_read_b128 v[120:123], v8 offset:30720
  s_waitcnt lgkmcnt(7)
  v_mfma_f32_32x32x16_bf16 v[40:55], v[124:127], a[92:95], v[40:55]
  buffer_load_dwordx4 v11, s[4:7], s37 offen sc1 lds
  s_add_u32 m0, m0, 4096
  s_add_u32 s37, s37, 4096
  ds_read_b128 v[124:127], v8 offset:31744
  s_waitcnt lgkmcnt(7)
  v_mfma_f32_32x32x16_bf16 v[40:55], v[96:99], a[96:99], v[40:55]
  ds_read_b128 v[96:99], v8 offset:0
  s_waitcnt lgkmcnt(7)
  v_mfma_f32_32x32x16_bf16 v[40:55], v[100:103], a[100:103], v[40:55]
  buffer_load_dwordx4 v11, s[4:7], s37 offen sc1 lds
  s_add_u32 m0, m0, 4096
  s_add_u32 s37, s37, 4096
  ds_read_b128 v[100:103], v8 offset:1024
  s_waitcnt lgkmcnt(7)
  v_mfma_f32_32x32x16_bf16 v[40:55], v[104:107], a[104:107], v[40:55]
  ds_read_b128 v[104:107], v8 offset:2048
  s_waitcnt lgkmcnt(7)
  v_mfma_f32_32x32x16_bf16 v[40:55], v[108:111], a[108:111], v[40:55]
  buffer_load_dwordx4 v11, s[4:7], s37 offen sc1 lds
  s_add_u32 m0, m0, 4096
  s_add_u32 s37, s37, 4096
  ds_read_b128 v[108:111], v8 offset:3072
  s_waitcnt lgkmcnt(7)
  v_mfma_f32_32x32x16_bf16 v[40:55], v[112:115], a[112:115], v[40:55]
  v_readfirstlane_b32 s31, v39
  s_lshl_b32 s32, s34, 3
  v_xor_b32 v37, s32, v37
  v_mov_b32 v38, 1
  s_and_b32 s31, s31, 3
  s_add_u32 s31, s31, s34
  s_cmp_eq_u32 s31, 4
  s_cselect_b32 s31, s30, 2146435072
  s_mov_b64 exec, 1
  buffer_store_dword v14, off, s[4:7], s31 sc1
  s_mov_b64 exec, -1
  s_mul_i32 s32, s34, 1024
  s_add_u32 s30, s30, s32
  s_mov_b32 s34, 0
  ds_read_b128 v[112:115], v8 offset:4096
  s_waitcnt lgkmcnt(7)
  v_mfma_f32_32x32x16_bf16 v[40:55], v[116:119], a[116:119], v[40:55]
  buffer_load_dwordx4 v11, s[4:7], s37 offen sc1 lds
  s_add_u32 m0, m0, 4096
  s_add_u32 s37, s37, 4096
  ds_read_b128 v[116:119], v8 offset:5120
  s_waitcnt lgkmcnt(7)
  v_mfma_f32_32x32x16_bf16 v[40:55], v[120:123], a[120:123], v[40:55]
  ds_read_b128 v[120:123], v8 offset:6144
  s_waitcnt lgkmcnt(7)
  v_mfma_f32_32x32x16_bf16 v[40:55], v[124:127], a[124:127], v[40:55]
  buffer_load_dwordx4 v11, s[4:7], s37 offen sc1 lds
  s_add_u32 m0, m0, 4096
  s_add_u32 s37, s37, 4096
  ds_read_b128 v[124:127], v8 offset:7168
  s_waitcnt lgkmcnt(7)
  v_mfma_f32_32x32x16_bf16 v[56:71], v[96:99], a[128:131], 0
  ds_read_b128 v[96:99], v8 offset:8192
  s_waitcnt lgkmcnt(7)
  v_mfma_f32_32x32x16_bf16 v[56:71], v[100:103], a[132:135], v[56:71]
  buffer_load_dwordx4 v11, s[4:7], s37 offen sc1 lds
  s_add_u32 m0, m0, 4096
  s_add_u32 s37, s37, 4096
  ds_read_b128 v[100:103], v8 offset:9216
  s_waitcnt lgkmcnt(7)
  v_mfma_f32_32x32x16_bf16 v[56:71], v[104:107], a[136:139], v[56:71]
  ds_read_b128 v[104:107], v8 offset:10240
  s_waitcnt lgkmcnt(7)
  v_mfma_f32_32x32x16_bf16 v[56:71], v[108:111], a[140:143], v[56:71]
  v_cvt_pk_bf16_f32 v72, v40, v41
  v_cvt_pk_bf16_f32 v73, v42, v43
  ds_read_b128 v[108:111], v8 offset:11264
  s_waitcnt lgkmcnt(7)
  v_mfma_f32_32x32x16_bf16 v[56:71], v[112:115], a[144:147], v[56:71]
  v_cvt_pk_bf16_f32 v74, v44, v45
  v_cvt_pk_bf16_f32 v75, v46, v47
  ds_read_b128 v[112:115], v8 offset:12288
  s_waitcnt lgkmcnt(7)
  v_mfma_f32_32x32x16_bf16 v[56:71], v[116:119], a[148:151], v[56:71]
  buffer_store_dwordx4 v[72:75], v9, s[4:7], s27 offen offset:0 sc1
  v_cvt_pk_bf16_f32 v76, v48, v49
  ds_read_b128 v[116:119], v8 offset:13312
  s_waitcnt lgkmcnt(7)
  v_mfma_f32_32x32x16_bf16 v[56:71], v[120:123], a[152:155], v[56:71]
  v_cvt_pk_bf16_f32 v77, v50, v51
  v_cvt_pk_bf16_f32 v78, v52, v53
  ds_read_b128 v[120:123], v8 offset:14336
  s_waitcnt lgkmcnt(7)
  v_mfma_f32_32x32x16_bf16 v[56:71], v[124:127], a[156:159], v[56:71]
  v_cvt_pk_bf16_f32 v79, v54, v55
  buffer_store_dwordx4 v[76:79], v10, s[4:7], s27 offen offset:0 sc1
  ds_read_b128 v[124:127], v8 offset:15360
  s_waitcnt lgkmcnt(7)
  v_mfma_f32_32x32x16_bf16 v[56:71], v[96:99], a[160:163], v[56:71]
  ds_read_b128 v[96:99], v8 offset:16384
  s_waitcnt lgkmcnt(7)
  v_mfma_f32_32x32x16_bf16 v[56:71], v[100:103], a[164:167], v[56:71]
  ds_read_b128 v[100:103], v8 offset:17408
  s_waitcnt lgkmcnt(7)
  v_mfma_f32_32x32x16_bf16 v[56:71], v[104:107], a[168:171], v[56:71]
  ds_read_b128 v[104:107], v8 offset:18432
  s_waitcnt lgkmcnt(7)
  v_mfma_f32_32x32x16_bf16 v[56:71], v[108:111], a[172:175], v[56:71]
  ds_read_b128 v[108:111], v8 offset:19456
  s_waitcnt lgkmcnt(7)
  v_mfma_f32_32x32x16_bf16 v[56:71], v[112:115], a[176:179], v[56:71]
  buffer_load_dword v13, v12, s[4:7], s29 offen sc1
  ds_read_b128 v[112:115], v8 offset:20480
  s_waitcnt lgkmcnt(7)
  v_mfma_f32_32x32x16_bf16 v[56:71], v[116:119], a[180:183], v[56:71]
  ds_read_b128 v[116:119], v8 offset:21504
  s_waitcnt lgkmcnt(7)
  v_mfma_f32_32x32x16_bf16 v[56:71], v[120:123], a[184:187], v[56:71]
  ds_read_b128 v[120:123], v8 offset:22528
  s_waitcnt lgkmcnt(7)
  v_mfma_f32_32x32x16_bf16 v[56:71], v[124:127], a[188:191], v[56:71]
  ds_read_b128 v[124:127], v8 offset:23552
  s_waitcnt lgkmcnt(7)
  v_mfma_f32_32x32x16_bf16 v[56:71], v[96:99], a[192:195], v[56:71]
  ds_read_b128 v[96:99], v8 offset:24576
  s_waitcnt lgkmcnt(7)
  v_mfma_f32_32x32x16_bf16 v[56:71], v[100:103], a[196:199], v[56:71]
  ds_read_b128 v[100:103], v8 offset:25600
  s_waitcnt lgkmcnt(7)
  v_mfma_f32_32x32x16_bf16 v[56:71], v[104:107], a[200:203], v[56:71]
  ds_read_b128 v[104:107], v8 offset:26624
  s_waitcnt lgkmcnt(7)
  v_mfma_f32_32x32x16_bf16 v[56:71], v[108:111], a[204:207], v[56:71]
  ds_read_b128 v[108:111], v8 offset:27648
  s_waitcnt lgkmcnt(7)
  v_mfma_f32_32x32x16_bf16 v[56:71], v[112:115], a[208:211], v[56:71]
  ds_read_b128 v[112:115], v8 offset:28672
  s_waitcnt lgkmcnt(7)
  v_mfma_f32_32x32x16_bf16 v[56:71], v[116:119], a[212:215], v[56:71]
  ds_read_b128 v[116:119], v8 offset:29696
  s_waitcnt lgkmcnt(7)
  v_mfma_f32_32x32x16_bf16 v[56:71], v[120:123], a[216:219], v[56:71]
  ds_read_b128 v[120:123], v8 offset:30720
  s_waitcnt lgkmcnt(7)
  v_mfma_f32_32x32x16_bf16 v[56:71], v[124:127], a[220:223], v[56:71]
  ds_read_b128 v[124:127], v8 offset:31744
  s_waitcnt lgkmcnt(7)
  v_mfma_f32_32x32x16_bf16 v[56:71], v[96:99], a[224:227], v[56:71]
  s_waitcnt lgkmcnt(6)
  v_mfma_f32_32x32x16_bf16 v[56:71], v[100:103], a[228:231], v[56:71]
  s_waitcnt lgkmcnt(5)
  v_mfma_f32_32x32x16_bf16 v[56:71], v[104:107], a[232:235], v[56:71]
  buffer_load_dword v13, v12, s[4:7], s29 offen sc1
  s_waitcnt lgkmcnt(4)
  v_mfma_f32_32x32x16_bf16 v[56:71], v[108:111], a[236:239], v[56:71]
  s_waitcnt lgkmcnt(3)
  v_mfma_f32_32x32x16_bf16 v[56:71], v[112:115], a[240:243], v[56:71]
  s_waitcnt lgkmcnt(2)
  v_mfma_f32_32x32x16_bf16 v[56:71], v[116:119], a[244:247], v[56:71]
  s_waitcnt lgkmcnt(1)
  v_mfma_f32_32x32x16_bf16 v[56:71], v[120:123], a[248:251], v[56:71]
  s_waitcnt lgkmcnt(0)
  v_mfma_f32_32x32x16_bf16 v[56:71], v[124:127], a[252:255], v[56:71]
  v_xor_b32 v8, 32768, v8
  s_nop 10
  v_cvt_pk_bf16_f32 v80, v56, v57
  v_cvt_pk_bf16_f32 v81, v58, v59
  v_cvt_pk_bf16_f32 v82, v60, v61
  v_cvt_pk_bf16_f32 v83, v62, v63
  buffer_store_dwordx4 v[80:83], v9, s[4:7], s27 offen offset:512 sc1
  v_cvt_pk_bf16_f32 v84, v64, v65
  v_cvt_pk_bf16_f32 v85, v66, v67
  v_cvt_pk_bf16_f32 v86, v68, v69
  v_cvt_pk_bf16_f32 v87, v70, v71
  buffer_store_dwordx4 v[84:87], v10, s[4:7], s27 offen offset:512 sc1
  s_add_u32 s27, s27, 262144
  s_mov_b32 s34, 1
  s_cmp_eq_u32 s28, 0
  s_cbranch_scc1 glast_68
  s_cmp_eq_u32 s33, 0
  s_cbranch_scc1 gblk_69
  s_cmp_lg_u32 s3, 0
  s_cbranch_scc1 post_70
  v_mov_b32 v39, s38
  ds_write_b32 v36, v39 offset:4
  s_waitcnt lgkmcnt(0)
post_70:
  s_add_u32 s26, s26, 32768
  s_xor_b32 s36, s36, 32768
  s_add_u32 s29, s29, 1024
  s_add_u32 s38, s38, 1
  s_branch gtop_67
gblk_69:
  s_waitcnt vmcnt(2)
  v_cmp_ne_u32 vcc, 0, v13
  s_nop 0
  s_cmp_eq_u64 vcc, exec
  s_cbranch_scc0 gblk2_71
  s_cmp_lg_u32 s3, 0
  s_cbranch_scc1 post_72
  v_mov_b32 v39, s38
  ds_write_b32 v36, v39 offset:4
  s_waitcnt lgkmcnt(0)
post_72:
  s_mov_b32 s37, s26
  s_mov_b32 m0, s36
  s_nop 0
  buffer_load_dwordx4 v11, s[4:7], s37 offen sc1 lds
  s_add_u32 m0, m0, 4096
  s_add_u32 s37, s37, 4096
  buffer_load_dwordx4 v11, s[4:7], s37 offen sc1 lds
  s_add_u32 m0, m0, 4096
  s_add_u32 s37, s37, 4096
  buffer_load_dwordx4 v11, s[4:7], s37 offen sc1 lds
  s_add_u32 m0, m0, 4096
  s_add_u32 s37, s37, 4096
  buffer_load_dwordx4 v11, s[4:7], s37 offen sc1 lds
  s_add_u32 m0, m0, 4096
  s_add_u32 s37, s37, 4096
  buffer_load_dwordx4 v11, s[4:7], s37 offen sc1 lds
  s_add_u32 m0, m0, 4096
  s_add_u32 s37, s37, 4096
  buffer_load_dwordx4 v11, s[4:7], s37 offen sc1 lds
  s_add_u32 m0, m0, 4096
  s_add_u32 s37, s37, 4096
  buffer_load_dwordx4 v11, s[4:7], s37 offen sc1 lds
  s_add_u32 m0, m0, 4096
  s_add_u32 s37, s37, 4096
  buffer_load_dwordx4 v11, s[4:7], s37 offen sc1 lds
  s_add_u32 s26, s26, 32768
  s_xor_b32 s36, s36, 32768
  s_add_u32 s29, s29, 1024
  s_add_u32 s38, s38, 1
  s_waitcnt vmcnt(8)
  s_mov_b64 exec, 1
  ds_add_rtn_u32 v39, v37, v38
  s_waitcnt lgkmcnt(0)
  v_readfirstlane_b32 s31, v39
  s_mov_b64 exec, -1
  v_xor_b32 v37, 8, v37
  s_and_b32 s31, s31, 3
  s_cmp_lg_u32 s31, 3
  s_cbranch_scc1 agg_73
  s_mov_b64 exec, 1
  buffer_store_dword v14, off, s[4:7], s30 sc1
  s_mov_b64 exec, -1
  s_waitcnt vmcnt(1)
  s_branch aggj_74
agg_73:
  s_waitcnt vmcnt(0)
aggj_74:
  s_add_u32 s30, s30, 1024
  s_mov_b32 s34, 0
  s_branch gtop_67
gblk2_71:
  s_waitcnt vmcnt(0)
  s_mov_b64 exec, 1
  ds_add_rtn_u32 v39, v37, v38
  s_waitcnt lgkmcnt(0)
  v_readfirstlane_b32 s31, v39
  s_mov_b64 exec, -1
  v_xor_b32 v37, 8, v37
  s_and_b32 s31, s31, 3
  s_cmp_lg_u32 s31, 3
  s_cbranch_scc1 agg_75
  s_mov_b64 exec, 1
  buffer_store_dword v14, off, s[4:7], s30 sc1
  s_mov_b64 exec, -1
agg_75:
  s_add_u32 s30, s30, 1024
  s_mov_b32 s34, 0
  s_cmp_lg_u32 s3, 0
  s_cbranch_scc1 wro_76
  s_mov_b32 s35, 0
poll_78:
  buffer_load_dword v13, v12, s[4:7], s29 offen sc1
  s_waitcnt vmcnt(0)
  v_cmp_ne_u32 vcc, 0, v13
  s_nop 0
  s_cmp_eq_u64 vcc, exec
  s_cbranch_scc1 polld_79
  s_sleep 2
  s_add_u32 s35, s35, 1
  s_cmp_lt_u32 s35, 131072
  s_cbranch_scc1 poll_78
  s_branch mega_kernel_end
polld_79:
  v_mov_b32 v13, s38
  ds_write_b32 v36, v13 offset:4
  s_waitcnt lgkmcnt(0)
  s_branch wrd_77
wro_76:
  s_mov_b32 s35, 0
wrl_80:
  ds_read_b32 v13, v36 offset:4
  s_add_u32 s35, s35, 1
  s_cmp_gt_u32 s35, 2097152
  s_cbranch_scc1 mega_kernel_end
  s_waitcnt lgkmcnt(0)
  v_readfirstlane_b32 s31, v13
  s_nop 0
  s_cmp_ge_u32 s31, s38
  s_cbranch_scc1 wrd_77
  s_sleep 1
  s_branch wrl_80
wrd_77:
  s_mov_b32 s37, s26
  s_mov_b32 m0, s36
  s_nop 0
  buffer_load_dwordx4 v11, s[4:7], s37 offen sc1 lds
  s_add_u32 m0, m0, 4096
  s_add_u32 s37, s37, 4096
  buffer_load_dwordx4 v11, s[4:7], s37 offen sc1 lds
  s_add_u32 m0, m0, 4096
  s_add_u32 s37, s37, 4096
  buffer_load_dwordx4 v11, s[4:7], s37 offen sc1 lds
  s_add_u32 m0, m0, 4096
  s_add_u32 s37, s37, 4096
  buffer_load_dwordx4 v11, s[4:7], s37 offen sc1 lds
  s_add_u32 m0, m0, 4096
  s_add_u32 s37, s37, 4096
  buffer_load_dwordx4 v11, s[4:7], s37 offen sc1 lds
  s_add_u32 m0, m0, 4096
  s_add_u32 s37, s37, 4096
  buffer_load_dwordx4 v11, s[4:7], s37 offen sc1 lds
  s_add_u32 m0, m0, 4096
  s_add_u32 s37, s37, 4096
  buffer_load_dwordx4 v11, s[4:7], s37 offen sc1 lds
  s_add_u32 m0, m0, 4096
  s_add_u32 s37, s37, 4096
  buffer_load_dwordx4 v11, s[4:7], s37 offen sc1 lds
  s_add_u32 s26, s26, 32768
  s_xor_b32 s36, s36, 32768
  s_add_u32 s29, s29, 1024
  s_add_u32 s38, s38, 1
  s_waitcnt vmcnt(0)
  s_branch gtop_67
glast_68:
  s_waitcnt vmcnt(0)
  s_mov_b64 exec, 1
  ds_add_rtn_u32 v39, v37, v38
  s_waitcnt lgkmcnt(0)
  v_readfirstlane_b32 s31, v39
  s_mov_b64 exec, -1
  v_xor_b32 v37, 8, v37
  s_and_b32 s31, s31, 3
  s_cmp_lg_u32 s31, 3
  s_cbranch_scc1 agg_81
  s_mov_b64 exec, 1
  buffer_store_dword v14, off, s[4:7], s30 sc1
  s_mov_b64 exec, -1
agg_81:
  s_add_u32 s30, s30, 1024
  s_mov_b32 s34, 0
  s_branch mega_kernel_end
r_init_14:
  s_mov_b32 s42, s98
  s_load_dwordx2 s[8:9], s[0:1], 0
  s_waitcnt lgkmcnt(0)
  s_mov_b32 s10, 2097152
  s_mov_b32 s11, 0x00020000
  s_lshl_b32 s24, s42, 2
  s_add_u32 s24, s24, s3
  s_lshl_b32 s25, s24, 12
  s_lshr_b32 s27, s24, 3
  s_lshl_b32 s27, s27, 15
  s_and_b32 s31, s24, 7
  s_lshl_b32 s31, s31, 6
  s_add_u32 s27, s27, s31
  s_add_u32 s27, s27, 4194304
  v_and_b32 v3, 3, v2
  v_lshrrev_b32 v4, 2, v2
  v_lshlrev_b32 v6, 10, v3
  v_lshl_add_u32 v6, v4, 4, v6
  v_lshlrev_b32 v7, 9, v4
  v_lshl_add_u32 v7, v3, 4, v7
  s_mov_b32 s40, 0xffff0000
  buffer_load_dwordx4 v[64:67], v6, s[8:11], s25 offen offset:0
  buffer_load_dwordx4 v[68:71], v6, s[8:11], s25 offen offset:256
  buffer_load_dwordx4 v[72:75], v6, s[8:11], s25 offen offset:512
  buffer_load_dwordx4 v[76:79], v6, s[8:11], s25 offen offset:768
  s_add_u32 s25, s25, 1048576
  buffer_load_dwordx4 v[80:83], v6, s[8:11], s25 offen offset:0
  buffer_load_dwordx4 v[84:87], v6, s[8:11], s25 offen offset:256
  buffer_load_dwordx4 v[88:91], v6, s[8:11], s25 offen offset:512
  buffer_load_dwordx4 v[92:95], v6, s[8:11], s25 offen offset:768
  s_add_u32 s25, s25, 1048576
  v_lshlrev_b32 v100, 4, v0
  v_mov_b32 v104, 0
  v_mov_b32 v108, -1
  v_mov_b32 v105, 0
  v_mov_b32 v109, -1
  v_mov_b32 v106, 0
  v_mov_b32 v110, -1
  v_mov_b32 v107, 0
  v_mov_b32 v111, -1
  s_mov_b32 s43, s42
  s_lshl_b32 s50, s43, 12
  buffer_store_dwordx4 v[104:107], v100, s[4:7], s50 offen sc1
  s_add_u32 s51, s50, 3145728
  s_cmp_lt_u32 s43, 16
  s_cselect_b32 s51, s51, 2146435072
  buffer_store_dwordx4 v[108:111], v100, s[4:7], s51 offen sc1
  s_lshl_b32 s50, s43, 13
  s_add_u32 s50, s50, 1048576
  buffer_store_dwordx4 v[108:111], v100, s[4:7], s50 offen sc1
  s_add_u32 s50, s50, 4096
  buffer_store_dwordx4 v[108:111], v100, s[4:7], s50 offen sc1
  s_add_u32 s43, s43, 64
  s_lshl_b32 s50, s43, 12
  buffer_store_dwordx4 v[104:107], v100, s[4:7], s50 offen sc1
  s_add_u32 s51, s50, 3145728
  s_cmp_lt_u32 s43, 16
  s_cselect_b32 s51, s51, 2146435072
  buffer_store_dwordx4 v[108:111], v100, s[4:7], s51 offen sc1
  s_lshl_b32 s50, s43, 13
  s_add_u32 s50, s50, 1048576
  buffer_store_dwordx4 v[108:111], v100, s[4:7], s50 offen sc1
  s_add_u32 s50, s50, 4096
  buffer_store_dwordx4 v[108:111], v100, s[4:7], s50 offen sc1
  s_add_u32 s43, s43, 64
  s_lshl_b32 s50, s43, 12
  buffer_store_dwordx4 v[104:107], v100, s[4:7], s50 offen sc1
  s_add_u32 s51, s50, 3145728
  s_cmp_lt_u32 s43, 16
  s_cselect_b32 s51, s51, 2146435072
  buffer_store_dwordx4 v[108:111], v100, s[4:7], s51 offen sc1
  s_lshl_b32 s50, s43, 13
  s_add_u32 s50, s50, 1048576
  buffer_store_dwordx4 v[108:111], v100, s[4:7], s50 offen sc1
  s_add_u32 s50, s50, 4096
  buffer_store_dwordx4 v[108:111], v100, s[4:7], s50 offen sc1
  s_add_u32 s43, s43, 64
  s_lshl_b32 s50, s43, 12
  buffer_store_dwordx4 v[104:107], v100, s[4:7], s50 offen sc1
  s_add_u32 s51, s50, 3145728
  s_cmp_lt_u32 s43, 16
  s_cselect_b32 s51, s51, 2146435072
  buffer_store_dwordx4 v[108:111], v100, s[4:7], s51 offen sc1
  s_lshl_b32 s50, s43, 13
  s_add_u32 s50, s50, 1048576
  buffer_store_dwordx4 v[108:111], v100, s[4:7], s50 offen sc1
  s_add_u32 s50, s50, 4096
  buffer_store_dwordx4 v[108:111], v100, s[4:7], s50 offen sc1
  s_add_u32 s43, s43, 64
  s_waitcnt vmcnt(20)
  v_lshlrev_b32 v16, 16, v64
  v_and_b32 v17, s40, v64
  v_lshlrev_b32 v18, 16, v65
  v_and_b32 v19, s40, v65
  v_lshlrev_b32 v20, 16, v66
  v_and_b32 v21, s40, v66
  v_lshlrev_b32 v22, 16, v67
  v_and_b32 v23, s40, v67
  v_lshlrev_b32 v24, 16, v68
  v_and_b32 v25, s40, v68
  v_lshlrev_b32 v26, 16, v69
  v_and_b32 v27, s40, v69
  v_lshlrev_b32 v28, 16, v70
  v_and_b32 v29, s40, v70
  v_lshlrev_b32 v30, 16, v71
  v_and_b32 v31, s40, v71
  v_lshlrev_b32 v32, 16, v72
  v_and_b32 v33, s40, v72
  v_lshlrev_b32 v34, 16, v73
  v_and_b32 v35, s40, v73
  v_lshlrev_b32 v36, 16, v74
  v_and_b32 v37, s40, v74
  v_lshlrev_b32 v38, 16, v75
  v_and_b32 v39, s40, v75
  v_lshlrev_b32 v40, 16, v76
  v_and_b32 v41, s40, v76
  v_lshlrev_b32 v42, 16, v77
  v_and_b32 v43, s40, v77
  v_lshlrev_b32 v44, 16, v78
  v_and_b32 v45, s40, v78
  v_lshlrev_b32 v46, 16, v79
  v_and_b32 v47, s40, v79
  v_add_f32 v8, v16, v17
  v_add_f32 v9, v18, v19
  v_add_f32 v8, v8, v20
  v_add_f32 v9, v9, v21
  v_add_f32 v8, v8, v22
  v_add_f32 v9, v9, v23
  v_add_f32 v8, v8, v24
  v_add_f32 v9, v9, v25
  v_add_f32 v8, v8, v26
  v_add_f32 v9, v9, v27
  v_add_f32 v8, v8, v28
  v_add_f32 v9, v9, v29
  v_add_f32 v8, v8, v30
  v_add_f32 v9, v9, v31
  v_add_f32 v8, v8, v32
  v_add_f32 v9, v9, v33
  v_add_f32 v8, v8, v34
  v_add_f32 v9, v9, v35
  v_add_f32 v8, v8, v36
  v_add_f32 v9, v9, v37
  v_add_f32 v8, v8, v38
  v_add_f32 v9, v9, v39
  v_add_f32 v8, v8, v40
  v_add_f32 v9, v9, v41
  v_add_f32 v8, v8, v42
  v_add_f32 v9, v9, v43
  v_add_f32 v8, v8, v44
  v_add_f32 v9, v9, v45
  v_add_f32 v8, v8, v46
  v_add_f32 v9, v9, v47
  v_add_f32 v8, v8, v9
  s_nop 1
  v_add_f32_dpp v8, v8, v8 row_ror:4 row_mask:0xf bank_mask:0xf
  s_nop 1
  v_add_f32_dpp v8, v8, v8 row_ror:8 row_mask:0xf bank_mask:0xf
  v_mov_b32 v10, v8
  s_nop 1
  v_permlane16_swap_b32 v8, v10
  v_add_f32 v8, v8, v10
  v_mov_b32 v10, v8
  s_nop 1
  v_permlane32_swap_b32 v8, v10
  v_add_f32 v8, v8, v10
  v_mul_f32 v8, 0x3b000000, v8
  v_mov_b32 v9, 0
  v_mov_b32 v11, 0
  v_sub_f32 v12, v16, v8
  v_sub_f32 v13, v17, v8
  v_fmac_f32 v9, v12, v12
  v_fmac_f32 v11, v13, v13
  v_sub_f32 v12, v18, v8
  v_sub_f32 v13, v19, v8
  v_fmac_f32 v9, v12, v12
  v_fmac_f32 v11, v13, v13
  v_sub_f32 v12, v20, v8
  v_sub_f32 v13, v21, v8
  v_fmac_f32 v9, v12, v12
  v_fmac_f32 v11, v13, v13
  v_sub_f32 v12, v22, v8
  v_sub_f32 v13, v23, v8
  v_fmac_f32 v9, v12, v12
  v_fmac_f32 v11, v13, v13
  v_sub_f32 v12, v24, v8
  v_sub_f32 v13, v25, v8
  v_fmac_f32 v9, v12, v12
  v_fmac_f32 v11, v13, v13
  v_sub_f32 v12, v26, v8
  v_sub_f32 v13, v27, v8
  v_fmac_f32 v9, v12, v12
  v_fmac_f32 v11, v13, v13
  v_sub_f32 v12, v28, v8
  v_sub_f32 v13, v29, v8
  v_fmac_f32 v9, v12, v12
  v_fmac_f32 v11, v13, v13
  v_sub_f32 v12, v30, v8
  v_sub_f32 v13, v31, v8
  v_fmac_f32 v9, v12, v12
  v_fmac_f32 v11, v13, v13
  v_sub_f32 v12, v32, v8
  v_sub_f32 v13, v33, v8
  v_fmac_f32 v9, v12, v12
  v_fmac_f32 v11, v13, v13
  v_sub_f32 v12, v34, v8
  v_sub_f32 v13, v35, v8
  v_fmac_f32 v9, v12, v12
  v_fmac_f32 v11, v13, v13
  v_sub_f32 v12, v36, v8
  v_sub_f32 v13, v37, v8
  v_fmac_f32 v9, v12, v12
  v_fmac_f32 v11, v13, v13
  v_sub_f32 v12, v38, v8
  v_sub_f32 v13, v39, v8
  v_fmac_f32 v9, v12, v12
  v_fmac_f32 v11, v13, v13
  v_sub_f32 v12, v40, v8
  v_sub_f32 v13, v41, v8
  v_fmac_f32 v9, v12, v12
  v_fmac_f32 v11, v13, v13
  v_sub_f32 v12, v42, v8
  v_sub_f32 v13, v43, v8
  v_fmac_f32 v9, v12, v12
  v_fmac_f32 v11, v13, v13
  v_sub_f32 v12, v44, v8
  v_sub_f32 v13, v45, v8
  v_fmac_f32 v9, v12, v12
  v_fmac_f32 v11, v13, v13
  v_sub_f32 v12, v46, v8
  v_sub_f32 v13, v47, v8
  v_fmac_f32 v9, v12, v12
  v_fmac_f32 v11, v13, v13
  v_add_f32 v9, v9, v11
  s_nop 1
  v_add_f32_dpp v9, v9, v9 row_ror:4 row_mask:0xf bank_mask:0xf
  s_nop 1
  v_add_f32_dpp v9, v9, v9 row_ror:8 row_mask:0xf bank_mask:0xf
  v_mov_b32 v10, v9
  s_nop 1
  v_permlane16_swap_b32 v9, v10
  v_add_f32 v9, v9, v10
  v_mov_b32 v10, v9
  s_nop 1
  v_permlane32_swap_b32 v9, v10
  v_add_f32 v9, v9, v10
  v_mul_f32 v9, 0x3b000000, v9
  v_cvt_pk_bf16_f32 v9, v9, v9
  v_lshlrev_b32 v9, 16, v9
  v_add_f32 v9, 0x3727c5ac, v9
  v_cvt_pk_bf16_f32 v9, v9, v9
  v_lshlrev_b32 v9, 16, v9
  v_sqrt_f32 v9, v9
  s_nop 0
  v_cvt_pk_bf16_f32 v9, v9, v9
  v_lshlrev_b32 v9, 16, v9
  v_rcp_f32 v9, v9
  v_cvt_pk_bf16_f32 v8, v8, v8
  v_lshlrev_b32 v8, 16, v8
  v_sub_f32 v16, v16, v8
  v_sub_f32 v17, v17, v8
  v_sub_f32 v18, v18, v8
  v_sub_f32 v19, v19, v8
  v_sub_f32 v20, v20, v8
  v_sub_f32 v21, v21, v8
  v_sub_f32 v22, v22, v8
  v_sub_f32 v23, v23, v8
  v_sub_f32 v24, v24, v8
  v_sub_f32 v25, v25, v8
  v_sub_f32 v26, v26, v8
  v_sub_f32 v27, v27, v8
  v_sub_f32 v28, v28, v8
  v_sub_f32 v29, v29, v8
  v_sub_f32 v30, v30, v8
  v_sub_f32 v31, v31, v8
  v_sub_f32 v32, v32, v8
  v_sub_f32 v33, v33, v8
  v_sub_f32 v34, v34, v8
  v_sub_f32 v35, v35, v8
  v_sub_f32 v36, v36, v8
  v_sub_f32 v37, v37, v8
  v_sub_f32 v38, v38, v8
  v_sub_f32 v39, v39, v8
  v_sub_f32 v40, v40, v8
  v_sub_f32 v41, v41, v8
  v_sub_f32 v42, v42, v8
  v_sub_f32 v43, v43, v8
  v_sub_f32 v44, v44, v8
  v_sub_f32 v45, v45, v8
  v_sub_f32 v46, v46, v8
  v_sub_f32 v47, v47, v8
  v_cvt_pk_bf16_f32 v64, v16, v17
  v_cvt_pk_bf16_f32 v65, v18, v19
  v_cvt_pk_bf16_f32 v66, v20, v21
  v_cvt_pk_bf16_f32 v67, v22, v23
  v_cvt_pk_bf16_f32 v68, v24, v25
  v_cvt_pk_bf16_f32 v69, v26, v27
  v_cvt_pk_bf16_f32 v70, v28, v29
  v_cvt_pk_bf16_f32 v71, v30, v31
  v_cvt_pk_bf16_f32 v72, v32, v33
  v_cvt_pk_bf16_f32 v73, v34, v35
  v_cvt_pk_bf16_f32 v74, v36, v37
  v_cvt_pk_bf16_f32 v75, v38, v39
  v_cvt_pk_bf16_f32 v76, v40, v41
  v_cvt_pk_bf16_f32 v77, v42, v43
  v_cvt_pk_bf16_f32 v78, v44, v45
  v_cvt_pk_bf16_f32 v79, v46, v47
  v_lshlrev_b32 v16, 16, v64
  v_and_b32 v17, s40, v64
  v_lshlrev_b32 v18, 16, v65
  v_and_b32 v19, s40, v65
  v_lshlrev_b32 v20, 16, v66
  v_and_b32 v21, s40, v66
  v_lshlrev_b32 v22, 16, v67
  v_and_b32 v23, s40, v67
  v_lshlrev_b32 v24, 16, v68
  v_and_b32 v25, s40, v68
  v_lshlrev_b32 v26, 16, v69
  v_and_b32 v27, s40, v69
  v_lshlrev_b32 v28, 16, v70
  v_and_b32 v29, s40, v70
  v_lshlrev_b32 v30, 16, v71
  v_and_b32 v31, s40, v71
  v_lshlrev_b32 v32, 16, v72
  v_and_b32 v33, s40, v72
  v_lshlrev_b32 v34, 16, v73
  v_and_b32 v35, s40, v73
  v_lshlrev_b32 v36, 16, v74
  v_and_b32 v37, s40, v74
  v_lshlrev_b32 v38, 16, v75
  v_and_b32 v39, s40, v75
  v_lshlrev_b32 v40, 16, v76
  v_and_b32 v41, s40, v76
  v_lshlrev_b32 v42, 16, v77
  v_and_b32 v43, s40, v77
  v_lshlrev_b32 v44, 16, v78
  v_and_b32 v45, s40, v78
  v_lshlrev_b32 v46, 16, v79
  v_and_b32 v47, s40, v79
  v_mul_f32 v16, v16, v9
  v_mul_f32 v17, v17, v9
  v_mul_f32 v18, v18, v9
  v_mul_f32 v19, v19, v9
  v_mul_f32 v20, v20, v9
  v_mul_f32 v21, v21, v9
  v_mul_f32 v22, v22, v9
  v_mul_f32 v23, v23, v9
  v_mul_f32 v24, v24, v9
  v_mul_f32 v25, v25, v9
  v_mul_f32 v26, v26, v9
  v_mul_f32 v27, v27, v9
  v_mul_f32 v28, v28, v9
  v_mul_f32 v29, v29, v9
  v_mul_f32 v30, v30, v9
  v_mul_f32 v31, v31, v9
  v_mul_f32 v32, v32, v9
  v_mul_f32 v33, v33, v9
  v_mul_f32 v34, v34, v9
  v_mul_f32 v35, v35, v9
  v_mul_f32 v36, v36, v9
  v_mul_f32 v37, v37, v9
  v_mul_f32 v38, v38, v9
  v_mul_f32 v39, v39, v9
  v_mul_f32 v40, v40, v9
  v_mul_f32 v41, v41, v9
  v_mul_f32 v42, v42, v9
  v_mul_f32 v43, v43, v9
  v_mul_f32 v44, v44, v9
  v_mul_f32 v45, v45, v9
  v_mul_f32 v46, v46, v9
  v_mul_f32 v47, v47, v9
  v_cvt_pk_bf16_f32 v64, v16, v17
  v_cvt_pk_bf16_f32 v65, v18, v19
  v_cvt_pk_bf16_f32 v66, v20, v21
  v_cvt_pk_bf16_f32 v67, v22, v23
  v_cvt_pk_bf16_f32 v68, v24, v25
  v_cvt_pk_bf16_f32 v69, v26, v27
  v_cvt_pk_bf16_f32 v70, v28, v29
  v_cvt_pk_bf16_f32 v71, v30, v31
  v_cvt_pk_bf16_f32 v72, v32, v33
  v_cvt_pk_bf16_f32 v73, v34, v35
  v_cvt_pk_bf16_f32 v74, v36, v37
  v_cvt_pk_bf16_f32 v75, v38, v39
  v_cvt_pk_bf16_f32 v76, v40, v41
  v_cvt_pk_bf16_f32 v77, v42, v43
  v_cvt_pk_bf16_f32 v78, v44, v45
  v_cvt_pk_bf16_f32 v79, v46, v47
  s_add_u32 s41, s27, 0
  buffer_store_dwordx4 v[64:67], v7, s[4:7], s41 offen sc1
  s_add_u32 s41, s27, 8192
  buffer_store_dwordx4 v[68:71], v7, s[4:7], s41 offen sc1
  s_add_u32 s41, s27, 16384
  buffer_store_dwordx4 v[72:75], v7, s[4:7], s41 offen sc1
  s_add_u32 s41, s27, 24576
  buffer_store_dwordx4 v[76:79], v7, s[4:7], s41 offen sc1
  s_add_u32 s27, s27, 1048576
  s_waitcnt vmcnt(20)
  v_lshlrev_b32 v16, 16, v80
  v_and_b32 v17, s40, v80
  v_lshlrev_b32 v18, 16, v81
  v_and_b32 v19, s40, v81
  v_lshlrev_b32 v20, 16, v82
  v_and_b32 v21, s40, v82
  v_lshlrev_b32 v22, 16, v83
  v_and_b32 v23, s40, v83
  v_lshlrev_b32 v24, 16, v84
  v_and_b32 v25, s40, v84
  v_lshlrev_b32 v26, 16, v85
  v_and_b32 v27, s40, v85
  v_lshlrev_b32 v28, 16, v86
  v_and_b32 v29, s40, v86
  v_lshlrev_b32 v30, 16, v87
  v_and_b32 v31, s40, v87
  v_lshlrev_b32 v32, 16, v88
  v_and_b32 v33, s40, v88
  v_lshlrev_b32 v34, 16, v89
  v_and_b32 v35, s40, v89
  v_lshlrev_b32 v36, 16, v90
  v_and_b32 v37, s40, v90
  v_lshlrev_b32 v38, 16, v91
  v_and_b32 v39, s40, v91
  v_lshlrev_b32 v40, 16, v92
  v_and_b32 v41, s40, v92
  v_lshlrev_b32 v42, 16, v93
  v_and_b32 v43, s40, v93
  v_lshlrev_b32 v44, 16, v94
  v_and_b32 v45, s40, v94
  v_lshlrev_b32 v46, 16, v95
  v_and_b32 v47, s40, v95
  v_add_f32 v8, v16, v17
  v_add_f32 v9, v18, v19
  v_add_f32 v8, v8, v20
  v_add_f32 v9, v9, v21
  v_add_f32 v8, v8, v22
  v_add_f32 v9, v9, v23
  v_add_f32 v8, v8, v24
  v_add_f32 v9, v9, v25
  v_add_f32 v8, v8, v26
  v_add_f32 v9, v9, v27
  v_add_f32 v8, v8, v28
  v_add_f32 v9, v9, v29
  v_add_f32 v8, v8, v30
  v_add_f32 v9, v9, v31
  v_add_f32 v8, v8, v32
  v_add_f32 v9, v9, v33
  v_add_f32 v8, v8, v34
  v_add_f32 v9, v9, v35
  v_add_f32 v8, v8, v36
  v_add_f32 v9, v9, v37
  v_add_f32 v8, v8, v38
  v_add_f32 v9, v9, v39
  v_add_f32 v8, v8, v40
  v_add_f32 v9, v9, v41
  v_add_f32 v8, v8, v42
  v_add_f32 v9, v9, v43
  v_add_f32 v8, v8, v44
  v_add_f32 v9, v9, v45
  v_add_f32 v8, v8, v46
  v_add_f32 v9, v9, v47
  v_add_f32 v8, v8, v9
  s_nop 1
  v_add_f32_dpp v8, v8, v8 row_ror:4 row_mask:0xf bank_mask:0xf
  s_nop 1
  v_add_f32_dpp v8, v8, v8 row_ror:8 row_mask:0xf bank_mask:0xf
  v_mov_b32 v10, v8
  s_nop 1
  v_permlane16_swap_b32 v8, v10
  v_add_f32 v8, v8, v10
  v_mov_b32 v10, v8
  s_nop 1
  v_permlane32_swap_b32 v8, v10
  v_add_f32 v8, v8, v10
  v_mul_f32 v8, 0x3b000000, v8
  v_mov_b32 v9, 0
  v_mov_b32 v11, 0
  v_sub_f32 v12, v16, v8
  v_sub_f32 v13, v17, v8
  v_fmac_f32 v9, v12, v12
  v_fmac_f32 v11, v13, v13
  v_sub_f32 v12, v18, v8
  v_sub_f32 v13, v19, v8
  v_fmac_f32 v9, v12, v12
  v_fmac_f32 v11, v13, v13
  v_sub_f32 v12, v20, v8
  v_sub_f32 v13, v21, v8
  v_fmac_f32 v9, v12, v12
  v_fmac_f32 v11, v13, v13
  v_sub_f32 v12, v22, v8
  v_sub_f32 v13, v23, v8
  v_fmac_f32 v9, v12, v12
  v_fmac_f32 v11, v13, v13
  v_sub_f32 v12, v24, v8
  v_sub_f32 v13, v25, v8
  v_fmac_f32 v9, v12, v12
  v_fmac_f32 v11, v13, v13
  v_sub_f32 v12, v26, v8
  v_sub_f32 v13, v27, v8
  v_fmac_f32 v9, v12, v12
  v_fmac_f32 v11, v13, v13
  v_sub_f32 v12, v28, v8
  v_sub_f32 v13, v29, v8
  v_fmac_f32 v9, v12, v12
  v_fmac_f32 v11, v13, v13
  v_sub_f32 v12, v30, v8
  v_sub_f32 v13, v31, v8
  v_fmac_f32 v9, v12, v12
  v_fmac_f32 v11, v13, v13
  v_sub_f32 v12, v32, v8
  v_sub_f32 v13, v33, v8
  v_fmac_f32 v9, v12, v12
  v_fmac_f32 v11, v13, v13
  v_sub_f32 v12, v34, v8
  v_sub_f32 v13, v35, v8
  v_fmac_f32 v9, v12, v12
  v_fmac_f32 v11, v13, v13
  v_sub_f32 v12, v36, v8
  v_sub_f32 v13, v37, v8
  v_fmac_f32 v9, v12, v12
  v_fmac_f32 v11, v13, v13
  v_sub_f32 v12, v38, v8
  v_sub_f32 v13, v39, v8
  v_fmac_f32 v9, v12, v12
  v_fmac_f32 v11, v13, v13
  v_sub_f32 v12, v40, v8
  v_sub_f32 v13, v41, v8
  v_fmac_f32 v9, v12, v12
  v_fmac_f32 v11, v13, v13
  v_sub_f32 v12, v42, v8
  v_sub_f32 v13, v43, v8
  v_fmac_f32 v9, v12, v12
  v_fmac_f32 v11, v13, v13
  v_sub_f32 v12, v44, v8
  v_sub_f32 v13, v45, v8
  v_fmac_f32 v9, v12, v12
  v_fmac_f32 v11, v13, v13
  v_sub_f32 v12, v46, v8
  v_sub_f32 v13, v47, v8
  v_fmac_f32 v9, v12, v12
  v_fmac_f32 v11, v13, v13
  v_add_f32 v9, v9, v11
  s_nop 1
  v_add_f32_dpp v9, v9, v9 row_ror:4 row_mask:0xf bank_mask:0xf
  s_nop 1
  v_add_f32_dpp v9, v9, v9 row_ror:8 row_mask:0xf bank_mask:0xf
  v_mov_b32 v10, v9
  s_nop 1
  v_permlane16_swap_b32 v9, v10
  v_add_f32 v9, v9, v10
  v_mov_b32 v10, v9
  s_nop 1
  v_permlane32_swap_b32 v9, v10
  v_add_f32 v9, v9, v10
  v_mul_f32 v9, 0x3b000000, v9
  v_cvt_pk_bf16_f32 v9, v9, v9
  v_lshlrev_b32 v9, 16, v9
  v_add_f32 v9, 0x3727c5ac, v9
  v_cvt_pk_bf16_f32 v9, v9, v9
  v_lshlrev_b32 v9, 16, v9
  v_sqrt_f32 v9, v9
  s_nop 0
  v_cvt_pk_bf16_f32 v9, v9, v9
  v_lshlrev_b32 v9, 16, v9
  v_rcp_f32 v9, v9
  v_cvt_pk_bf16_f32 v8, v8, v8
  v_lshlrev_b32 v8, 16, v8
  v_sub_f32 v16, v16, v8
  v_sub_f32 v17, v17, v8
  v_sub_f32 v18, v18, v8
  v_sub_f32 v19, v19, v8
  v_sub_f32 v20, v20, v8
  v_sub_f32 v21, v21, v8
  v_sub_f32 v22, v22, v8
  v_sub_f32 v23, v23, v8
  v_sub_f32 v24, v24, v8
  v_sub_f32 v25, v25, v8
  v_sub_f32 v26, v26, v8
  v_sub_f32 v27, v27, v8
  v_sub_f32 v28, v28, v8
  v_sub_f32 v29, v29, v8
  v_sub_f32 v30, v30, v8
  v_sub_f32 v31, v31, v8
  v_sub_f32 v32, v32, v8
  v_sub_f32 v33, v33, v8
  v_sub_f32 v34, v34, v8
  v_sub_f32 v35, v35, v8
  v_sub_f32 v36, v36, v8
  v_sub_f32 v37, v37, v8
  v_sub_f32 v38, v38, v8
  v_sub_f32 v39, v39, v8
  v_sub_f32 v40, v40, v8
  v_sub_f32 v41, v41, v8
  v_sub_f32 v42, v42, v8
  v_sub_f32 v43, v43, v8
  v_sub_f32 v44, v44, v8
  v_sub_f32 v45, v45, v8
  v_sub_f32 v46, v46, v8
  v_sub_f32 v47, v47, v8
  v_cvt_pk_bf16_f32 v80, v16, v17
  v_cvt_pk_bf16_f32 v81, v18, v19
  v_cvt_pk_bf16_f32 v82, v20, v21
  v_cvt_pk_bf16_f32 v83, v22, v23
  v_cvt_pk_bf16_f32 v84, v24, v25
  v_cvt_pk_bf16_f32 v85, v26, v27
  v_cvt_pk_bf16_f32 v86, v28, v29
  v_cvt_pk_bf16_f32 v87, v30, v31
  v_cvt_pk_bf16_f32 v88, v32, v33
  v_cvt_pk_bf16_f32 v89, v34, v35
  v_cvt_pk_bf16_f32 v90, v36, v37
  v_cvt_pk_bf16_f32 v91, v38, v39
  v_cvt_pk_bf16_f32 v92, v40, v41
  v_cvt_pk_bf16_f32 v93, v42, v43
  v_cvt_pk_bf16_f32 v94, v44, v45
  v_cvt_pk_bf16_f32 v95, v46, v47
  v_lshlrev_b32 v16, 16, v80
  v_and_b32 v17, s40, v80
  v_lshlrev_b32 v18, 16, v81
  v_and_b32 v19, s40, v81
  v_lshlrev_b32 v20, 16, v82
  v_and_b32 v21, s40, v82
  v_lshlrev_b32 v22, 16, v83
  v_and_b32 v23, s40, v83
  v_lshlrev_b32 v24, 16, v84
  v_and_b32 v25, s40, v84
  v_lshlrev_b32 v26, 16, v85
  v_and_b32 v27, s40, v85
  v_lshlrev_b32 v28, 16, v86
  v_and_b32 v29, s40, v86
  v_lshlrev_b32 v30, 16, v87
  v_and_b32 v31, s40, v87
  v_lshlrev_b32 v32, 16, v88
  v_and_b32 v33, s40, v88
  v_lshlrev_b32 v34, 16, v89
  v_and_b32 v35, s40, v89
  v_lshlrev_b32 v36, 16, v90
  v_and_b32 v37, s40, v90
  v_lshlrev_b32 v38, 16, v91
  v_and_b32 v39, s40, v91
  v_lshlrev_b32 v40, 16, v92
  v_and_b32 v41, s40, v92
  v_lshlrev_b32 v42, 16, v93
  v_and_b32 v43, s40, v93
  v_lshlrev_b32 v44, 16, v94
  v_and_b32 v45, s40, v94
  v_lshlrev_b32 v46, 16, v95
  v_and_b32 v47, s40, v95
  v_mul_f32 v16, v16, v9
  v_mul_f32 v17, v17, v9
  v_mul_f32 v18, v18, v9
  v_mul_f32 v19, v19, v9
  v_mul_f32 v20, v20, v9
  v_mul_f32 v21, v21, v9
  v_mul_f32 v22, v22, v9
  v_mul_f32 v23, v23, v9
  v_mul_f32 v24, v24, v9
  v_mul_f32 v25, v25, v9
  v_mul_f32 v26, v26, v9
  v_mul_f32 v27, v27, v9
  v_mul_f32 v28, v28, v9
  v_mul_f32 v29, v29, v9
  v_mul_f32 v30, v30, v9
  v_mul_f32 v31, v31, v9
  v_mul_f32 v32, v32, v9
  v_mul_f32 v33, v33, v9
  v_mul_f32 v34, v34, v9
  v_mul_f32 v35, v35, v9
  v_mul_f32 v36, v36, v9
  v_mul_f32 v37, v37, v9
  v_mul_f32 v38, v38, v9
  v_mul_f32 v39, v39, v9
  v_mul_f32 v40, v40, v9
  v_mul_f32 v41, v41, v9
  v_mul_f32 v42, v42, v9
  v_mul_f32 v43, v43, v9
  v_mul_f32 v44, v44, v9
  v_mul_f32 v45, v45, v9
  v_mul_f32 v46, v46, v9
  v_mul_f32 v47, v47, v9
  v_cvt_pk_bf16_f32 v80, v16, v17
  v_cvt_pk_bf16_f32 v81, v18, v19
  v_cvt_pk_bf16_f32 v82, v20, v21
  v_cvt_pk_bf16_f32 v83, v22, v23
  v_cvt_pk_bf16_f32 v84, v24, v25
  v_cvt_pk_bf16_f32 v85, v26, v27
  v_cvt_pk_bf16_f32 v86, v28, v29
  v_cvt_pk_bf16_f32 v87, v30, v31
  v_cvt_pk_bf16_f32 v88, v32, v33
  v_cvt_pk_bf16_f32 v89, v34, v35
  v_cvt_pk_bf16_f32 v90, v36, v37
  v_cvt_pk_bf16_f32 v91, v38, v39
  v_cvt_pk_bf16_f32 v92, v40, v41
  v_cvt_pk_bf16_f32 v93, v42, v43
  v_cvt_pk_bf16_f32 v94, v44, v45
  v_cvt_pk_bf16_f32 v95, v46, v47
  s_add_u32 s41, s27, 0
  buffer_store_dwordx4 v[80:83], v7, s[4:7], s41 offen sc1
  s_add_u32 s41, s27, 8192
  buffer_store_dwordx4 v[84:87], v7, s[4:7], s41 offen sc1
  s_add_u32 s41, s27, 16384
  buffer_store_dwordx4 v[88:91], v7, s[4:7], s41 offen sc1
  s_add_u32 s41, s27, 24576
  buffer_store_dwordx4 v[92:95], v7, s[4:7], s41 offen sc1
  s_add_u32 s27, s27, 1048576
  s_waitcnt vmcnt(0)
  s_barrier
  s_cmp_lg_u32 s3, 0
  s_cbranch_scc1 iws_82
  s_and_b32 s40, s96, 1
  s_lshl_b32 s40, s40, 7
  v_mov_b32 v4, 1
  s_mov_b64 exec, 1
  buffer_atomic_add v4, off, s[92:95], s40 offset:64 sc1
  s_mov_b64 exec, -1
iws_82:
  s_mov_b32 s44, 3
  s_mov_b32 s45, s98
  s_cmp_lt_u32 s98, 38
  s_cbranch_scc1 r_proj_13
r_group_15:
  v_and_b32 v3, 1, v2
  v_lshlrev_b32 v3, 7, v3
  s_mov_b32 s89, 0
wi_83:
  buffer_load_dword v4, v3, s[92:95], 0 offen offset:64 sc1
  s_waitcnt vmcnt(0)
  v_readlane_b32 s80, v4, 0
  v_readlane_b32 s81, v4, 1
  s_nop 0
  s_add_u32 s80, s80, s81
  s_cmp_ge_u32 s80, 64
  s_cbranch_scc1 wid_84
  s_sleep 8
  s_add_u32 s89, s89, 1
  s_cmp_lt_u32 s89, 131072
  s_cbranch_scc1 wi_83
  s_branch mega_kernel_end
wid_84:
  s_mov_b32 s90, 0
pur_85:
  s_add_u32 s90, s90, 1
  s_cmp_gt_u32 s90, 131072
  s_cbranch_scc1 mega_kernel_end
  v_and_b32 v3, 7, v2
  v_lshlrev_b32 v3, 2, v3
  v_cmp_ne_u32 vcc, 0, v3
  v_add_u32 v4, 128, v3
  s_nop 0
  v_cndmask_b32 v3, 0, v4, vcc
  buffer_load_dword v4, v3, s[92:95], 0 offen sc1
  s_waitcnt vmcnt(0)
  v_readlane_b32 s80, v4, 0
  v_readlane_b32 s81, v4, 1
  v_readlane_b32 s82, v4, 2
  v_readlane_b32 s83, v4, 3
  v_readlane_b32 s84, v4, 4
  v_readlane_b32 s85, v4, 5
  v_readlane_b32 s86, v4, 6
  v_readlane_b32 s87, v4, 7
  s_add_u32 s88, s80, s81
  s_add_u32 s88, s88, s82
  s_add_u32 s88, s88, s83
  s_add_u32 s88, s88, s84
  s_add_u32 s88, s88, s85
  s_add_u32 s88, s88, s86
  s_add_u32 s88, s88, s87
  s_lshr_b32 s89, s96, 5
  v_readlane_b32 s89, v4, s89
  s_mov_b32 s91, 1
  s_cmp_ge_u32 s89, 32
  s_cbranch_scc1 purd_86
  s_mov_b32 s91, 0
  s_cmp_lt_u32 s88, 256
  s_cbranch_scc1 pur_85
purd_86:
  s_lshl_b32 s46, s97, 16
  s_cmp_lt_u32 s98, 8
  s_cbranch_scc1 r_rl2_20
  s_sub_u32 s98, s98, 8
  s_cmp_lt_u32 s98, 8
  s_cbranch_scc1 r_dn_18
  s_sub_u32 s98, s98, 8
  s_cmp_lt_u32 s98, 14
  s_cbranch_scc1 r_gu_17
  s_sub_u32 s98, s98, 14
  s_cmp_lt_u32 s98, 8
  s_cbranch_scc1 r_rl_19
  s_sub_u32 s98, s98, 8
  s_cmp_lt_u32 s98, 32
  s_cbranch_scc1 r_ao_16
  s_sub_u32 s98, s98, 32
  s_branch mega_kernel_end
r_ao_16:
  s_load_dwordx2 s[8:9], s[0:1], 40
  s_waitcnt lgkmcnt(0)
  s_mov_b32 s10, 4194304
  s_mov_b32 s11, 0x00020000
  s_and_b32 s41, s98, 1
  s_bfe_u32 s42, s98, 0x30001
  s_lshr_b32 s43, s98, 4
  s_lshl_b32 s24, s42, 19
  s_lshl_b32 s40, s41, 9
  s_add_u32 s24, s24, s40
  s_lshl_b32 s40, s3, 7
  s_add_u32 s24, s24, s40
  s_add_u32 s25, s24, 64
  s_lshl_b32 s27, s42, 15
  s_lshl_b32 s40, s97, 24
  s_add_u32 s27, s27, s40
  s_lshl_b32 s40, s41, 11
  s_add_u32 s27, s27, s40
  s_lshl_b32 s40, s3, 9
  s_add_u32 s27, s27, s40
  s_add_u32 s27, s27, 138412032
  s_mul_i32 s40, s43, 262144
  s_add_u32 s27, s27, s40
  s_mov_b32 s28, 32
  s_lshl_b32 s47, s42, 2
  s_add_u32 s47, s47, s3
  s_lshl_b32 s48, s43, 5
  s_add_u32 s48, s48, s47
  s_lshl_b32 s40, s48, 13
  s_mul_i32 s49, s97, 16777216
  s_add_u32 s40, s40, s49
  s_add_u32 s50, s40, 37748736
  s_add_u32 s51, s40, 71303168
  s_add_u32 s52, s40, 104857600
  s_lshl_b32 s40, s48, 11
  s_mul_i32 s49, s97, 4194304
  s_add_u32 s40, s40, s49
  s_add_u32 s53, s40, 20971520
  s_add_u32 s54, s40, 29360128
  s_lshl_b32 s49, s43, 10
  s_add_u32 s49, s49, s46
  s_lshl_b32 s40, s47, 4
  s_add_u32 s29, s49, s40
  s_add_u32 s29, s29, 131072
  s_lshr_b32 s40, s47, 1
  s_lshl_b32 s40, s40, 2
  s_add_u32 s55, s49, s40
  s_add_u32 s55, s55, 0
  s_and_b32 s40, s98, 15
  s_lshl_b32 s40, s40, 2
  s_add_u32 s30, s49, s40
  s_add_u32 s30, s30, 393216
  s_add_u32 s64, s49, 516096
  s_sub_u32 s64, s64, s29
  s_add_u32 s62, s27, 2097152
  v_lshrrev_b32 v3, 2, v2
  s_mov_b32 s31, 1024
  v_mul_lo_u32 v6, v3, s31
  v_and_b32 v3, 3, v2
  v_lshl_add_u32 v6, v3, 4, v6
  v_bfe_u32 v4, v2, 2, 2
  v_lshrrev_b32 v5, 5, v2
  v_lshl_add_u32 v4, v5, 3, v4
  v_lshlrev_b32 v7, 6, v4
  v_bfe_u32 v4, v2, 4, 1
  v_lshl_add_u32 v7, v4, 5, v7
  v_and_b32 v4, 1, v2
  v_lshl_add_u32 v7, v4, 4, v7
  v_bfe_u32 v4, v2, 1, 1
  v_lshl_add_u32 v7, v4, 3, v7
  s_lshl_b32 s31, s3, 15
  v_add_u32 v7, s31, v7
  v_mov_b32 v14, 1
  s_lshl_b32 s36, s3, 15
  s_add_u32 m0, s36, 0
  s_nop 0
  buffer_load_dwordx4 v6, s[8:11], s24 offen lds
  s_add_u32 s24, s24, 16384
  s_add_u32 m0, m0, 1024
  s_nop 0
  buffer_load_dwordx4 v6, s[8:11], s25 offen lds
  s_add_u32 s25, s25, 16384
  s_add_u32 m0, m0, 1024
  s_nop 0
  buffer_load_dwordx4 v6, s[8:11], s24 offen lds
  s_add_u32 s24, s24, 16384
  s_add_u32 m0, m0, 1024
  s_nop 0
  buffer_load_dwordx4 v6, s[8:11], s25 offen lds
  s_add_u32 s25, s25, 16384
  s_add_u32 m0, m0, 1024
  s_nop 0
  buffer_load_dwordx4 v6, s[8:11], s24 offen lds
  s_add_u32 s24, s24, 16384
  s_add_u32 m0, m0, 1024
  s_nop 0
  buffer_load_dwordx4 v6, s[8:11], s25 offen lds
  s_add_u32 s25, s25, 16384
  s_add_u32 m0, m0, 1024
  s_nop 0
  buffer_load_dwordx4 v6, s[8:11], s24 offen lds
  s_add_u32 s24, s24, 16384
  s_add_u32 m0, m0, 1024
  s_nop 0
  buffer_load_dwordx4 v6, s[8:11], s25 offen lds
  s_add_u32 s25, s25, 16384
  s_add_u32 m0, m0, 1024
  s_nop 0
  buffer_load_dwordx4 v6, s[8:11], s24 offen lds
  s_add_u32 s24, s24, 16384
  s_add_u32 m0, m0, 1024
  s_nop 0
  buffer_load_dwordx4 v6, s[8:11], s25 offen lds
  s_add_u32 s25, s25, 16384
  s_add_u32 m0, m0, 1024
  s_nop 0
  buffer_load_dwordx4 v6, s[8:11], s24 offen lds
  s_add_u32 s24, s24, 16384
  s_add_u32 m0, m0, 1024
  s_nop 0
  buffer_load_dwordx4 v6, s[8:11], s25 offen lds
  s_add_u32 s25, s25, 16384
  s_add_u32 m0, m0, 1024
  s_nop 0
  buffer_load_dwordx4 v6, s[8:11], s24 offen lds
  s_add_u32 s24, s24, 16384
  s_add_u32 m0, m0, 1024
  s_nop 0
  buffer_load_dwordx4 v6, s[8:11], s25 offen lds
  s_add_u32 s25, s25, 16384
  s_add_u32 m0, m0, 1024
  s_nop 0
  buffer_load_dwordx4 v6, s[8:11], s24 offen lds
  s_add_u32 s24, s24, 16384
  s_add_u32 m0, m0, 1024
  s_nop 0
  buffer_load_dwordx4 v6, s[8:11], s25 offen lds
  s_add_u32 s25, s25, 16384
  s_lshl_b32 s36, s3, 15
  s_add_u32 m0, s36, 16384
  s_nop 0
  buffer_load_dwordx4 v6, s[8:11], s24 offen lds
  s_add_u32 s24, s24, 16384
  s_add_u32 m0, m0, 1024
  s_nop 0
  buffer_load_dwordx4 v6, s[8:11], s25 offen lds
  s_add_u32 s25, s25, 16384
  s_add_u32 m0, m0, 1024
  s_nop 0
  buffer_load_dwordx4 v6, s[8:11], s24 offen lds
  s_add_u32 s24, s24, 16384
  s_add_u32 m0, m0, 1024
  s_nop 0
  buffer_load_dwordx4 v6, s[8:11], s25 offen lds
  s_add_u32 s25, s25, 16384
  s_add_u32 m0, m0, 1024
  s_nop 0
  buffer_load_dwordx4 v6, s[8:11], s24 offen lds
  s_add_u32 s24, s24, 16384
  s_add_u32 m0, m0, 1024
  s_nop 0
  buffer_load_dwordx4 v6, s[8:11], s25 offen lds
  s_add_u32 s25, s25, 16384
  s_add_u32 m0, m0, 1024
  s_nop 0
  buffer_load_dwordx4 v6, s[8:11], s24 offen lds
  s_add_u32 s24, s24, 16384
  s_add_u32 m0, m0, 1024
  s_nop 0
  buffer_load_dwordx4 v6, s[8:11], s25 offen lds
  s_add_u32 s25, s25, 16384
  s_add_u32 m0, m0, 1024
  s_nop 0
  buffer_load_dwordx4 v6, s[8:11], s24 offen lds
  s_add_u32 s24, s24, 16384
  s_add_u32 m0, m0, 1024
  s_nop 0
  buffer_load_dwordx4 v6, s[8:11], s25 offen lds
  s_add_u32 s25, s25, 16384
  s_add_u32 m0, m0, 1024
  s_nop 0
  buffer_load_dwordx4 v6, s[8:11], s24 offen lds
  s_add_u32 s24, s24, 16384
  s_add_u32 m0, m0, 1024
  s_nop 0
  buffer_load_dwordx4 v6, s[8:11], s25 offen lds
  s_add_u32 s25, s25, 16384
  s_add_u32 m0, m0, 1024
  s_nop 0
  buffer_load_dwordx4 v6, s[8:11], s24 offen lds
  s_add_u32 s24, s24, 16384
  s_add_u32 m0, m0, 1024
  s_nop 0
  buffer_load_dwordx4 v6, s[8:11], s25 offen lds
  s_add_u32 s25, s25, 16384
  s_add_u32 m0, m0, 1024
  s_nop 0
  buffer_load_dwordx4 v6, s[8:11], s24 offen lds
  s_add_u32 s24, s24, 16384
  s_add_u32 m0, m0, 1024
  s_nop 0
  buffer_load_dwordx4 v6, s[8:11], s25 offen lds
  s_add_u32 s25, s25, 16384
  s_waitcnt vmcnt(16)
  ds_read_b64_tr_b16 a[0:1], v7 offset:0
  ds_read_b64_tr_b16 a[2:3], v7 offset:256
  ds_read_b64_tr_b16 a[128:129], v7 offset:1024
  ds_read_b64_tr_b16 a[130:131], v7 offset:1280
  ds_read_b64_tr_b16 a[4:5], v7 offset:2048
  ds_read_b64_tr_b16 a[6:7], v7 offset:2304
  ds_read_b64_tr_b16 a[132:133], v7 offset:3072
  ds_read_b64_tr_b16 a[134:135], v7 offset:3328
  ds_read_b64_tr_b16 a[8:9], v7 offset:4096
  ds_read_b64_tr_b16 a[10:11], v7 offset:4352
  ds_read_b64_tr_b16 a[136:137], v7 offset:5120
  ds_read_b64_tr_b16 a[138:139], v7 offset:5376
  ds_read_b64_tr_b16 a[12:13], v7 offset:6144
  ds_read_b64_tr_b16 a[14:15], v7 offset:6400
  ds_read_b64_tr_b16 a[140:141], v7 offset:7168
  ds_read_b64_tr_b16 a[142:143], v7 offset:7424
  ds_read_b64_tr_b16 a[16:17], v7 offset:8192
  ds_read_b64_tr_b16 a[18:19], v7 offset:8448
  ds_read_b64_tr_b16 a[144:145], v7 offset:9216
  ds_read_b64_tr_b16 a[146:147], v7 offset:9472
  ds_read_b64_tr_b16 a[20:21], v7 offset:10240
  ds_read_b64_tr_b16 a[22:23], v7 offset:10496
  ds_read_b64_tr_b16 a[148:149], v7 offset:11264
  ds_read_b64_tr_b16 a[150:151], v7 offset:11520
  ds_read_b64_tr_b16 a[24:25], v7 offset:12288
  ds_read_b64_tr_b16 a[26:27], v7 offset:12544
  ds_read_b64_tr_b16 a[152:153], v7 offset:13312
  ds_read_b64_tr_b16 a[154:155], v7 offset:13568
  ds_read_b64_tr_b16 a[28:29], v7 offset:14336
  ds_read_b64_tr_b16 a[30:31], v7 offset:14592
  ds_read_b64_tr_b16 a[156:157], v7 offset:15360
  ds_read_b64_tr_b16 a[158:159], v7 offset:15616
  s_waitcnt lgkmcnt(0)
  s_lshl_b32 s36, s3, 15
  s_add_u32 m0, s36, 0
  s_nop 0
  buffer_load_dwordx4 v6, s[8:11], s24 offen lds
  s_add_u32 s24, s24, 16384
  s_add_u32 m0, m0, 1024
  s_nop 0
  buffer_load_dwordx4 v6, s[8:11], s25 offen lds
  s_add_u32 s25, s25, 16384
  s_add_u32 m0, m0, 1024
  s_nop 0
  buffer_load_dwordx4 v6, s[8:11], s24 offen lds
  s_add_u32 s24, s24, 16384
  s_add_u32 m0, m0, 1024
  s_nop 0
  buffer_load_dwordx4 v6, s[8:11], s25 offen lds
  s_add_u32 s25, s25, 16384
  s_add_u32 m0, m0, 1024
  s_nop 0
  buffer_load_dwordx4 v6, s[8:11], s24 offen lds
  s_add_u32 s24, s24, 16384
  s_add_u32 m0, m0, 1024
  s_nop 0
  buffer_load_dwordx4 v6, s[8:11], s25 offen lds
  s_add_u32 s25, s25, 16384
  s_add_u32 m0, m0, 1024
  s_nop 0
  buffer_load_dwordx4 v6, s[8:11], s24 offen lds
  s_add_u32 s24, s24, 16384
  s_add_u32 m0, m0, 1024
  s_nop 0
  buffer_load_dwordx4 v6, s[8:11], s25 offen lds
  s_add_u32 s25, s25, 16384
  s_add_u32 m0, m0, 1024
  s_nop 0
  buffer_load_dwordx4 v6, s[8:11], s24 offen lds
  s_add_u32 s24, s24, 16384
  s_add_u32 m0, m0, 1024
  s_nop 0
  buffer_load_dwordx4 v6, s[8:11], s25 offen lds
  s_add_u32 s25, s25, 16384
  s_add_u32 m0, m0, 1024
  s_nop 0
  buffer_load_dwordx4 v6, s[8:11], s24 offen lds
  s_add_u32 s24, s24, 16384
  s_add_u32 m0, m0, 1024
  s_nop 0
  buffer_load_dwordx4 v6, s[8:11], s25 offen lds
  s_add_u32 s25, s25, 16384
  s_add_u32 m0, m0, 1024
  s_nop 0
  buffer_load_dwordx4 v6, s[8:11], s24 offen lds
  s_add_u32 s24, s24, 16384
  s_add_u32 m0, m0, 1024
  s_nop 0
  buffer_load_dwordx4 v6, s[8:11], s25 offen lds
  s_add_u32 s25, s25, 16384
  s_add_u32 m0, m0, 1024
  s_nop 0
  buffer_load_dwordx4 v6, s[8:11], s24 offen lds
  s_add_u32 s24, s24, 16384
  s_add_u32 m0, m0, 1024
  s_nop 0
  buffer_load_dwordx4 v6, s[8:11], s25 offen lds
  s_add_u32 s25, s25, 16384
  s_waitcnt vmcnt(16)
  ds_read_b64_tr_b16 a[32:33], v7 offset:16384
  ds_read_b64_tr_b16 a[34:35], v7 offset:16640
  ds_read_b64_tr_b16 a[160:161], v7 offset:17408
  ds_read_b64_tr_b16 a[162:163], v7 offset:17664
  ds_read_b64_tr_b16 a[36:37], v7 offset:18432
  ds_read_b64_tr_b16 a[38:39], v7 offset:18688
  ds_read_b64_tr_b16 a[164:165], v7 offset:19456
  ds_read_b64_tr_b16 a[166:167], v7 offset:19712
  ds_read_b64_tr_b16 a[40:41], v7 offset:20480
  ds_read_b64_tr_b16 a[42:43], v7 offset:20736
  ds_read_b64_tr_b16 a[168:169], v7 offset:21504
  ds_read_b64_tr_b16 a[170:171], v7 offset:21760
  ds_read_b64_tr_b16 a[44:45], v7 offset:22528
  ds_read_b64_tr_b16 a[46:47], v7 offset:22784
  ds_read_b64_tr_b16 a[172:173], v7 offset:23552
  ds_read_b64_tr_b16 a[174:175], v7 offset:23808
  ds_read_b64_tr_b16 a[48:49], v7 offset:24576
  ds_read_b64_tr_b16 a[50:51], v7 offset:24832
  ds_read_b64_tr_b16 a[176:177], v7 offset:25600
  ds_read_b64_tr_b16 a[178:179], v7 offset:25856
  ds_read_b64_tr_b16 a[52:53], v7 offset:26624
  ds_read_b64_tr_b16 a[54:55], v7 offset:26880
  ds_read_b64_tr_b16 a[180:181], v7 offset:27648
  ds_read_b64_tr_b16 a[182:183], v7 offset:27904
  ds_read_b64_tr_b16 a[56:57], v7 offset:28672
  ds_read_b64_tr_b16 a[58:59], v7 offset:28928
  ds_read_b64_tr_b16 a[184:185], v7 offset:29696
  ds_read_b64_tr_b16 a[186:187], v7 offset:29952
  ds_read_b64_tr_b16 a[60:61], v7 offset:30720
  ds_read_b64_tr_b16 a[62:63], v7 offset:30976
  ds_read_b64_tr_b16 a[188:189], v7 offset:31744
  ds_read_b64_tr_b16 a[190:191], v7 offset:32000
  s_waitcnt lgkmcnt(0)
  s_lshl_b32 s36, s3, 15
  s_add_u32 m0, s36, 16384
  s_nop 0
  buffer_load_dwordx4 v6, s[8:11], s24 offen lds
  s_add_u32 s24, s24, 16384
  s_add_u32 m0, m0, 1024
  s_nop 0
  buffer_load_dwordx4 v6, s[8:11], s25 offen lds
  s_add_u32 s25, s25, 16384
  s_add_u32 m0, m0, 1024
  s_nop 0
  buffer_load_dwordx4 v6, s[8:11], s24 offen lds
  s_add_u32 s24, s24, 16384
  s_add_u32 m0, m0, 1024
  s_nop 0
  buffer_load_dwordx4 v6, s[8:11], s25 offen lds
  s_add_u32 s25, s25, 16384
  s_add_u32 m0, m0, 1024
  s_nop 0
  buffer_load_dwordx4 v6, s[8:11], s24 offen lds
  s_add_u32 s24, s24, 16384
  s_add_u32 m0, m0, 1024
  s_nop 0
  buffer_load_dwordx4 v6, s[8:11], s25 offen lds
  s_add_u32 s25, s25, 16384
  s_add_u32 m0, m0, 1024
  s_nop 0
  buffer_load_dwordx4 v6, s[8:11], s24 offen lds
  s_add_u32 s24, s24, 16384
  s_add_u32 m0, m0, 1024
  s_nop 0
  buffer_load_dwordx4 v6, s[8:11], s25 offen lds
  s_add_u32 s25, s25, 16384
  s_add_u32 m0, m0, 1024
  s_nop 0
  buffer_load_dwordx4 v6, s[8:11], s24 offen lds
  s_add_u32 s24, s24, 16384
  s_add_u32 m0, m0, 1024
  s_nop 0
  buffer_load_dwordx4 v6, s[8:11], s25 offen lds
  s_add_u32 s25, s25, 16384
  s_add_u32 m0, m0, 1024
  s_nop 0
  buffer_load_dwordx4 v6, s[8:11], s24 offen lds
  s_add_u32 s24, s24, 16384
  s_add_u32 m0, m0, 1024
  s_nop 0
  buffer_load_dwordx4 v6, s[8:11], s25 offen lds
  s_add_u32 s25, s25, 16384
  s_add_u32 m0, m0, 1024
  s_nop 0
  buffer_load_dwordx4 v6, s[8:11], s24 offen lds
  s_add_u32 s24, s24, 16384
  s_add_u32 m0, m0, 1024
  s_nop 0
  buffer_load_dwordx4 v6, s[8:11], s25 offen lds
  s_add_u32 s25, s25, 16384
  s_add_u32 m0, m0, 1024
  s_nop 0
  buffer_load_dwordx4 v6, s[8:11], s24 offen lds
  s_add_u32 s24, s24, 16384
  s_add_u32 m0, m0, 1024
  s_nop 0
  buffer_load_dwordx4 v6, s[8:11], s25 offen lds
  s_add_u32 s25, s25, 16384
  s_waitcnt vmcnt(16)
  ds_read_b64_tr_b16 a[64:65], v7 offset:0
  ds_read_b64_tr_b16 a[66:67], v7 offset:256
  ds_read_b64_tr_b16 a[192:193], v7 offset:1024
  ds_read_b64_tr_b16 a[194:195], v7 offset:1280
  ds_read_b64_tr_b16 a[68:69], v7 offset:2048
  ds_read_b64_tr_b16 a[70:71], v7 offset:2304
  ds_read_b64_tr_b16 a[196:197], v7 offset:3072
  ds_read_b64_tr_b16 a[198:199], v7 offset:3328
  ds_read_b64_tr_b16 a[72:73], v7 offset:4096
  ds_read_b64_tr_b16 a[74:75], v7 offset:4352
  ds_read_b64_tr_b16 a[200:201], v7 offset:5120
  ds_read_b64_tr_b16 a[202:203], v7 offset:5376
  ds_read_b64_tr_b16 a[76:77], v7 offset:6144
  ds_read_b64_tr_b16 a[78:79], v7 offset:6400
  ds_read_b64_tr_b16 a[204:205], v7 offset:7168
  ds_read_b64_tr_b16 a[206:207], v7 offset:7424
  ds_read_b64_tr_b16 a[80:81], v7 offset:8192
  ds_read_b64_tr_b16 a[82:83], v7 offset:8448
  ds_read_b64_tr_b16 a[208:209], v7 offset:9216
  ds_read_b64_tr_b16 a[210:211], v7 offset:9472
  ds_read_b64_tr_b16 a[84:85], v7 offset:10240
  ds_read_b64_tr_b16 a[86:87], v7 offset:10496
  ds_read_b64_tr_b16 a[212:213], v7 offset:11264
  ds_read_b64_tr_b16 a[214:215], v7 offset:11520
  ds_read_b64_tr_b16 a[88:89], v7 offset:12288
  ds_read_b64_tr_b16 a[90:91], v7 offset:12544
  ds_read_b64_tr_b16 a[216:217], v7 offset:13312
  ds_read_b64_tr_b16 a[218:219], v7 offset:13568
  ds_read_b64_tr_b16 a[92:93], v7 offset:14336
  ds_read_b64_tr_b16 a[94:95], v7 offset:14592
  ds_read_b64_tr_b16 a[220:221], v7 offset:15360
  ds_read_b64_tr_b16 a[222:223], v7 offset:15616
  s_waitcnt lgkmcnt(0)
  s_waitcnt vmcnt(0)
  ds_read_b64_tr_b16 a[96:97], v7 offset:16384
  ds_read_b64_tr_b16 a[98:99], v7 offset:16640
  ds_read_b64_tr_b16 a[224:225], v7 offset:17408
  ds_read_b64_tr_b16 a[226:227], v7 offset:17664
  ds_read_b64_tr_b16 a[100:101], v7 offset:18432
  ds_read_b64_tr_b16 a[102:103], v7 offset:18688
  ds_read_b64_tr_b16 a[228:229], v7 offset:19456
  ds_read_b64_tr_b16 a[230:231], v7 offset:19712
  ds_read_b64_tr_b16 a[104:105], v7 offset:20480
  ds_read_b64_tr_b16 a[106:107], v7 offset:20736
  ds_read_b64_tr_b16 a[232:233], v7 offset:21504
  ds_read_b64_tr_b16 a[234:235], v7 offset:21760
  ds_read_b64_tr_b16 a[108:109], v7 offset:22528
  ds_read_b64_tr_b16 a[110:111], v7 offset:22784
  ds_read_b64_tr_b16 a[236:237], v7 offset:23552
  ds_read_b64_tr_b16 a[238:239], v7 offset:23808
  ds_read_b64_tr_b16 a[112:113], v7 offset:24576
  ds_read_b64_tr_b16 a[114:115], v7 offset:24832
  ds_read_b64_tr_b16 a[240:241], v7 offset:25600
  ds_read_b64_tr_b16 a[242:243], v7 offset:25856
  ds_read_b64_tr_b16 a[116:117], v7 offset:26624
  ds_read_b64_tr_b16 a[118:119], v7 offset:26880
  ds_read_b64_tr_b16 a[244:245], v7 offset:27648
  ds_read_b64_tr_b16 a[246:247], v7 offset:27904
  ds_read_b64_tr_b16 a[120:121], v7 offset:28672
  ds_read_b64_tr_b16 a[122:123], v7 offset:28928
  ds_read_b64_tr_b16 a[248:249], v7 offset:29696
  ds_read_b64_tr_b16 a[250:251], v7 offset:29952
  ds_read_b64_tr_b16 a[124:125], v7 offset:30720
  ds_read_b64_tr_b16 a[126:127], v7 offset:30976
  ds_read_b64_tr_b16 a[252:253], v7 offset:31744
  ds_read_b64_tr_b16 a[254:255], v7 offset:32000
  s_waitcnt lgkmcnt(0)
  v_mov_b32 v8, v1
  v_bfe_u32 v3, v2, 2, 3
  v_lshlrev_b32 v9, 12, v3
  v_lshrrev_b32 v4, 5, v2
  v_lshl_add_u32 v9, v4, 6, v9
  v_and_b32 v3, 3, v2
  v_lshl_add_u32 v9, v3, 4, v9
  v_mov_b32 v14, v9
  v_and_b32 v3, 0x13, v2
  v_bfe_u32 v4, v2, 2, 1
  v_lshl_or_b32 v3, v4, 3, v3
  v_bfe_u32 v4, v2, 3, 1
  v_lshl_or_b32 v3, v4, 2, v3
  v_lshrrev_b32 v4, 5, v2
  v_lshlrev_b32 v6, 4, v3
  v_lshl_add_u32 v6, v4, 9, v6
  v_lshlrev_b32 v8, 4, v3
  v_lshl_add_u32 v8, v4, 11, v8
  v_lshlrev_b32 v9, 3, v3
  v_lshl_add_u32 v9, v4, 10, v9
  v_and_b32 v5, 7, v2
  v_lshlrev_b32 v7, 4, v5
  v_lshl_add_u32 v7, v4, 7, v7
  v_and_b32 v5, 31, v2
  v_lshlrev_b32 v4, 3, v4
  v_sub_u32 v5, v5, v4
  v_mov_b32 v3, 0xf149f2ca
  v_cmp_gt_i32 vcc, 0, v5
  s_nop 1
  v_cndmask_b32 v16, 0, v3, vcc
  v_cmp_gt_i32 vcc, 1, v5
  s_nop 1
  v_cndmask_b32 v17, 0, v3, vcc
  v_cmp_gt_i32 vcc, 2, v5
  s_nop 1
  v_cndmask_b32 v18, 0, v3, vcc
  v_cmp_gt_i32 vcc, 3, v5
  s_nop 1
  v_cndmask_b32 v19, 0, v3, vcc
  v_cmp_gt_i32 vcc, 4, v5
  s_nop 1
  v_cndmask_b32 v20, 0, v3, vcc
  v_cmp_gt_i32 vcc, 5, v5
  s_nop 1
  v_cndmask_b32 v21, 0, v3, vcc
  v_cmp_gt_i32 vcc, 6, v5
  s_nop 1
  v_cndmask_b32 v22, 0, v3, vcc
  v_cmp_gt_i32 vcc, 7, v5
  s_nop 1
  v_cndmask_b32 v23, 0, v3, vcc
  v_cmp_gt_i32 vcc, 16, v5
  s_nop 1
  v_cndmask_b32 v24, 0, v3, vcc
  v_cmp_gt_i32 vcc, 17, v5
  s_nop 1
  v_cndmask_b32 v25, 0, v3, vcc
  v_cmp_gt_i32 vcc, 18, v5
  s_nop 1
  v_cndmask_b32 v26, 0, v3, vcc
  v_cmp_gt_i32 vcc, 19, v5
  s_nop 1
  v_cndmask_b32 v27, 0, v3, vcc
  v_cmp_gt_i32 vcc, 20, v5
  s_nop 1
  v_cndmask_b32 v28, 0, v3, vcc
  v_cmp_gt_i32 vcc, 21, v5
  s_nop 1
  v_cndmask_b32 v29, 0, v3, vcc
  v_cmp_gt_i32 vcc, 22, v5
  s_nop 1
  v_cndmask_b32 v30, 0, v3, vcc
  v_cmp_gt_i32 vcc, 23, v5
  s_nop 1
  v_cndmask_b32 v31, 0, v3, vcc
  v_mov_b32 v162, 0
  v_mov_b32 v163, 0
  v_mov_b32 v166, 0
  v_mov_b32 v167, 0
  v_mov_b32 v170, 0
  v_mov_b32 v171, 0
  v_mov_b32 v174, 0
  v_mov_b32 v175, 0
  v_mov_b32 v218, 0
  v_mov_b32 v219, 0
  v_mov_b32 v12, 1
  s_mov_b32 s40, 0x3e0293ee
  v_mov_b32 v10, 0
  s_mov_b32 s63, 0
  v_subrev_u32 v3, 1, v2
  v_cmp_gt_u32 vcc, 4, v3
  v_lshlrev_b32 v3, 2, v3
  v_add_u32 v3, s64, v3
  v_cndmask_b32 v242, v10, v3, vcc
  v_min_u32 v3, 2, v2
  v_lshlrev_b32 v13, 6, v3
  s_lshl_b32 s31, s3, 13
  v_add_u32 v15, s31, v1
  v_mov_b32 v240, v1
  v_mov_b32 v236, 163584
  v_mov_b32 v238, 0
  ds_write_b32 v236, v238
  ds_write_b32 v236, v238 offset:4
  ds_write_b32 v236, v238 offset:8
  s_waitcnt lgkmcnt(0)
  v_mov_b32 v238, 1
  v_mov_b32 v237, 163584
  s_barrier
  s_cmp_eq_u32 s91, 0
  s_cbranch_scc1 aog_87
  s_mov_b32 s35, 0
poll_88:
  buffer_load_dword v11, v13, s[4:7], s55 offen sc1
  s_waitcnt vmcnt(0)
  v_cmp_ne_u32 vcc, 0, v11
  s_nop 0
  s_cmp_eq_u64 vcc, exec
  s_cbranch_scc1 polld_89
  s_sleep 8
  s_add_u32 s35, s35, 1
  s_cmp_lt_u32 s35, 131072
  s_cbranch_scc1 poll_88
  s_branch mega_kernel_end
polld_89:
  s_mov_b32 s56, s50
  s_mov_b32 s58, s51
  s_mov_b32 s60, s52
  s_add_u32 s57, s56, 4096
  s_add_u32 s59, s58, 4096
  s_add_u32 s61, s60, 4096
  buffer_load_dwordx4 v[64:67], v6, s[4:7], s58 offen offset:0 sc1
  buffer_load_dwordx4 v[32:35], v1, s[4:7], s56 offen offset:0 sc1
  buffer_load_dwordx4 v[68:71], v6, s[4:7], s58 offen offset:1024 sc1
  buffer_load_dwordx4 v[36:39], v1, s[4:7], s56 offen offset:1024 sc1
  buffer_load_dwordx4 v[72:75], v6, s[4:7], s58 offen offset:2048 sc1
  buffer_load_dwordx4 v[40:43], v1, s[4:7], s56 offen offset:2048 sc1
  buffer_load_dwordx4 v[76:79], v6, s[4:7], s58 offen offset:3072 sc1
  buffer_load_dwordx4 v[44:47], v1, s[4:7], s56 offen offset:3072 sc1
  buffer_load_dwordx4 v[80:83], v6, s[4:7], s59 offen offset:0 sc1
  buffer_load_dwordx4 v[48:51], v1, s[4:7], s57 offen offset:0 sc1
  buffer_load_dwordx4 v[84:87], v6, s[4:7], s59 offen offset:1024 sc1
  buffer_load_dwordx4 v[52:55], v1, s[4:7], s57 offen offset:1024 sc1
  buffer_load_dwordx4 v[88:91], v6, s[4:7], s59 offen offset:2048 sc1
  buffer_load_dwordx4 v[56:59], v1, s[4:7], s57 offen offset:2048 sc1
  buffer_load_dwordx4 v[92:95], v6, s[4:7], s59 offen offset:3072 sc1
  buffer_load_dwordx4 v[60:63], v1, s[4:7], s57 offen offset:3072 sc1
  buffer_load_dwordx4 v[128:131], v8, s[4:7], s60 offen offset:0 sc1
  buffer_load_dwordx4 v[132:135], v8, s[4:7], s61 offen offset:0 sc1
  buffer_load_dwordx4 v[136:139], v8, s[4:7], s60 offen offset:512 sc1
  buffer_load_dwordx4 v[140:143], v8, s[4:7], s61 offen offset:512 sc1
  buffer_load_dwordx4 v[144:147], v8, s[4:7], s60 offen offset:1024 sc1
  buffer_load_dwordx4 v[148:151], v8, s[4:7], s61 offen offset:1024 sc1
  buffer_load_dwordx4 v[152:155], v8, s[4:7], s60 offen offset:1536 sc1
  buffer_load_dwordx4 v[156:159], v8, s[4:7], s61 offen offset:1536 sc1
  s_add_u32 s50, s50, 524288
  s_add_u32 s51, s51, 524288
  s_add_u32 s52, s52, 524288
  s_add_u32 s55, s55, 2048
  s_mov_b32 s34, 0
aotop_90:
  s_sub_u32 s28, s28, 1
  buffer_load_dword v11, v10, s[4:7], s29 offen sc1
  s_waitcnt vmcnt(9)
  v_mfma_f32_32x32x16_bf16 v[176:191], v[64:67], v[32:35], 0
  v_mfma_f32_32x32x16_bf16 v[176:191], v[68:71], v[36:39], v[176:191]
  v_mfma_f32_32x32x16_bf16 v[176:191], v[72:75], v[40:43], v[176:191]
  v_mfma_f32_32x32x16_bf16 v[176:191], v[76:79], v[44:47], v[176:191]
  v_mfma_f32_32x32x16_bf16 v[176:191], v[80:83], v[48:51], v[176:191]
  v_mfma_f32_32x32x16_bf16 v[176:191], v[84:87], v[52:55], v[176:191]
  v_mfma_f32_32x32x16_bf16 v[176:191], v[88:91], v[56:59], v[176:191]
  v_mfma_f32_32x32x16_bf16 v[176:191], v[92:95], v[60:63], v[176:191]
  s_nop 11
  v_fma_f32 v176, v176, s40, v16
  v_fma_f32 v177, v177, s40, v17
  v_fma_f32 v178, v178, s40, v18
  v_fma_f32 v179, v179, s40, v19
  v_fma_f32 v180, v180, s40, v20
  v_fma_f32 v181, v181, s40, v21
  v_fma_f32 v182, v182, s40, v22
  v_fma_f32 v183, v183, s40, v23
  v_fma_f32 v184, v184, s40, v24
  v_fma_f32 v185, v185, s40, v25
  v_fma_f32 v186, v186, s40, v26
  v_fma_f32 v187, v187, s40, v27
  v_fma_f32 v188, v188, s40, v28
  v_fma_f32 v189, v189, s40, v29
  v_fma_f32 v190, v190, s40, v30
  v_fma_f32 v191, v191, s40, v31
  v_max3_f32 v3, v176, v177, v178
  v_max3_f32 v3, v3, v179, v180
  v_max3_f32 v3, v3, v181, v182
  v_max3_f32 v3, v3, v183, v184
  v_max3_f32 v3, v3, v185, v186
  v_max3_f32 v3, v3, v187, v188
  v_max3_f32 v3, v3, v189, v190
  v_max_f32 v3, v3, v191
  s_waitcnt vmcnt(0)
  s_cmp_eq_u32 s34, 0
  s_cbranch_scc1 aons_91
  s_mov_b64 exec, 1
  ds_add_rtn_u32 v239, v237, v238
  s_waitcnt lgkmcnt(0)
  v_readfirstlane_b32 s31, v239
  s_mov_b64 exec, -1
  v_xor_b32 v237, 8, v237
  s_and_b32 s31, s31, 3
  s_cmp_lg_u32 s31, 3
  s_cbranch_scc1 agg_92
  s_mov_b64 exec, 1
  buffer_store_dword v12, off, s[4:7], s30
  s_mov_b64 exec, -1
agg_92:
  s_add_u32 s30, s30, 2048
  s_mov_b32 s34, 0
aons_91:
  v_cmp_ne_u32 vcc, 0, v11
  s_nop 0
  s_cmp_eq_u64 vcc, exec
  s_cbranch_scc1 aogo_93
  s_mov_b32 s35, 0
poll_94:
  buffer_load_dword v11, v10, s[4:7], s29 offen sc1
  s_waitcnt vmcnt(0)
  v_cmp_ne_u32 vcc, 0, v11
  s_nop 0
  s_cmp_eq_u64 vcc, exec
  s_cbranch_scc1 polld_95
  s_sleep 2
  s_add_u32 s35, s35, 1
  s_cmp_lt_u32 s35, 131072
  s_cbranch_scc1 poll_94
  s_branch mega_kernel_end
polld_95:
aogo_93:
  s_add_u32 s29, s29, 2048
  s_add_u32 s63, s63, 1
  s_cmp_ge_u32 s63, 4
  s_cselect_b64 vcc, -1, 0
  v_cndmask_b32 v10, v10, v242, vcc
  buffer_load_dwordx4 v[96:99], v7, s[4:7], s53 offen offset:0 sc1
  buffer_load_dwordx4 v[100:103], v7, s[4:7], s53 offen offset:256 sc1
  buffer_load_dwordx4 v[104:107], v7, s[4:7], s53 offen offset:512 sc1
  buffer_load_dwordx4 v[108:111], v7, s[4:7], s53 offen offset:768 sc1
  buffer_load_dwordx4 v[112:115], v7, s[4:7], s53 offen offset:1024 sc1
  buffer_load_dwordx4 v[116:119], v7, s[4:7], s53 offen offset:1280 sc1
  buffer_load_dwordx4 v[120:123], v7, s[4:7], s53 offen offset:1536 sc1
  buffer_load_dwordx4 v[124:127], v7, s[4:7], s53 offen offset:1792 sc1
  buffer_load_dwordx2 v[160:161], v9, s[4:7], s54 offen offset:0 sc1
  buffer_load_dwordx2 v[164:165], v9, s[4:7], s54 offen offset:256 sc1
  buffer_load_dwordx2 v[168:169], v9, s[4:7], s54 offen offset:512 sc1
  buffer_load_dwordx2 v[172:173], v9, s[4:7], s54 offen offset:768 sc1
  buffer_load_dword v241, v13, s[4:7], s55 offen sc1
  s_add_u32 s53, s53, 131072
  s_add_u32 s54, s54, 131072
  s_waitcnt vmcnt(12)
  v_mfma_f32_32x32x16_bf16 v[192:207], v[96:99], v[32:35], 0
  s_waitcnt vmcnt(11)
  v_mfma_f32_32x32x16_bf16 v[192:207], v[100:103], v[36:39], v[192:207]
  s_waitcnt vmcnt(10)
  v_mfma_f32_32x32x16_bf16 v[192:207], v[104:107], v[40:43], v[192:207]
  s_waitcnt vmcnt(9)
  v_mfma_f32_32x32x16_bf16 v[192:207], v[108:111], v[44:47], v[192:207]
  s_waitcnt vmcnt(8)
  v_mfma_f32_32x32x16_bf16 v[192:207], v[112:115], v[48:51], v[192:207]
  s_waitcnt vmcnt(7)
  v_mfma_f32_32x32x16_bf16 v[192:207], v[116:119], v[52:55], v[192:207]
  s_waitcnt vmcnt(6)
  v_mfma_f32_32x32x16_bf16 v[192:207], v[120:123], v[56:59], v[192:207]
  s_waitcnt vmcnt(5)
  v_mfma_f32_32x32x16_bf16 v[192:207], v[124:127], v[60:63], v[192:207]
  s_nop 11
  v_mul_f32 v192, s40, v192
  v_mul_f32 v193, s40, v193
  v_mul_f32 v194, s40, v194
  v_mul_f32 v195, s40, v195
  v_max3_f32 v3, v3, v192, v193
  v_max3_f32 v3, v3, v194, v195
  v_mov_b32 v4, v3
  s_nop 1
  v_permlane32_swap_b32 v3, v4
  v_max_f32 v3, v3, v4
  v_sub_f32 v176, v176, v3
  v_sub_f32 v177, v177, v3
  v_sub_f32 v178, v178, v3
  v_sub_f32 v179, v179, v3
  v_sub_f32 v180, v180, v3
  v_sub_f32 v181, v181, v3
  v_sub_f32 v182, v182, v3
  v_sub_f32 v183, v183, v3
  v_sub_f32 v184, v184, v3
  v_sub_f32 v185, v185, v3
  v_sub_f32 v186, v186, v3
  v_sub_f32 v187, v187, v3
  v_sub_f32 v188, v188, v3
  v_sub_f32 v189, v189, v3
  v_sub_f32 v190, v190, v3
  v_sub_f32 v191, v191, v3
  v_sub_f32 v192, v192, v3
  v_sub_f32 v193, v193, v3
  v_sub_f32 v194, v194, v3
  v_sub_f32 v195, v195, v3
  v_exp_f32 v176, v176
  v_exp_f32 v177, v177
  v_exp_f32 v178, v178
  v_exp_f32 v179, v179
  v_exp_f32 v180, v180
  v_exp_f32 v181, v181
  v_exp_f32 v182, v182
  v_exp_f32 v183, v183
  v_exp_f32 v184, v184
  v_exp_f32 v185, v185
  v_exp_f32 v186, v186
  v_exp_f32 v187, v187
  v_exp_f32 v188, v188
  v_exp_f32 v189, v189
  v_exp_f32 v190, v190
  v_exp_f32 v191, v191
  v_exp_f32 v192, v192
  v_exp_f32 v193, v193
  v_exp_f32 v194, v194
  v_exp_f32 v195, v195
  v_add_f32 v4, v176, v177
  v_add_f32 v5, v178, v179
  v_add_f32 v4, v4, v180
  v_add_f32 v5, v5, v181
  v_add_f32 v4, v4, v182
  v_add_f32 v5, v5, v183
  v_add_f32 v4, v4, v184
  v_add_f32 v5, v5, v185
  v_add_f32 v4, v4, v186
  v_add_f32 v5, v5, v187
  v_add_f32 v4, v4, v188
  v_add_f32 v5, v5, v189
  v_add_f32 v4, v4, v190
  v_add_f32 v5, v5, v191
  v_add_f32 v4, v4, v192
  v_add_f32 v5, v5, v193
  v_add_f32 v4, v4, v194
  v_add_f32 v5, v5, v195
  v_add_f32 v4, v4, v5
  v_mov_b32 v5, v4
  s_nop 1
  v_permlane32_swap_b32 v4, v5
  v_add_f32 v4, v4, v5
  v_rcp_f32 v4, v4
  s_nop 0
  v_mul_f32 v176, v176, v4
  v_mul_f32 v177, v177, v4
  v_mul_f32 v178, v178, v4
  v_mul_f32 v179, v179, v4
  v_mul_f32 v180, v180, v4
  v_mul_f32 v181, v181, v4
  v_mul_f32 v182, v182, v4
  v_mul_f32 v183, v183, v4
  v_mul_f32 v184, v184, v4
  v_mul_f32 v185, v185, v4
  v_mul_f32 v186, v186, v4
  v_mul_f32 v187, v187, v4
  v_mul_f32 v188, v188, v4
  v_mul_f32 v189, v189, v4
  v_mul_f32 v190, v190, v4
  v_mul_f32 v191, v191, v4
  v_mul_f32 v192, v192, v4
  v_mul_f32 v193, v193, v4
  v_mul_f32 v194, v194, v4
  v_mul_f32 v195, v195, v4
  v_cvt_pk_bf16_f32 v208, v176, v177
  v_cvt_pk_bf16_f32 v209, v178, v179
  v_cvt_pk_bf16_f32 v210, v180, v181
  v_cvt_pk_bf16_f32 v211, v182, v183
  v_cvt_pk_bf16_f32 v212, v184, v185
  v_cvt_pk_bf16_f32 v213, v186, v187
  v_cvt_pk_bf16_f32 v214, v188, v189
  v_cvt_pk_bf16_f32 v215, v190, v191
  v_cvt_pk_bf16_f32 v216, v192, v193
  v_cvt_pk_bf16_f32 v217, v194, v195
  s_waitcnt vmcnt(0)
  v_mfma_f32_32x32x16_bf16 v[32:47], v[128:131], v[208:211], 0
  v_mfma_f32_32x32x16_bf16 v[32:47], v[132:135], v[212:215], v[32:47]
  v_mfma_f32_32x32x16_bf16 v[32:47], v[160:163], v[216:219], v[32:47]
  v_mfma_f32_32x32x16_bf16 v[48:63], v[136:139], v[208:211], 0
  v_mfma_f32_32x32x16_bf16 v[48:63], v[140:143], v[212:215], v[48:63]
  v_mfma_f32_32x32x16_bf16 v[48:63], v[164:167], v[216:219], v[48:63]
  v_mfma_f32_32x32x16_bf16 v[64:79], v[144:147], v[208:211], 0
  s_nop 7
  v_cvt_pk_bf16_f32 v96, v32, v33
  v_cvt_pk_bf16_f32 v97, v34, v35
  v_cvt_pk_bf16_f32 v98, v36, v37
  v_cvt_pk_bf16_f32 v99, v38, v39
  v_mfma_f32_32x32x16_bf16 v[64:79], v[148:151], v[212:215], v[64:79]
  ds_write_b128 v15, v[96:99] offset:0
  v_cvt_pk_bf16_f32 v100, v40, v41
  v_cvt_pk_bf16_f32 v101, v42, v43
  v_cvt_pk_bf16_f32 v102, v44, v45
  v_mfma_f32_32x32x16_bf16 v[64:79], v[168:171], v[216:219], v[64:79]
  v_cvt_pk_bf16_f32 v103, v46, v47
  ds_write_b128 v15, v[100:103] offset:1024
  v_mfma_f32_32x32x16_bf16 v[80:95], v[152:155], v[208:211], 0
  v_cvt_pk_bf16_f32 v104, v48, v49
  v_cvt_pk_bf16_f32 v105, v50, v51
  v_cvt_pk_bf16_f32 v106, v52, v53
  v_cvt_pk_bf16_f32 v107, v54, v55
  v_mfma_f32_32x32x16_bf16 v[80:95], v[156:159], v[212:215], v[80:95]
  ds_write_b128 v15, v[104:107] offset:2048
  v_cvt_pk_bf16_f32 v108, v56, v57
  v_cvt_pk_bf16_f32 v109, v58, v59
  v_cvt_pk_bf16_f32 v110, v60, v61
  v_mfma_f32_32x32x16_bf16 v[80:95], v[172:175], v[216:219], v[80:95]
  v_cvt_pk_bf16_f32 v111, v62, v63
  ds_write_b128 v15, v[108:111] offset:3072
  v_cmp_ne_u32 vcc, 0, v241
  s_nop 0
  s_cmp_eq_u64 vcc, exec
  s_cselect_b32 s33, 1, 0
  s_cmp_eq_u32 s28, 0
  s_cselect_b32 s33, 0, s33
  s_cmp_eq_u32 s33, 1
  s_cselect_b32 s56, s50, 2146435072
  s_cselect_b32 s58, s51, 2146435072
  s_cselect_b32 s60, s52, 2146435072
  s_add_u32 s57, s56, 4096
  s_add_u32 s59, s58, 4096
  s_add_u32 s61, s60, 4096
  v_cvt_pk_bf16_f32 v112, v64, v65
  v_cvt_pk_bf16_f32 v113, v66, v67
  v_cvt_pk_bf16_f32 v114, v68, v69
  v_cvt_pk_bf16_f32 v115, v70, v71
  ds_write_b128 v15, v[112:115] offset:4096
  v_cvt_pk_bf16_f32 v116, v72, v73
  v_cvt_pk_bf16_f32 v117, v74, v75
  v_cvt_pk_bf16_f32 v118, v76, v77
  v_cvt_pk_bf16_f32 v119, v78, v79
  ds_write_b128 v15, v[116:119] offset:5120
  v_cvt_pk_bf16_f32 v120, v80, v81
  v_cvt_pk_bf16_f32 v121, v82, v83
  v_cvt_pk_bf16_f32 v122, v84, v85
  v_cvt_pk_bf16_f32 v123, v86, v87
  ds_write_b128 v15, v[120:123] offset:6144
  v_cvt_pk_bf16_f32 v124, v88, v89
  v_cvt_pk_bf16_f32 v125, v90, v91
  v_cvt_pk_bf16_f32 v126, v92, v93
  v_cvt_pk_bf16_f32 v127, v94, v95
  ds_write_b128 v15, v[124:127] offset:7168
  s_waitcnt lgkmcnt(0)
  s_barrier
  ds_read_b128 v[96:99], v240 offset:0
  ds_read_b128 v[100:103], v240 offset:1024
  ds_read_b128 v[104:107], v240 offset:2048
  ds_read_b128 v[108:111], v240 offset:3072
  ds_read_b128 v[112:115], v240 offset:4096
  ds_read_b128 v[116:119], v240 offset:5120
  ds_read_b128 v[120:123], v240 offset:6144
  ds_read_b128 v[124:127], v240 offset:7168
  s_waitcnt lgkmcnt(7)
  v_mfma_f32_32x32x16_bf16 v[176:191], a[0:3], v[96:99], 0
  buffer_load_dwordx4 v[64:67], v6, s[4:7], s58 offen offset:0 sc1
  ds_read_b128 v[96:99], v240 offset:8192
  s_waitcnt lgkmcnt(7)
  v_mfma_f32_32x32x16_bf16 v[176:191], a[4:7], v[100:103], v[176:191]
  ds_read_b128 v[100:103], v240 offset:9216
  s_waitcnt lgkmcnt(7)
  v_mfma_f32_32x32x16_bf16 v[176:191], a[8:11], v[104:107], v[176:191]
  buffer_load_dwordx4 v[32:35], v1, s[4:7], s56 offen offset:0 sc1
  ds_read_b128 v[104:107], v240 offset:10240
  s_waitcnt lgkmcnt(7)
  v_mfma_f32_32x32x16_bf16 v[176:191], a[12:15], v[108:111], v[176:191]
  ds_read_b128 v[108:111], v240 offset:11264
  s_waitcnt lgkmcnt(7)
  v_mfma_f32_32x32x16_bf16 v[176:191], a[16:19], v[112:115], v[176:191]
  buffer_load_dwordx4 v[68:71], v6, s[4:7], s58 offen offset:1024 sc1
  ds_read_b128 v[112:115], v240 offset:12288
  s_waitcnt lgkmcnt(7)
  v_mfma_f32_32x32x16_bf16 v[176:191], a[20:23], v[116:119], v[176:191]
  ds_read_b128 v[116:119], v240 offset:13312
  s_waitcnt lgkmcnt(7)
  v_mfma_f32_32x32x16_bf16 v[176:191], a[24:27], v[120:123], v[176:191]
  buffer_load_dwordx4 v[36:39], v1, s[4:7], s56 offen offset:1024 sc1
  ds_read_b128 v[120:123], v240 offset:14336
  s_waitcnt lgkmcnt(7)
  v_mfma_f32_32x32x16_bf16 v[176:191], a[28:31], v[124:127], v[176:191]
  ds_read_b128 v[124:127], v240 offset:15360
  s_waitcnt lgkmcnt(7)
  v_mfma_f32_32x32x16_bf16 v[176:191], a[32:35], v[96:99], v[176:191]
  buffer_load_dwordx4 v[72:75], v6, s[4:7], s58 offen offset:2048 sc1
  ds_read_b128 v[96:99], v240 offset:16384
  s_waitcnt lgkmcnt(7)
  v_mfma_f32_32x32x16_bf16 v[176:191], a[36:39], v[100:103], v[176:191]
  ds_read_b128 v[100:103], v240 offset:17408
  s_waitcnt lgkmcnt(7)
  v_mfma_f32_32x32x16_bf16 v[176:191], a[40:43], v[104:107], v[176:191]
  buffer_load_dwordx4 v[40:43], v1, s[4:7], s56 offen offset:2048 sc1
  ds_read_b128 v[104:107], v240 offset:18432
  s_waitcnt lgkmcnt(7)
  v_mfma_f32_32x32x16_bf16 v[176:191], a[44:47], v[108:111], v[176:191]
  ds_read_b128 v[108:111], v240 offset:19456
  s_waitcnt lgkmcnt(7)
  v_mfma_f32_32x32x16_bf16 v[176:191], a[48:51], v[112:115], v[176:191]
  buffer_load_dwordx4 v[76:79], v6, s[4:7], s58 offen offset:3072 sc1
  ds_read_b128 v[112:115], v240 offset:20480
  s_waitcnt lgkmcnt(7)
  v_mfma_f32_32x32x16_bf16 v[176:191], a[52:55], v[116:119], v[176:191]
  ds_read_b128 v[116:119], v240 offset:21504
  s_waitcnt lgkmcnt(7)
  v_mfma_f32_32x32x16_bf16 v[176:191], a[56:59], v[120:123], v[176:191]
  buffer_load_dwordx4 v[44:47], v1, s[4:7], s56 offen offset:3072 sc1
  ds_read_b128 v[120:123], v240 offset:22528
  s_waitcnt lgkmcnt(7)
  v_mfma_f32_32x32x16_bf16 v[176:191], a[60:63], v[124:127], v[176:191]
  ds_read_b128 v[124:127], v240 offset:23552
  s_waitcnt lgkmcnt(7)
  v_mfma_f32_32x32x16_bf16 v[176:191], a[64:67], v[96:99], v[176:191]
  buffer_load_dwordx4 v[80:83], v6, s[4:7], s59 offen offset:0 sc1
  ds_read_b128 v[96:99], v240 offset:24576
  s_waitcnt lgkmcnt(7)
  v_mfma_f32_32x32x16_bf16 v[176:191], a[68:71], v[100:103], v[176:191]
  ds_read_b128 v[100:103], v240 offset:25600
  s_waitcnt lgkmcnt(7)
  v_mfma_f32_32x32x16_bf16 v[176:191], a[72:75], v[104:107], v[176:191]
  buffer_load_dwordx4 v[48:51], v1, s[4:7], s57 offen offset:0 sc1
  ds_read_b128 v[104:107], v240 offset:26624
  s_waitcnt lgkmcnt(7)
  v_mfma_f32_32x32x16_bf16 v[176:191], a[76:79], v[108:111], v[176:191]
  ds_read_b128 v[108:111], v240 offset:27648
  s_waitcnt lgkmcnt(7)
  v_mfma_f32_32x32x16_bf16 v[176:191], a[80:83], v[112:115], v[176:191]
  buffer_load_dwordx4 v[84:87], v6, s[4:7], s59 offen offset:1024 sc1
  ds_read_b128 v[112:115], v240 offset:28672
  s_waitcnt lgkmcnt(7)
  v_mfma_f32_32x32x16_bf16 v[176:191], a[84:87], v[116:119], v[176:191]
  ds_read_b128 v[116:119], v240 offset:29696
  s_waitcnt lgkmcnt(7)
  v_mfma_f32_32x32x16_bf16 v[176:191], a[88:91], v[120:123], v[176:191]
  buffer_load_dwordx4 v[52:55], v1, s[4:7], s57 offen offset:1024 sc1
  ds_read_b128 v[120:123], v240 offset:30720
  s_waitcnt lgkmcnt(7)
  v_mfma_f32_32x32x16_bf16 v[176:191], a[92:95], v[124:127], v[176:191]
  ds_read_b128 v[124:127], v240 offset:31744
  s_waitcnt lgkmcnt(7)
  v_mfma_f32_32x32x16_bf16 v[176:191], a[96:99], v[96:99], v[176:191]
  buffer_load_dwordx4 v[88:91], v6, s[4:7], s59 offen offset:2048 sc1
  ds_read_b128 v[96:99], v240 offset:0
  s_waitcnt lgkmcnt(7)
  v_mfma_f32_32x32x16_bf16 v[176:191], a[100:103], v[100:103], v[176:191]
  ds_read_b128 v[100:103], v240 offset:1024
  s_waitcnt lgkmcnt(7)
  v_mfma_f32_32x32x16_bf16 v[176:191], a[104:107], v[104:107], v[176:191]
  buffer_load_dwordx4 v[56:59], v1, s[4:7], s57 offen offset:2048 sc1
  ds_read_b128 v[104:107], v240 offset:2048
  s_waitcnt lgkmcnt(7)
  v_mfma_f32_32x32x16_bf16 v[176:191], a[108:111], v[108:111], v[176:191]
  ds_read_b128 v[108:111], v240 offset:3072
  s_waitcnt lgkmcnt(7)
  v_mfma_f32_32x32x16_bf16 v[176:191], a[112:115], v[112:115], v[176:191]
  buffer_load_dwordx4 v[92:95], v6, s[4:7], s59 offen offset:3072 sc1
  ds_read_b128 v[112:115], v240 offset:4096
  s_waitcnt lgkmcnt(7)
  v_mfma_f32_32x32x16_bf16 v[176:191], a[116:119], v[116:119], v[176:191]
  ds_read_b128 v[116:119], v240 offset:5120
  s_waitcnt lgkmcnt(7)
  v_mfma_f32_32x32x16_bf16 v[176:191], a[120:123], v[120:123], v[176:191]
  buffer_load_dwordx4 v[60:63], v1, s[4:7], s57 offen offset:3072 sc1
  ds_read_b128 v[120:123], v240 offset:6144
  s_waitcnt lgkmcnt(7)
  v_mfma_f32_32x32x16_bf16 v[176:191], a[124:127], v[124:127], v[176:191]
  ds_read_b128 v[124:127], v240 offset:7168
  s_waitcnt lgkmcnt(7)
  v_mfma_f32_32x32x16_bf16 v[192:207], a[128:131], v[96:99], 0
  buffer_load_dwordx4 v[128:131], v8, s[4:7], s60 offen offset:0 sc1
  ds_read_b128 v[96:99], v240 offset:8192
  s_waitcnt lgkmcnt(7)
  v_mfma_f32_32x32x16_bf16 v[192:207], a[132:135], v[100:103], v[192:207]
  ds_read_b128 v[100:103], v240 offset:9216
  s_waitcnt lgkmcnt(7)
  v_mfma_f32_32x32x16_bf16 v[192:207], a[136:139], v[104:107], v[192:207]
  buffer_load_dwordx4 v[132:135], v8, s[4:7], s61 offen offset:0 sc1
  ds_read_b128 v[104:107], v240 offset:10240
  s_waitcnt lgkmcnt(7)
  v_mfma_f32_32x32x16_bf16 v[192:207], a[140:143], v[108:111], v[192:207]
  v_cvt_pk_bf16_f32 v220, v176, v177
  v_cvt_pk_bf16_f32 v221, v178, v179
  ds_read_b128 v[108:111], v240 offset:11264
  s_waitcnt lgkmcnt(7)
  v_mfma_f32_32x32x16_bf16 v[192:207], a[144:147], v[112:115], v[192:207]
  buffer_load_dwordx4 v[136:139], v8, s[4:7], s60 offen offset:512 sc1
  v_cvt_pk_bf16_f32 v222, v180, v181
  v_cvt_pk_bf16_f32 v223, v182, v183
  ds_read_b128 v[112:115], v240 offset:12288
  s_waitcnt lgkmcnt(7)
  v_mfma_f32_32x32x16_bf16 v[192:207], a[148:151], v[116:119], v[192:207]
  buffer_store_dwordx4 v[220:223], v14, s[4:7], s27 offen offset:0
  v_cvt_pk_bf16_f32 v224, v184, v185
  ds_read_b128 v[116:119], v240 offset:13312
  s_waitcnt lgkmcnt(7)
  v_mfma_f32_32x32x16_bf16 v[192:207], a[152:155], v[120:123], v[192:207]
  buffer_load_dwordx4 v[140:143], v8, s[4:7], s61 offen offset:512 sc1
  v_cvt_pk_bf16_f32 v225, v186, v187
  v_cvt_pk_bf16_f32 v226, v188, v189
  ds_read_b128 v[120:123], v240 offset:14336
  s_waitcnt lgkmcnt(7)
  v_mfma_f32_32x32x16_bf16 v[192:207], a[156:159], v[124:127], v[192:207]
  v_cvt_pk_bf16_f32 v227, v190, v191
  buffer_store_dwordx4 v[224:227], v14, s[4:7], s27 offen offset:128
  ds_read_b128 v[124:127], v240 offset:15360
  s_waitcnt lgkmcnt(7)
  v_mfma_f32_32x32x16_bf16 v[192:207], a[160:163], v[96:99], v[192:207]
  buffer_load_dwordx4 v[144:147], v8, s[4:7], s60 offen offset:1024 sc1
  ds_read_b128 v[96:99], v240 offset:16384
  s_waitcnt lgkmcnt(7)
  v_mfma_f32_32x32x16_bf16 v[192:207], a[164:167], v[100:103], v[192:207]
  ds_read_b128 v[100:103], v240 offset:17408
  s_waitcnt lgkmcnt(7)
  v_mfma_f32_32x32x16_bf16 v[192:207], a[168:171], v[104:107], v[192:207]
  buffer_load_dwordx4 v[148:151], v8, s[4:7], s61 offen offset:1024 sc1
  ds_read_b128 v[104:107], v240 offset:18432
  s_waitcnt lgkmcnt(7)
  v_mfma_f32_32x32x16_bf16 v[192:207], a[172:175], v[108:111], v[192:207]
  ds_read_b128 v[108:111], v240 offset:19456
  s_waitcnt lgkmcnt(7)
  v_mfma_f32_32x32x16_bf16 v[192:207], a[176:179], v[112:115], v[192:207]
  buffer_load_dwordx4 v[152:155], v8, s[4:7], s60 offen offset:1536 sc1
  ds_read_b128 v[112:115], v240 offset:20480
  s_waitcnt lgkmcnt(7)
  v_mfma_f32_32x32x16_bf16 v[192:207], a[180:183], v[116:119], v[192:207]
  ds_read_b128 v[116:119], v240 offset:21504
  s_waitcnt lgkmcnt(7)
  v_mfma_f32_32x32x16_bf16 v[192:207], a[184:187], v[120:123], v[192:207]
  buffer_load_dwordx4 v[156:159], v8, s[4:7], s61 offen offset:1536 sc1
  ds_read_b128 v[120:123], v240 offset:22528
  s_waitcnt lgkmcnt(7)
  v_mfma_f32_32x32x16_bf16 v[192:207], a[188:191], v[124:127], v[192:207]
  ds_read_b128 v[124:127], v240 offset:23552
  s_waitcnt lgkmcnt(7)
  v_mfma_f32_32x32x16_bf16 v[192:207], a[192:195], v[96:99], v[192:207]
  ds_read_b128 v[96:99], v240 offset:24576
  s_waitcnt lgkmcnt(7)
  v_mfma_f32_32x32x16_bf16 v[192:207], a[196:199], v[100:103], v[192:207]
  ds_read_b128 v[100:103], v240 offset:25600
  s_waitcnt lgkmcnt(7)
  v_mfma_f32_32x32x16_bf16 v[192:207], a[200:203], v[104:107], v[192:207]
  ds_read_b128 v[104:107], v240 offset:26624
  s_waitcnt lgkmcnt(7)
  v_mfma_f32_32x32x16_bf16 v[192:207], a[204:207], v[108:111], v[192:207]
  ds_read_b128 v[108:111], v240 offset:27648
  s_waitcnt lgkmcnt(7)
  v_mfma_f32_32x32x16_bf16 v[192:207], a[208:211], v[112:115], v[192:207]
  ds_read_b128 v[112:115], v240 offset:28672
  s_waitcnt lgkmcnt(7)
  v_mfma_f32_32x32x16_bf16 v[192:207], a[212:215], v[116:119], v[192:207]
  ds_read_b128 v[116:119], v240 offset:29696
  s_waitcnt lgkmcnt(7)
  v_mfma_f32_32x32x16_bf16 v[192:207], a[216:219], v[120:123], v[192:207]
  ds_read_b128 v[120:123], v240 offset:30720
  s_waitcnt lgkmcnt(7)
  v_mfma_f32_32x32x16_bf16 v[192:207], a[220:223], v[124:127], v[192:207]
  ds_read_b128 v[124:127], v240 offset:31744
  s_waitcnt lgkmcnt(7)
  v_mfma_f32_32x32x16_bf16 v[192:207], a[224:227], v[96:99], v[192:207]
  s_waitcnt lgkmcnt(6)
  v_mfma_f32_32x32x16_bf16 v[192:207], a[228:231], v[100:103], v[192:207]
  s_waitcnt lgkmcnt(5)
  v_mfma_f32_32x32x16_bf16 v[192:207], a[232:235], v[104:107], v[192:207]
  s_waitcnt lgkmcnt(4)
  v_mfma_f32_32x32x16_bf16 v[192:207], a[236:239], v[108:111], v[192:207]
  s_waitcnt lgkmcnt(3)
  v_mfma_f32_32x32x16_bf16 v[192:207], a[240:243], v[112:115], v[192:207]
  s_waitcnt lgkmcnt(2)
  v_mfma_f32_32x32x16_bf16 v[192:207], a[244:247], v[116:119], v[192:207]
  s_waitcnt lgkmcnt(1)
  v_mfma_f32_32x32x16_bf16 v[192:207], a[248:251], v[120:123], v[192:207]
  s_waitcnt lgkmcnt(0)
  v_mfma_f32_32x32x16_bf16 v[192:207], a[252:255], v[124:127], v[192:207]
  v_xor_b32 v240, 32768, v240
  v_xor_b32 v15, 32768, v15
  s_nop 9
  v_cvt_pk_bf16_f32 v228, v192, v193
  v_cvt_pk_bf16_f32 v229, v194, v195
  v_cvt_pk_bf16_f32 v230, v196, v197
  v_cvt_pk_bf16_f32 v231, v198, v199
  buffer_store_dwordx4 v[228:231], v14, s[4:7], s27 offen offset:256
  v_cvt_pk_bf16_f32 v232, v200, v201
  v_cvt_pk_bf16_f32 v233, v202, v203
  v_cvt_pk_bf16_f32 v234, v204, v205
  v_cvt_pk_bf16_f32 v235, v206, v207
  buffer_store_dwordx4 v[232:235], v14, s[4:7], s27 offen offset:384
  s_add_u32 s27, s27, 524288
  s_cmp_ge_u32 s27, s62
  s_cselect_b32 s78, 2097152, 0
  s_sub_u32 s27, s27, s78
  s_mov_b32 s34, 1
  s_cmp_eq_u32 s33, 1
  s_cbranch_scc1 aopf_96
  s_waitcnt vmcnt(0)
  s_mov_b64 exec, 1
  ds_add_rtn_u32 v239, v237, v238
  s_waitcnt lgkmcnt(0)
  v_readfirstlane_b32 s31, v239
  s_mov_b64 exec, -1
  v_xor_b32 v237, 8, v237
  s_and_b32 s31, s31, 3
  s_cmp_lg_u32 s31, 3
  s_cbranch_scc1 agg_97
  s_mov_b64 exec, 1
  buffer_store_dword v12, off, s[4:7], s30
  s_mov_b64 exec, -1
agg_97:
  s_add_u32 s30, s30, 2048
  s_mov_b32 s34, 0
  s_cmp_eq_u32 s28, 0
  s_cbranch_scc1 mega_kernel_end
  s_mov_b32 s35, 0
poll_98:
  buffer_load_dword v11, v13, s[4:7], s55 offen sc1
  s_waitcnt vmcnt(0)
  v_cmp_ne_u32 vcc, 0, v11
  s_nop 0
  s_cmp_eq_u64 vcc, exec
  s_cbranch_scc1 polld_99
  s_sleep 4
  s_add_u32 s35, s35, 1
  s_cmp_lt_u32 s35, 131072
  s_cbranch_scc1 poll_98
  s_branch mega_kernel_end
polld_99:
  s_mov_b32 s56, s50
  s_mov_b32 s58, s51
  s_mov_b32 s60, s52
  s_add_u32 s57, s56, 4096
  s_add_u32 s59, s58, 4096
  s_add_u32 s61, s60, 4096
  buffer_load_dwordx4 v[64:67], v6, s[4:7], s58 offen offset:0 sc1
  buffer_load_dwordx4 v[32:35], v1, s[4:7], s56 offen offset:0 sc1
  buffer_load_dwordx4 v[68:71], v6, s[4:7], s58 offen offset:1024 sc1
  buffer_load_dwordx4 v[36:39], v1, s[4:7], s56 offen offset:1024 sc1
  buffer_load_dwordx4 v[72:75], v6, s[4:7], s58 offen offset:2048 sc1
  buffer_load_dwordx4 v[40:43], v1, s[4:7], s56 offen offset:2048 sc1
  buffer_load_dwordx4 v[76:79], v6, s[4:7], s58 offen offset:3072 sc1
  buffer_load_dwordx4 v[44:47], v1, s[4:7], s56 offen offset:3072 sc1
  buffer_load_dwordx4 v[80:83], v6, s[4:7], s59 offen offset:0 sc1
  buffer_load_dwordx4 v[48:51], v1, s[4:7], s57 offen offset:0 sc1
  buffer_load_dwordx4 v[84:87], v6, s[4:7], s59 offen offset:1024 sc1
  buffer_load_dwordx4 v[52:55], v1, s[4:7], s57 offen offset:1024 sc1
  buffer_load_dwordx4 v[88:91], v6, s[4:7], s59 offen offset:2048 sc1
  buffer_load_dwordx4 v[56:59], v1, s[4:7], s57 offen offset:2048 sc1
  buffer_load_dwordx4 v[92:95], v6, s[4:7], s59 offen offset:3072 sc1
  buffer_load_dwordx4 v[60:63], v1, s[4:7], s57 offen offset:3072 sc1
  buffer_load_dwordx4 v[128:131], v8, s[4:7], s60 offen offset:0 sc1
  buffer_load_dwordx4 v[132:135], v8, s[4:7], s61 offen offset:0 sc1
  buffer_load_dwordx4 v[136:139], v8, s[4:7], s60 offen offset:512 sc1
  buffer_load_dwordx4 v[140:143], v8, s[4:7], s61 offen offset:512 sc1
  buffer_load_dwordx4 v[144:147], v8, s[4:7], s60 offen offset:1024 sc1
  buffer_load_dwordx4 v[148:151], v8, s[4:7], s61 offen offset:1024 sc1
  buffer_load_dwordx4 v[152:155], v8, s[4:7], s60 offen offset:1536 sc1
  buffer_load_dwordx4 v[156:159], v8, s[4:7], s61 offen offset:1536 sc1
aopf_96:
  s_add_u32 s50, s50, 524288
  s_add_u32 s51, s51, 524288
  s_add_u32 s52, s52, 524288
  s_add_u32 s55, s55, 2048
  s_branch aotop_90
aog_87:
  s_mov_b32 s35, 0
poll_100:
  buffer_load_dword v11, v13, s[4:7], s55 offen sc1
  s_waitcnt vmcnt(0)
  v_cmp_ne_u32 vcc, 0, v11
  s_nop 0
  s_cmp_eq_u64 vcc, exec
  s_cbranch_scc1 polld_101
  s_sleep 8
  s_add_u32 s35, s35, 1
  s_cmp_lt_u32 s35, 131072
  s_cbranch_scc1 poll_100
  s_branch mega_kernel_end
polld_101:
  s_mov_b32 s56, s50
  s_mov_b32 s58, s51
  s_mov_b32 s60, s52
  s_add_u32 s57, s56, 4096
  s_add_u32 s59, s58, 4096
  s_add_u32 s61, s60, 4096
  buffer_load_dwordx4 v[64:67], v6, s[4:7], s58 offen offset:0 sc1
  buffer_load_dwordx4 v[32:35], v1, s[4:7], s56 offen offset:0 sc1
  buffer_load_dwordx4 v[68:71], v6, s[4:7], s58 offen offset:1024 sc1
  buffer_load_dwordx4 v[36:39], v1, s[4:7], s56 offen offset:1024 sc1
  buffer_load_dwordx4 v[72:75], v6, s[4:7], s58 offen offset:2048 sc1
  buffer_load_dwordx4 v[40:43], v1, s[4:7], s56 offen offset:2048 sc1
  buffer_load_dwordx4 v[76:79], v6, s[4:7], s58 offen offset:3072 sc1
  buffer_load_dwordx4 v[44:47], v1, s[4:7], s56 offen offset:3072 sc1
  buffer_load_dwordx4 v[80:83], v6, s[4:7], s59 offen offset:0 sc1
  buffer_load_dwordx4 v[48:51], v1, s[4:7], s57 offen offset:0 sc1
  buffer_load_dwordx4 v[84:87], v6, s[4:7], s59 offen offset:1024 sc1
  buffer_load_dwordx4 v[52:55], v1, s[4:7], s57 offen offset:1024 sc1
  buffer_load_dwordx4 v[88:91], v6, s[4:7], s59 offen offset:2048 sc1
  buffer_load_dwordx4 v[56:59], v1, s[4:7], s57 offen offset:2048 sc1
  buffer_load_dwordx4 v[92:95], v6, s[4:7], s59 offen offset:3072 sc1
  buffer_load_dwordx4 v[60:63], v1, s[4:7], s57 offen offset:3072 sc1
  buffer_load_dwordx4 v[128:131], v8, s[4:7], s60 offen offset:0 sc1
  buffer_load_dwordx4 v[132:135], v8, s[4:7], s61 offen offset:0 sc1
  buffer_load_dwordx4 v[136:139], v8, s[4:7], s60 offen offset:512 sc1
  buffer_load_dwordx4 v[140:143], v8, s[4:7], s61 offen offset:512 sc1
  buffer_load_dwordx4 v[144:147], v8, s[4:7], s60 offen offset:1024 sc1
  buffer_load_dwordx4 v[148:151], v8, s[4:7], s61 offen offset:1024 sc1
  buffer_load_dwordx4 v[152:155], v8, s[4:7], s60 offen offset:1536 sc1
  buffer_load_dwordx4 v[156:159], v8, s[4:7], s61 offen offset:1536 sc1
  s_add_u32 s50, s50, 524288
  s_add_u32 s51, s51, 524288
  s_add_u32 s52, s52, 524288
  s_add_u32 s55, s55, 2048
  s_mov_b32 s34, 0
aotop_102:
  s_sub_u32 s28, s28, 1
  buffer_load_dword v11, v10, s[4:7], s29 offen sc1
  s_waitcnt vmcnt(9)
  v_mfma_f32_32x32x16_bf16 v[176:191], v[64:67], v[32:35], 0
  v_mfma_f32_32x32x16_bf16 v[176:191], v[68:71], v[36:39], v[176:191]
  v_mfma_f32_32x32x16_bf16 v[176:191], v[72:75], v[40:43], v[176:191]
  v_mfma_f32_32x32x16_bf16 v[176:191], v[76:79], v[44:47], v[176:191]
  v_mfma_f32_32x32x16_bf16 v[176:191], v[80:83], v[48:51], v[176:191]
  v_mfma_f32_32x32x16_bf16 v[176:191], v[84:87], v[52:55], v[176:191]
  v_mfma_f32_32x32x16_bf16 v[176:191], v[88:91], v[56:59], v[176:191]
  v_mfma_f32_32x32x16_bf16 v[176:191], v[92:95], v[60:63], v[176:191]
  s_nop 11
  v_fma_f32 v176, v176, s40, v16
  v_fma_f32 v177, v177, s40, v17
  v_fma_f32 v178, v178, s40, v18
  v_fma_f32 v179, v179, s40, v19
  v_fma_f32 v180, v180, s40, v20
  v_fma_f32 v181, v181, s40, v21
  v_fma_f32 v182, v182, s40, v22
  v_fma_f32 v183, v183, s40, v23
  v_fma_f32 v184, v184, s40, v24
  v_fma_f32 v185, v185, s40, v25
  v_fma_f32 v186, v186, s40, v26
  v_fma_f32 v187, v187, s40, v27
  v_fma_f32 v188, v188, s40, v28
  v_fma_f32 v189, v189, s40, v29
  v_fma_f32 v190, v190, s40, v30
  v_fma_f32 v191, v191, s40, v31
  v_max3_f32 v3, v176, v177, v178
  v_max3_f32 v3, v3, v179, v180
  v_max3_f32 v3, v3, v181, v182
  v_max3_f32 v3, v3, v183, v184
  v_max3_f32 v3, v3, v185, v186
  v_max3_f32 v3, v3, v187, v188
  v_max3_f32 v3, v3, v189, v190
  v_max_f32 v3, v3, v191
  s_waitcnt vmcnt(0)
  s_cmp_eq_u32 s34, 0
  s_cbranch_scc1 aons_103
  s_mov_b64 exec, 1
  ds_add_rtn_u32 v239, v237, v238
  s_waitcnt lgkmcnt(0)
  v_readfirstlane_b32 s31, v239
  s_mov_b64 exec, -1
  v_xor_b32 v237, 8, v237
  s_and_b32 s31, s31, 3
  s_cmp_lg_u32 s31, 3
  s_cbranch_scc1 agg_104
  s_mov_b64 exec, 1
  buffer_store_dword v12, off, s[4:7], s30 sc1
  s_mov_b64 exec, -1
agg_104:
  s_add_u32 s30, s30, 2048
  s_mov_b32 s34, 0
aons_103:
  v_cmp_ne_u32 vcc, 0, v11
  s_nop 0
  s_cmp_eq_u64 vcc, exec
  s_cbranch_scc1 aogo_105
  s_mov_b32 s35, 0
poll_106:
  buffer_load_dword v11, v10, s[4:7], s29 offen sc1
  s_waitcnt vmcnt(0)
  v_cmp_ne_u32 vcc, 0, v11
  s_nop 0
  s_cmp_eq_u64 vcc, exec
  s_cbranch_scc1 polld_107
  s_sleep 2
  s_add_u32 s35, s35, 1
  s_cmp_lt_u32 s35, 131072
  s_cbranch_scc1 poll_106
  s_branch mega_kernel_end
polld_107:
aogo_105:
  s_add_u32 s29, s29, 2048
  s_add_u32 s63, s63, 1
  s_cmp_ge_u32 s63, 4
  s_cselect_b64 vcc, -1, 0
  v_cndmask_b32 v10, v10, v242, vcc
  buffer_load_dwordx4 v[96:99], v7, s[4:7], s53 offen offset:0 sc1
  buffer_load_dwordx4 v[100:103], v7, s[4:7], s53 offen offset:256 sc1
  buffer_load_dwordx4 v[104:107], v7, s[4:7], s53 offen offset:512 sc1
  buffer_load_dwordx4 v[108:111], v7, s[4:7], s53 offen offset:768 sc1
  buffer_load_dwordx4 v[112:115], v7, s[4:7], s53 offen offset:1024 sc1
  buffer_load_dwordx4 v[116:119], v7, s[4:7], s53 offen offset:1280 sc1
  buffer_load_dwordx4 v[120:123], v7, s[4:7], s53 offen offset:1536 sc1
  buffer_load_dwordx4 v[124:127], v7, s[4:7], s53 offen offset:1792 sc1
  buffer_load_dwordx2 v[160:161], v9, s[4:7], s54 offen offset:0 sc1
  buffer_load_dwordx2 v[164:165], v9, s[4:7], s54 offen offset:256 sc1
  buffer_load_dwordx2 v[168:169], v9, s[4:7], s54 offen offset:512 sc1
  buffer_load_dwordx2 v[172:173], v9, s[4:7], s54 offen offset:768 sc1
  buffer_load_dword v241, v13, s[4:7], s55 offen sc1
  s_add_u32 s53, s53, 131072
  s_add_u32 s54, s54, 131072
  s_waitcnt vmcnt(12)
  v_mfma_f32_32x32x16_bf16 v[192:207], v[96:99], v[32:35], 0
  s_waitcnt vmcnt(11)
  v_mfma_f32_32x32x16_bf16 v[192:207], v[100:103], v[36:39], v[192:207]
  s_waitcnt vmcnt(10)
  v_mfma_f32_32x32x16_bf16 v[192:207], v[104:107], v[40:43], v[192:207]
  s_waitcnt vmcnt(9)
  v_mfma_f32_32x32x16_bf16 v[192:207], v[108:111], v[44:47], v[192:207]
  s_waitcnt vmcnt(8)
  v_mfma_f32_32x32x16_bf16 v[192:207], v[112:115], v[48:51], v[192:207]
  s_waitcnt vmcnt(7)
  v_mfma_f32_32x32x16_bf16 v[192:207], v[116:119], v[52:55], v[192:207]
  s_waitcnt vmcnt(6)
  v_mfma_f32_32x32x16_bf16 v[192:207], v[120:123], v[56:59], v[192:207]
  s_waitcnt vmcnt(5)
  v_mfma_f32_32x32x16_bf16 v[192:207], v[124:127], v[60:63], v[192:207]
  s_nop 11
  v_mul_f32 v192, s40, v192
  v_mul_f32 v193, s40, v193
  v_mul_f32 v194, s40, v194
  v_mul_f32 v195, s40, v195
  v_max3_f32 v3, v3, v192, v193
  v_max3_f32 v3, v3, v194, v195
  v_mov_b32 v4, v3
  s_nop 1
  v_permlane32_swap_b32 v3, v4
  v_max_f32 v3, v3, v4
  v_sub_f32 v176, v176, v3
  v_sub_f32 v177, v177, v3
  v_sub_f32 v178, v178, v3
  v_sub_f32 v179, v179, v3
  v_sub_f32 v180, v180, v3
  v_sub_f32 v181, v181, v3
  v_sub_f32 v182, v182, v3
  v_sub_f32 v183, v183, v3
  v_sub_f32 v184, v184, v3
  v_sub_f32 v185, v185, v3
  v_sub_f32 v186, v186, v3
  v_sub_f32 v187, v187, v3
  v_sub_f32 v188, v188, v3
  v_sub_f32 v189, v189, v3
  v_sub_f32 v190, v190, v3
  v_sub_f32 v191, v191, v3
  v_sub_f32 v192, v192, v3
  v_sub_f32 v193, v193, v3
  v_sub_f32 v194, v194, v3
  v_sub_f32 v195, v195, v3
  v_exp_f32 v176, v176
  v_exp_f32 v177, v177
  v_exp_f32 v178, v178
  v_exp_f32 v179, v179
  v_exp_f32 v180, v180
  v_exp_f32 v181, v181
  v_exp_f32 v182, v182
  v_exp_f32 v183, v183
  v_exp_f32 v184, v184
  v_exp_f32 v185, v185
  v_exp_f32 v186, v186
  v_exp_f32 v187, v187
  v_exp_f32 v188, v188
  v_exp_f32 v189, v189
  v_exp_f32 v190, v190
  v_exp_f32 v191, v191
  v_exp_f32 v192, v192
  v_exp_f32 v193, v193
  v_exp_f32 v194, v194
  v_exp_f32 v195, v195
  v_add_f32 v4, v176, v177
  v_add_f32 v5, v178, v179
  v_add_f32 v4, v4, v180
  v_add_f32 v5, v5, v181
  v_add_f32 v4, v4, v182
  v_add_f32 v5, v5, v183
  v_add_f32 v4, v4, v184
  v_add_f32 v5, v5, v185
  v_add_f32 v4, v4, v186
  v_add_f32 v5, v5, v187
  v_add_f32 v4, v4, v188
  v_add_f32 v5, v5, v189
  v_add_f32 v4, v4, v190
  v_add_f32 v5, v5, v191
  v_add_f32 v4, v4, v192
  v_add_f32 v5, v5, v193
  v_add_f32 v4, v4, v194
  v_add_f32 v5, v5, v195
  v_add_f32 v4, v4, v5
  v_mov_b32 v5, v4
  s_nop 1
  v_permlane32_swap_b32 v4, v5
  v_add_f32 v4, v4, v5
  v_rcp_f32 v4, v4
  s_nop 0
  v_mul_f32 v176, v176, v4
  v_mul_f32 v177, v177, v4
  v_mul_f32 v178, v178, v4
  v_mul_f32 v179, v179, v4
  v_mul_f32 v180, v180, v4
  v_mul_f32 v181, v181, v4
  v_mul_f32 v182, v182, v4
  v_mul_f32 v183, v183, v4
  v_mul_f32 v184, v184, v4
  v_mul_f32 v185, v185, v4
  v_mul_f32 v186, v186, v4
  v_mul_f32 v187, v187, v4
  v_mul_f32 v188, v188, v4
  v_mul_f32 v189, v189, v4
  v_mul_f32 v190, v190, v4
  v_mul_f32 v191, v191, v4
  v_mul_f32 v192, v192, v4
  v_mul_f32 v193, v193, v4
  v_mul_f32 v194, v194, v4
  v_mul_f32 v195, v195, v4
  v_cvt_pk_bf16_f32 v208, v176, v177
  v_cvt_pk_bf16_f32 v209, v178, v179
  v_cvt_pk_bf16_f32 v210, v180, v181
  v_cvt_pk_bf16_f32 v211, v182, v183
  v_cvt_pk_bf16_f32 v212, v184, v185
  v_cvt_pk_bf16_f32 v213, v186, v187
  v_cvt_pk_bf16_f32 v214, v188, v189
  v_cvt_pk_bf16_f32 v215, v190, v191
  v_cvt_pk_bf16_f32 v216, v192, v193
  v_cvt_pk_bf16_f32 v217, v194, v195
  s_waitcnt vmcnt(0)
  v_mfma_f32_32x32x16_bf16 v[32:47], v[128:131], v[208:211], 0
  v_mfma_f32_32x32x16_bf16 v[32:47], v[132:135], v[212:215], v[32:47]
  v_mfma_f32_32x32x16_bf16 v[32:47], v[160:163], v[216:219], v[32:47]
  v_mfma_f32_32x32x16_bf16 v[48:63], v[136:139], v[208:211], 0
  v_mfma_f32_32x32x16_bf16 v[48:63], v[140:143], v[212:215], v[48:63]
  v_mfma_f32_32x32x16_bf16 v[48:63], v[164:167], v[216:219], v[48:63]
  v_mfma_f32_32x32x16_bf16 v[64:79], v[144:147], v[208:211], 0
  s_nop 7
  v_cvt_pk_bf16_f32 v96, v32, v33
  v_cvt_pk_bf16_f32 v97, v34, v35
  v_cvt_pk_bf16_f32 v98, v36, v37
  v_cvt_pk_bf16_f32 v99, v38, v39
  v_mfma_f32_32x32x16_bf16 v[64:79], v[148:151], v[212:215], v[64:79]
  ds_write_b128 v15, v[96:99] offset:0
  v_cvt_pk_bf16_f32 v100, v40, v41
  v_cvt_pk_bf16_f32 v101, v42, v43
  v_cvt_pk_bf16_f32 v102, v44, v45
  v_mfma_f32_32x32x16_bf16 v[64:79], v[168:171], v[216:219], v[64:79]
  v_cvt_pk_bf16_f32 v103, v46, v47
  ds_write_b128 v15, v[100:103] offset:1024
  v_mfma_f32_32x32x16_bf16 v[80:95], v[152:155], v[208:211], 0
  v_cvt_pk_bf16_f32 v104, v48, v49
  v_cvt_pk_bf16_f32 v105, v50, v51
  v_cvt_pk_bf16_f32 v106, v52, v53
  v_cvt_pk_bf16_f32 v107, v54, v55
  v_mfma_f32_32x32x16_bf16 v[80:95], v[156:159], v[212:215], v[80:95]
  ds_write_b128 v15, v[104:107] offset:2048
  v_cvt_pk_bf16_f32 v108, v56, v57
  v_cvt_pk_bf16_f32 v109, v58, v59
  v_cvt_pk_bf16_f32 v110, v60, v61
  v_mfma_f32_32x32x16_bf16 v[80:95], v[172:175], v[216:219], v[80:95]
  v_cvt_pk_bf16_f32 v111, v62, v63
  ds_write_b128 v15, v[108:111] offset:3072
  v_cmp_ne_u32 vcc, 0, v241
  s_nop 0
  s_cmp_eq_u64 vcc, exec
  s_cselect_b32 s33, 1, 0
  s_cmp_eq_u32 s28, 0
  s_cselect_b32 s33, 0, s33
  s_cmp_eq_u32 s33, 1
  s_cselect_b32 s56, s50, 2146435072
  s_cselect_b32 s58, s51, 2146435072
  s_cselect_b32 s60, s52, 2146435072
  s_add_u32 s57, s56, 4096
  s_add_u32 s59, s58, 4096
  s_add_u32 s61, s60, 4096
  v_cvt_pk_bf16_f32 v112, v64, v65
  v_cvt_pk_bf16_f32 v113, v66, v67
  v_cvt_pk_bf16_f32 v114, v68, v69
  v_cvt_pk_bf16_f32 v115, v70, v71
  ds_write_b128 v15, v[112:115] offset:4096
  v_cvt_pk_bf16_f32 v116, v72, v73
  v_cvt_pk_bf16_f32 v117, v74, v75
  v_cvt_pk_bf16_f32 v118, v76, v77
  v_cvt_pk_bf16_f32 v119, v78, v79
  ds_write_b128 v15, v[116:119] offset:5120
  v_cvt_pk_bf16_f32 v120, v80, v81
  v_cvt_pk_bf16_f32 v121, v82, v83
  v_cvt_pk_bf16_f32 v122, v84, v85
  v_cvt_pk_bf16_f32 v123, v86, v87
  ds_write_b128 v15, v[120:123] offset:6144
  v_cvt_pk_bf16_f32 v124, v88, v89
  v_cvt_pk_bf16_f32 v125, v90, v91
  v_cvt_pk_bf16_f32 v126, v92, v93
  v_cvt_pk_bf16_f32 v127, v94, v95
  ds_write_b128 v15, v[124:127] offset:7168
  s_waitcnt lgkmcnt(0)
  s_barrier
  ds_read_b128 v[96:99], v240 offset:0
  ds_read_b128 v[100:103], v240 offset:1024
  ds_read_b128 v[104:107], v240 offset:2048
  ds_read_b128 v[108:111], v240 offset:3072
  ds_read_b128 v[112:115], v240 offset:4096
  ds_read_b128 v[116:119], v240 offset:5120
  ds_read_b128 v[120:123], v240 offset:6144
  ds_read_b128 v[124:127], v240 offset:7168
  s_waitcnt lgkmcnt(7)
  v_mfma_f32_32x32x16_bf16 v[176:191], a[0:3], v[96:99], 0
  buffer_load_dwordx4 v[64:67], v6, s[4:7], s58 offen offset:0 sc1
  ds_read_b128 v[96:99], v240 offset:8192
  s_waitcnt lgkmcnt(7)
  v_mfma_f32_32x32x16_bf16 v[176:191], a[4:7], v[100:103], v[176:191]
  ds_read_b128 v[100:103], v240 offset:9216
  s_waitcnt lgkmcnt(7)
  v_mfma_f32_32x32x16_bf16 v[176:191], a[8:11], v[104:107], v[176:191]
  buffer_load_dwordx4 v[32:35], v1, s[4:7], s56 offen offset:0 sc1
  ds_read_b128 v[104:107], v240 offset:10240
  s_waitcnt lgkmcnt(7)
  v_mfma_f32_32x32x16_bf16 v[176:191], a[12:15], v[108:111], v[176:191]
  ds_read_b128 v[108:111], v240 offset:11264
  s_waitcnt lgkmcnt(7)
  v_mfma_f32_32x32x16_bf16 v[176:191], a[16:19], v[112:115], v[176:191]
  buffer_load_dwordx4 v[68:71], v6, s[4:7], s58 offen offset:1024 sc1
  ds_read_b128 v[112:115], v240 offset:12288
  s_waitcnt lgkmcnt(7)
  v_mfma_f32_32x32x16_bf16 v[176:191], a[20:23], v[116:119], v[176:191]
  ds_read_b128 v[116:119], v240 offset:13312
  s_waitcnt lgkmcnt(7)
  v_mfma_f32_32x32x16_bf16 v[176:191], a[24:27], v[120:123], v[176:191]
  buffer_load_dwordx4 v[36:39], v1, s[4:7], s56 offen offset:1024 sc1
  ds_read_b128 v[120:123], v240 offset:14336
  s_waitcnt lgkmcnt(7)
  v_mfma_f32_32x32x16_bf16 v[176:191], a[28:31], v[124:127], v[176:191]
  ds_read_b128 v[124:127], v240 offset:15360
  s_waitcnt lgkmcnt(7)
  v_mfma_f32_32x32x16_bf16 v[176:191], a[32:35], v[96:99], v[176:191]
  buffer_load_dwordx4 v[72:75], v6, s[4:7], s58 offen offset:2048 sc1
  ds_read_b128 v[96:99], v240 offset:16384
  s_waitcnt lgkmcnt(7)
  v_mfma_f32_32x32x16_bf16 v[176:191], a[36:39], v[100:103], v[176:191]
  ds_read_b128 v[100:103], v240 offset:17408
  s_waitcnt lgkmcnt(7)
  v_mfma_f32_32x32x16_bf16 v[176:191], a[40:43], v[104:107], v[176:191]
  buffer_load_dwordx4 v[40:43], v1, s[4:7], s56 offen offset:2048 sc1
  ds_read_b128 v[104:107], v240 offset:18432
  s_waitcnt lgkmcnt(7)
  v_mfma_f32_32x32x16_bf16 v[176:191], a[44:47], v[108:111], v[176:191]
  ds_read_b128 v[108:111], v240 offset:19456
  s_waitcnt lgkmcnt(7)
  v_mfma_f32_32x32x16_bf16 v[176:191], a[48:51], v[112:115], v[176:191]
  buffer_load_dwordx4 v[76:79], v6, s[4:7], s58 offen offset:3072 sc1
  ds_read_b128 v[112:115], v240 offset:20480
  s_waitcnt lgkmcnt(7)
  v_mfma_f32_32x32x16_bf16 v[176:191], a[52:55], v[116:119], v[176:191]
  ds_read_b128 v[116:119], v240 offset:21504
  s_waitcnt lgkmcnt(7)
  v_mfma_f32_32x32x16_bf16 v[176:191], a[56:59], v[120:123], v[176:191]
  buffer_load_dwordx4 v[44:47], v1, s[4:7], s56 offen offset:3072 sc1
  ds_read_b128 v[120:123], v240 offset:22528
  s_waitcnt lgkmcnt(7)
  v_mfma_f32_32x32x16_bf16 v[176:191], a[60:63], v[124:127], v[176:191]
  ds_read_b128 v[124:127], v240 offset:23552
  s_waitcnt lgkmcnt(7)
  v_mfma_f32_32x32x16_bf16 v[176:191], a[64:67], v[96:99], v[176:191]
  buffer_load_dwordx4 v[80:83], v6, s[4:7], s59 offen offset:0 sc1
  ds_read_b128 v[96:99], v240 offset:24576
  s_waitcnt lgkmcnt(7)
  v_mfma_f32_32x32x16_bf16 v[176:191], a[68:71], v[100:103], v[176:191]
  ds_read_b128 v[100:103], v240 offset:25600
  s_waitcnt lgkmcnt(7)
  v_mfma_f32_32x32x16_bf16 v[176:191], a[72:75], v[104:107], v[176:191]
  buffer_load_dwordx4 v[48:51], v1, s[4:7], s57 offen offset:0 sc1
  ds_read_b128 v[104:107], v240 offset:26624
  s_waitcnt lgkmcnt(7)
  v_mfma_f32_32x32x16_bf16 v[176:191], a[76:79], v[108:111], v[176:191]
  ds_read_b128 v[108:111], v240 offset:27648
  s_waitcnt lgkmcnt(7)
  v_mfma_f32_32x32x16_bf16 v[176:191], a[80:83], v[112:115], v[176:191]
  buffer_load_dwordx4 v[84:87], v6, s[4:7], s59 offen offset:1024 sc1
  ds_read_b128 v[112:115], v240 offset:28672
  s_waitcnt lgkmcnt(7)
  v_mfma_f32_32x32x16_bf16 v[176:191], a[84:87], v[116:119], v[176:191]
  ds_read_b128 v[116:119], v240 offset:29696
  s_waitcnt lgkmcnt(7)
  v_mfma_f32_32x32x16_bf16 v[176:191], a[88:91], v[120:123], v[176:191]
  buffer_load_dwordx4 v[52:55], v1, s[4:7], s57 offen offset:1024 sc1
  ds_read_b128 v[120:123], v240 offset:30720
  s_waitcnt lgkmcnt(7)
  v_mfma_f32_32x32x16_bf16 v[176:191], a[92:95], v[124:127], v[176:191]
  ds_read_b128 v[124:127], v240 offset:31744
  s_waitcnt lgkmcnt(7)
  v_mfma_f32_32x32x16_bf16 v[176:191], a[96:99], v[96:99], v[176:191]
  buffer_load_dwordx4 v[88:91], v6, s[4:7], s59 offen offset:2048 sc1
  ds_read_b128 v[96:99], v240 offset:0
  s_waitcnt lgkmcnt(7)
  v_mfma_f32_32x32x16_bf16 v[176:191], a[100:103], v[100:103], v[176:191]
  ds_read_b128 v[100:103], v240 offset:1024
  s_waitcnt lgkmcnt(7)
  v_mfma_f32_32x32x16_bf16 v[176:191], a[104:107], v[104:107], v[176:191]
  buffer_load_dwordx4 v[56:59], v1, s[4:7], s57 offen offset:2048 sc1
  ds_read_b128 v[104:107], v240 offset:2048
  s_waitcnt lgkmcnt(7)
  v_mfma_f32_32x32x16_bf16 v[176:191], a[108:111], v[108:111], v[176:191]
  ds_read_b128 v[108:111], v240 offset:3072
  s_waitcnt lgkmcnt(7)
  v_mfma_f32_32x32x16_bf16 v[176:191], a[112:115], v[112:115], v[176:191]
  buffer_load_dwordx4 v[92:95], v6, s[4:7], s59 offen offset:3072 sc1
  ds_read_b128 v[112:115], v240 offset:4096
  s_waitcnt lgkmcnt(7)
  v_mfma_f32_32x32x16_bf16 v[176:191], a[116:119], v[116:119], v[176:191]
  ds_read_b128 v[116:119], v240 offset:5120
  s_waitcnt lgkmcnt(7)
  v_mfma_f32_32x32x16_bf16 v[176:191], a[120:123], v[120:123], v[176:191]
  buffer_load_dwordx4 v[60:63], v1, s[4:7], s57 offen offset:3072 sc1
  ds_read_b128 v[120:123], v240 offset:6144
  s_waitcnt lgkmcnt(7)
  v_mfma_f32_32x32x16_bf16 v[176:191], a[124:127], v[124:127], v[176:191]
  ds_read_b128 v[124:127], v240 offset:7168
  s_waitcnt lgkmcnt(7)
  v_mfma_f32_32x32x16_bf16 v[192:207], a[128:131], v[96:99], 0
  buffer_load_dwordx4 v[128:131], v8, s[4:7], s60 offen offset:0 sc1
  ds_read_b128 v[96:99], v240 offset:8192
  s_waitcnt lgkmcnt(7)
  v_mfma_f32_32x32x16_bf16 v[192:207], a[132:135], v[100:103], v[192:207]
  ds_read_b128 v[100:103], v240 offset:9216
  s_waitcnt lgkmcnt(7)
  v_mfma_f32_32x32x16_bf16 v[192:207], a[136:139], v[104:107], v[192:207]
  buffer_load_dwordx4 v[132:135], v8, s[4:7], s61 offen offset:0 sc1
  ds_read_b128 v[104:107], v240 offset:10240
  s_waitcnt lgkmcnt(7)
  v_mfma_f32_32x32x16_bf16 v[192:207], a[140:143], v[108:111], v[192:207]
  v_cvt_pk_bf16_f32 v220, v176, v177
  v_cvt_pk_bf16_f32 v221, v178, v179
  ds_read_b128 v[108:111], v240 offset:11264
  s_waitcnt lgkmcnt(7)
  v_mfma_f32_32x32x16_bf16 v[192:207], a[144:147], v[112:115], v[192:207]
  buffer_load_dwordx4 v[136:139], v8, s[4:7], s60 offen offset:512 sc1
  v_cvt_pk_bf16_f32 v222, v180, v181
  v_cvt_pk_bf16_f32 v223, v182, v183
  ds_read_b128 v[112:115], v240 offset:12288
  s_waitcnt lgkmcnt(7)
  v_mfma_f32_32x32x16_bf16 v[192:207], a[148:151], v[116:119], v[192:207]
  buffer_store_dwordx4 v[220:223], v14, s[4:7], s27 offen offset:0 sc1
  v_cvt_pk_bf16_f32 v224, v184, v185
  ds_read_b128 v[116:119], v240 offset:13312
  s_waitcnt lgkmcnt(7)
  v_mfma_f32_32x32x16_bf16 v[192:207], a[152:155], v[120:123], v[192:207]
  buffer_load_dwordx4 v[140:143], v8, s[4:7], s61 offen offset:512 sc1
  v_cvt_pk_bf16_f32 v225, v186, v187
  v_cvt_pk_bf16_f32 v226, v188, v189
  ds_read_b128 v[120:123], v240 offset:14336
  s_waitcnt lgkmcnt(7)
  v_mfma_f32_32x32x16_bf16 v[192:207], a[156:159], v[124:127], v[192:207]
  v_cvt_pk_bf16_f32 v227, v190, v191
  buffer_store_dwordx4 v[224:227], v14, s[4:7], s27 offen offset:128 sc1
  ds_read_b128 v[124:127], v240 offset:15360
  s_waitcnt lgkmcnt(7)
  v_mfma_f32_32x32x16_bf16 v[192:207], a[160:163], v[96:99], v[192:207]
  buffer_load_dwordx4 v[144:147], v8, s[4:7], s60 offen offset:1024 sc1
  ds_read_b128 v[96:99], v240 offset:16384
  s_waitcnt lgkmcnt(7)
  v_mfma_f32_32x32x16_bf16 v[192:207], a[164:167], v[100:103], v[192:207]
  ds_read_b128 v[100:103], v240 offset:17408
  s_waitcnt lgkmcnt(7)
  v_mfma_f32_32x32x16_bf16 v[192:207], a[168:171], v[104:107], v[192:207]
  buffer_load_dwordx4 v[148:151], v8, s[4:7], s61 offen offset:1024 sc1
  ds_read_b128 v[104:107], v240 offset:18432
  s_waitcnt lgkmcnt(7)
  v_mfma_f32_32x32x16_bf16 v[192:207], a[172:175], v[108:111], v[192:207]
  ds_read_b128 v[108:111], v240 offset:19456
  s_waitcnt lgkmcnt(7)
  v_mfma_f32_32x32x16_bf16 v[192:207], a[176:179], v[112:115], v[192:207]
  buffer_load_dwordx4 v[152:155], v8, s[4:7], s60 offen offset:1536 sc1
  ds_read_b128 v[112:115], v240 offset:20480
  s_waitcnt lgkmcnt(7)
  v_mfma_f32_32x32x16_bf16 v[192:207], a[180:183], v[116:119], v[192:207]
  ds_read_b128 v[116:119], v240 offset:21504
  s_waitcnt lgkmcnt(7)
  v_mfma_f32_32x32x16_bf16 v[192:207], a[184:187], v[120:123], v[192:207]
  buffer_load_dwordx4 v[156:159], v8, s[4:7], s61 offen offset:1536 sc1
  ds_read_b128 v[120:123], v240 offset:22528
  s_waitcnt lgkmcnt(7)
  v_mfma_f32_32x32x16_bf16 v[192:207], a[188:191], v[124:127], v[192:207]
  ds_read_b128 v[124:127], v240 offset:23552
  s_waitcnt lgkmcnt(7)
  v_mfma_f32_32x32x16_bf16 v[192:207], a[192:195], v[96:99], v[192:207]
  ds_read_b128 v[96:99], v240 offset:24576
  s_waitcnt lgkmcnt(7)
  v_mfma_f32_32x32x16_bf16 v[192:207], a[196:199], v[100:103], v[192:207]
  ds_read_b128 v[100:103], v240 offset:25600
  s_waitcnt lgkmcnt(7)
  v_mfma_f32_32x32x16_bf16 v[192:207], a[200:203], v[104:107], v[192:207]
  ds_read_b128 v[104:107], v240 offset:26624
  s_waitcnt lgkmcnt(7)
  v_mfma_f32_32x32x16_bf16 v[192:207], a[204:207], v[108:111], v[192:207]
  ds_read_b128 v[108:111], v240 offset:27648
  s_waitcnt lgkmcnt(7)
  v_mfma_f32_32x32x16_bf16 v[192:207], a[208:211], v[112:115], v[192:207]
  ds_read_b128 v[112:115], v240 offset:28672
  s_waitcnt lgkmcnt(7)
  v_mfma_f32_32x32x16_bf16 v[192:207], a[212:215], v[116:119], v[192:207]
  ds_read_b128 v[116:119], v240 offset:29696
  s_waitcnt lgkmcnt(7)
  v_mfma_f32_32x32x16_bf16 v[192:207], a[216:219], v[120:123], v[192:207]
  ds_read_b128 v[120:123], v240 offset:30720
  s_waitcnt lgkmcnt(7)
  v_mfma_f32_32x32x16_bf16 v[192:207], a[220:223], v[124:127], v[192:207]
  ds_read_b128 v[124:127], v240 offset:31744
  s_waitcnt lgkmcnt(7)
  v_mfma_f32_32x32x16_bf16 v[192:207], a[224:227], v[96:99], v[192:207]
  s_waitcnt lgkmcnt(6)
  v_mfma_f32_32x32x16_bf16 v[192:207], a[228:231], v[100:103], v[192:207]
  s_waitcnt lgkmcnt(5)
  v_mfma_f32_32x32x16_bf16 v[192:207], a[232:235], v[104:107], v[192:207]
  s_waitcnt lgkmcnt(4)
  v_mfma_f32_32x32x16_bf16 v[192:207], a[236:239], v[108:111], v[192:207]
  s_waitcnt lgkmcnt(3)
  v_mfma_f32_32x32x16_bf16 v[192:207], a[240:243], v[112:115], v[192:207]
  s_waitcnt lgkmcnt(2)
  v_mfma_f32_32x32x16_bf16 v[192:207], a[244:247], v[116:119], v[192:207]
  s_waitcnt lgkmcnt(1)
  v_mfma_f32_32x32x16_bf16 v[192:207], a[248:251], v[120:123], v[192:207]
  s_waitcnt lgkmcnt(0)
  v_mfma_f32_32x32x16_bf16 v[192:207], a[252:255], v[124:127], v[192:207]
  v_xor_b32 v240, 32768, v240
  v_xor_b32 v15, 32768, v15
  s_nop 9
  v_cvt_pk_bf16_f32 v228, v192, v193
  v_cvt_pk_bf16_f32 v229, v194, v195
  v_cvt_pk_bf16_f32 v230, v196, v197
  v_cvt_pk_bf16_f32 v231, v198, v199
  buffer_store_dwordx4 v[228:231], v14, s[4:7], s27 offen offset:256 sc1
  v_cvt_pk_bf16_f32 v232, v200, v201
  v_cvt_pk_bf16_f32 v233, v202, v203
  v_cvt_pk_bf16_f32 v234, v204, v205
  v_cvt_pk_bf16_f32 v235, v206, v207
  buffer_store_dwordx4 v[232:235], v14, s[4:7], s27 offen offset:384 sc1
  s_add_u32 s27, s27, 524288
  s_cmp_ge_u32 s27, s62
  s_cselect_b32 s78, 2097152, 0
  s_sub_u32 s27, s27, s78
  s_mov_b32 s34, 1
  s_cmp_eq_u32 s33, 1
  s_cbranch_scc1 aopf_108
  s_waitcnt vmcnt(0)
  s_mov_b64 exec, 1
  ds_add_rtn_u32 v239, v237, v238
  s_waitcnt lgkmcnt(0)
  v_readfirstlane_b32 s31, v239
  s_mov_b64 exec, -1
  v_xor_b32 v237, 8, v237
  s_and_b32 s31, s31, 3
  s_cmp_lg_u32 s31, 3
  s_cbranch_scc1 agg_109
  s_mov_b64 exec, 1
  buffer_store_dword v12, off, s[4:7], s30 sc1
  s_mov_b64 exec, -1
agg_109:
  s_add_u32 s30, s30, 2048
  s_mov_b32 s34, 0
  s_cmp_eq_u32 s28, 0
  s_cbranch_scc1 mega_kernel_end
  s_mov_b32 s35, 0
poll_110:
  buffer_load_dword v11, v13, s[4:7], s55 offen sc1
  s_waitcnt vmcnt(0)
  v_cmp_ne_u32 vcc, 0, v11
  s_nop 0
  s_cmp_eq_u64 vcc, exec
  s_cbranch_scc1 polld_111
  s_sleep 4
  s_add_u32 s35, s35, 1
  s_cmp_lt_u32 s35, 131072
  s_cbranch_scc1 poll_110
  s_branch mega_kernel_end
polld_111:
  s_mov_b32 s56, s50
  s_mov_b32 s58, s51
  s_mov_b32 s60, s52
  s_add_u32 s57, s56, 4096
  s_add_u32 s59, s58, 4096
  s_add_u32 s61, s60, 4096
  buffer_load_dwordx4 v[64:67], v6, s[4:7], s58 offen offset:0 sc1
  buffer_load_dwordx4 v[32:35], v1, s[4:7], s56 offen offset:0 sc1
  buffer_load_dwordx4 v[68:71], v6, s[4:7], s58 offen offset:1024 sc1
  buffer_load_dwordx4 v[36:39], v1, s[4:7], s56 offen offset:1024 sc1
  buffer_load_dwordx4 v[72:75], v6, s[4:7], s58 offen offset:2048 sc1
  buffer_load_dwordx4 v[40:43], v1, s[4:7], s56 offen offset:2048 sc1
  buffer_load_dwordx4 v[76:79], v6, s[4:7], s58 offen offset:3072 sc1
  buffer_load_dwordx4 v[44:47], v1, s[4:7], s56 offen offset:3072 sc1
  buffer_load_dwordx4 v[80:83], v6, s[4:7], s59 offen offset:0 sc1
  buffer_load_dwordx4 v[48:51], v1, s[4:7], s57 offen offset:0 sc1
  buffer_load_dwordx4 v[84:87], v6, s[4:7], s59 offen offset:1024 sc1
  buffer_load_dwordx4 v[52:55], v1, s[4:7], s57 offen offset:1024 sc1
  buffer_load_dwordx4 v[88:91], v6, s[4:7], s59 offen offset:2048 sc1
  buffer_load_dwordx4 v[56:59], v1, s[4:7], s57 offen offset:2048 sc1
  buffer_load_dwordx4 v[92:95], v6, s[4:7], s59 offen offset:3072 sc1
  buffer_load_dwordx4 v[60:63], v1, s[4:7], s57 offen offset:3072 sc1
  buffer_load_dwordx4 v[128:131], v8, s[4:7], s60 offen offset:0 sc1
  buffer_load_dwordx4 v[132:135], v8, s[4:7], s61 offen offset:0 sc1
  buffer_load_dwordx4 v[136:139], v8, s[4:7], s60 offen offset:512 sc1
  buffer_load_dwordx4 v[140:143], v8, s[4:7], s61 offen offset:512 sc1
  buffer_load_dwordx4 v[144:147], v8, s[4:7], s60 offen offset:1024 sc1
  buffer_load_dwordx4 v[148:151], v8, s[4:7], s61 offen offset:1024 sc1
  buffer_load_dwordx4 v[152:155], v8, s[4:7], s60 offen offset:1536 sc1
  buffer_load_dwordx4 v[156:159], v8, s[4:7], s61 offen offset:1536 sc1
aopf_108:
  s_add_u32 s50, s50, 524288
  s_add_u32 s51, s51, 524288
  s_add_u32 s52, s52, 524288
  s_add_u32 s55, s55, 2048
  s_branch aotop_102
r_gu_17:
  s_load_dwordx2 s[8:9], s[0:1], 64
  s_waitcnt lgkmcnt(0)
  s_mov_b32 s10, 1835008
  s_mov_b32 s11, 0x00020000
  s_load_dwordx2 s[12:13], s[0:1], 72
  s_waitcnt lgkmcnt(0)
  s_mov_b32 s14, 1835008
  s_mov_b32 s15, 0x00020000
  s_lshl_b32 s24, s98, 8
  s_lshl_b32 s40, s3, 6
  s_add_u32 s24, s24, s40
  s_mov_b32 s25, s24
  s_mul_i32 s26, s97, 4194304
  s_add_u32 s26, s26, 6291456
  s_lshl_b32 s27, s98, 13
  s_lshl_b32 s40, s3, 11
  s_add_u32 s27, s27, s40
  s_add_u32 s27, s27, 171966464
  s_lshl_b32 s40, s97, 23
  s_add_u32 s27, s27, s40
  s_mov_b32 s28, 64
  s_add_u32 s29, s46, 524288
  s_lshl_b32 s30, s98, 2
  s_add_u32 s30, s30, s46
  s_add_u32 s30, s30, 655360
  s_mov_b32 s54, 253952
  s_add_u32 s52, s27, 917504
  v_lshrrev_b32 v3, 2, v2
  s_mov_b32 s31, 3584
  v_mul_lo_u32 v6, v3, s31
  v_and_b32 v3, 3, v2
  v_lshl_add_u32 v6, v3, 4, v6
  v_bfe_u32 v4, v2, 2, 2
  v_lshrrev_b32 v5, 5, v2
  v_lshl_add_u32 v4, v5, 3, v4
  v_lshlrev_b32 v7, 6, v4
  v_bfe_u32 v4, v2, 4, 1
  v_lshl_add_u32 v7, v4, 5, v7
  v_and_b32 v4, 1, v2
  v_lshl_add_u32 v7, v4, 4, v7
  v_bfe_u32 v4, v2, 1, 1
  v_lshl_add_u32 v7, v4, 3, v7
  s_lshl_b32 s31, s3, 15
  v_add_u32 v7, s31, v7
  v_mov_b32 v14, 1
  s_lshl_b32 s36, s3, 15
  s_add_u32 m0, s36, 0
  s_nop 0
  buffer_load_dwordx4 v6, s[8:11], s24 offen lds
  s_add_u32 s24, s24, 57344
  s_add_u32 m0, m0, 1024
  s_nop 0
  buffer_load_dwordx4 v6, s[12:15], s25 offen lds
  s_add_u32 s25, s25, 57344
  s_add_u32 m0, m0, 1024
  s_nop 0
  buffer_load_dwordx4 v6, s[8:11], s24 offen lds
  s_add_u32 s24, s24, 57344
  s_add_u32 m0, m0, 1024
  s_nop 0
  buffer_load_dwordx4 v6, s[12:15], s25 offen lds
  s_add_u32 s25, s25, 57344
  s_add_u32 m0, m0, 1024
  s_nop 0
  buffer_load_dwordx4 v6, s[8:11], s24 offen lds
  s_add_u32 s24, s24, 57344
  s_add_u32 m0, m0, 1024
  s_nop 0
  buffer_load_dwordx4 v6, s[12:15], s25 offen lds
  s_add_u32 s25, s25, 57344
  s_add_u32 m0, m0, 1024
  s_nop 0
  buffer_load_dwordx4 v6, s[8:11], s24 offen lds
  s_add_u32 s24, s24, 57344
  s_add_u32 m0, m0, 1024
  s_nop 0
  buffer_load_dwordx4 v6, s[12:15], s25 offen lds
  s_add_u32 s25, s25, 57344
  s_add_u32 m0, m0, 1024
  s_nop 0
  buffer_load_dwordx4 v6, s[8:11], s24 offen lds
  s_add_u32 s24, s24, 57344
  s_add_u32 m0, m0, 1024
  s_nop 0
  buffer_load_dwordx4 v6, s[12:15], s25 offen lds
  s_add_u32 s25, s25, 57344
  s_add_u32 m0, m0, 1024
  s_nop 0
  buffer_load_dwordx4 v6, s[8:11], s24 offen lds
  s_add_u32 s24, s24, 57344
  s_add_u32 m0, m0, 1024
  s_nop 0
  buffer_load_dwordx4 v6, s[12:15], s25 offen lds
  s_add_u32 s25, s25, 57344
  s_add_u32 m0, m0, 1024
  s_nop 0
  buffer_load_dwordx4 v6, s[8:11], s24 offen lds
  s_add_u32 s24, s24, 57344
  s_add_u32 m0, m0, 1024
  s_nop 0
  buffer_load_dwordx4 v6, s[12:15], s25 offen lds
  s_add_u32 s25, s25, 57344
  s_add_u32 m0, m0, 1024
  s_nop 0
  buffer_load_dwordx4 v6, s[8:11], s24 offen lds
  s_add_u32 s24, s24, 57344
  s_add_u32 m0, m0, 1024
  s_nop 0
  buffer_load_dwordx4 v6, s[12:15], s25 offen lds
  s_add_u32 s25, s25, 57344
  s_lshl_b32 s36, s3, 15
  s_add_u32 m0, s36, 16384
  s_nop 0
  buffer_load_dwordx4 v6, s[8:11], s24 offen lds
  s_add_u32 s24, s24, 57344
  s_add_u32 m0, m0, 1024
  s_nop 0
  buffer_load_dwordx4 v6, s[12:15], s25 offen lds
  s_add_u32 s25, s25, 57344
  s_add_u32 m0, m0, 1024
  s_nop 0
  buffer_load_dwordx4 v6, s[8:11], s24 offen lds
  s_add_u32 s24, s24, 57344
  s_add_u32 m0, m0, 1024
  s_nop 0
  buffer_load_dwordx4 v6, s[12:15], s25 offen lds
  s_add_u32 s25, s25, 57344
  s_add_u32 m0, m0, 1024
  s_nop 0
  buffer_load_dwordx4 v6, s[8:11], s24 offen lds
  s_add_u32 s24, s24, 57344
  s_add_u32 m0, m0, 1024
  s_nop 0
  buffer_load_dwordx4 v6, s[12:15], s25 offen lds
  s_add_u32 s25, s25, 57344
  s_add_u32 m0, m0, 1024
  s_nop 0
  buffer_load_dwordx4 v6, s[8:11], s24 offen lds
  s_add_u32 s24, s24, 57344
  s_add_u32 m0, m0, 1024
  s_nop 0
  buffer_load_dwordx4 v6, s[12:15], s25 offen lds
  s_add_u32 s25, s25, 57344
  s_add_u32 m0, m0, 1024
  s_nop 0
  buffer_load_dwordx4 v6, s[8:11], s24 offen lds
  s_add_u32 s24, s24, 57344
  s_add_u32 m0, m0, 1024
  s_nop 0
  buffer_load_dwordx4 v6, s[12:15], s25 offen lds
  s_add_u32 s25, s25, 57344
  s_add_u32 m0, m0, 1024
  s_nop 0
  buffer_load_dwordx4 v6, s[8:11], s24 offen lds
  s_add_u32 s24, s24, 57344
  s_add_u32 m0, m0, 1024
  s_nop 0
  buffer_load_dwordx4 v6, s[12:15], s25 offen lds
  s_add_u32 s25, s25, 57344
  s_add_u32 m0, m0, 1024
  s_nop 0
  buffer_load_dwordx4 v6, s[8:11], s24 offen lds
  s_add_u32 s24, s24, 57344
  s_add_u32 m0, m0, 1024
  s_nop 0
  buffer_load_dwordx4 v6, s[12:15], s25 offen lds
  s_add_u32 s25, s25, 57344
  s_add_u32 m0, m0, 1024
  s_nop 0
  buffer_load_dwordx4 v6, s[8:11], s24 offen lds
  s_add_u32 s24, s24, 57344
  s_add_u32 m0, m0, 1024
  s_nop 0
  buffer_load_dwordx4 v6, s[12:15], s25 offen lds
  s_add_u32 s25, s25, 57344
  s_waitcnt vmcnt(16)
  ds_read_b64_tr_b16 a[0:1], v7 offset:0
  ds_read_b64_tr_b16 a[2:3], v7 offset:256
  ds_read_b64_tr_b16 a[128:129], v7 offset:1024
  ds_read_b64_tr_b16 a[130:131], v7 offset:1280
  ds_read_b64_tr_b16 a[4:5], v7 offset:2048
  ds_read_b64_tr_b16 a[6:7], v7 offset:2304
  ds_read_b64_tr_b16 a[132:133], v7 offset:3072
  ds_read_b64_tr_b16 a[134:135], v7 offset:3328
  ds_read_b64_tr_b16 a[8:9], v7 offset:4096
  ds_read_b64_tr_b16 a[10:11], v7 offset:4352
  ds_read_b64_tr_b16 a[136:137], v7 offset:5120
  ds_read_b64_tr_b16 a[138:139], v7 offset:5376
  ds_read_b64_tr_b16 a[12:13], v7 offset:6144
  ds_read_b64_tr_b16 a[14:15], v7 offset:6400
  ds_read_b64_tr_b16 a[140:141], v7 offset:7168
  ds_read_b64_tr_b16 a[142:143], v7 offset:7424
  ds_read_b64_tr_b16 a[16:17], v7 offset:8192
  ds_read_b64_tr_b16 a[18:19], v7 offset:8448
  ds_read_b64_tr_b16 a[144:145], v7 offset:9216
  ds_read_b64_tr_b16 a[146:147], v7 offset:9472
  ds_read_b64_tr_b16 a[20:21], v7 offset:10240
  ds_read_b64_tr_b16 a[22:23], v7 offset:10496
  ds_read_b64_tr_b16 a[148:149], v7 offset:11264
  ds_read_b64_tr_b16 a[150:151], v7 offset:11520
  ds_read_b64_tr_b16 a[24:25], v7 offset:12288
  ds_read_b64_tr_b16 a[26:27], v7 offset:12544
  ds_read_b64_tr_b16 a[152:153], v7 offset:13312
  ds_read_b64_tr_b16 a[154:155], v7 offset:13568
  ds_read_b64_tr_b16 a[28:29], v7 offset:14336
  ds_read_b64_tr_b16 a[30:31], v7 offset:14592
  ds_read_b64_tr_b16 a[156:157], v7 offset:15360
  ds_read_b64_tr_b16 a[158:159], v7 offset:15616
  s_waitcnt lgkmcnt(0)
  s_lshl_b32 s36, s3, 15
  s_add_u32 m0, s36, 0
  s_nop 0
  buffer_load_dwordx4 v6, s[8:11], s24 offen lds
  s_add_u32 s24, s24, 57344
  s_add_u32 m0, m0, 1024
  s_nop 0
  buffer_load_dwordx4 v6, s[12:15], s25 offen lds
  s_add_u32 s25, s25, 57344
  s_add_u32 m0, m0, 1024
  s_nop 0
  buffer_load_dwordx4 v6, s[8:11], s24 offen lds
  s_add_u32 s24, s24, 57344
  s_add_u32 m0, m0, 1024
  s_nop 0
  buffer_load_dwordx4 v6, s[12:15], s25 offen lds
  s_add_u32 s25, s25, 57344
  s_add_u32 m0, m0, 1024
  s_nop 0
  buffer_load_dwordx4 v6, s[8:11], s24 offen lds
  s_add_u32 s24, s24, 57344
  s_add_u32 m0, m0, 1024
  s_nop 0
  buffer_load_dwordx4 v6, s[12:15], s25 offen lds
  s_add_u32 s25, s25, 57344
  s_add_u32 m0, m0, 1024
  s_nop 0
  buffer_load_dwordx4 v6, s[8:11], s24 offen lds
  s_add_u32 s24, s24, 57344
  s_add_u32 m0, m0, 1024
  s_nop 0
  buffer_load_dwordx4 v6, s[12:15], s25 offen lds
  s_add_u32 s25, s25, 57344
  s_add_u32 m0, m0, 1024
  s_nop 0
  buffer_load_dwordx4 v6, s[8:11], s24 offen lds
  s_add_u32 s24, s24, 57344
  s_add_u32 m0, m0, 1024
  s_nop 0
  buffer_load_dwordx4 v6, s[12:15], s25 offen lds
  s_add_u32 s25, s25, 57344
  s_add_u32 m0, m0, 1024
  s_nop 0
  buffer_load_dwordx4 v6, s[8:11], s24 offen lds
  s_add_u32 s24, s24, 57344
  s_add_u32 m0, m0, 1024
  s_nop 0
  buffer_load_dwordx4 v6, s[12:15], s25 offen lds
  s_add_u32 s25, s25, 57344
  s_add_u32 m0, m0, 1024
  s_nop 0
  buffer_load_dwordx4 v6, s[8:11], s24 offen lds
  s_add_u32 s24, s24, 57344
  s_add_u32 m0, m0, 1024
  s_nop 0
  buffer_load_dwordx4 v6, s[12:15], s25 offen lds
  s_add_u32 s25, s25, 57344
  s_add_u32 m0, m0, 1024
  s_nop 0
  buffer_load_dwordx4 v6, s[8:11], s24 offen lds
  s_add_u32 s24, s24, 57344
  s_add_u32 m0, m0, 1024
  s_nop 0
  buffer_load_dwordx4 v6, s[12:15], s25 offen lds
  s_add_u32 s25, s25, 57344
  s_waitcnt vmcnt(16)
  ds_read_b64_tr_b16 a[32:33], v7 offset:16384
  ds_read_b64_tr_b16 a[34:35], v7 offset:16640
  ds_read_b64_tr_b16 a[160:161], v7 offset:17408
  ds_read_b64_tr_b16 a[162:163], v7 offset:17664
  ds_read_b64_tr_b16 a[36:37], v7 offset:18432
  ds_read_b64_tr_b16 a[38:39], v7 offset:18688
  ds_read_b64_tr_b16 a[164:165], v7 offset:19456
  ds_read_b64_tr_b16 a[166:167], v7 offset:19712
  ds_read_b64_tr_b16 a[40:41], v7 offset:20480
  ds_read_b64_tr_b16 a[42:43], v7 offset:20736
  ds_read_b64_tr_b16 a[168:169], v7 offset:21504
  ds_read_b64_tr_b16 a[170:171], v7 offset:21760
  ds_read_b64_tr_b16 a[44:45], v7 offset:22528
  ds_read_b64_tr_b16 a[46:47], v7 offset:22784
  ds_read_b64_tr_b16 a[172:173], v7 offset:23552
  ds_read_b64_tr_b16 a[174:175], v7 offset:23808
  ds_read_b64_tr_b16 a[48:49], v7 offset:24576
  ds_read_b64_tr_b16 a[50:51], v7 offset:24832
  ds_read_b64_tr_b16 a[176:177], v7 offset:25600
  ds_read_b64_tr_b16 a[178:179], v7 offset:25856
  ds_read_b64_tr_b16 a[52:53], v7 offset:26624
  ds_read_b64_tr_b16 a[54:55], v7 offset:26880
  ds_read_b64_tr_b16 a[180:181], v7 offset:27648
  ds_read_b64_tr_b16 a[182:183], v7 offset:27904
  ds_read_b64_tr_b16 a[56:57], v7 offset:28672
  ds_read_b64_tr_b16 a[58:59], v7 offset:28928
  ds_read_b64_tr_b16 a[184:185], v7 offset:29696
  ds_read_b64_tr_b16 a[186:187], v7 offset:29952
  ds_read_b64_tr_b16 a[60:61], v7 offset:30720
  ds_read_b64_tr_b16 a[62:63], v7 offset:30976
  ds_read_b64_tr_b16 a[188:189], v7 offset:31744
  ds_read_b64_tr_b16 a[190:191], v7 offset:32000
  s_waitcnt lgkmcnt(0)
  s_lshl_b32 s36, s3, 15
  s_add_u32 m0, s36, 16384
  s_nop 0
  buffer_load_dwordx4 v6, s[8:11], s24 offen lds
  s_add_u32 s24, s24, 57344
  s_add_u32 m0, m0, 1024
  s_nop 0
  buffer_load_dwordx4 v6, s[12:15], s25 offen lds
  s_add_u32 s25, s25, 57344
  s_add_u32 m0, m0, 1024
  s_nop 0
  buffer_load_dwordx4 v6, s[8:11], s24 offen lds
  s_add_u32 s24, s24, 57344
  s_add_u32 m0, m0, 1024
  s_nop 0
  buffer_load_dwordx4 v6, s[12:15], s25 offen lds
  s_add_u32 s25, s25, 57344
  s_add_u32 m0, m0, 1024
  s_nop 0
  buffer_load_dwordx4 v6, s[8:11], s24 offen lds
  s_add_u32 s24, s24, 57344
  s_add_u32 m0, m0, 1024
  s_nop 0
  buffer_load_dwordx4 v6, s[12:15], s25 offen lds
  s_add_u32 s25, s25, 57344
  s_add_u32 m0, m0, 1024
  s_nop 0
  buffer_load_dwordx4 v6, s[8:11], s24 offen lds
  s_add_u32 s24, s24, 57344
  s_add_u32 m0, m0, 1024
  s_nop 0
  buffer_load_dwordx4 v6, s[12:15], s25 offen lds
  s_add_u32 s25, s25, 57344
  s_add_u32 m0, m0, 1024
  s_nop 0
  buffer_load_dwordx4 v6, s[8:11], s24 offen lds
  s_add_u32 s24, s24, 57344
  s_add_u32 m0, m0, 1024
  s_nop 0
  buffer_load_dwordx4 v6, s[12:15], s25 offen lds
  s_add_u32 s25, s25, 57344
  s_add_u32 m0, m0, 1024
  s_nop 0
  buffer_load_dwordx4 v6, s[8:11], s24 offen lds
  s_add_u32 s24, s24, 57344
  s_add_u32 m0, m0, 1024
  s_nop 0
  buffer_load_dwordx4 v6, s[12:15], s25 offen lds
  s_add_u32 s25, s25, 57344
  s_add_u32 m0, m0, 1024
  s_nop 0
  buffer_load_dwordx4 v6, s[8:11], s24 offen lds
  s_add_u32 s24, s24, 57344
  s_add_u32 m0, m0, 1024
  s_nop 0
  buffer_load_dwordx4 v6, s[12:15], s25 offen lds
  s_add_u32 s25, s25, 57344
  s_add_u32 m0, m0, 1024
  s_nop 0
  buffer_load_dwordx4 v6, s[8:11], s24 offen lds
  s_add_u32 s24, s24, 57344
  s_add_u32 m0, m0, 1024
  s_nop 0
  buffer_load_dwordx4 v6, s[12:15], s25 offen lds
  s_add_u32 s25, s25, 57344
  s_waitcnt vmcnt(16)
  ds_read_b64_tr_b16 a[64:65], v7 offset:0
  ds_read_b64_tr_b16 a[66:67], v7 offset:256
  ds_read_b64_tr_b16 a[192:193], v7 offset:1024
  ds_read_b64_tr_b16 a[194:195], v7 offset:1280
  ds_read_b64_tr_b16 a[68:69], v7 offset:2048
  ds_read_b64_tr_b16 a[70:71], v7 offset:2304
  ds_read_b64_tr_b16 a[196:197], v7 offset:3072
  ds_read_b64_tr_b16 a[198:199], v7 offset:3328
  ds_read_b64_tr_b16 a[72:73], v7 offset:4096
  ds_read_b64_tr_b16 a[74:75], v7 offset:4352
  ds_read_b64_tr_b16 a[200:201], v7 offset:5120
  ds_read_b64_tr_b16 a[202:203], v7 offset:5376
  ds_read_b64_tr_b16 a[76:77], v7 offset:6144
  ds_read_b64_tr_b16 a[78:79], v7 offset:6400
  ds_read_b64_tr_b16 a[204:205], v7 offset:7168
  ds_read_b64_tr_b16 a[206:207], v7 offset:7424
  ds_read_b64_tr_b16 a[80:81], v7 offset:8192
  ds_read_b64_tr_b16 a[82:83], v7 offset:8448
  ds_read_b64_tr_b16 a[208:209], v7 offset:9216
  ds_read_b64_tr_b16 a[210:211], v7 offset:9472
  ds_read_b64_tr_b16 a[84:85], v7 offset:10240
  ds_read_b64_tr_b16 a[86:87], v7 offset:10496
  ds_read_b64_tr_b16 a[212:213], v7 offset:11264
  ds_read_b64_tr_b16 a[214:215], v7 offset:11520
  ds_read_b64_tr_b16 a[88:89], v7 offset:12288
  ds_read_b64_tr_b16 a[90:91], v7 offset:12544
  ds_read_b64_tr_b16 a[216:217], v7 offset:13312
  ds_read_b64_tr_b16 a[218:219], v7 offset:13568
  ds_read_b64_tr_b16 a[92:93], v7 offset:14336
  ds_read_b64_tr_b16 a[94:95], v7 offset:14592
  ds_read_b64_tr_b16 a[220:221], v7 offset:15360
  ds_read_b64_tr_b16 a[222:223], v7 offset:15616
  s_waitcnt lgkmcnt(0)
  s_waitcnt vmcnt(0)
  ds_read_b64_tr_b16 a[96:97], v7 offset:16384
  ds_read_b64_tr_b16 a[98:99], v7 offset:16640
  ds_read_b64_tr_b16 a[224:225], v7 offset:17408
  ds_read_b64_tr_b16 a[226:227], v7 offset:17664
  ds_read_b64_tr_b16 a[100:101], v7 offset:18432
  ds_read_b64_tr_b16 a[102:103], v7 offset:18688
  ds_read_b64_tr_b16 a[228:229], v7 offset:19456
  ds_read_b64_tr_b16 a[230:231], v7 offset:19712
  ds_read_b64_tr_b16 a[104:105], v7 offset:20480
  ds_read_b64_tr_b16 a[106:107], v7 offset:20736
  ds_read_b64_tr_b16 a[232:233], v7 offset:21504
  ds_read_b64_tr_b16 a[234:235], v7 offset:21760
  ds_read_b64_tr_b16 a[108:109], v7 offset:22528
  ds_read_b64_tr_b16 a[110:111], v7 offset:22784
  ds_read_b64_tr_b16 a[236:237], v7 offset:23552
  ds_read_b64_tr_b16 a[238:239], v7 offset:23808
  ds_read_b64_tr_b16 a[112:113], v7 offset:24576
  ds_read_b64_tr_b16 a[114:115], v7 offset:24832
  ds_read_b64_tr_b16 a[240:241], v7 offset:25600
  ds_read_b64_tr_b16 a[242:243], v7 offset:25856
  ds_read_b64_tr_b16 a[116:117], v7 offset:26624
  ds_read_b64_tr_b16 a[118:119], v7 offset:26880
  ds_read_b64_tr_b16 a[244:245], v7 offset:27648
  ds_read_b64_tr_b16 a[246:247], v7 offset:27904
  ds_read_b64_tr_b16 a[120:121], v7 offset:28672
  ds_read_b64_tr_b16 a[122:123], v7 offset:28928
  ds_read_b64_tr_b16 a[248:249], v7 offset:29696
  ds_read_b64_tr_b16 a[250:251], v7 offset:29952
  ds_read_b64_tr_b16 a[124:125], v7 offset:30720
  ds_read_b64_tr_b16 a[126:127], v7 offset:30976
  ds_read_b64_tr_b16 a[252:253], v7 offset:31744
  ds_read_b64_tr_b16 a[254:255], v7 offset:32000
  s_waitcnt lgkmcnt(0)
  v_mov_b32 v8, v1
  v_mov_b32 v9, v1
  s_mov_b32 s40, 0xbdd2d3e8
  v_mov_b32 v5, 0xc0135761
  s_cmp_eq_u32 s91, 0
  s_cbranch_scc1 gg_112
  s_lshl_b32 s31, s3, 10
  v_add_u32 v11, s31, v1
  s_mov_b32 s36, s31
  v_min_u32 v12, 3, v2
  v_lshlrev_b32 v12, 2, v12
  v_subrev_u32 v3, 4, v2
  v_cmp_gt_u32 vcc, 8, v3
  v_lshlrev_b32 v3, 2, v3
  v_add_u32 v3, s54, v3
  v_cndmask_b32 v15, v12, v3, vcc
  v_and_b32 v8, 0x7fff, v8
  v_mov_b32 v36, 163584
  v_mov_b32 v38, 0
  ds_write_b32 v36, v38
  ds_write_b32 v36, v38 offset:4
  ds_write_b32 v36, v38 offset:8
  s_waitcnt lgkmcnt(0)
  v_mov_b32 v38, 1
  v_mov_b32 v37, 163584
  s_mov_b32 s38, 1
  s_barrier
  s_cmp_lg_u32 s3, 0
  s_cbranch_scc1 wro_113
  s_mov_b32 s35, 0
poll_115:
  buffer_load_dword v13, v12, s[4:7], s29 offen sc1
  s_waitcnt vmcnt(0)
  v_cmp_ne_u32 vcc, 0, v13
  s_nop 0
  s_cmp_eq_u64 vcc, exec
  s_cbranch_scc1 polld_116
  s_sleep 8
  s_add_u32 s35, s35, 1
  s_cmp_lt_u32 s35, 131072
  s_cbranch_scc1 poll_115
  s_branch mega_kernel_end
polld_116:
  v_mov_b32 v13, s38
  ds_write_b32 v36, v13 offset:4
  s_waitcnt lgkmcnt(0)
  s_branch wrd_114
wro_113:
  s_mov_b32 s35, 0
wrl_117:
  ds_read_b32 v13, v36 offset:4
  s_add_u32 s35, s35, 1
  s_cmp_gt_u32 s35, 2097152
  s_cbranch_scc1 mega_kernel_end
  s_waitcnt lgkmcnt(0)
  v_readfirstlane_b32 s31, v13
  s_nop 0
  s_cmp_ge_u32 s31, s38
  s_cbranch_scc1 wrd_114
  s_sleep 1
  s_branch wrl_117
wrd_114:
  s_mov_b32 s37, s26
  s_mov_b32 m0, s36
  s_nop 0
  buffer_load_dwordx4 v11, s[4:7], s37 offen sc1 lds
  s_add_u32 m0, m0, 4096
  s_add_u32 s37, s37, 4096
  buffer_load_dwordx4 v11, s[4:7], s37 offen sc1 lds
  s_add_u32 m0, m0, 4096
  s_add_u32 s37, s37, 4096
  buffer_load_dwordx4 v11, s[4:7], s37 offen sc1 lds
  s_add_u32 m0, m0, 4096
  s_add_u32 s37, s37, 4096
  buffer_load_dwordx4 v11, s[4:7], s37 offen sc1 lds
  s_add_u32 m0, m0, 4096
  s_add_u32 s37, s37, 4096
  buffer_load_dwordx4 v11, s[4:7], s37 offen sc1 lds
  s_add_u32 m0, m0, 4096
  s_add_u32 s37, s37, 4096
  buffer_load_dwordx4 v11, s[4:7], s37 offen sc1 lds
  s_add_u32 m0, m0, 4096
  s_add_u32 s37, s37, 4096
  buffer_load_dwordx4 v11, s[4:7], s37 offen sc1 lds
  s_add_u32 m0, m0, 4096
  s_add_u32 s37, s37, 4096
  buffer_load_dwordx4 v11, s[4:7], s37 offen sc1 lds
  s_add_u32 s26, s26, 32768
  s_xor_b32 s36, s36, 32768
  s_add_u32 s29, s29, 1024
  s_add_u32 s38, s38, 1
  s_cmp_ge_u32 s38, 9
  s_cselect_b64 vcc, -1, 0
  v_cndmask_b32 v12, v12, v15, vcc
  s_mov_b32 s34, 0
  s_waitcnt vmcnt(0)
gtop_118:
  s_waitcnt vmcnt(2)
  s_barrier
  ds_read_b128 v[96:99], v8 offset:0
  ds_read_b128 v[100:103], v8 offset:1024
  ds_read_b128 v[104:107], v8 offset:2048
  ds_read_b128 v[108:111], v8 offset:3072
  ds_read_b128 v[112:115], v8 offset:4096
  ds_read_b128 v[116:119], v8 offset:5120
  ds_read_b128 v[120:123], v8 offset:6144
  s_sub_u32 s28, s28, 1
  v_mov_b32 v13, 0
  buffer_load_dword v13, v12, s[4:7], s29 offen sc1
  s_cmp_eq_u32 s28, 0
  s_cselect_b32 s33, 2, 0
  ds_read_b128 v[124:127], v8 offset:7168
  s_waitcnt lgkmcnt(7)
  v_mfma_f32_32x32x16_bf16 v[40:55], a[0:3], v[96:99], 0
  ds_read_b128 v[96:99], v8 offset:8192
  s_waitcnt lgkmcnt(7)
  v_mfma_f32_32x32x16_bf16 v[40:55], a[4:7], v[100:103], v[40:55]
  ds_read_b128 v[100:103], v8 offset:9216
  s_waitcnt lgkmcnt(7)
  v_mfma_f32_32x32x16_bf16 v[40:55], a[8:11], v[104:107], v[40:55]
  ds_read_b128 v[104:107], v8 offset:10240
  s_waitcnt lgkmcnt(7)
  v_mfma_f32_32x32x16_bf16 v[40:55], a[12:15], v[108:111], v[40:55]
  ds_read_b128 v[108:111], v8 offset:11264
  s_waitcnt lgkmcnt(7)
  v_mfma_f32_32x32x16_bf16 v[40:55], a[16:19], v[112:115], v[40:55]
  ds_read_b128 v[112:115], v8 offset:12288
  s_waitcnt lgkmcnt(7)
  v_mfma_f32_32x32x16_bf16 v[40:55], a[20:23], v[116:119], v[40:55]
  ds_read_b128 v[116:119], v8 offset:13312
  s_waitcnt lgkmcnt(7)
  v_mfma_f32_32x32x16_bf16 v[40:55], a[24:27], v[120:123], v[40:55]
  buffer_load_dword v13, v12, s[4:7], s29 offen sc1
  ds_read_b128 v[120:123], v8 offset:14336
  s_waitcnt lgkmcnt(7)
  v_mfma_f32_32x32x16_bf16 v[40:55], a[28:31], v[124:127], v[40:55]
  ds_read_b128 v[124:127], v8 offset:15360
  s_waitcnt lgkmcnt(7)
  v_mfma_f32_32x32x16_bf16 v[40:55], a[32:35], v[96:99], v[40:55]
  ds_read_b128 v[96:99], v8 offset:16384
  s_waitcnt lgkmcnt(7)
  v_mfma_f32_32x32x16_bf16 v[40:55], a[36:39], v[100:103], v[40:55]
  ds_read_b128 v[100:103], v8 offset:17408
  s_waitcnt lgkmcnt(7)
  v_mfma_f32_32x32x16_bf16 v[40:55], a[40:43], v[104:107], v[40:55]
  ds_read_b128 v[104:107], v8 offset:18432
  s_waitcnt lgkmcnt(7)
  v_mfma_f32_32x32x16_bf16 v[40:55], a[44:47], v[108:111], v[40:55]
  ds_read_b128 v[108:111], v8 offset:19456
  s_waitcnt lgkmcnt(7)
  v_mfma_f32_32x32x16_bf16 v[40:55], a[48:51], v[112:115], v[40:55]
  ds_read_b128 v[112:115], v8 offset:20480
  s_waitcnt lgkmcnt(7)
  v_mfma_f32_32x32x16_bf16 v[40:55], a[52:55], v[116:119], v[40:55]
  ds_read_b128 v[116:119], v8 offset:21504
  s_waitcnt lgkmcnt(7)
  v_mfma_f32_32x32x16_bf16 v[40:55], a[56:59], v[120:123], v[40:55]
  ds_read_b128 v[120:123], v8 offset:22528
  s_waitcnt lgkmcnt(7)
  v_mfma_f32_32x32x16_bf16 v[40:55], a[60:63], v[124:127], v[40:55]
  ds_read_b128 v[124:127], v8 offset:23552
  s_waitcnt lgkmcnt(7)
  v_mfma_f32_32x32x16_bf16 v[40:55], a[64:67], v[96:99], v[40:55]
  ds_read_b128 v[96:99], v8 offset:24576
  s_waitcnt lgkmcnt(7)
  v_mfma_f32_32x32x16_bf16 v[40:55], a[68:71], v[100:103], v[40:55]
  ds_read_b128 v[100:103], v8 offset:25600
  s_waitcnt lgkmcnt(7)
  v_mfma_f32_32x32x16_bf16 v[40:55], a[72:75], v[104:107], v[40:55]
  v_cmp_ne_u32 vcc, 0, v13
  s_nop 0
  s_cmp_eq_u64 vcc, exec
  s_cselect_b32 s31, s33, 1
  s_cmp_eq_u32 s31, 0
  s_cselect_b32 s37, s26, 2146435072
  s_cselect_b32 m0, s36, 65536
  s_cselect_b32 s33, 1, s33
  s_waitcnt vmcnt(2)
  v_mov_b32 v38, s34
  s_mov_b64 exec, 1
  ds_add_rtn_u32 v39, v37, v38
  s_mov_b64 exec, -1
  ds_read_b128 v[104:107], v8 offset:26624
  s_waitcnt lgkmcnt(7)
  v_mfma_f32_32x32x16_bf16 v[40:55], a[76:79], v[108:111], v[40:55]
  buffer_load_dwordx4 v11, s[4:7], s37 offen sc1 lds
  s_add_u32 m0, m0, 4096
  s_add_u32 s37, s37, 4096
  ds_read_b128 v[108:111], v8 offset:27648
  s_waitcnt lgkmcnt(7)
  v_mfma_f32_32x32x16_bf16 v[40:55], a[80:83], v[112:115], v[40:55]
  ds_read_b128 v[112:115], v8 offset:28672
  s_waitcnt lgkmcnt(7)
  v_mfma_f32_32x32x16_bf16 v[40:55], a[84:87], v[116:119], v[40:55]
  buffer_load_dwordx4 v11, s[4:7], s37 offen sc1 lds
  s_add_u32 m0, m0, 4096
  s_add_u32 s37, s37, 4096
  ds_read_b128 v[116:119], v8 offset:29696
  s_waitcnt lgkmcnt(7)
  v_mfma_f32_32x32x16_bf16 v[40:55], a[88:91], v[120:123], v[40:55]
  ds_read_b128 v[120:123], v8 offset:30720
  s_waitcnt lgkmcnt(7)
  v_mfma_f32_32x32x16_bf16 v[40:55], a[92:95], v[124:127], v[40:55]
  buffer_load_dwordx4 v11, s[4:7], s37 offen sc1 lds
  s_add_u32 m0, m0, 4096
  s_add_u32 s37, s37, 4096
  ds_read_b128 v[124:127], v8 offset:31744
  s_waitcnt lgkmcnt(7)
  v_mfma_f32_32x32x16_bf16 v[40:55], a[96:99], v[96:99], v[40:55]
  ds_read_b128 v[96:99], v8 offset:0
  s_waitcnt lgkmcnt(7)
  v_mfma_f32_32x32x16_bf16 v[40:55], a[100:103], v[100:103], v[40:55]
  buffer_load_dwordx4 v11, s[4:7], s37 offen sc1 lds
  s_add_u32 m0, m0, 4096
  s_add_u32 s37, s37, 4096
  ds_read_b128 v[100:103], v8 offset:1024
  s_waitcnt lgkmcnt(7)
  v_mfma_f32_32x32x16_bf16 v[40:55], a[104:107], v[104:107], v[40:55]
  ds_read_b128 v[104:107], v8 offset:2048
  s_waitcnt lgkmcnt(7)
  v_mfma_f32_32x32x16_bf16 v[40:55], a[108:111], v[108:111], v[40:55]
  buffer_load_dwordx4 v11, s[4:7], s37 offen sc1 lds
  s_add_u32 m0, m0, 4096
  s_add_u32 s37, s37, 4096
  ds_read_b128 v[108:111], v8 offset:3072
  s_waitcnt lgkmcnt(7)
  v_mfma_f32_32x32x16_bf16 v[40:55], a[112:115], v[112:115], v[40:55]
  v_readfirstlane_b32 s31, v39
  s_lshl_b32 s32, s34, 3
  v_xor_b32 v37, s32, v37
  v_mov_b32 v38, 1
  s_and_b32 s31, s31, 3
  s_add_u32 s31, s31, s34
  s_cmp_eq_u32 s31, 4
  s_cselect_b32 s31, s30, 2146435072
  s_mov_b64 exec, 1
  buffer_store_dword v14, off, s[4:7], s31
  s_mov_b64 exec, -1
  s_mul_i32 s32, s34, 1024
  s_add_u32 s30, s30, s32
  s_mov_b32 s34, 0
  ds_read_b128 v[112:115], v8 offset:4096
  s_waitcnt lgkmcnt(7)
  v_mfma_f32_32x32x16_bf16 v[40:55], a[116:119], v[116:119], v[40:55]
  buffer_load_dwordx4 v11, s[4:7], s37 offen sc1 lds
  s_add_u32 m0, m0, 4096
  s_add_u32 s37, s37, 4096
  ds_read_b128 v[116:119], v8 offset:5120
  s_waitcnt lgkmcnt(7)
  v_mfma_f32_32x32x16_bf16 v[40:55], a[120:123], v[120:123], v[40:55]
  ds_read_b128 v[120:123], v8 offset:6144
  s_waitcnt lgkmcnt(7)
  v_mfma_f32_32x32x16_bf16 v[40:55], a[124:127], v[124:127], v[40:55]
  buffer_load_dwordx4 v11, s[4:7], s37 offen sc1 lds
  s_add_u32 m0, m0, 4096
  s_add_u32 s37, s37, 4096
  ds_read_b128 v[124:127], v8 offset:7168
  s_waitcnt lgkmcnt(7)
  v_mfma_f32_32x32x16_bf16 v[56:71], a[128:131], v[96:99], 0
  ds_read_b128 v[96:99], v8 offset:8192
  s_waitcnt lgkmcnt(7)
  v_mfma_f32_32x32x16_bf16 v[56:71], a[132:135], v[100:103], v[56:71]
  buffer_load_dwordx4 v11, s[4:7], s37 offen sc1 lds
  s_add_u32 m0, m0, 4096
  s_add_u32 s37, s37, 4096
  ds_read_b128 v[100:103], v8 offset:9216
  s_waitcnt lgkmcnt(7)
  v_mfma_f32_32x32x16_bf16 v[56:71], a[136:139], v[104:107], v[56:71]
  ds_read_b128 v[104:107], v8 offset:10240
  s_waitcnt lgkmcnt(7)
  v_mfma_f32_32x32x16_bf16 v[56:71], a[140:143], v[108:111], v[56:71]
  v_mul_f32 v72, v40, v40
  v_mul_f32 v73, v41, v41
  v_fma_f32 v72, v72, s40, v5
  v_mul_f32 v74, v42, v42
  ds_read_b128 v[108:111], v8 offset:11264
  s_waitcnt lgkmcnt(7)
  v_mfma_f32_32x32x16_bf16 v[56:71], a[144:147], v[112:115], v[56:71]
  v_fma_f32 v73, v73, s40, v5
  v_mul_f32 v72, v72, v40
  v_exp_f32 v72, v72
  v_mul_f32 v75, v43, v43
  ds_read_b128 v[112:115], v8 offset:12288
  s_waitcnt lgkmcnt(7)
  v_mfma_f32_32x32x16_bf16 v[56:71], a[148:151], v[116:119], v[56:71]
  v_fma_f32 v74, v74, s40, v5
  v_mul_f32 v73, v73, v41
  v_exp_f32 v73, v73
  v_mul_f32 v76, v44, v44
  ds_read_b128 v[116:119], v8 offset:13312
  s_waitcnt lgkmcnt(7)
  v_mfma_f32_32x32x16_bf16 v[56:71], a[152:155], v[120:123], v[56:71]
  v_fma_f32 v75, v75, s40, v5
  v_mul_f32 v74, v74, v42
  v_add_f32 v72, 1.0, v72
  v_exp_f32 v74, v74
  ds_read_b128 v[120:123], v8 offset:14336
  s_waitcnt lgkmcnt(7)
  v_mfma_f32_32x32x16_bf16 v[56:71], a[156:159], v[124:127], v[56:71]
  v_mul_f32 v77, v45, v45
  v_fma_f32 v76, v76, s40, v5
  v_mul_f32 v75, v75, v43
  v_rcp_f32 v72, v72
  ds_read_b128 v[124:127], v8 offset:15360
  s_waitcnt lgkmcnt(7)
  v_mfma_f32_32x32x16_bf16 v[56:71], a[160:163], v[96:99], v[56:71]
  v_add_f32 v73, 1.0, v73
  v_exp_f32 v75, v75
  v_mul_f32 v78, v46, v46
  v_fma_f32 v77, v77, s40, v5
  ds_read_b128 v[96:99], v8 offset:16384
  s_waitcnt lgkmcnt(7)
  v_mfma_f32_32x32x16_bf16 v[56:71], a[164:167], v[100:103], v[56:71]
  v_mul_f32 v76, v76, v44
  v_rcp_f32 v73, v73
  v_add_f32 v74, 1.0, v74
  v_mul_f32 v72, v72, v40
  ds_read_b128 v[100:103], v8 offset:17408
  s_waitcnt lgkmcnt(7)
  v_mfma_f32_32x32x16_bf16 v[56:71], a[168:171], v[104:107], v[56:71]
  v_exp_f32 v76, v76
  v_mul_f32 v79, v47, v47
  v_fma_f32 v78, v78, s40, v5
  v_mul_f32 v77, v77, v45
  ds_read_b128 v[104:107], v8 offset:18432
  s_waitcnt lgkmcnt(7)
  v_mfma_f32_32x32x16_bf16 v[56:71], a[172:175], v[108:111], v[56:71]
  v_rcp_f32 v74, v74
  v_add_f32 v75, 1.0, v75
  v_mul_f32 v73, v73, v41
  v_exp_f32 v77, v77
  ds_read_b128 v[108:111], v8 offset:19456
  s_waitcnt lgkmcnt(7)
  v_mfma_f32_32x32x16_bf16 v[56:71], a[176:179], v[112:115], v[56:71]
  v_mul_f32 v80, v48, v48
  v_fma_f32 v79, v79, s40, v5
  v_mul_f32 v78, v78, v46
  v_rcp_f32 v75, v75
  buffer_load_dword v13, v12, s[4:7], s29 offen sc1
  ds_read_b128 v[112:115], v8 offset:20480
  s_waitcnt lgkmcnt(7)
  v_mfma_f32_32x32x16_bf16 v[56:71], a[180:183], v[116:119], v[56:71]
  v_add_f32 v76, 1.0, v76
  v_mul_f32 v74, v74, v42
  v_exp_f32 v78, v78
  v_mul_f32 v81, v49, v49
  ds_read_b128 v[116:119], v8 offset:21504
  s_waitcnt lgkmcnt(7)
  v_mfma_f32_32x32x16_bf16 v[56:71], a[184:187], v[120:123], v[56:71]
  v_fma_f32 v80, v80, s40, v5
  v_mul_f32 v79, v79, v47
  v_rcp_f32 v76, v76
  v_add_f32 v77, 1.0, v77
  ds_read_b128 v[120:123], v8 offset:22528
  s_waitcnt lgkmcnt(7)
  v_mfma_f32_32x32x16_bf16 v[56:71], a[188:191], v[124:127], v[56:71]
  v_mul_f32 v75, v75, v43
  v_exp_f32 v79, v79
  v_mul_f32 v82, v50, v50
  v_fma_f32 v81, v81, s40, v5
  ds_read_b128 v[124:127], v8 offset:23552
  s_waitcnt lgkmcnt(7)
  v_mfma_f32_32x32x16_bf16 v[56:71], a[192:195], v[96:99], v[56:71]
  v_mul_f32 v80, v80, v48
  v_rcp_f32 v77, v77
  v_add_f32 v78, 1.0, v78
  v_mul_f32 v76, v76, v44
  ds_read_b128 v[96:99], v8 offset:24576
  s_waitcnt lgkmcnt(7)
  v_mfma_f32_32x32x16_bf16 v[56:71], a[196:199], v[100:103], v[56:71]
  v_exp_f32 v80, v80
  v_mul_f32 v83, v51, v51
  v_fma_f32 v82, v82, s40, v5
  v_mul_f32 v81, v81, v49
  ds_read_b128 v[100:103], v8 offset:25600
  s_waitcnt lgkmcnt(7)
  v_mfma_f32_32x32x16_bf16 v[56:71], a[200:203], v[104:107], v[56:71]
  v_rcp_f32 v78, v78
  v_add_f32 v79, 1.0, v79
  v_mul_f32 v77, v77, v45
  v_exp_f32 v81, v81
  ds_read_b128 v[104:107], v8 offset:26624
  s_waitcnt lgkmcnt(7)
  v_mfma_f32_32x32x16_bf16 v[56:71], a[204:207], v[108:111], v[56:71]
  v_mul_f32 v84, v52, v52
  v_fma_f32 v83, v83, s40, v5
  v_mul_f32 v82, v82, v50
  v_rcp_f32 v79, v79
  ds_read_b128 v[108:111], v8 offset:27648
  s_waitcnt lgkmcnt(7)
  v_mfma_f32_32x32x16_bf16 v[56:71], a[208:211], v[112:115], v[56:71]
  v_add_f32 v80, 1.0, v80
  v_mul_f32 v78, v78, v46
  v_exp_f32 v82, v82
  v_mul_f32 v85, v53, v53
  ds_read_b128 v[112:115], v8 offset:28672
  s_waitcnt lgkmcnt(7)
  v_mfma_f32_32x32x16_bf16 v[56:71], a[212:215], v[116:119], v[56:71]
  v_fma_f32 v84, v84, s40, v5
  v_mul_f32 v83, v83, v51
  v_rcp_f32 v80, v80
  v_add_f32 v81, 1.0, v81
  ds_read_b128 v[116:119], v8 offset:29696
  s_waitcnt lgkmcnt(7)
  v_mfma_f32_32x32x16_bf16 v[56:71], a[216:219], v[120:123], v[56:71]
  v_mul_f32 v79, v79, v47
  v_exp_f32 v83, v83
  v_mul_f32 v86, v54, v54
  v_fma_f32 v85, v85, s40, v5
  ds_read_b128 v[120:123], v8 offset:30720
  s_waitcnt lgkmcnt(7)
  v_mfma_f32_32x32x16_bf16 v[56:71], a[220:223], v[124:127], v[56:71]
  v_mul_f32 v84, v84, v52
  v_rcp_f32 v81, v81
  v_add_f32 v82, 1.0, v82
  v_mul_f32 v80, v80, v48
  ds_read_b128 v[124:127], v8 offset:31744
  s_waitcnt lgkmcnt(7)
  v_mfma_f32_32x32x16_bf16 v[56:71], a[224:227], v[96:99], v[56:71]
  v_exp_f32 v84, v84
  v_mul_f32 v87, v55, v55
  v_fma_f32 v86, v86, s40, v5
  v_mul_f32 v85, v85, v53
  s_waitcnt lgkmcnt(6)
  v_mfma_f32_32x32x16_bf16 v[56:71], a[228:231], v[100:103], v[56:71]
  v_rcp_f32 v82, v82
  v_add_f32 v83, 1.0, v83
  v_mul_f32 v81, v81, v49
  v_exp_f32 v85, v85
  s_waitcnt lgkmcnt(5)
  v_mfma_f32_32x32x16_bf16 v[56:71], a[232:235], v[104:107], v[56:71]
  v_fma_f32 v87, v87, s40, v5
  v_mul_f32 v86, v86, v54
  v_rcp_f32 v83, v83
  v_add_f32 v84, 1.0, v84
  buffer_load_dword v13, v12, s[4:7], s29 offen sc1
  s_waitcnt lgkmcnt(4)
  v_mfma_f32_32x32x16_bf16 v[56:71], a[236:239], v[108:111], v[56:71]
  v_mul_f32 v82, v82, v50
  v_exp_f32 v86, v86
  v_mul_f32 v87, v87, v55
  v_rcp_f32 v84, v84
  s_waitcnt lgkmcnt(3)
  v_mfma_f32_32x32x16_bf16 v[56:71], a[240:243], v[112:115], v[56:71]
  v_add_f32 v85, 1.0, v85
  v_mul_f32 v83, v83, v51
  v_exp_f32 v87, v87
  v_rcp_f32 v85, v85
  s_waitcnt lgkmcnt(2)
  v_mfma_f32_32x32x16_bf16 v[56:71], a[244:247], v[116:119], v[56:71]
  v_add_f32 v86, 1.0, v86
  v_mul_f32 v84, v84, v52
  v_rcp_f32 v86, v86
  v_add_f32 v87, 1.0, v87
  s_waitcnt lgkmcnt(1)
  v_mfma_f32_32x32x16_bf16 v[56:71], a[248:251], v[120:123], v[56:71]
  v_mul_f32 v85, v85, v53
  v_rcp_f32 v87, v87
  v_mul_f32 v86, v86, v54
  v_mul_f32 v87, v87, v55
  s_waitcnt lgkmcnt(0)
  v_mfma_f32_32x32x16_bf16 v[56:71], a[252:255], v[124:127], v[56:71]
  v_xor_b32 v8, 32768, v8
  s_nop 10
  v_mul_f32 v72, v72, v56
  v_mul_f32 v73, v73, v57
  v_mul_f32 v74, v74, v58
  v_mul_f32 v75, v75, v59
  v_mul_f32 v76, v76, v60
  v_mul_f32 v77, v77, v61
  v_mul_f32 v78, v78, v62
  v_mul_f32 v79, v79, v63
  v_cvt_pk_bf16_f32 v88, v72, v73
  v_cvt_pk_bf16_f32 v89, v74, v75
  v_cvt_pk_bf16_f32 v90, v76, v77
  v_cvt_pk_bf16_f32 v91, v78, v79
  buffer_store_dwordx4 v[88:91], v9, s[4:7], s27 offen offset:0
  v_mul_f32 v80, v80, v64
  v_mul_f32 v81, v81, v65
  v_mul_f32 v82, v82, v66
  v_mul_f32 v83, v83, v67
  v_mul_f32 v84, v84, v68
  v_mul_f32 v85, v85, v69
  v_mul_f32 v86, v86, v70
  v_mul_f32 v87, v87, v71
  v_cvt_pk_bf16_f32 v92, v80, v81
  v_cvt_pk_bf16_f32 v93, v82, v83
  v_cvt_pk_bf16_f32 v94, v84, v85
  v_cvt_pk_bf16_f32 v95, v86, v87
  buffer_store_dwordx4 v[92:95], v9, s[4:7], s27 offen offset:1024
  s_add_u32 s27, s27, 114688
  s_cmp_ge_u32 s27, s52
  s_cselect_b32 s78, 917504, 0
  s_sub_u32 s27, s27, s78
  s_mov_b32 s34, 1
  s_cmp_eq_u32 s28, 0
  s_cbranch_scc1 glast_119
  s_cmp_eq_u32 s33, 0
  s_cbranch_scc1 gblk_120
  s_cmp_lg_u32 s3, 0
  s_cbranch_scc1 post_121
  v_mov_b32 v39, s38
  ds_write_b32 v36, v39 offset:4
  s_waitcnt lgkmcnt(0)
post_121:
  s_add_u32 s26, s26, 32768
  s_xor_b32 s36, s36, 32768
  s_add_u32 s29, s29, 1024
  s_add_u32 s38, s38, 1
  s_cmp_ge_u32 s38, 9
  s_cselect_b64 vcc, -1, 0
  v_cndmask_b32 v12, v12, v15, vcc
  s_branch gtop_118
gblk_120:
  s_waitcnt vmcnt(2)
  v_cmp_ne_u32 vcc, 0, v13
  s_nop 0
  s_cmp_eq_u64 vcc, exec
  s_cbranch_scc0 gblk2_122
  s_cmp_lg_u32 s3, 0
  s_cbranch_scc1 post_123
  v_mov_b32 v39, s38
  ds_write_b32 v36, v39 offset:4
  s_waitcnt lgkmcnt(0)
post_123:
  s_mov_b32 s37, s26
  s_mov_b32 m0, s36
  s_nop 0
  buffer_load_dwordx4 v11, s[4:7], s37 offen sc1 lds
  s_add_u32 m0, m0, 4096
  s_add_u32 s37, s37, 4096
  buffer_load_dwordx4 v11, s[4:7], s37 offen sc1 lds
  s_add_u32 m0, m0, 4096
  s_add_u32 s37, s37, 4096
  buffer_load_dwordx4 v11, s[4:7], s37 offen sc1 lds
  s_add_u32 m0, m0, 4096
  s_add_u32 s37, s37, 4096
  buffer_load_dwordx4 v11, s[4:7], s37 offen sc1 lds
  s_add_u32 m0, m0, 4096
  s_add_u32 s37, s37, 4096
  buffer_load_dwordx4 v11, s[4:7], s37 offen sc1 lds
  s_add_u32 m0, m0, 4096
  s_add_u32 s37, s37, 4096
  buffer_load_dwordx4 v11, s[4:7], s37 offen sc1 lds
  s_add_u32 m0, m0, 4096
  s_add_u32 s37, s37, 4096
  buffer_load_dwordx4 v11, s[4:7], s37 offen sc1 lds
  s_add_u32 m0, m0, 4096
  s_add_u32 s37, s37, 4096
  buffer_load_dwordx4 v11, s[4:7], s37 offen sc1 lds
  s_add_u32 s26, s26, 32768
  s_xor_b32 s36, s36, 32768
  s_add_u32 s29, s29, 1024
  s_add_u32 s38, s38, 1
  s_cmp_ge_u32 s38, 9
  s_cselect_b64 vcc, -1, 0
  v_cndmask_b32 v12, v12, v15, vcc
  s_waitcnt vmcnt(8)
  s_mov_b64 exec, 1
  ds_add_rtn_u32 v39, v37, v38
  s_waitcnt lgkmcnt(0)
  v_readfirstlane_b32 s31, v39
  s_mov_b64 exec, -1
  v_xor_b32 v37, 8, v37
  s_and_b32 s31, s31, 3
  s_cmp_lg_u32 s31, 3
  s_cbranch_scc1 agg_124
  s_mov_b64 exec, 1
  buffer_store_dword v14, off, s[4:7], s30
  s_mov_b64 exec, -1
  s_waitcnt vmcnt(1)
  s_branch aggj_125
agg_124:
  s_waitcnt vmcnt(0)
aggj_125:
  s_add_u32 s30, s30, 1024
  s_mov_b32 s34, 0
  s_branch gtop_118
gblk2_122:
  s_waitcnt vmcnt(0)
  s_mov_b64 exec, 1
  ds_add_rtn_u32 v39, v37, v38
  s_waitcnt lgkmcnt(0)
  v_readfirstlane_b32 s31, v39
  s_mov_b64 exec, -1
  v_xor_b32 v37, 8, v37
  s_and_b32 s31, s31, 3
  s_cmp_lg_u32 s31, 3
  s_cbranch_scc1 agg_126
  s_mov_b64 exec, 1
  buffer_store_dword v14, off, s[4:7], s30
  s_mov_b64 exec, -1
agg_126:
  s_add_u32 s30, s30, 1024
  s_mov_b32 s34, 0
  s_cmp_lg_u32 s3, 0
  s_cbranch_scc1 wro_127
  s_mov_b32 s35, 0
poll_129:
  buffer_load_dword v13, v12, s[4:7], s29 offen sc1
  s_waitcnt vmcnt(0)
  v_cmp_ne_u32 vcc, 0, v13
  s_nop 0
  s_cmp_eq_u64 vcc, exec
  s_cbranch_scc1 polld_130
  s_sleep 2
  s_add_u32 s35, s35, 1
  s_cmp_lt_u32 s35, 131072
  s_cbranch_scc1 poll_129
  s_branch mega_kernel_end
polld_130:
  v_mov_b32 v13, s38
  ds_write_b32 v36, v13 offset:4
  s_waitcnt lgkmcnt(0)
  s_branch wrd_128
wro_127:
  s_mov_b32 s35, 0
wrl_131:
  ds_read_b32 v13, v36 offset:4
  s_add_u32 s35, s35, 1
  s_cmp_gt_u32 s35, 2097152
  s_cbranch_scc1 mega_kernel_end
  s_waitcnt lgkmcnt(0)
  v_readfirstlane_b32 s31, v13
  s_nop 0
  s_cmp_ge_u32 s31, s38
  s_cbranch_scc1 wrd_128
  s_sleep 1
  s_branch wrl_131
wrd_128:
  s_mov_b32 s37, s26
  s_mov_b32 m0, s36
  s_nop 0
  buffer_load_dwordx4 v11, s[4:7], s37 offen sc1 lds
  s_add_u32 m0, m0, 4096
  s_add_u32 s37, s37, 4096
  buffer_load_dwordx4 v11, s[4:7], s37 offen sc1 lds
  s_add_u32 m0, m0, 4096
  s_add_u32 s37, s37, 4096
  buffer_load_dwordx4 v11, s[4:7], s37 offen sc1 lds
  s_add_u32 m0, m0, 4096
  s_add_u32 s37, s37, 4096
  buffer_load_dwordx4 v11, s[4:7], s37 offen sc1 lds
  s_add_u32 m0, m0, 4096
  s_add_u32 s37, s37, 4096
  buffer_load_dwordx4 v11, s[4:7], s37 offen sc1 lds
  s_add_u32 m0, m0, 4096
  s_add_u32 s37, s37, 4096
  buffer_load_dwordx4 v11, s[4:7], s37 offen sc1 lds
  s_add_u32 m0, m0, 4096
  s_add_u32 s37, s37, 4096
  buffer_load_dwordx4 v11, s[4:7], s37 offen sc1 lds
  s_add_u32 m0, m0, 4096
  s_add_u32 s37, s37, 4096
  buffer_load_dwordx4 v11, s[4:7], s37 offen sc1 lds
  s_add_u32 s26, s26, 32768
  s_xor_b32 s36, s36, 32768
  s_add_u32 s29, s29, 1024
  s_add_u32 s38, s38, 1
  s_cmp_ge_u32 s38, 9
  s_cselect_b64 vcc, -1, 0
  v_cndmask_b32 v12, v12, v15, vcc
  s_waitcnt vmcnt(0)
  s_branch gtop_118
glast_119:
  s_waitcnt vmcnt(0)
  s_mov_b64 exec, 1
  ds_add_rtn_u32 v39, v37, v38
  s_waitcnt lgkmcnt(0)
  v_readfirstlane_b32 s31, v39
  s_mov_b64 exec, -1
  v_xor_b32 v37, 8, v37
  s_and_b32 s31, s31, 3
  s_cmp_lg_u32 s31, 3
  s_cbranch_scc1 agg_132
  s_mov_b64 exec, 1
  buffer_store_dword v14, off, s[4:7], s30
  s_mov_b64 exec, -1
agg_132:
  s_add_u32 s30, s30, 1024
  s_mov_b32 s34, 0
  s_branch mega_kernel_end
gg_112:
  s_lshl_b32 s31, s3, 10
  v_add_u32 v11, s31, v1
  s_mov_b32 s36, s31
  v_min_u32 v12, 3, v2
  v_lshlrev_b32 v12, 2, v12
  v_subrev_u32 v3, 4, v2
  v_cmp_gt_u32 vcc, 8, v3
  v_lshlrev_b32 v3, 2, v3
  v_add_u32 v3, s54, v3
  v_cndmask_b32 v15, v12, v3, vcc
  v_and_b32 v8, 0x7fff, v8
  v_mov_b32 v36, 163584
  v_mov_b32 v38, 0
  ds_write_b32 v36, v38
  ds_write_b32 v36, v38 offset:4
  ds_write_b32 v36, v38 offset:8
  s_waitcnt lgkmcnt(0)
  v_mov_b32 v38, 1
  v_mov_b32 v37, 163584
  s_mov_b32 s38, 1
  s_barrier
  s_cmp_lg_u32 s3, 0
  s_cbranch_scc1 wro_133
  s_mov_b32 s35, 0
poll_135:
  buffer_load_dword v13, v12, s[4:7], s29 offen sc1
  s_waitcnt vmcnt(0)
  v_cmp_ne_u32 vcc, 0, v13
  s_nop 0
  s_cmp_eq_u64 vcc, exec
  s_cbranch_scc1 polld_136
  s_sleep 8
  s_add_u32 s35, s35, 1
  s_cmp_lt_u32 s35, 131072
  s_cbranch_scc1 poll_135
  s_branch mega_kernel_end
polld_136:
  v_mov_b32 v13, s38
  ds_write_b32 v36, v13 offset:4
  s_waitcnt lgkmcnt(0)
  s_branch wrd_134
wro_133:
  s_mov_b32 s35, 0
wrl_137:
  ds_read_b32 v13, v36 offset:4
  s_add_u32 s35, s35, 1
  s_cmp_gt_u32 s35, 2097152
  s_cbranch_scc1 mega_kernel_end
  s_waitcnt lgkmcnt(0)
  v_readfirstlane_b32 s31, v13
  s_nop 0
  s_cmp_ge_u32 s31, s38
  s_cbranch_scc1 wrd_134
  s_sleep 1
  s_branch wrl_137
wrd_134:
  s_mov_b32 s37, s26
  s_mov_b32 m0, s36
  s_nop 0
  buffer_load_dwordx4 v11, s[4:7], s37 offen sc1 lds
  s_add_u32 m0, m0, 4096
  s_add_u32 s37, s37, 4096
  buffer_load_dwordx4 v11, s[4:7], s37 offen sc1 lds
  s_add_u32 m0, m0, 4096
  s_add_u32 s37, s37, 4096
  buffer_load_dwordx4 v11, s[4:7], s37 offen sc1 lds
  s_add_u32 m0, m0, 4096
  s_add_u32 s37, s37, 4096
  buffer_load_dwordx4 v11, s[4:7], s37 offen sc1 lds
  s_add_u32 m0, m0, 4096
  s_add_u32 s37, s37, 4096
  buffer_load_dwordx4 v11, s[4:7], s37 offen sc1 lds
  s_add_u32 m0, m0, 4096
  s_add_u32 s37, s37, 4096
  buffer_load_dwordx4 v11, s[4:7], s37 offen sc1 lds
  s_add_u32 m0, m0, 4096
  s_add_u32 s37, s37, 4096
  buffer_load_dwordx4 v11, s[4:7], s37 offen sc1 lds
  s_add_u32 m0, m0, 4096
  s_add_u32 s37, s37, 4096
  buffer_load_dwordx4 v11, s[4:7], s37 offen sc1 lds
  s_add_u32 s26, s26, 32768
  s_xor_b32 s36, s36, 32768
  s_add_u32 s29, s29, 1024
  s_add_u32 s38, s38, 1
  s_cmp_ge_u32 s38, 9
  s_cselect_b64 vcc, -1, 0
  v_cndmask_b32 v12, v12, v15, vcc
  s_mov_b32 s34, 0
  s_waitcnt vmcnt(0)
gtop_138:
  s_waitcnt vmcnt(2)
  s_barrier
  ds_read_b128 v[96:99], v8 offset:0
  ds_read_b128 v[100:103], v8 offset:1024
  ds_read_b128 v[104:107], v8 offset:2048
  ds_read_b128 v[108:111], v8 offset:3072
  ds_read_b128 v[112:115], v8 offset:4096
  ds_read_b128 v[116:119], v8 offset:5120
  ds_read_b128 v[120:123], v8 offset:6144
  s_sub_u32 s28, s28, 1
  v_mov_b32 v13, 0
  buffer_load_dword v13, v12, s[4:7], s29 offen sc1
  s_cmp_eq_u32 s28, 0
  s_cselect_b32 s33, 2, 0
  ds_read_b128 v[124:127], v8 offset:7168
  s_waitcnt lgkmcnt(7)
  v_mfma_f32_32x32x16_bf16 v[40:55], a[0:3], v[96:99], 0
  ds_read_b128 v[96:99], v8 offset:8192
  s_waitcnt lgkmcnt(7)
  v_mfma_f32_32x32x16_bf16 v[40:55], a[4:7], v[100:103], v[40:55]
  ds_read_b128 v[100:103], v8 offset:9216
  s_waitcnt lgkmcnt(7)
  v_mfma_f32_32x32x16_bf16 v[40:55], a[8:11], v[104:107], v[40:55]
  ds_read_b128 v[104:107], v8 offset:10240
  s_waitcnt lgkmcnt(7)
  v_mfma_f32_32x32x16_bf16 v[40:55], a[12:15], v[108:111], v[40:55]
  ds_read_b128 v[108:111], v8 offset:11264
  s_waitcnt lgkmcnt(7)
  v_mfma_f32_32x32x16_bf16 v[40:55], a[16:19], v[112:115], v[40:55]
  ds_read_b128 v[112:115], v8 offset:12288
  s_waitcnt lgkmcnt(7)
  v_mfma_f32_32x32x16_bf16 v[40:55], a[20:23], v[116:119], v[40:55]
  ds_read_b128 v[116:119], v8 offset:13312
  s_waitcnt lgkmcnt(7)
  v_mfma_f32_32x32x16_bf16 v[40:55], a[24:27], v[120:123], v[40:55]
  buffer_load_dword v13, v12, s[4:7], s29 offen sc1
  ds_read_b128 v[120:123], v8 offset:14336
  s_waitcnt lgkmcnt(7)
  v_mfma_f32_32x32x16_bf16 v[40:55], a[28:31], v[124:127], v[40:55]
  ds_read_b128 v[124:127], v8 offset:15360
  s_waitcnt lgkmcnt(7)
  v_mfma_f32_32x32x16_bf16 v[40:55], a[32:35], v[96:99], v[40:55]
  ds_read_b128 v[96:99], v8 offset:16384
  s_waitcnt lgkmcnt(7)
  v_mfma_f32_32x32x16_bf16 v[40:55], a[36:39], v[100:103], v[40:55]
  ds_read_b128 v[100:103], v8 offset:17408
  s_waitcnt lgkmcnt(7)
  v_mfma_f32_32x32x16_bf16 v[40:55], a[40:43], v[104:107], v[40:55]
  ds_read_b128 v[104:107], v8 offset:18432
  s_waitcnt lgkmcnt(7)
  v_mfma_f32_32x32x16_bf16 v[40:55], a[44:47], v[108:111], v[40:55]
  ds_read_b128 v[108:111], v8 offset:19456
  s_waitcnt lgkmcnt(7)
  v_mfma_f32_32x32x16_bf16 v[40:55], a[48:51], v[112:115], v[40:55]
  ds_read_b128 v[112:115], v8 offset:20480
  s_waitcnt lgkmcnt(7)
  v_mfma_f32_32x32x16_bf16 v[40:55], a[52:55], v[116:119], v[40:55]
  ds_read_b128 v[116:119], v8 offset:21504
  s_waitcnt lgkmcnt(7)
  v_mfma_f32_32x32x16_bf16 v[40:55], a[56:59], v[120:123], v[40:55]
  ds_read_b128 v[120:123], v8 offset:22528
  s_waitcnt lgkmcnt(7)
  v_mfma_f32_32x32x16_bf16 v[40:55], a[60:63], v[124:127], v[40:55]
  ds_read_b128 v[124:127], v8 offset:23552
  s_waitcnt lgkmcnt(7)
  v_mfma_f32_32x32x16_bf16 v[40:55], a[64:67], v[96:99], v[40:55]
  ds_read_b128 v[96:99], v8 offset:24576
  s_waitcnt lgkmcnt(7)
  v_mfma_f32_32x32x16_bf16 v[40:55], a[68:71], v[100:103], v[40:55]
  ds_read_b128 v[100:103], v8 offset:25600
  s_waitcnt lgkmcnt(7)
  v_mfma_f32_32x32x16_bf16 v[40:55], a[72:75], v[104:107], v[40:55]
  v_cmp_ne_u32 vcc, 0, v13
  s_nop 0
  s_cmp_eq_u64 vcc, exec
  s_cselect_b32 s31, s33, 1
  s_cmp_eq_u32 s31, 0
  s_cselect_b32 s37, s26, 2146435072
  s_cselect_b32 m0, s36, 65536
  s_cselect_b32 s33, 1, s33
  s_waitcnt vmcnt(2)
  v_mov_b32 v38, s34
  s_mov_b64 exec, 1
  ds_add_rtn_u32 v39, v37, v38
  s_mov_b64 exec, -1
  ds_read_b128 v[104:107], v8 offset:26624
  s_waitcnt lgkmcnt(7)
  v_mfma_f32_32x32x16_bf16 v[40:55], a[76:79], v[108:111], v[40:55]
  buffer_load_dwordx4 v11, s[4:7], s37 offen sc1 lds
  s_add_u32 m0, m0, 4096
  s_add_u32 s37, s37, 4096
  ds_read_b128 v[108:111], v8 offset:27648
  s_waitcnt lgkmcnt(7)
  v_mfma_f32_32x32x16_bf16 v[40:55], a[80:83], v[112:115], v[40:55]
  ds_read_b128 v[112:115], v8 offset:28672
  s_waitcnt lgkmcnt(7)
  v_mfma_f32_32x32x16_bf16 v[40:55], a[84:87], v[116:119], v[40:55]
  buffer_load_dwordx4 v11, s[4:7], s37 offen sc1 lds
  s_add_u32 m0, m0, 4096
  s_add_u32 s37, s37, 4096
  ds_read_b128 v[116:119], v8 offset:29696
  s_waitcnt lgkmcnt(7)
  v_mfma_f32_32x32x16_bf16 v[40:55], a[88:91], v[120:123], v[40:55]
  ds_read_b128 v[120:123], v8 offset:30720
  s_waitcnt lgkmcnt(7)
  v_mfma_f32_32x32x16_bf16 v[40:55], a[92:95], v[124:127], v[40:55]
  buffer_load_dwordx4 v11, s[4:7], s37 offen sc1 lds
  s_add_u32 m0, m0, 4096
  s_add_u32 s37, s37, 4096
  ds_read_b128 v[124:127], v8 offset:31744
  s_waitcnt lgkmcnt(7)
  v_mfma_f32_32x32x16_bf16 v[40:55], a[96:99], v[96:99], v[40:55]
  ds_read_b128 v[96:99], v8 offset:0
  s_waitcnt lgkmcnt(7)
  v_mfma_f32_32x32x16_bf16 v[40:55], a[100:103], v[100:103], v[40:55]
  buffer_load_dwordx4 v11, s[4:7], s37 offen sc1 lds
  s_add_u32 m0, m0, 4096
  s_add_u32 s37, s37, 4096
  ds_read_b128 v[100:103], v8 offset:1024
  s_waitcnt lgkmcnt(7)
  v_mfma_f32_32x32x16_bf16 v[40:55], a[104:107], v[104:107], v[40:55]
  ds_read_b128 v[104:107], v8 offset:2048
  s_waitcnt lgkmcnt(7)
  v_mfma_f32_32x32x16_bf16 v[40:55], a[108:111], v[108:111], v[40:55]
  buffer_load_dwordx4 v11, s[4:7], s37 offen sc1 lds
  s_add_u32 m0, m0, 4096
  s_add_u32 s37, s37, 4096
  ds_read_b128 v[108:111], v8 offset:3072
  s_waitcnt lgkmcnt(7)
  v_mfma_f32_32x32x16_bf16 v[40:55], a[112:115], v[112:115], v[40:55]
  v_readfirstlane_b32 s31, v39
  s_lshl_b32 s32, s34, 3
  v_xor_b32 v37, s32, v37
  v_mov_b32 v38, 1
  s_and_b32 s31, s31, 3
  s_add_u32 s31, s31, s34
  s_cmp_eq_u32 s31, 4
  s_cselect_b32 s31, s30, 2146435072
  s_mov_b64 exec, 1
  buffer_store_dword v14, off, s[4:7], s31 sc1
  s_mov_b64 exec, -1
  s_mul_i32 s32, s34, 1024
  s_add_u32 s30, s30, s32
  s_mov_b32 s34, 0
  ds_read_b128 v[112:115], v8 offset:4096
  s_waitcnt lgkmcnt(7)
  v_mfma_f32_32x32x16_bf16 v[40:55], a[116:119], v[116:119], v[40:55]
  buffer_load_dwordx4 v11, s[4:7], s37 offen sc1 lds
  s_add_u32 m0, m0, 4096
  s_add_u32 s37, s37, 4096
  ds_read_b128 v[116:119], v8 offset:5120
  s_waitcnt lgkmcnt(7)
  v_mfma_f32_32x32x16_bf16 v[40:55], a[120:123], v[120:123], v[40:55]
  ds_read_b128 v[120:123], v8 offset:6144
  s_waitcnt lgkmcnt(7)
  v_mfma_f32_32x32x16_bf16 v[40:55], a[124:127], v[124:127], v[40:55]
  buffer_load_dwordx4 v11, s[4:7], s37 offen sc1 lds
  s_add_u32 m0, m0, 4096
  s_add_u32 s37, s37, 4096
  ds_read_b128 v[124:127], v8 offset:7168
  s_waitcnt lgkmcnt(7)
  v_mfma_f32_32x32x16_bf16 v[56:71], a[128:131], v[96:99], 0
  ds_read_b128 v[96:99], v8 offset:8192
  s_waitcnt lgkmcnt(7)
  v_mfma_f32_32x32x16_bf16 v[56:71], a[132:135], v[100:103], v[56:71]
  buffer_load_dwordx4 v11, s[4:7], s37 offen sc1 lds
  s_add_u32 m0, m0, 4096
  s_add_u32 s37, s37, 4096
  ds_read_b128 v[100:103], v8 offset:9216
  s_waitcnt lgkmcnt(7)
  v_mfma_f32_32x32x16_bf16 v[56:71], a[136:139], v[104:107], v[56:71]
  ds_read_b128 v[104:107], v8 offset:10240
  s_waitcnt lgkmcnt(7)
  v_mfma_f32_32x32x16_bf16 v[56:71], a[140:143], v[108:111], v[56:71]
  v_mul_f32 v72, v40, v40
  v_mul_f32 v73, v41, v41
  v_fma_f32 v72, v72, s40, v5
  v_mul_f32 v74, v42, v42
  ds_read_b128 v[108:111], v8 offset:11264
  s_waitcnt lgkmcnt(7)
  v_mfma_f32_32x32x16_bf16 v[56:71], a[144:147], v[112:115], v[56:71]
  v_fma_f32 v73, v73, s40, v5
  v_mul_f32 v72, v72, v40
  v_exp_f32 v72, v72
  v_mul_f32 v75, v43, v43
  ds_read_b128 v[112:115], v8 offset:12288
  s_waitcnt lgkmcnt(7)
  v_mfma_f32_32x32x16_bf16 v[56:71], a[148:151], v[116:119], v[56:71]
  v_fma_f32 v74, v74, s40, v5
  v_mul_f32 v73, v73, v41
  v_exp_f32 v73, v73
  v_mul_f32 v76, v44, v44
  ds_read_b128 v[116:119], v8 offset:13312
  s_waitcnt lgkmcnt(7)
  v_mfma_f32_32x32x16_bf16 v[56:71], a[152:155], v[120:123], v[56:71]
  v_fma_f32 v75, v75, s40, v5
  v_mul_f32 v74, v74, v42
  v_add_f32 v72, 1.0, v72
  v_exp_f32 v74, v74
  ds_read_b128 v[120:123], v8 offset:14336
  s_waitcnt lgkmcnt(7)
  v_mfma_f32_32x32x16_bf16 v[56:71], a[156:159], v[124:127], v[56:71]
  v_mul_f32 v77, v45, v45
  v_fma_f32 v76, v76, s40, v5
  v_mul_f32 v75, v75, v43
  v_rcp_f32 v72, v72
  ds_read_b128 v[124:127], v8 offset:15360
  s_waitcnt lgkmcnt(7)
  v_mfma_f32_32x32x16_bf16 v[56:71], a[160:163], v[96:99], v[56:71]
  v_add_f32 v73, 1.0, v73
  v_exp_f32 v75, v75
  v_mul_f32 v78, v46, v46
  v_fma_f32 v77, v77, s40, v5
  ds_read_b128 v[96:99], v8 offset:16384
  s_waitcnt lgkmcnt(7)
  v_mfma_f32_32x32x16_bf16 v[56:71], a[164:167], v[100:103], v[56:71]
  v_mul_f32 v76, v76, v44
  v_rcp_f32 v73, v73
  v_add_f32 v74, 1.0, v74
  v_mul_f32 v72, v72, v40
  ds_read_b128 v[100:103], v8 offset:17408
  s_waitcnt lgkmcnt(7)
  v_mfma_f32_32x32x16_bf16 v[56:71], a[168:171], v[104:107], v[56:71]
  v_exp_f32 v76, v76
  v_mul_f32 v79, v47, v47
  v_fma_f32 v78, v78, s40, v5
  v_mul_f32 v77, v77, v45
  ds_read_b128 v[104:107], v8 offset:18432
  s_waitcnt lgkmcnt(7)
  v_mfma_f32_32x32x16_bf16 v[56:71], a[172:175], v[108:111], v[56:71]
  v_rcp_f32 v74, v74
  v_add_f32 v75, 1.0, v75
  v_mul_f32 v73, v73, v41
  v_exp_f32 v77, v77
  ds_read_b128 v[108:111], v8 offset:19456
  s_waitcnt lgkmcnt(7)
  v_mfma_f32_32x32x16_bf16 v[56:71], a[176:179], v[112:115], v[56:71]
  v_mul_f32 v80, v48, v48
  v_fma_f32 v79, v79, s40, v5
  v_mul_f32 v78, v78, v46
  v_rcp_f32 v75, v75
  buffer_load_dword v13, v12, s[4:7], s29 offen sc1
  ds_read_b128 v[112:115], v8 offset:20480
  s_waitcnt lgkmcnt(7)
  v_mfma_f32_32x32x16_bf16 v[56:71], a[180:183], v[116:119], v[56:71]
  v_add_f32 v76, 1.0, v76
  v_mul_f32 v74, v74, v42
  v_exp_f32 v78, v78
  v_mul_f32 v81, v49, v49
  ds_read_b128 v[116:119], v8 offset:21504
  s_waitcnt lgkmcnt(7)
  v_mfma_f32_32x32x16_bf16 v[56:71], a[184:187], v[120:123], v[56:71]
  v_fma_f32 v80, v80, s40, v5
  v_mul_f32 v79, v79, v47
  v_rcp_f32 v76, v76
  v_add_f32 v77, 1.0, v77
  ds_read_b128 v[120:123], v8 offset:22528
  s_waitcnt lgkmcnt(7)
  v_mfma_f32_32x32x16_bf16 v[56:71], a[188:191], v[124:127], v[56:71]
  v_mul_f32 v75, v75, v43
  v_exp_f32 v79, v79
  v_mul_f32 v82, v50, v50
  v_fma_f32 v81, v81, s40, v5
  ds_read_b128 v[124:127], v8 offset:23552
  s_waitcnt lgkmcnt(7)
  v_mfma_f32_32x32x16_bf16 v[56:71], a[192:195], v[96:99], v[56:71]
  v_mul_f32 v80, v80, v48
  v_rcp_f32 v77, v77
  v_add_f32 v78, 1.0, v78
  v_mul_f32 v76, v76, v44
  ds_read_b128 v[96:99], v8 offset:24576
  s_waitcnt lgkmcnt(7)
  v_mfma_f32_32x32x16_bf16 v[56:71], a[196:199], v[100:103], v[56:71]
  v_exp_f32 v80, v80
  v_mul_f32 v83, v51, v51
  v_fma_f32 v82, v82, s40, v5
  v_mul_f32 v81, v81, v49
  ds_read_b128 v[100:103], v8 offset:25600
  s_waitcnt lgkmcnt(7)
  v_mfma_f32_32x32x16_bf16 v[56:71], a[200:203], v[104:107], v[56:71]
  v_rcp_f32 v78, v78
  v_add_f32 v79, 1.0, v79
  v_mul_f32 v77, v77, v45
  v_exp_f32 v81, v81
  ds_read_b128 v[104:107], v8 offset:26624
  s_waitcnt lgkmcnt(7)
  v_mfma_f32_32x32x16_bf16 v[56:71], a[204:207], v[108:111], v[56:71]
  v_mul_f32 v84, v52, v52
  v_fma_f32 v83, v83, s40, v5
  v_mul_f32 v82, v82, v50
  v_rcp_f32 v79, v79
  ds_read_b128 v[108:111], v8 offset:27648
  s_waitcnt lgkmcnt(7)
  v_mfma_f32_32x32x16_bf16 v[56:71], a[208:211], v[112:115], v[56:71]
  v_add_f32 v80, 1.0, v80
  v_mul_f32 v78, v78, v46
  v_exp_f32 v82, v82
  v_mul_f32 v85, v53, v53
  ds_read_b128 v[112:115], v8 offset:28672
  s_waitcnt lgkmcnt(7)
  v_mfma_f32_32x32x16_bf16 v[56:71], a[212:215], v[116:119], v[56:71]
  v_fma_f32 v84, v84, s40, v5
  v_mul_f32 v83, v83, v51
  v_rcp_f32 v80, v80
  v_add_f32 v81, 1.0, v81
  ds_read_b128 v[116:119], v8 offset:29696
  s_waitcnt lgkmcnt(7)
  v_mfma_f32_32x32x16_bf16 v[56:71], a[216:219], v[120:123], v[56:71]
  v_mul_f32 v79, v79, v47
  v_exp_f32 v83, v83
  v_mul_f32 v86, v54, v54
  v_fma_f32 v85, v85, s40, v5
  ds_read_b128 v[120:123], v8 offset:30720
  s_waitcnt lgkmcnt(7)
  v_mfma_f32_32x32x16_bf16 v[56:71], a[220:223], v[124:127], v[56:71]
  v_mul_f32 v84, v84, v52
  v_rcp_f32 v81, v81
  v_add_f32 v82, 1.0, v82
  v_mul_f32 v80, v80, v48
  ds_read_b128 v[124:127], v8 offset:31744
  s_waitcnt lgkmcnt(7)
  v_mfma_f32_32x32x16_bf16 v[56:71], a[224:227], v[96:99], v[56:71]
  v_exp_f32 v84, v84
  v_mul_f32 v87, v55, v55
  v_fma_f32 v86, v86, s40, v5
  v_mul_f32 v85, v85, v53
  s_waitcnt lgkmcnt(6)
  v_mfma_f32_32x32x16_bf16 v[56:71], a[228:231], v[100:103], v[56:71]
  v_rcp_f32 v82, v82
  v_add_f32 v83, 1.0, v83
  v_mul_f32 v81, v81, v49
  v_exp_f32 v85, v85
  s_waitcnt lgkmcnt(5)
  v_mfma_f32_32x32x16_bf16 v[56:71], a[232:235], v[104:107], v[56:71]
  v_fma_f32 v87, v87, s40, v5
  v_mul_f32 v86, v86, v54
  v_rcp_f32 v83, v83
  v_add_f32 v84, 1.0, v84
  buffer_load_dword v13, v12, s[4:7], s29 offen sc1
  s_waitcnt lgkmcnt(4)
  v_mfma_f32_32x32x16_bf16 v[56:71], a[236:239], v[108:111], v[56:71]
  v_mul_f32 v82, v82, v50
  v_exp_f32 v86, v86
  v_mul_f32 v87, v87, v55
  v_rcp_f32 v84, v84
  s_waitcnt lgkmcnt(3)
  v_mfma_f32_32x32x16_bf16 v[56:71], a[240:243], v[112:115], v[56:71]
  v_add_f32 v85, 1.0, v85
  v_mul_f32 v83, v83, v51
  v_exp_f32 v87, v87
  v_rcp_f32 v85, v85
  s_waitcnt lgkmcnt(2)
  v_mfma_f32_32x32x16_bf16 v[56:71], a[244:247], v[116:119], v[56:71]
  v_add_f32 v86, 1.0, v86
  v_mul_f32 v84, v84, v52
  v_rcp_f32 v86, v86
  v_add_f32 v87, 1.0, v87
  s_waitcnt lgkmcnt(1)
  v_mfma_f32_32x32x16_bf16 v[56:71], a[248:251], v[120:123], v[56:71]
  v_mul_f32 v85, v85, v53
  v_rcp_f32 v87, v87
  v_mul_f32 v86, v86, v54
  v_mul_f32 v87, v87, v55
  s_waitcnt lgkmcnt(0)
  v_mfma_f32_32x32x16_bf16 v[56:71], a[252:255], v[124:127], v[56:71]
  v_xor_b32 v8, 32768, v8
  s_nop 10
  v_mul_f32 v72, v72, v56
  v_mul_f32 v73, v73, v57
  v_mul_f32 v74, v74, v58
  v_mul_f32 v75, v75, v59
  v_mul_f32 v76, v76, v60
  v_mul_f32 v77, v77, v61
  v_mul_f32 v78, v78, v62
  v_mul_f32 v79, v79, v63
  v_cvt_pk_bf16_f32 v88, v72, v73
  v_cvt_pk_bf16_f32 v89, v74, v75
  v_cvt_pk_bf16_f32 v90, v76, v77
  v_cvt_pk_bf16_f32 v91, v78, v79
  buffer_store_dwordx4 v[88:91], v9, s[4:7], s27 offen offset:0 sc1
  v_mul_f32 v80, v80, v64
  v_mul_f32 v81, v81, v65
  v_mul_f32 v82, v82, v66
  v_mul_f32 v83, v83, v67
  v_mul_f32 v84, v84, v68
  v_mul_f32 v85, v85, v69
  v_mul_f32 v86, v86, v70
  v_mul_f32 v87, v87, v71
  v_cvt_pk_bf16_f32 v92, v80, v81
  v_cvt_pk_bf16_f32 v93, v82, v83
  v_cvt_pk_bf16_f32 v94, v84, v85
  v_cvt_pk_bf16_f32 v95, v86, v87
  buffer_store_dwordx4 v[92:95], v9, s[4:7], s27 offen offset:1024 sc1
  s_add_u32 s27, s27, 114688
  s_cmp_ge_u32 s27, s52
  s_cselect_b32 s78, 917504, 0
  s_sub_u32 s27, s27, s78
  s_mov_b32 s34, 1
  s_cmp_eq_u32 s28, 0
  s_cbranch_scc1 glast_139
  s_cmp_eq_u32 s33, 0
  s_cbranch_scc1 gblk_140
  s_cmp_lg_u32 s3, 0
  s_cbranch_scc1 post_141
  v_mov_b32 v39, s38
  ds_write_b32 v36, v39 offset:4
  s_waitcnt lgkmcnt(0)
post_141:
  s_add_u32 s26, s26, 32768
  s_xor_b32 s36, s36, 32768
  s_add_u32 s29, s29, 1024
  s_add_u32 s38, s38, 1
  s_cmp_ge_u32 s38, 9
  s_cselect_b64 vcc, -1, 0
  v_cndmask_b32 v12, v12, v15, vcc
  s_branch gtop_138
gblk_140:
  s_waitcnt vmcnt(2)
  v_cmp_ne_u32 vcc, 0, v13
  s_nop 0
  s_cmp_eq_u64 vcc, exec
  s_cbranch_scc0 gblk2_142
  s_cmp_lg_u32 s3, 0
  s_cbranch_scc1 post_143
  v_mov_b32 v39, s38
  ds_write_b32 v36, v39 offset:4
  s_waitcnt lgkmcnt(0)
post_143:
  s_mov_b32 s37, s26
  s_mov_b32 m0, s36
  s_nop 0
  buffer_load_dwordx4 v11, s[4:7], s37 offen sc1 lds
  s_add_u32 m0, m0, 4096
  s_add_u32 s37, s37, 4096
  buffer_load_dwordx4 v11, s[4:7], s37 offen sc1 lds
  s_add_u32 m0, m0, 4096
  s_add_u32 s37, s37, 4096
  buffer_load_dwordx4 v11, s[4:7], s37 offen sc1 lds
  s_add_u32 m0, m0, 4096
  s_add_u32 s37, s37, 4096
  buffer_load_dwordx4 v11, s[4:7], s37 offen sc1 lds
  s_add_u32 m0, m0, 4096
  s_add_u32 s37, s37, 4096
  buffer_load_dwordx4 v11, s[4:7], s37 offen sc1 lds
  s_add_u32 m0, m0, 4096
  s_add_u32 s37, s37, 4096
  buffer_load_dwordx4 v11, s[4:7], s37 offen sc1 lds
  s_add_u32 m0, m0, 4096
  s_add_u32 s37, s37, 4096
  buffer_load_dwordx4 v11, s[4:7], s37 offen sc1 lds
  s_add_u32 m0, m0, 4096
  s_add_u32 s37, s37, 4096
  buffer_load_dwordx4 v11, s[4:7], s37 offen sc1 lds
  s_add_u32 s26, s26, 32768
  s_xor_b32 s36, s36, 32768
  s_add_u32 s29, s29, 1024
  s_add_u32 s38, s38, 1
  s_cmp_ge_u32 s38, 9
  s_cselect_b64 vcc, -1, 0
  v_cndmask_b32 v12, v12, v15, vcc
  s_waitcnt vmcnt(8)
  s_mov_b64 exec, 1
  ds_add_rtn_u32 v39, v37, v38
  s_waitcnt lgkmcnt(0)
  v_readfirstlane_b32 s31, v39
  s_mov_b64 exec, -1
  v_xor_b32 v37, 8, v37
  s_and_b32 s31, s31, 3
  s_cmp_lg_u32 s31, 3
  s_cbranch_scc1 agg_144
  s_mov_b64 exec, 1
  buffer_store_dword v14, off, s[4:7], s30 sc1
  s_mov_b64 exec, -1
  s_waitcnt vmcnt(1)
  s_branch aggj_145
agg_144:
  s_waitcnt vmcnt(0)
aggj_145:
  s_add_u32 s30, s30, 1024
  s_mov_b32 s34, 0
  s_branch gtop_138
gblk2_142:
  s_waitcnt vmcnt(0)
  s_mov_b64 exec, 1
  ds_add_rtn_u32 v39, v37, v38
  s_waitcnt lgkmcnt(0)
  v_readfirstlane_b32 s31, v39
  s_mov_b64 exec, -1
  v_xor_b32 v37, 8, v37
  s_and_b32 s31, s31, 3
  s_cmp_lg_u32 s31, 3
  s_cbranch_scc1 agg_146
  s_mov_b64 exec, 1
  buffer_store_dword v14, off, s[4:7], s30 sc1
  s_mov_b64 exec, -1
agg_146:
  s_add_u32 s30, s30, 1024
  s_mov_b32 s34, 0
  s_cmp_lg_u32 s3, 0
  s_cbranch_scc1 wro_147
  s_mov_b32 s35, 0
poll_149:
  buffer_load_dword v13, v12, s[4:7], s29 offen sc1
  s_waitcnt vmcnt(0)
  v_cmp_ne_u32 vcc, 0, v13
  s_nop 0
  s_cmp_eq_u64 vcc, exec
  s_cbranch_scc1 polld_150
  s_sleep 2
  s_add_u32 s35, s35, 1
  s_cmp_lt_u32 s35, 131072
  s_cbranch_scc1 poll_149
  s_branch mega_kernel_end
polld_150:
  v_mov_b32 v13, s38
  ds_write_b32 v36, v13 offset:4
  s_waitcnt lgkmcnt(0)
  s_branch wrd_148
wro_147:
  s_mov_b32 s35, 0
wrl_151:
  ds_read_b32 v13, v36 offset:4
  s_add_u32 s35, s35, 1
  s_cmp_gt_u32 s35, 2097152
  s_cbranch_scc1 mega_kernel_end
  s_waitcnt lgkmcnt(0)
  v_readfirstlane_b32 s31, v13
  s_nop 0
  s_cmp_ge_u32 s31, s38
  s_cbranch_scc1 wrd_148
  s_sleep 1
  s_branch wrl_151
wrd_148:
  s_mov_b32 s37, s26
  s_mov_b32 m0, s36
  s_nop 0
  buffer_load_dwordx4 v11, s[4:7], s37 offen sc1 lds
  s_add_u32 m0, m0, 4096
  s_add_u32 s37, s37, 4096
  buffer_load_dwordx4 v11, s[4:7], s37 offen sc1 lds
  s_add_u32 m0, m0, 4096
  s_add_u32 s37, s37, 4096
  buffer_load_dwordx4 v11, s[4:7], s37 offen sc1 lds
  s_add_u32 m0, m0, 4096
  s_add_u32 s37, s37, 4096
  buffer_load_dwordx4 v11, s[4:7], s37 offen sc1 lds
  s_add_u32 m0, m0, 4096
  s_add_u32 s37, s37, 4096
  buffer_load_dwordx4 v11, s[4:7], s37 offen sc1 lds
  s_add_u32 m0, m0, 4096
  s_add_u32 s37, s37, 4096
  buffer_load_dwordx4 v11, s[4:7], s37 offen sc1 lds
  s_add_u32 m0, m0, 4096
  s_add_u32 s37, s37, 4096
  buffer_load_dwordx4 v11, s[4:7], s37 offen sc1 lds
  s_add_u32 m0, m0, 4096
  s_add_u32 s37, s37, 4096
  buffer_load_dwordx4 v11, s[4:7], s37 offen sc1 lds
  s_add_u32 s26, s26, 32768
  s_xor_b32 s36, s36, 32768
  s_add_u32 s29, s29, 1024
  s_add_u32 s38, s38, 1
  s_cmp_ge_u32 s38, 9
  s_cselect_b64 vcc, -1, 0
  v_cndmask_b32 v12, v12, v15, vcc
  s_waitcnt vmcnt(0)
  s_branch gtop_138
glast_139:
  s_waitcnt vmcnt(0)
  s_mov_b64 exec, 1
  ds_add_rtn_u32 v39, v37, v38
  s_waitcnt lgkmcnt(0)
  v_readfirstlane_b32 s31, v39
  s_mov_b64 exec, -1
  v_xor_b32 v37, 8, v37
  s_and_b32 s31, s31, 3
  s_cmp_lg_u32 s31, 3
  s_cbranch_scc1 agg_152
  s_mov_b64 exec, 1
  buffer_store_dword v14, off, s[4:7], s30 sc1
  s_mov_b64 exec, -1
agg_152:
  s_add_u32 s30, s30, 1024
  s_mov_b32 s34, 0
  s_branch mega_kernel_end
r_dn_18:
  s_load_dwordx2 s[8:9], s[0:1], 80
  s_waitcnt lgkmcnt(0)
  s_mov_b32 s10, 1835008
  s_mov_b32 s11, 0x00020000
  s_and_b32 s41, s98, 1
  s_lshr_b32 s42, s98, 1
  s_mul_i32 s24, s42, 458752
  s_lshl_b32 s40, s41, 9
  s_add_u32 s24, s24, s40
  s_lshl_b32 s40, s3, 7
  s_add_u32 s24, s24, s40
  s_add_u32 s25, s24, 64
  s_mul_i32 s26, s42, 28672
  s_add_u32 s26, s26, 171966464
  s_lshl_b32 s40, s97, 23
  s_add_u32 s26, s26, s40
  s_lshl_b32 s27, s42, 15
  s_lshl_b32 s40, s97, 23
  s_add_u32 s27, s27, s40
  s_lshl_b32 s40, s41, 11
  s_add_u32 s27, s27, s40
  s_lshl_b32 s40, s3, 9
  s_add_u32 s27, s27, s40
  s_add_u32 s27, s27, 188743680
  s_mov_b32 s28, 64
  s_mul_i32 s29, s42, 7
  s_lshr_b32 s29, s29, 1
  s_lshl_b32 s29, s29, 2
  s_add_u32 s29, s29, s46
  s_add_u32 s29, s29, 655360
  s_lshl_b32 s30, s98, 2
  s_add_u32 s30, s30, s46
  s_add_u32 s30, s30, 786432
  s_add_u32 s54, s46, 909312
  s_sub_u32 s54, s54, s29
  s_add_u32 s52, s26, 917504
  s_add_u32 s53, s27, 1048576
  v_lshrrev_b32 v3, 2, v2
  s_mov_b32 s31, 1024
  v_mul_lo_u32 v6, v3, s31
  v_and_b32 v3, 3, v2
  v_lshl_add_u32 v6, v3, 4, v6
  v_bfe_u32 v4, v2, 2, 2
  v_lshrrev_b32 v5, 5, v2
  v_lshl_add_u32 v4, v5, 3, v4
  v_lshlrev_b32 v7, 6, v4
  v_bfe_u32 v4, v2, 4, 1
  v_lshl_add_u32 v7, v4, 5, v7
  v_and_b32 v4, 1, v2
  v_lshl_add_u32 v7, v4, 4, v7
  v_bfe_u32 v4, v2, 1, 1
  v_lshl_add_u32 v7, v4, 3, v7
  s_lshl_b32 s31, s3, 15
  v_add_u32 v7, s31, v7
  v_mov_b32 v14, 1
  s_lshl_b32 s36, s3, 15
  s_add_u32 m0, s36, 0
  s_nop 0
  buffer_load_dwordx4 v6, s[8:11], s24 offen lds
  s_add_u32 s24, s24, 16384
  s_add_u32 m0, m0, 1024
  s_nop 0
  buffer_load_dwordx4 v6, s[8:11], s25 offen lds
  s_add_u32 s25, s25, 16384
  s_add_u32 m0, m0, 1024
  s_nop 0
  buffer_load_dwordx4 v6, s[8:11], s24 offen lds
  s_add_u32 s24, s24, 16384
  s_add_u32 m0, m0, 1024
  s_nop 0
  buffer_load_dwordx4 v6, s[8:11], s25 offen lds
  s_add_u32 s25, s25, 16384
  s_add_u32 m0, m0, 1024
  s_nop 0
  buffer_load_dwordx4 v6, s[8:11], s24 offen lds
  s_add_u32 s24, s24, 16384
  s_add_u32 m0, m0, 1024
  s_nop 0
  buffer_load_dwordx4 v6, s[8:11], s25 offen lds
  s_add_u32 s25, s25, 16384
  s_add_u32 m0, m0, 1024
  s_nop 0
  buffer_load_dwordx4 v6, s[8:11], s24 offen lds
  s_add_u32 s24, s24, 16384
  s_add_u32 m0, m0, 1024
  s_nop 0
  buffer_load_dwordx4 v6, s[8:11], s25 offen lds
  s_add_u32 s25, s25, 16384
  s_add_u32 m0, m0, 1024
  s_nop 0
  buffer_load_dwordx4 v6, s[8:11], s24 offen lds
  s_add_u32 s24, s24, 16384
  s_add_u32 m0, m0, 1024
  s_nop 0
  buffer_load_dwordx4 v6, s[8:11], s25 offen lds
  s_add_u32 s25, s25, 16384
  s_add_u32 m0, m0, 1024
  s_nop 0
  buffer_load_dwordx4 v6, s[8:11], s24 offen lds
  s_add_u32 s24, s24, 16384
  s_add_u32 m0, m0, 1024
  s_nop 0
  buffer_load_dwordx4 v6, s[8:11], s25 offen lds
  s_add_u32 s25, s25, 16384
  s_add_u32 m0, m0, 1024
  s_nop 0
  buffer_load_dwordx4 v6, s[8:11], s24 offen lds
  s_add_u32 s24, s24, 16384
  s_add_u32 m0, m0, 1024
  s_nop 0
  buffer_load_dwordx4 v6, s[8:11], s25 offen lds
  s_add_u32 s25, s25, 16384
  s_add_u32 m0, m0, 1024
  s_nop 0
  buffer_load_dwordx4 v6, s[8:11], s24 offen lds
  s_add_u32 s24, s24, 16384
  s_add_u32 m0, m0, 1024
  s_nop 0
  buffer_load_dwordx4 v6, s[8:11], s25 offen lds
  s_add_u32 s25, s25, 16384
  s_lshl_b32 s36, s3, 15
  s_add_u32 m0, s36, 16384
  s_nop 0
  buffer_load_dwordx4 v6, s[8:11], s24 offen lds
  s_add_u32 s24, s24, 16384
  s_add_u32 m0, m0, 1024
  s_nop 0
  buffer_load_dwordx4 v6, s[8:11], s25 offen lds
  s_add_u32 s25, s25, 16384
  s_add_u32 m0, m0, 1024
  s_nop 0
  buffer_load_dwordx4 v6, s[8:11], s24 offen lds
  s_add_u32 s24, s24, 16384
  s_add_u32 m0, m0, 1024
  s_nop 0
  buffer_load_dwordx4 v6, s[8:11], s25 offen lds
  s_add_u32 s25, s25, 16384
  s_add_u32 m0, m0, 1024
  s_nop 0
  buffer_load_dwordx4 v6, s[8:11], s24 offen lds
  s_add_u32 s24, s24, 16384
  s_add_u32 m0, m0, 1024
  s_nop 0
  buffer_load_dwordx4 v6, s[8:11], s25 offen lds
  s_add_u32 s25, s25, 16384
  s_add_u32 m0, m0, 1024
  s_nop 0
  buffer_load_dwordx4 v6, s[8:11], s24 offen lds
  s_add_u32 s24, s24, 16384
  s_add_u32 m0, m0, 1024
  s_nop 0
  buffer_load_dwordx4 v6, s[8:11], s25 offen lds
  s_add_u32 s25, s25, 16384
  s_add_u32 m0, m0, 1024
  s_nop 0
  buffer_load_dwordx4 v6, s[8:11], s24 offen lds
  s_add_u32 s24, s24, 16384
  s_add_u32 m0, m0, 1024
  s_nop 0
  buffer_load_dwordx4 v6, s[8:11], s25 offen lds
  s_add_u32 s25, s25, 16384
  s_add_u32 m0, m0, 1024
  s_nop 0
  buffer_load_dwordx4 v6, s[8:11], s24 offen lds
  s_add_u32 s24, s24, 16384
  s_add_u32 m0, m0, 1024
  s_nop 0
  buffer_load_dwordx4 v6, s[8:11], s25 offen lds
  s_add_u32 s25, s25, 16384
  s_add_u32 m0, m0, 1024
  s_nop 0
  buffer_load_dwordx4 v6, s[8:11], s24 offen lds
  s_add_u32 s24, s24, 16384
  s_add_u32 m0, m0, 1024
  s_nop 0
  buffer_load_dwordx4 v6, s[8:11], s25 offen lds
  s_add_u32 s25, s25, 16384
  s_add_u32 m0, m0, 1024
  s_nop 0
  buffer_load_dwordx4 v6, s[8:11], s24 offen lds
  s_add_u32 s24, s24, 16384
  s_add_u32 m0, m0, 1024
  s_nop 0
  buffer_load_dwordx4 v6, s[8:11], s25 offen lds
  s_add_u32 s25, s25, 16384
  s_waitcnt vmcnt(16)
  ds_read_b64_tr_b16 a[0:1], v7 offset:0
  ds_read_b64_tr_b16 a[2:3], v7 offset:256
  ds_read_b64_tr_b16 a[128:129], v7 offset:1024
  ds_read_b64_tr_b16 a[130:131], v7 offset:1280
  ds_read_b64_tr_b16 a[4:5], v7 offset:2048
  ds_read_b64_tr_b16 a[6:7], v7 offset:2304
  ds_read_b64_tr_b16 a[132:133], v7 offset:3072
  ds_read_b64_tr_b16 a[134:135], v7 offset:3328
  ds_read_b64_tr_b16 a[8:9], v7 offset:4096
  ds_read_b64_tr_b16 a[10:11], v7 offset:4352
  ds_read_b64_tr_b16 a[136:137], v7 offset:5120
  ds_read_b64_tr_b16 a[138:139], v7 offset:5376
  ds_read_b64_tr_b16 a[12:13], v7 offset:6144
  ds_read_b64_tr_b16 a[14:15], v7 offset:6400
  ds_read_b64_tr_b16 a[140:141], v7 offset:7168
  ds_read_b64_tr_b16 a[142:143], v7 offset:7424
  ds_read_b64_tr_b16 a[16:17], v7 offset:8192
  ds_read_b64_tr_b16 a[18:19], v7 offset:8448
  ds_read_b64_tr_b16 a[144:145], v7 offset:9216
  ds_read_b64_tr_b16 a[146:147], v7 offset:9472
  ds_read_b64_tr_b16 a[20:21], v7 offset:10240
  ds_read_b64_tr_b16 a[22:23], v7 offset:10496
  ds_read_b64_tr_b16 a[148:149], v7 offset:11264
  ds_read_b64_tr_b16 a[150:151], v7 offset:11520
  ds_read_b64_tr_b16 a[24:25], v7 offset:12288
  ds_read_b64_tr_b16 a[26:27], v7 offset:12544
  ds_read_b64_tr_b16 a[152:153], v7 offset:13312
  ds_read_b64_tr_b16 a[154:155], v7 offset:13568
  ds_read_b64_tr_b16 a[28:29], v7 offset:14336
  ds_read_b64_tr_b16 a[30:31], v7 offset:14592
  ds_read_b64_tr_b16 a[156:157], v7 offset:15360
  ds_read_b64_tr_b16 a[158:159], v7 offset:15616
  s_waitcnt lgkmcnt(0)
  s_lshl_b32 s36, s3, 15
  s_add_u32 m0, s36, 0
  s_nop 0
  buffer_load_dwordx4 v6, s[8:11], s24 offen lds
  s_add_u32 s24, s24, 16384
  s_add_u32 m0, m0, 1024
  s_nop 0
  buffer_load_dwordx4 v6, s[8:11], s25 offen lds
  s_add_u32 s25, s25, 16384
  s_add_u32 m0, m0, 1024
  s_nop 0
  buffer_load_dwordx4 v6, s[8:11], s24 offen lds
  s_add_u32 s24, s24, 16384
  s_add_u32 m0, m0, 1024
  s_nop 0
  buffer_load_dwordx4 v6, s[8:11], s25 offen lds
  s_add_u32 s25, s25, 16384
  s_add_u32 m0, m0, 1024
  s_nop 0
  buffer_load_dwordx4 v6, s[8:11], s24 offen lds
  s_add_u32 s24, s24, 16384
  s_add_u32 m0, m0, 1024
  s_nop 0
  buffer_load_dwordx4 v6, s[8:11], s25 offen lds
  s_add_u32 s25, s25, 16384
  s_add_u32 m0, m0, 1024
  s_nop 0
  buffer_load_dwordx4 v6, s[8:11], s24 offen lds
  s_add_u32 s24, s24, 16384
  s_add_u32 m0, m0, 1024
  s_nop 0
  buffer_load_dwordx4 v6, s[8:11], s25 offen lds
  s_add_u32 s25, s25, 16384
  s_add_u32 m0, m0, 1024
  s_nop 0
  buffer_load_dwordx4 v6, s[8:11], s24 offen lds
  s_add_u32 s24, s24, 16384
  s_add_u32 m0, m0, 1024
  s_nop 0
  buffer_load_dwordx4 v6, s[8:11], s25 offen lds
  s_add_u32 s25, s25, 16384
  s_add_u32 m0, m0, 1024
  s_nop 0
  buffer_load_dwordx4 v6, s[8:11], s24 offen lds
  s_add_u32 s24, s24, 16384
  s_add_u32 m0, m0, 1024
  s_nop 0
  buffer_load_dwordx4 v6, s[8:11], s25 offen lds
  s_add_u32 s25, s25, 16384
  s_add_u32 m0, m0, 1024
  s_nop 0
  buffer_load_dwordx4 v6, s[8:11], s24 offen lds
  s_add_u32 s24, s24, 16384
  s_add_u32 m0, m0, 1024
  s_nop 0
  buffer_load_dwordx4 v6, s[8:11], s25 offen lds
  s_add_u32 s25, s25, 16384
  s_add_u32 m0, m0, 1024
  s_nop 0
  buffer_load_dwordx4 v6, s[8:11], s24 offen lds
  s_add_u32 s24, s24, 16384
  s_add_u32 m0, m0, 1024
  s_nop 0
  buffer_load_dwordx4 v6, s[8:11], s25 offen lds
  s_add_u32 s25, s25, 16384
  s_waitcnt vmcnt(16)
  ds_read_b64_tr_b16 a[32:33], v7 offset:16384
  ds_read_b64_tr_b16 a[34:35], v7 offset:16640
  ds_read_b64_tr_b16 a[160:161], v7 offset:17408
  ds_read_b64_tr_b16 a[162:163], v7 offset:17664
  ds_read_b64_tr_b16 a[36:37], v7 offset:18432
  ds_read_b64_tr_b16 a[38:39], v7 offset:18688
  ds_read_b64_tr_b16 a[164:165], v7 offset:19456
  ds_read_b64_tr_b16 a[166:167], v7 offset:19712
  ds_read_b64_tr_b16 a[40:41], v7 offset:20480
  ds_read_b64_tr_b16 a[42:43], v7 offset:20736
  ds_read_b64_tr_b16 a[168:169], v7 offset:21504
  ds_read_b64_tr_b16 a[170:171], v7 offset:21760
  ds_read_b64_tr_b16 a[44:45], v7 offset:22528
  ds_read_b64_tr_b16 a[46:47], v7 offset:22784
  ds_read_b64_tr_b16 a[172:173], v7 offset:23552
  ds_read_b64_tr_b16 a[174:175], v7 offset:23808
  ds_read_b64_tr_b16 a[48:49], v7 offset:24576
  ds_read_b64_tr_b16 a[50:51], v7 offset:24832
  ds_read_b64_tr_b16 a[176:177], v7 offset:25600
  ds_read_b64_tr_b16 a[178:179], v7 offset:25856
  ds_read_b64_tr_b16 a[52:53], v7 offset:26624
  ds_read_b64_tr_b16 a[54:55], v7 offset:26880
  ds_read_b64_tr_b16 a[180:181], v7 offset:27648
  ds_read_b64_tr_b16 a[182:183], v7 offset:27904
  ds_read_b64_tr_b16 a[56:57], v7 offset:28672
  ds_read_b64_tr_b16 a[58:59], v7 offset:28928
  ds_read_b64_tr_b16 a[184:185], v7 offset:29696
  ds_read_b64_tr_b16 a[186:187], v7 offset:29952
  ds_read_b64_tr_b16 a[60:61], v7 offset:30720
  ds_read_b64_tr_b16 a[62:63], v7 offset:30976
  ds_read_b64_tr_b16 a[188:189], v7 offset:31744
  ds_read_b64_tr_b16 a[190:191], v7 offset:32000
  s_waitcnt lgkmcnt(0)
  s_lshl_b32 s36, s3, 15
  s_add_u32 m0, s36, 16384
  s_nop 0
  buffer_load_dwordx4 v6, s[8:11], s24 offen lds
  s_add_u32 s24, s24, 16384
  s_add_u32 m0, m0, 1024
  s_nop 0
  buffer_load_dwordx4 v6, s[8:11], s25 offen lds
  s_add_u32 s25, s25, 16384
  s_add_u32 m0, m0, 1024
  s_nop 0
  buffer_load_dwordx4 v6, s[8:11], s24 offen lds
  s_add_u32 s24, s24, 16384
  s_add_u32 m0, m0, 1024
  s_nop 0
  buffer_load_dwordx4 v6, s[8:11], s25 offen lds
  s_add_u32 s25, s25, 16384
  s_add_u32 m0, m0, 1024
  s_nop 0
  buffer_load_dwordx4 v6, s[8:11], s24 offen lds
  s_add_u32 s24, s24, 16384
  s_add_u32 m0, m0, 1024
  s_nop 0
  buffer_load_dwordx4 v6, s[8:11], s25 offen lds
  s_add_u32 s25, s25, 16384
  s_add_u32 m0, m0, 1024
  s_nop 0
  buffer_load_dwordx4 v6, s[8:11], s24 offen lds
  s_add_u32 s24, s24, 16384
  s_add_u32 m0, m0, 1024
  s_nop 0
  buffer_load_dwordx4 v6, s[8:11], s25 offen lds
  s_add_u32 s25, s25, 16384
  s_waitcnt vmcnt(8)
  ds_read_b64_tr_b16 a[64:65], v7 offset:0
  ds_read_b64_tr_b16 a[66:67], v7 offset:256
  ds_read_b64_tr_b16 a[192:193], v7 offset:1024
  ds_read_b64_tr_b16 a[194:195], v7 offset:1280
  ds_read_b64_tr_b16 a[68:69], v7 offset:2048
  ds_read_b64_tr_b16 a[70:71], v7 offset:2304
  ds_read_b64_tr_b16 a[196:197], v7 offset:3072
  ds_read_b64_tr_b16 a[198:199], v7 offset:3328
  ds_read_b64_tr_b16 a[72:73], v7 offset:4096
  ds_read_b64_tr_b16 a[74:75], v7 offset:4352
  ds_read_b64_tr_b16 a[200:201], v7 offset:5120
  ds_read_b64_tr_b16 a[202:203], v7 offset:5376
  ds_read_b64_tr_b16 a[76:77], v7 offset:6144
  ds_read_b64_tr_b16 a[78:79], v7 offset:6400
  ds_read_b64_tr_b16 a[204:205], v7 offset:7168
  ds_read_b64_tr_b16 a[206:207], v7 offset:7424
  ds_read_b64_tr_b16 a[80:81], v7 offset:8192
  ds_read_b64_tr_b16 a[82:83], v7 offset:8448
  ds_read_b64_tr_b16 a[208:209], v7 offset:9216
  ds_read_b64_tr_b16 a[210:211], v7 offset:9472
  ds_read_b64_tr_b16 a[84:85], v7 offset:10240
  ds_read_b64_tr_b16 a[86:87], v7 offset:10496
  ds_read_b64_tr_b16 a[212:213], v7 offset:11264
  ds_read_b64_tr_b16 a[214:215], v7 offset:11520
  ds_read_b64_tr_b16 a[88:89], v7 offset:12288
  ds_read_b64_tr_b16 a[90:91], v7 offset:12544
  ds_read_b64_tr_b16 a[216:217], v7 offset:13312
  ds_read_b64_tr_b16 a[218:219], v7 offset:13568
  ds_read_b64_tr_b16 a[92:93], v7 offset:14336
  ds_read_b64_tr_b16 a[94:95], v7 offset:14592
  ds_read_b64_tr_b16 a[220:221], v7 offset:15360
  ds_read_b64_tr_b16 a[222:223], v7 offset:15616
  s_waitcnt lgkmcnt(0)
  s_waitcnt vmcnt(0)
  ds_read_b64_tr_b16 a[96:97], v7 offset:16384
  ds_read_b64_tr_b16 a[98:99], v7 offset:16640
  ds_read_b64_tr_b16 a[224:225], v7 offset:17408
  ds_read_b64_tr_b16 a[226:227], v7 offset:17664
  ds_read_b64_tr_b16 a[100:101], v7 offset:18432
  ds_read_b64_tr_b16 a[102:103], v7 offset:18688
  ds_read_b64_tr_b16 a[228:229], v7 offset:19456
  ds_read_b64_tr_b16 a[230:231], v7 offset:19712
  ds_read_b64_tr_b16 a[104:105], v7 offset:20480
  ds_read_b64_tr_b16 a[106:107], v7 offset:20736
  ds_read_b64_tr_b16 a[232:233], v7 offset:21504
  ds_read_b64_tr_b16 a[234:235], v7 offset:21760
  ds_read_b64_tr_b16 a[108:109], v7 offset:22528
  ds_read_b64_tr_b16 a[110:111], v7 offset:22784
  ds_read_b64_tr_b16 a[236:237], v7 offset:23552
  ds_read_b64_tr_b16 a[238:239], v7 offset:23808
  s_waitcnt lgkmcnt(0)
  v_mov_b32 v8, v1
  v_bfe_u32 v3, v2, 2, 3
  v_lshlrev_b32 v9, 12, v3
  v_lshrrev_b32 v4, 5, v2
  v_lshl_add_u32 v9, v4, 6, v9
  v_and_b32 v3, 3, v2
  v_lshl_add_u32 v9, v3, 4, v9
  s_cmp_eq_u32 s91, 0
  s_cbranch_scc1 gg_153
  s_lshl_b32 s31, s3, 10
  v_add_u32 v11, s31, v1
  s_mov_b32 s36, s31
  v_min_u32 v12, 3, v2
  v_lshlrev_b32 v12, 2, v12
  v_subrev_u32 v3, 4, v2
  v_cmp_gt_u32 vcc, 4, v3
  v_lshlrev_b32 v3, 2, v3
  v_add_u32 v3, s54, v3
  v_cndmask_b32 v15, v12, v3, vcc
  v_and_b32 v8, 0x7fff, v8
  v_mov_b32 v36, 163584
  v_mov_b32 v38, 0
  ds_write_b32 v36, v38
  ds_write_b32 v36, v38 offset:4
  ds_write_b32 v36, v38 offset:8
  s_waitcnt lgkmcnt(0)
  v_mov_b32 v38, 1
  v_mov_b32 v37, 163584
  s_mov_b32 s38, 1
  s_barrier
  s_cmp_lg_u32 s3, 0
  s_cbranch_scc1 wro_154
  s_mov_b32 s35, 0
poll_156:
  buffer_load_dword v13, v12, s[4:7], s29 offen sc1
  s_waitcnt vmcnt(0)
  v_cmp_ne_u32 vcc, 0, v13
  s_nop 0
  s_cmp_eq_u64 vcc, exec
  s_cbranch_scc1 polld_157
  s_sleep 8
  s_add_u32 s35, s35, 1
  s_cmp_lt_u32 s35, 131072
  s_cbranch_scc1 poll_156
  s_branch mega_kernel_end
polld_157:
  v_mov_b32 v13, s38
  ds_write_b32 v36, v13 offset:4
  s_waitcnt lgkmcnt(0)
  s_branch wrd_155
wro_154:
  s_mov_b32 s35, 0
wrl_158:
  ds_read_b32 v13, v36 offset:4
  s_add_u32 s35, s35, 1
  s_cmp_gt_u32 s35, 2097152
  s_cbranch_scc1 mega_kernel_end
  s_waitcnt lgkmcnt(0)
  v_readfirstlane_b32 s31, v13
  s_nop 0
  s_cmp_ge_u32 s31, s38
  s_cbranch_scc1 wrd_155
  s_sleep 1
  s_branch wrl_158
wrd_155:
  s_mov_b32 s37, s26
  s_mov_b32 m0, s36
  s_nop 0
  buffer_load_dwordx4 v11, s[4:7], s37 offen sc1 lds
  s_add_u32 m0, m0, 4096
  s_add_u32 s37, s37, 4096
  buffer_load_dwordx4 v11, s[4:7], s37 offen sc1 lds
  s_add_u32 m0, m0, 4096
  s_add_u32 s37, s37, 4096
  buffer_load_dwordx4 v11, s[4:7], s37 offen sc1 lds
  s_add_u32 m0, m0, 4096
  s_add_u32 s37, s37, 4096
  buffer_load_dwordx4 v11, s[4:7], s37 offen sc1 lds
  s_add_u32 m0, m0, 4096
  s_add_u32 s37, s37, 4096
  buffer_load_dwordx4 v11, s[4:7], s37 offen sc1 lds
  s_add_u32 m0, m0, 4096
  s_add_u32 s37, s37, 4096
  buffer_load_dwordx4 v11, s[4:7], s37 offen sc1 lds
  s_add_u32 m0, m0, 4096
  s_add_u32 s37, s37, 4096
  buffer_load_dwordx4 v11, s[4:7], s37 offen sc1 lds
  s_add_u32 s26, s26, 114688
  s_cmp_ge_u32 s26, s52
  s_cselect_b32 s78, 917504, 0
  s_sub_u32 s26, s26, s78
  s_xor_b32 s36, s36, 32768
  s_add_u32 s29, s29, 1024
  s_add_u32 s38, s38, 1
  s_cmp_ge_u32 s38, 9
  s_cselect_b64 vcc, -1, 0
  v_cndmask_b32 v12, v12, v15, vcc
  s_mov_b32 s34, 0
  s_waitcnt vmcnt(0)
gtop_159:
  s_waitcnt vmcnt(2)
  s_barrier
  ds_read_b128 v[96:99], v8 offset:0
  ds_read_b128 v[100:103], v8 offset:1024
  ds_read_b128 v[104:107], v8 offset:2048
  ds_read_b128 v[108:111], v8 offset:3072
  ds_read_b128 v[112:115], v8 offset:4096
  ds_read_b128 v[116:119], v8 offset:5120
  ds_read_b128 v[120:123], v8 offset:6144
  s_sub_u32 s28, s28, 1
  v_mov_b32 v13, 0
  buffer_load_dword v13, v12, s[4:7], s29 offen sc1
  s_cmp_eq_u32 s28, 0
  s_cselect_b32 s33, 2, 0
  ds_read_b128 v[124:127], v8 offset:7168
  s_waitcnt lgkmcnt(7)
  v_mfma_f32_32x32x16_bf16 v[40:55], a[0:3], v[96:99], 0
  ds_read_b128 v[96:99], v8 offset:8192
  s_waitcnt lgkmcnt(7)
  v_mfma_f32_32x32x16_bf16 v[40:55], a[4:7], v[100:103], v[40:55]
  ds_read_b128 v[100:103], v8 offset:9216
  s_waitcnt lgkmcnt(7)
  v_mfma_f32_32x32x16_bf16 v[40:55], a[8:11], v[104:107], v[40:55]
  ds_read_b128 v[104:107], v8 offset:10240
  s_waitcnt lgkmcnt(7)
  v_mfma_f32_32x32x16_bf16 v[40:55], a[12:15], v[108:111], v[40:55]
  ds_read_b128 v[108:111], v8 offset:11264
  s_waitcnt lgkmcnt(7)
  v_mfma_f32_32x32x16_bf16 v[40:55], a[16:19], v[112:115], v[40:55]
  ds_read_b128 v[112:115], v8 offset:12288
  s_waitcnt lgkmcnt(7)
  v_mfma_f32_32x32x16_bf16 v[40:55], a[20:23], v[116:119], v[40:55]
  ds_read_b128 v[116:119], v8 offset:13312
  s_waitcnt lgkmcnt(7)
  v_mfma_f32_32x32x16_bf16 v[40:55], a[24:27], v[120:123], v[40:55]
  buffer_load_dword v13, v12, s[4:7], s29 offen sc1
  ds_read_b128 v[120:123], v8 offset:14336
  s_waitcnt lgkmcnt(7)
  v_mfma_f32_32x32x16_bf16 v[40:55], a[28:31], v[124:127], v[40:55]
  ds_read_b128 v[124:127], v8 offset:15360
  s_waitcnt lgkmcnt(7)
  v_mfma_f32_32x32x16_bf16 v[40:55], a[32:35], v[96:99], v[40:55]
  ds_read_b128 v[96:99], v8 offset:16384
  s_waitcnt lgkmcnt(7)
  v_mfma_f32_32x32x16_bf16 v[40:55], a[36:39], v[100:103], v[40:55]
  ds_read_b128 v[100:103], v8 offset:17408
  s_waitcnt lgkmcnt(7)
  v_mfma_f32_32x32x16_bf16 v[40:55], a[40:43], v[104:107], v[40:55]
  ds_read_b128 v[104:107], v8 offset:18432
  s_waitcnt lgkmcnt(7)
  v_mfma_f32_32x32x16_bf16 v[40:55], a[44:47], v[108:111], v[40:55]
  ds_read_b128 v[108:111], v8 offset:19456
  s_waitcnt lgkmcnt(7)
  v_mfma_f32_32x32x16_bf16 v[40:55], a[48:51], v[112:115], v[40:55]
  ds_read_b128 v[112:115], v8 offset:20480
  s_waitcnt lgkmcnt(7)
  v_mfma_f32_32x32x16_bf16 v[40:55], a[52:55], v[116:119], v[40:55]
  ds_read_b128 v[116:119], v8 offset:21504
  s_waitcnt lgkmcnt(7)
  v_mfma_f32_32x32x16_bf16 v[40:55], a[56:59], v[120:123], v[40:55]
  v_cmp_ne_u32 vcc, 0, v13
  s_nop 0
  s_cmp_eq_u64 vcc, exec
  s_cselect_b32 s31, s33, 1
  s_cmp_eq_u32 s31, 0
  s_cselect_b32 s37, s26, 2146435072
  s_cselect_b32 m0, s36, 65536
  s_cselect_b32 s33, 1, s33
  ds_read_b128 v[120:123], v8 offset:22528
  s_waitcnt lgkmcnt(7)
  v_mfma_f32_32x32x16_bf16 v[40:55], a[60:63], v[124:127], v[40:55]
  buffer_load_dwordx4 v11, s[4:7], s37 offen sc1 lds
  s_add_u32 m0, m0, 4096
  s_add_u32 s37, s37, 4096
  ds_read_b128 v[124:127], v8 offset:23552
  s_waitcnt lgkmcnt(7)
  v_mfma_f32_32x32x16_bf16 v[40:55], a[64:67], v[96:99], v[40:55]
  ds_read_b128 v[96:99], v8 offset:24576
  s_waitcnt lgkmcnt(7)
  v_mfma_f32_32x32x16_bf16 v[40:55], a[68:71], v[100:103], v[40:55]
  buffer_load_dwordx4 v11, s[4:7], s37 offen sc1 lds
  s_add_u32 m0, m0, 4096
  s_add_u32 s37, s37, 4096
  ds_read_b128 v[100:103], v8 offset:25600
  s_waitcnt lgkmcnt(7)
  v_mfma_f32_32x32x16_bf16 v[40:55], a[72:75], v[104:107], v[40:55]
  s_waitcnt vmcnt(4)
  v_mov_b32 v38, s34
  s_mov_b64 exec, 1
  ds_add_rtn_u32 v39, v37, v38
  s_mov_b64 exec, -1
  ds_read_b128 v[104:107], v8 offset:26624
  s_waitcnt lgkmcnt(7)
  v_mfma_f32_32x32x16_bf16 v[40:55], a[76:79], v[108:111], v[40:55]
  buffer_load_dwordx4 v11, s[4:7], s37 offen sc1 lds
  s_add_u32 m0, m0, 4096
  s_add_u32 s37, s37, 4096
  ds_read_b128 v[108:111], v8 offset:27648
  s_waitcnt lgkmcnt(7)
  v_mfma_f32_32x32x16_bf16 v[40:55], a[80:83], v[112:115], v[40:55]
  ds_read_b128 v[112:115], v8 offset:0
  s_waitcnt lgkmcnt(7)
  v_mfma_f32_32x32x16_bf16 v[40:55], a[84:87], v[116:119], v[40:55]
  buffer_load_dwordx4 v11, s[4:7], s37 offen sc1 lds
  s_add_u32 m0, m0, 4096
  s_add_u32 s37, s37, 4096
  ds_read_b128 v[116:119], v8 offset:1024
  s_waitcnt lgkmcnt(7)
  v_mfma_f32_32x32x16_bf16 v[40:55], a[88:91], v[120:123], v[40:55]
  ds_read_b128 v[120:123], v8 offset:2048
  s_waitcnt lgkmcnt(7)
  v_mfma_f32_32x32x16_bf16 v[40:55], a[92:95], v[124:127], v[40:55]
  buffer_load_dwordx4 v11, s[4:7], s37 offen sc1 lds
  s_add_u32 m0, m0, 4096
  s_add_u32 s37, s37, 4096
  ds_read_b128 v[124:127], v8 offset:3072
  s_waitcnt lgkmcnt(7)
  v_mfma_f32_32x32x16_bf16 v[40:55], a[96:99], v[96:99], v[40:55]
  ds_read_b128 v[96:99], v8 offset:4096
  s_waitcnt lgkmcnt(7)
  v_mfma_f32_32x32x16_bf16 v[40:55], a[100:103], v[100:103], v[40:55]
  buffer_load_dwordx4 v11, s[4:7], s37 offen sc1 lds
  s_add_u32 m0, m0, 4096
  s_add_u32 s37, s37, 4096
  ds_read_b128 v[100:103], v8 offset:5120
  s_waitcnt lgkmcnt(7)
  v_mfma_f32_32x32x16_bf16 v[40:55], a[104:107], v[104:107], v[40:55]
  ds_read_b128 v[104:107], v8 offset:6144
  s_waitcnt lgkmcnt(7)
  v_mfma_f32_32x32x16_bf16 v[40:55], a[108:111], v[108:111], v[40:55]
  buffer_load_dwordx4 v11, s[4:7], s37 offen sc1 lds
  s_add_u32 m0, m0, 4096
  s_add_u32 s37, s37, 4096
  ds_read_b128 v[108:111], v8 offset:7168
  s_waitcnt lgkmcnt(7)
  v_mfma_f32_32x32x16_bf16 v[56:71], a[128:131], v[112:115], 0
  v_readfirstlane_b32 s31, v39
  s_lshl_b32 s32, s34, 3
  v_xor_b32 v37, s32, v37
  v_mov_b32 v38, 1
  s_and_b32 s31, s31, 3
  s_add_u32 s31, s31, s34
  s_cmp_eq_u32 s31, 4
  s_cselect_b32 s31, s30, 2146435072
  s_mov_b64 exec, 1
  buffer_store_dword v14, off, s[4:7], s31
  s_mov_b64 exec, -1
  s_mul_i32 s32, s34, 1024
  s_add_u32 s30, s30, s32
  s_mov_b32 s34, 0
  ds_read_b128 v[112:115], v8 offset:8192
  s_waitcnt lgkmcnt(7)
  v_mfma_f32_32x32x16_bf16 v[56:71], a[132:135], v[116:119], v[56:71]
  ds_read_b128 v[116:119], v8 offset:9216
  s_waitcnt lgkmcnt(7)
  v_mfma_f32_32x32x16_bf16 v[56:71], a[136:139], v[120:123], v[56:71]
  ds_read_b128 v[120:123], v8 offset:10240
  s_waitcnt lgkmcnt(7)
  v_mfma_f32_32x32x16_bf16 v[56:71], a[140:143], v[124:127], v[56:71]
  v_cvt_pk_bf16_f32 v72, v40, v41
  v_cvt_pk_bf16_f32 v73, v42, v43
  ds_read_b128 v[124:127], v8 offset:11264
  s_waitcnt lgkmcnt(7)
  v_mfma_f32_32x32x16_bf16 v[56:71], a[144:147], v[96:99], v[56:71]
  v_cvt_pk_bf16_f32 v74, v44, v45
  v_cvt_pk_bf16_f32 v75, v46, v47
  ds_read_b128 v[96:99], v8 offset:12288
  s_waitcnt lgkmcnt(7)
  v_mfma_f32_32x32x16_bf16 v[56:71], a[148:151], v[100:103], v[56:71]
  buffer_store_dwordx4 v[72:75], v9, s[4:7], s27 offen offset:0
  v_cvt_pk_bf16_f32 v76, v48, v49
  ds_read_b128 v[100:103], v8 offset:13312
  s_waitcnt lgkmcnt(7)
  v_mfma_f32_32x32x16_bf16 v[56:71], a[152:155], v[104:107], v[56:71]
  v_cvt_pk_bf16_f32 v77, v50, v51
  v_cvt_pk_bf16_f32 v78, v52, v53
  ds_read_b128 v[104:107], v8 offset:14336
  s_waitcnt lgkmcnt(7)
  v_mfma_f32_32x32x16_bf16 v[56:71], a[156:159], v[108:111], v[56:71]
  v_cvt_pk_bf16_f32 v79, v54, v55
  buffer_store_dwordx4 v[76:79], v9, s[4:7], s27 offen offset:128
  ds_read_b128 v[108:111], v8 offset:15360
  s_waitcnt lgkmcnt(7)
  v_mfma_f32_32x32x16_bf16 v[56:71], a[160:163], v[112:115], v[56:71]
  buffer_load_dword v13, v12, s[4:7], s29 offen sc1
  ds_read_b128 v[112:115], v8 offset:16384
  s_waitcnt lgkmcnt(7)
  v_mfma_f32_32x32x16_bf16 v[56:71], a[164:167], v[116:119], v[56:71]
  ds_read_b128 v[116:119], v8 offset:17408
  s_waitcnt lgkmcnt(7)
  v_mfma_f32_32x32x16_bf16 v[56:71], a[168:171], v[120:123], v[56:71]
  ds_read_b128 v[120:123], v8 offset:18432
  s_waitcnt lgkmcnt(7)
  v_mfma_f32_32x32x16_bf16 v[56:71], a[172:175], v[124:127], v[56:71]
  ds_read_b128 v[124:127], v8 offset:19456
  s_waitcnt lgkmcnt(7)
  v_mfma_f32_32x32x16_bf16 v[56:71], a[176:179], v[96:99], v[56:71]
  ds_read_b128 v[96:99], v8 offset:20480
  s_waitcnt lgkmcnt(7)
  v_mfma_f32_32x32x16_bf16 v[56:71], a[180:183], v[100:103], v[56:71]
  ds_read_b128 v[100:103], v8 offset:21504
  s_waitcnt lgkmcnt(7)
  v_mfma_f32_32x32x16_bf16 v[56:71], a[184:187], v[104:107], v[56:71]
  ds_read_b128 v[104:107], v8 offset:22528
  s_waitcnt lgkmcnt(7)
  v_mfma_f32_32x32x16_bf16 v[56:71], a[188:191], v[108:111], v[56:71]
  ds_read_b128 v[108:111], v8 offset:23552
  s_waitcnt lgkmcnt(7)
  v_mfma_f32_32x32x16_bf16 v[56:71], a[192:195], v[112:115], v[56:71]
  ds_read_b128 v[112:115], v8 offset:24576
  s_waitcnt lgkmcnt(7)
  v_mfma_f32_32x32x16_bf16 v[56:71], a[196:199], v[116:119], v[56:71]
  ds_read_b128 v[116:119], v8 offset:25600
  s_waitcnt lgkmcnt(7)
  v_mfma_f32_32x32x16_bf16 v[56:71], a[200:203], v[120:123], v[56:71]
  ds_read_b128 v[120:123], v8 offset:26624
  s_waitcnt lgkmcnt(7)
  v_mfma_f32_32x32x16_bf16 v[56:71], a[204:207], v[124:127], v[56:71]
  ds_read_b128 v[124:127], v8 offset:27648
  s_waitcnt lgkmcnt(7)
  v_mfma_f32_32x32x16_bf16 v[56:71], a[208:211], v[96:99], v[56:71]
  s_waitcnt lgkmcnt(6)
  v_mfma_f32_32x32x16_bf16 v[56:71], a[212:215], v[100:103], v[56:71]
  s_waitcnt lgkmcnt(5)
  v_mfma_f32_32x32x16_bf16 v[56:71], a[216:219], v[104:107], v[56:71]
  buffer_load_dword v13, v12, s[4:7], s29 offen sc1
  s_waitcnt lgkmcnt(4)
  v_mfma_f32_32x32x16_bf16 v[56:71], a[220:223], v[108:111], v[56:71]
  s_waitcnt lgkmcnt(3)
  v_mfma_f32_32x32x16_bf16 v[56:71], a[224:227], v[112:115], v[56:71]
  s_waitcnt lgkmcnt(2)
  v_mfma_f32_32x32x16_bf16 v[56:71], a[228:231], v[116:119], v[56:71]
  s_waitcnt lgkmcnt(1)
  v_mfma_f32_32x32x16_bf16 v[56:71], a[232:235], v[120:123], v[56:71]
  s_waitcnt lgkmcnt(0)
  v_mfma_f32_32x32x16_bf16 v[56:71], a[236:239], v[124:127], v[56:71]
  v_xor_b32 v8, 32768, v8
  s_nop 10
  v_cvt_pk_bf16_f32 v80, v56, v57
  v_cvt_pk_bf16_f32 v81, v58, v59
  v_cvt_pk_bf16_f32 v82, v60, v61
  v_cvt_pk_bf16_f32 v83, v62, v63
  buffer_store_dwordx4 v[80:83], v9, s[4:7], s27 offen offset:256
  v_cvt_pk_bf16_f32 v84, v64, v65
  v_cvt_pk_bf16_f32 v85, v66, v67
  v_cvt_pk_bf16_f32 v86, v68, v69
  v_cvt_pk_bf16_f32 v87, v70, v71
  buffer_store_dwordx4 v[84:87], v9, s[4:7], s27 offen offset:384
  s_add_u32 s27, s27, 131072
  s_cmp_ge_u32 s27, s53
  s_cselect_b32 s78, 1048576, 0
  s_sub_u32 s27, s27, s78
  s_mov_b32 s34, 1
  s_cmp_eq_u32 s28, 0
  s_cbranch_scc1 glast_160
  s_cmp_eq_u32 s33, 0
  s_cbranch_scc1 gblk_161
  s_cmp_lg_u32 s3, 0
  s_cbranch_scc1 post_162
  v_mov_b32 v39, s38
  ds_write_b32 v36, v39 offset:4
  s_waitcnt lgkmcnt(0)
post_162:
  s_add_u32 s26, s26, 114688
  s_cmp_ge_u32 s26, s52
  s_cselect_b32 s78, 917504, 0
  s_sub_u32 s26, s26, s78
  s_xor_b32 s36, s36, 32768
  s_add_u32 s29, s29, 1024
  s_add_u32 s38, s38, 1
  s_cmp_ge_u32 s38, 9
  s_cselect_b64 vcc, -1, 0
  v_cndmask_b32 v12, v12, v15, vcc
  s_branch gtop_159
gblk_161:
  s_waitcnt vmcnt(2)
  v_cmp_ne_u32 vcc, 0, v13
  s_nop 0
  s_cmp_eq_u64 vcc, exec
  s_cbranch_scc0 gblk2_163
  s_cmp_lg_u32 s3, 0
  s_cbranch_scc1 post_164
  v_mov_b32 v39, s38
  ds_write_b32 v36, v39 offset:4
  s_waitcnt lgkmcnt(0)
post_164:
  s_mov_b32 s37, s26
  s_mov_b32 m0, s36
  s_nop 0
  buffer_load_dwordx4 v11, s[4:7], s37 offen sc1 lds
  s_add_u32 m0, m0, 4096
  s_add_u32 s37, s37, 4096
  buffer_load_dwordx4 v11, s[4:7], s37 offen sc1 lds
  s_add_u32 m0, m0, 4096
  s_add_u32 s37, s37, 4096
  buffer_load_dwordx4 v11, s[4:7], s37 offen sc1 lds
  s_add_u32 m0, m0, 4096
  s_add_u32 s37, s37, 4096
  buffer_load_dwordx4 v11, s[4:7], s37 offen sc1 lds
  s_add_u32 m0, m0, 4096
  s_add_u32 s37, s37, 4096
  buffer_load_dwordx4 v11, s[4:7], s37 offen sc1 lds
  s_add_u32 m0, m0, 4096
  s_add_u32 s37, s37, 4096
  buffer_load_dwordx4 v11, s[4:7], s37 offen sc1 lds
  s_add_u32 m0, m0, 4096
  s_add_u32 s37, s37, 4096
  buffer_load_dwordx4 v11, s[4:7], s37 offen sc1 lds
  s_add_u32 s26, s26, 114688
  s_cmp_ge_u32 s26, s52
  s_cselect_b32 s78, 917504, 0
  s_sub_u32 s26, s26, s78
  s_xor_b32 s36, s36, 32768
  s_add_u32 s29, s29, 1024
  s_add_u32 s38, s38, 1
  s_cmp_ge_u32 s38, 9
  s_cselect_b64 vcc, -1, 0
  v_cndmask_b32 v12, v12, v15, vcc
  s_waitcnt vmcnt(7)
  s_mov_b64 exec, 1
  ds_add_rtn_u32 v39, v37, v38
  s_waitcnt lgkmcnt(0)
  v_readfirstlane_b32 s31, v39
  s_mov_b64 exec, -1
  v_xor_b32 v37, 8, v37
  s_and_b32 s31, s31, 3
  s_cmp_lg_u32 s31, 3
  s_cbranch_scc1 agg_165
  s_mov_b64 exec, 1
  buffer_store_dword v14, off, s[4:7], s30
  s_mov_b64 exec, -1
  s_waitcnt vmcnt(1)
  s_branch aggj_166
agg_165:
  s_waitcnt vmcnt(0)
aggj_166:
  s_add_u32 s30, s30, 1024
  s_mov_b32 s34, 0
  s_branch gtop_159
gblk2_163:
  s_waitcnt vmcnt(0)
  s_mov_b64 exec, 1
  ds_add_rtn_u32 v39, v37, v38
  s_waitcnt lgkmcnt(0)
  v_readfirstlane_b32 s31, v39
  s_mov_b64 exec, -1
  v_xor_b32 v37, 8, v37
  s_and_b32 s31, s31, 3
  s_cmp_lg_u32 s31, 3
  s_cbranch_scc1 agg_167
  s_mov_b64 exec, 1
  buffer_store_dword v14, off, s[4:7], s30
  s_mov_b64 exec, -1
agg_167:
  s_add_u32 s30, s30, 1024
  s_mov_b32 s34, 0
  s_cmp_lg_u32 s3, 0
  s_cbranch_scc1 wro_168
  s_mov_b32 s35, 0
poll_170:
  buffer_load_dword v13, v12, s[4:7], s29 offen sc1
  s_waitcnt vmcnt(0)
  v_cmp_ne_u32 vcc, 0, v13
  s_nop 0
  s_cmp_eq_u64 vcc, exec
  s_cbranch_scc1 polld_171
  s_sleep 2
  s_add_u32 s35, s35, 1
  s_cmp_lt_u32 s35, 131072
  s_cbranch_scc1 poll_170
  s_branch mega_kernel_end
polld_171:
  v_mov_b32 v13, s38
  ds_write_b32 v36, v13 offset:4
  s_waitcnt lgkmcnt(0)
  s_branch wrd_169
wro_168:
  s_mov_b32 s35, 0
wrl_172:
  ds_read_b32 v13, v36 offset:4
  s_add_u32 s35, s35, 1
  s_cmp_gt_u32 s35, 2097152
  s_cbranch_scc1 mega_kernel_end
  s_waitcnt lgkmcnt(0)
  v_readfirstlane_b32 s31, v13
  s_nop 0
  s_cmp_ge_u32 s31, s38
  s_cbranch_scc1 wrd_169
  s_sleep 1
  s_branch wrl_172
wrd_169:
  s_mov_b32 s37, s26
  s_mov_b32 m0, s36
  s_nop 0
  buffer_load_dwordx4 v11, s[4:7], s37 offen sc1 lds
  s_add_u32 m0, m0, 4096
  s_add_u32 s37, s37, 4096
  buffer_load_dwordx4 v11, s[4:7], s37 offen sc1 lds
  s_add_u32 m0, m0, 4096
  s_add_u32 s37, s37, 4096
  buffer_load_dwordx4 v11, s[4:7], s37 offen sc1 lds
  s_add_u32 m0, m0, 4096
  s_add_u32 s37, s37, 4096
  buffer_load_dwordx4 v11, s[4:7], s37 offen sc1 lds
  s_add_u32 m0, m0, 4096
  s_add_u32 s37, s37, 4096
  buffer_load_dwordx4 v11, s[4:7], s37 offen sc1 lds
  s_add_u32 m0, m0, 4096
  s_add_u32 s37, s37, 4096
  buffer_load_dwordx4 v11, s[4:7], s37 offen sc1 lds
  s_add_u32 m0, m0, 4096
  s_add_u32 s37, s37, 4096
  buffer_load_dwordx4 v11, s[4:7], s37 offen sc1 lds
  s_add_u32 s26, s26, 114688
  s_cmp_ge_u32 s26, s52
  s_cselect_b32 s78, 917504, 0
  s_sub_u32 s26, s26, s78
  s_xor_b32 s36, s36, 32768
  s_add_u32 s29, s29, 1024
  s_add_u32 s38, s38, 1
  s_cmp_ge_u32 s38, 9
  s_cselect_b64 vcc, -1, 0
  v_cndmask_b32 v12, v12, v15, vcc
  s_waitcnt vmcnt(0)
  s_branch gtop_159
glast_160:
  s_waitcnt vmcnt(0)
  s_mov_b64 exec, 1
  ds_add_rtn_u32 v39, v37, v38
  s_waitcnt lgkmcnt(0)
  v_readfirstlane_b32 s31, v39
  s_mov_b64 exec, -1
  v_xor_b32 v37, 8, v37
  s_and_b32 s31, s31, 3
  s_cmp_lg_u32 s31, 3
  s_cbranch_scc1 agg_173
  s_mov_b64 exec, 1
  buffer_store_dword v14, off, s[4:7], s30
  s_mov_b64 exec, -1
agg_173:
  s_add_u32 s30, s30, 1024
  s_mov_b32 s34, 0
  s_branch mega_kernel_end
gg_153:
  s_lshl_b32 s31, s3, 10
  v_add_u32 v11, s31, v1
  s_mov_b32 s36, s31
  v_min_u32 v12, 3, v2
  v_lshlrev_b32 v12, 2, v12
  v_subrev_u32 v3, 4, v2
  v_cmp_gt_u32 vcc, 4, v3
  v_lshlrev_b32 v3, 2, v3
  v_add_u32 v3, s54, v3
  v_cndmask_b32 v15, v12, v3, vcc
  v_and_b32 v8, 0x7fff, v8
  v_mov_b32 v36, 163584
  v_mov_b32 v38, 0
  ds_write_b32 v36, v38
  ds_write_b32 v36, v38 offset:4
  ds_write_b32 v36, v38 offset:8
  s_waitcnt lgkmcnt(0)
  v_mov_b32 v38, 1
  v_mov_b32 v37, 163584
  s_mov_b32 s38, 1
  s_barrier
  s_cmp_lg_u32 s3, 0
  s_cbranch_scc1 wro_174
  s_mov_b32 s35, 0
poll_176:
  buffer_load_dword v13, v12, s[4:7], s29 offen sc1
  s_waitcnt vmcnt(0)
  v_cmp_ne_u32 vcc, 0, v13
  s_nop 0
  s_cmp_eq_u64 vcc, exec
  s_cbranch_scc1 polld_177
  s_sleep 8
  s_add_u32 s35, s35, 1
  s_cmp_lt_u32 s35, 131072
  s_cbranch_scc1 poll_176
  s_branch mega_kernel_end
polld_177:
  v_mov_b32 v13, s38
  ds_write_b32 v36, v13 offset:4
  s_waitcnt lgkmcnt(0)
  s_branch wrd_175
wro_174:
  s_mov_b32 s35, 0
wrl_178:
  ds_read_b32 v13, v36 offset:4
  s_add_u32 s35, s35, 1
  s_cmp_gt_u32 s35, 2097152
  s_cbranch_scc1 mega_kernel_end
  s_waitcnt lgkmcnt(0)
  v_readfirstlane_b32 s31, v13
  s_nop 0
  s_cmp_ge_u32 s31, s38
  s_cbranch_scc1 wrd_175
  s_sleep 1
  s_branch wrl_178
wrd_175:
  s_mov_b32 s37, s26
  s_mov_b32 m0, s36
  s_nop 0
  buffer_load_dwordx4 v11, s[4:7], s37 offen sc1 lds
  s_add_u32 m0, m0, 4096
  s_add_u32 s37, s37, 4096
  buffer_load_dwordx4 v11, s[4:7], s37 offen sc1 lds
  s_add_u32 m0, m0, 4096
  s_add_u32 s37, s37, 4096
  buffer_load_dwordx4 v11, s[4:7], s37 offen sc1 lds
  s_add_u32 m0, m0, 4096
  s_add_u32 s37, s37, 4096
  buffer_load_dwordx4 v11, s[4:7], s37 offen sc1 lds
  s_add_u32 m0, m0, 4096
  s_add_u32 s37, s37, 4096
  buffer_load_dwordx4 v11, s[4:7], s37 offen sc1 lds
  s_add_u32 m0, m0, 4096
  s_add_u32 s37, s37, 4096
  buffer_load_dwordx4 v11, s[4:7], s37 offen sc1 lds
  s_add_u32 m0, m0, 4096
  s_add_u32 s37, s37, 4096
  buffer_load_dwordx4 v11, s[4:7], s37 offen sc1 lds
  s_add_u32 s26, s26, 114688
  s_cmp_ge_u32 s26, s52
  s_cselect_b32 s78, 917504, 0
  s_sub_u32 s26, s26, s78
  s_xor_b32 s36, s36, 32768
  s_add_u32 s29, s29, 1024
  s_add_u32 s38, s38, 1
  s_cmp_ge_u32 s38, 9
  s_cselect_b64 vcc, -1, 0
  v_cndmask_b32 v12, v12, v15, vcc
  s_mov_b32 s34, 0
  s_waitcnt vmcnt(0)
gtop_179:
  s_waitcnt vmcnt(2)
  s_barrier
  ds_read_b128 v[96:99], v8 offset:0
  ds_read_b128 v[100:103], v8 offset:1024
  ds_read_b128 v[104:107], v8 offset:2048
  ds_read_b128 v[108:111], v8 offset:3072
  ds_read_b128 v[112:115], v8 offset:4096
  ds_read_b128 v[116:119], v8 offset:5120
  ds_read_b128 v[120:123], v8 offset:6144
  s_sub_u32 s28, s28, 1
  v_mov_b32 v13, 0
  buffer_load_dword v13, v12, s[4:7], s29 offen sc1
  s_cmp_eq_u32 s28, 0
  s_cselect_b32 s33, 2, 0
  ds_read_b128 v[124:127], v8 offset:7168
  s_waitcnt lgkmcnt(7)
  v_mfma_f32_32x32x16_bf16 v[40:55], a[0:3], v[96:99], 0
  ds_read_b128 v[96:99], v8 offset:8192
  s_waitcnt lgkmcnt(7)
  v_mfma_f32_32x32x16_bf16 v[40:55], a[4:7], v[100:103], v[40:55]
  ds_read_b128 v[100:103], v8 offset:9216
  s_waitcnt lgkmcnt(7)
  v_mfma_f32_32x32x16_bf16 v[40:55], a[8:11], v[104:107], v[40:55]
  ds_read_b128 v[104:107], v8 offset:10240
  s_waitcnt lgkmcnt(7)
  v_mfma_f32_32x32x16_bf16 v[40:55], a[12:15], v[108:111], v[40:55]
  ds_read_b128 v[108:111], v8 offset:11264
  s_waitcnt lgkmcnt(7)
  v_mfma_f32_32x32x16_bf16 v[40:55], a[16:19], v[112:115], v[40:55]
  ds_read_b128 v[112:115], v8 offset:12288
  s_waitcnt lgkmcnt(7)
  v_mfma_f32_32x32x16_bf16 v[40:55], a[20:23], v[116:119], v[40:55]
  ds_read_b128 v[116:119], v8 offset:13312
  s_waitcnt lgkmcnt(7)
  v_mfma_f32_32x32x16_bf16 v[40:55], a[24:27], v[120:123], v[40:55]
  buffer_load_dword v13, v12, s[4:7], s29 offen sc1
  ds_read_b128 v[120:123], v8 offset:14336
  s_waitcnt lgkmcnt(7)
  v_mfma_f32_32x32x16_bf16 v[40:55], a[28:31], v[124:127], v[40:55]
  ds_read_b128 v[124:127], v8 offset:15360
  s_waitcnt lgkmcnt(7)
  v_mfma_f32_32x32x16_bf16 v[40:55], a[32:35], v[96:99], v[40:55]
  ds_read_b128 v[96:99], v8 offset:16384
  s_waitcnt lgkmcnt(7)
  v_mfma_f32_32x32x16_bf16 v[40:55], a[36:39], v[100:103], v[40:55]
  ds_read_b128 v[100:103], v8 offset:17408
  s_waitcnt lgkmcnt(7)
  v_mfma_f32_32x32x16_bf16 v[40:55], a[40:43], v[104:107], v[40:55]
  ds_read_b128 v[104:107], v8 offset:18432
  s_waitcnt lgkmcnt(7)
  v_mfma_f32_32x32x16_bf16 v[40:55], a[44:47], v[108:111], v[40:55]
  ds_read_b128 v[108:111], v8 offset:19456
  s_waitcnt lgkmcnt(7)
  v_mfma_f32_32x32x16_bf16 v[40:55], a[48:51], v[112:115], v[40:55]
  ds_read_b128 v[112:115], v8 offset:20480
  s_waitcnt lgkmcnt(7)
  v_mfma_f32_32x32x16_bf16 v[40:55], a[52:55], v[116:119], v[40:55]
  ds_read_b128 v[116:119], v8 offset:21504
  s_waitcnt lgkmcnt(7)
  v_mfma_f32_32x32x16_bf16 v[40:55], a[56:59], v[120:123], v[40:55]
  v_cmp_ne_u32 vcc, 0, v13
  s_nop 0
  s_cmp_eq_u64 vcc, exec
  s_cselect_b32 s31, s33, 1
  s_cmp_eq_u32 s31, 0
  s_cselect_b32 s37, s26, 2146435072
  s_cselect_b32 m0, s36, 65536
  s_cselect_b32 s33, 1, s33
  ds_read_b128 v[120:123], v8 offset:22528
  s_waitcnt lgkmcnt(7)
  v_mfma_f32_32x32x16_bf16 v[40:55], a[60:63], v[124:127], v[40:55]
  buffer_load_dwordx4 v11, s[4:7], s37 offen sc1 lds
  s_add_u32 m0, m0, 4096
  s_add_u32 s37, s37, 4096
  ds_read_b128 v[124:127], v8 offset:23552
  s_waitcnt lgkmcnt(7)
  v_mfma_f32_32x32x16_bf16 v[40:55], a[64:67], v[96:99], v[40:55]
  ds_read_b128 v[96:99], v8 offset:24576
  s_waitcnt lgkmcnt(7)
  v_mfma_f32_32x32x16_bf16 v[40:55], a[68:71], v[100:103], v[40:55]
  buffer_load_dwordx4 v11, s[4:7], s37 offen sc1 lds
  s_add_u32 m0, m0, 4096
  s_add_u32 s37, s37, 4096
  ds_read_b128 v[100:103], v8 offset:25600
  s_waitcnt lgkmcnt(7)
  v_mfma_f32_32x32x16_bf16 v[40:55], a[72:75], v[104:107], v[40:55]
  s_waitcnt vmcnt(4)
  v_mov_b32 v38, s34
  s_mov_b64 exec, 1
  ds_add_rtn_u32 v39, v37, v38
  s_mov_b64 exec, -1
  ds_read_b128 v[104:107], v8 offset:26624
  s_waitcnt lgkmcnt(7)
  v_mfma_f32_32x32x16_bf16 v[40:55], a[76:79], v[108:111], v[40:55]
  buffer_load_dwordx4 v11, s[4:7], s37 offen sc1 lds
  s_add_u32 m0, m0, 4096
  s_add_u32 s37, s37, 4096
  ds_read_b128 v[108:111], v8 offset:27648
  s_waitcnt lgkmcnt(7)
  v_mfma_f32_32x32x16_bf16 v[40:55], a[80:83], v[112:115], v[40:55]
  ds_read_b128 v[112:115], v8 offset:0
  s_waitcnt lgkmcnt(7)
  v_mfma_f32_32x32x16_bf16 v[40:55], a[84:87], v[116:119], v[40:55]
  buffer_load_dwordx4 v11, s[4:7], s37 offen sc1 lds
  s_add_u32 m0, m0, 4096
  s_add_u32 s37, s37, 4096
  ds_read_b128 v[116:119], v8 offset:1024
  s_waitcnt lgkmcnt(7)
  v_mfma_f32_32x32x16_bf16 v[40:55], a[88:91], v[120:123], v[40:55]
  ds_read_b128 v[120:123], v8 offset:2048
  s_waitcnt lgkmcnt(7)
  v_mfma_f32_32x32x16_bf16 v[40:55], a[92:95], v[124:127], v[40:55]
  buffer_load_dwordx4 v11, s[4:7], s37 offen sc1 lds
  s_add_u32 m0, m0, 4096
  s_add_u32 s37, s37, 4096
  ds_read_b128 v[124:127], v8 offset:3072
  s_waitcnt lgkmcnt(7)
  v_mfma_f32_32x32x16_bf16 v[40:55], a[96:99], v[96:99], v[40:55]
  ds_read_b128 v[96:99], v8 offset:4096
  s_waitcnt lgkmcnt(7)
  v_mfma_f32_32x32x16_bf16 v[40:55], a[100:103], v[100:103], v[40:55]
  buffer_load_dwordx4 v11, s[4:7], s37 offen sc1 lds
  s_add_u32 m0, m0, 4096
  s_add_u32 s37, s37, 4096
  ds_read_b128 v[100:103], v8 offset:5120
  s_waitcnt lgkmcnt(7)
  v_mfma_f32_32x32x16_bf16 v[40:55], a[104:107], v[104:107], v[40:55]
  ds_read_b128 v[104:107], v8 offset:6144
  s_waitcnt lgkmcnt(7)
  v_mfma_f32_32x32x16_bf16 v[40:55], a[108:111], v[108:111], v[40:55]
  buffer_load_dwordx4 v11, s[4:7], s37 offen sc1 lds
  s_add_u32 m0, m0, 4096
  s_add_u32 s37, s37, 4096
  ds_read_b128 v[108:111], v8 offset:7168
  s_waitcnt lgkmcnt(7)
  v_mfma_f32_32x32x16_bf16 v[56:71], a[128:131], v[112:115], 0
  v_readfirstlane_b32 s31, v39
  s_lshl_b32 s32, s34, 3
  v_xor_b32 v37, s32, v37
  v_mov_b32 v38, 1
  s_and_b32 s31, s31, 3
  s_add_u32 s31, s31, s34
  s_cmp_eq_u32 s31, 4
  s_cselect_b32 s31, s30, 2146435072
  s_mov_b64 exec, 1
  buffer_store_dword v14, off, s[4:7], s31 sc1
  s_mov_b64 exec, -1
  s_mul_i32 s32, s34, 1024
  s_add_u32 s30, s30, s32
  s_mov_b32 s34, 0
  ds_read_b128 v[112:115], v8 offset:8192
  s_waitcnt lgkmcnt(7)
  v_mfma_f32_32x32x16_bf16 v[56:71], a[132:135], v[116:119], v[56:71]
  ds_read_b128 v[116:119], v8 offset:9216
  s_waitcnt lgkmcnt(7)
  v_mfma_f32_32x32x16_bf16 v[56:71], a[136:139], v[120:123], v[56:71]
  ds_read_b128 v[120:123], v8 offset:10240
  s_waitcnt lgkmcnt(7)
  v_mfma_f32_32x32x16_bf16 v[56:71], a[140:143], v[124:127], v[56:71]
  v_cvt_pk_bf16_f32 v72, v40, v41
  v_cvt_pk_bf16_f32 v73, v42, v43
  ds_read_b128 v[124:127], v8 offset:11264
  s_waitcnt lgkmcnt(7)
  v_mfma_f32_32x32x16_bf16 v[56:71], a[144:147], v[96:99], v[56:71]
  v_cvt_pk_bf16_f32 v74, v44, v45
  v_cvt_pk_bf16_f32 v75, v46, v47
  ds_read_b128 v[96:99], v8 offset:12288
  s_waitcnt lgkmcnt(7)
  v_mfma_f32_32x32x16_bf16 v[56:71], a[148:151], v[100:103], v[56:71]
  buffer_store_dwordx4 v[72:75], v9, s[4:7], s27 offen offset:0 sc1
  v_cvt_pk_bf16_f32 v76, v48, v49
  ds_read_b128 v[100:103], v8 offset:13312
  s_waitcnt lgkmcnt(7)
  v_mfma_f32_32x32x16_bf16 v[56:71], a[152:155], v[104:107], v[56:71]
  v_cvt_pk_bf16_f32 v77, v50, v51
  v_cvt_pk_bf16_f32 v78, v52, v53
  ds_read_b128 v[104:107], v8 offset:14336
  s_waitcnt lgkmcnt(7)
  v_mfma_f32_32x32x16_bf16 v[56:71], a[156:159], v[108:111], v[56:71]
  v_cvt_pk_bf16_f32 v79, v54, v55
  buffer_store_dwordx4 v[76:79], v9, s[4:7], s27 offen offset:128 sc1
  ds_read_b128 v[108:111], v8 offset:15360
  s_waitcnt lgkmcnt(7)
  v_mfma_f32_32x32x16_bf16 v[56:71], a[160:163], v[112:115], v[56:71]
  buffer_load_dword v13, v12, s[4:7], s29 offen sc1
  ds_read_b128 v[112:115], v8 offset:16384
  s_waitcnt lgkmcnt(7)
  v_mfma_f32_32x32x16_bf16 v[56:71], a[164:167], v[116:119], v[56:71]
  ds_read_b128 v[116:119], v8 offset:17408
  s_waitcnt lgkmcnt(7)
  v_mfma_f32_32x32x16_bf16 v[56:71], a[168:171], v[120:123], v[56:71]
  ds_read_b128 v[120:123], v8 offset:18432
  s_waitcnt lgkmcnt(7)
  v_mfma_f32_32x32x16_bf16 v[56:71], a[172:175], v[124:127], v[56:71]
  ds_read_b128 v[124:127], v8 offset:19456
  s_waitcnt lgkmcnt(7)
  v_mfma_f32_32x32x16_bf16 v[56:71], a[176:179], v[96:99], v[56:71]
  ds_read_b128 v[96:99], v8 offset:20480
  s_waitcnt lgkmcnt(7)
  v_mfma_f32_32x32x16_bf16 v[56:71], a[180:183], v[100:103], v[56:71]
  ds_read_b128 v[100:103], v8 offset:21504
  s_waitcnt lgkmcnt(7)
  v_mfma_f32_32x32x16_bf16 v[56:71], a[184:187], v[104:107], v[56:71]
  ds_read_b128 v[104:107], v8 offset:22528
  s_waitcnt lgkmcnt(7)
  v_mfma_f32_32x32x16_bf16 v[56:71], a[188:191], v[108:111], v[56:71]
  ds_read_b128 v[108:111], v8 offset:23552
  s_waitcnt lgkmcnt(7)
  v_mfma_f32_32x32x16_bf16 v[56:71], a[192:195], v[112:115], v[56:71]
  ds_read_b128 v[112:115], v8 offset:24576
  s_waitcnt lgkmcnt(7)
  v_mfma_f32_32x32x16_bf16 v[56:71], a[196:199], v[116:119], v[56:71]
  ds_read_b128 v[116:119], v8 offset:25600
  s_waitcnt lgkmcnt(7)
  v_mfma_f32_32x32x16_bf16 v[56:71], a[200:203], v[120:123], v[56:71]
  ds_read_b128 v[120:123], v8 offset:26624
  s_waitcnt lgkmcnt(7)
  v_mfma_f32_32x32x16_bf16 v[56:71], a[204:207], v[124:127], v[56:71]
  ds_read_b128 v[124:127], v8 offset:27648
  s_waitcnt lgkmcnt(7)
  v_mfma_f32_32x32x16_bf16 v[56:71], a[208:211], v[96:99], v[56:71]
  s_waitcnt lgkmcnt(6)
  v_mfma_f32_32x32x16_bf16 v[56:71], a[212:215], v[100:103], v[56:71]
  s_waitcnt lgkmcnt(5)
  v_mfma_f32_32x32x16_bf16 v[56:71], a[216:219], v[104:107], v[56:71]
  buffer_load_dword v13, v12, s[4:7], s29 offen sc1
  s_waitcnt lgkmcnt(4)
  v_mfma_f32_32x32x16_bf16 v[56:71], a[220:223], v[108:111], v[56:71]
  s_waitcnt lgkmcnt(3)
  v_mfma_f32_32x32x16_bf16 v[56:71], a[224:227], v[112:115], v[56:71]
  s_waitcnt lgkmcnt(2)
  v_mfma_f32_32x32x16_bf16 v[56:71], a[228:231], v[116:119], v[56:71]
  s_waitcnt lgkmcnt(1)
  v_mfma_f32_32x32x16_bf16 v[56:71], a[232:235], v[120:123], v[56:71]
  s_waitcnt lgkmcnt(0)
  v_mfma_f32_32x32x16_bf16 v[56:71], a[236:239], v[124:127], v[56:71]
  v_xor_b32 v8, 32768, v8
  s_nop 10
  v_cvt_pk_bf16_f32 v80, v56, v57
  v_cvt_pk_bf16_f32 v81, v58, v59
  v_cvt_pk_bf16_f32 v82, v60, v61
  v_cvt_pk_bf16_f32 v83, v62, v63
  buffer_store_dwordx4 v[80:83], v9, s[4:7], s27 offen offset:256 sc1
  v_cvt_pk_bf16_f32 v84, v64, v65
  v_cvt_pk_bf16_f32 v85, v66, v67
  v_cvt_pk_bf16_f32 v86, v68, v69
  v_cvt_pk_bf16_f32 v87, v70, v71
  buffer_store_dwordx4 v[84:87], v9, s[4:7], s27 offen offset:384 sc1
  s_add_u32 s27, s27, 131072
  s_cmp_ge_u32 s27, s53
  s_cselect_b32 s78, 1048576, 0
  s_sub_u32 s27, s27, s78
  s_mov_b32 s34, 1
  s_cmp_eq_u32 s28, 0
  s_cbranch_scc1 glast_180
  s_cmp_eq_u32 s33, 0
  s_cbranch_scc1 gblk_181
  s_cmp_lg_u32 s3, 0
  s_cbranch_scc1 post_182
  v_mov_b32 v39, s38
  ds_write_b32 v36, v39 offset:4
  s_waitcnt lgkmcnt(0)
post_182:
  s_add_u32 s26, s26, 114688
  s_cmp_ge_u32 s26, s52
  s_cselect_b32 s78, 917504, 0
  s_sub_u32 s26, s26, s78
  s_xor_b32 s36, s36, 32768
  s_add_u32 s29, s29, 1024
  s_add_u32 s38, s38, 1
  s_cmp_ge_u32 s38, 9
  s_cselect_b64 vcc, -1, 0
  v_cndmask_b32 v12, v12, v15, vcc
  s_branch gtop_179
gblk_181:
  s_waitcnt vmcnt(2)
  v_cmp_ne_u32 vcc, 0, v13
  s_nop 0
  s_cmp_eq_u64 vcc, exec
  s_cbranch_scc0 gblk2_183
  s_cmp_lg_u32 s3, 0
  s_cbranch_scc1 post_184
  v_mov_b32 v39, s38
  ds_write_b32 v36, v39 offset:4
  s_waitcnt lgkmcnt(0)
post_184:
  s_mov_b32 s37, s26
  s_mov_b32 m0, s36
  s_nop 0
  buffer_load_dwordx4 v11, s[4:7], s37 offen sc1 lds
  s_add_u32 m0, m0, 4096
  s_add_u32 s37, s37, 4096
  buffer_load_dwordx4 v11, s[4:7], s37 offen sc1 lds
  s_add_u32 m0, m0, 4096
  s_add_u32 s37, s37, 4096
  buffer_load_dwordx4 v11, s[4:7], s37 offen sc1 lds
  s_add_u32 m0, m0, 4096
  s_add_u32 s37, s37, 4096
  buffer_load_dwordx4 v11, s[4:7], s37 offen sc1 lds
  s_add_u32 m0, m0, 4096
  s_add_u32 s37, s37, 4096
  buffer_load_dwordx4 v11, s[4:7], s37 offen sc1 lds
  s_add_u32 m0, m0, 4096
  s_add_u32 s37, s37, 4096
  buffer_load_dwordx4 v11, s[4:7], s37 offen sc1 lds
  s_add_u32 m0, m0, 4096
  s_add_u32 s37, s37, 4096
  buffer_load_dwordx4 v11, s[4:7], s37 offen sc1 lds
  s_add_u32 s26, s26, 114688
  s_cmp_ge_u32 s26, s52
  s_cselect_b32 s78, 917504, 0
  s_sub_u32 s26, s26, s78
  s_xor_b32 s36, s36, 32768
  s_add_u32 s29, s29, 1024
  s_add_u32 s38, s38, 1
  s_cmp_ge_u32 s38, 9
  s_cselect_b64 vcc, -1, 0
  v_cndmask_b32 v12, v12, v15, vcc
  s_waitcnt vmcnt(7)
  s_mov_b64 exec, 1
  ds_add_rtn_u32 v39, v37, v38
  s_waitcnt lgkmcnt(0)
  v_readfirstlane_b32 s31, v39
  s_mov_b64 exec, -1
  v_xor_b32 v37, 8, v37
  s_and_b32 s31, s31, 3
  s_cmp_lg_u32 s31, 3
  s_cbranch_scc1 agg_185
  s_mov_b64 exec, 1
  buffer_store_dword v14, off, s[4:7], s30 sc1
  s_mov_b64 exec, -1
  s_waitcnt vmcnt(1)
  s_branch aggj_186
agg_185:
  s_waitcnt vmcnt(0)
aggj_186:
  s_add_u32 s30, s30, 1024
  s_mov_b32 s34, 0
  s_branch gtop_179
gblk2_183:
  s_waitcnt vmcnt(0)
  s_mov_b64 exec, 1
  ds_add_rtn_u32 v39, v37, v38
  s_waitcnt lgkmcnt(0)
  v_readfirstlane_b32 s31, v39
  s_mov_b64 exec, -1
  v_xor_b32 v37, 8, v37
  s_and_b32 s31, s31, 3
  s_cmp_lg_u32 s31, 3
  s_cbranch_scc1 agg_187
  s_mov_b64 exec, 1
  buffer_store_dword v14, off, s[4:7], s30 sc1
  s_mov_b64 exec, -1
agg_187:
  s_add_u32 s30, s30, 1024
  s_mov_b32 s34, 0
  s_cmp_lg_u32 s3, 0
  s_cbranch_scc1 wro_188
  s_mov_b32 s35, 0
poll_190:
  buffer_load_dword v13, v12, s[4:7], s29 offen sc1
  s_waitcnt vmcnt(0)
  v_cmp_ne_u32 vcc, 0, v13
  s_nop 0
  s_cmp_eq_u64 vcc, exec
  s_cbranch_scc1 polld_191
  s_sleep 2
  s_add_u32 s35, s35, 1
  s_cmp_lt_u32 s35, 131072
  s_cbranch_scc1 poll_190
  s_branch mega_kernel_end
polld_191:
  v_mov_b32 v13, s38
  ds_write_b32 v36, v13 offset:4
  s_waitcnt lgkmcnt(0)
  s_branch wrd_189
wro_188:
  s_mov_b32 s35, 0
wrl_192:
  ds_read_b32 v13, v36 offset:4
  s_add_u32 s35, s35, 1
  s_cmp_gt_u32 s35, 2097152
  s_cbranch_scc1 mega_kernel_end
  s_waitcnt lgkmcnt(0)
  v_readfirstlane_b32 s31, v13
  s_nop 0
  s_cmp_ge_u32 s31, s38
  s_cbranch_scc1 wrd_189
  s_sleep 1
  s_branch wrl_192
wrd_189:
  s_mov_b32 s37, s26
  s_mov_b32 m0, s36
  s_nop 0
  buffer_load_dwordx4 v11, s[4:7], s37 offen sc1 lds
  s_add_u32 m0, m0, 4096
  s_add_u32 s37, s37, 4096
  buffer_load_dwordx4 v11, s[4:7], s37 offen sc1 lds
  s_add_u32 m0, m0, 4096
  s_add_u32 s37, s37, 4096
  buffer_load_dwordx4 v11, s[4:7], s37 offen sc1 lds
  s_add_u32 m0, m0, 4096
  s_add_u32 s37, s37, 4096
  buffer_load_dwordx4 v11, s[4:7], s37 offen sc1 lds
  s_add_u32 m0, m0, 4096
  s_add_u32 s37, s37, 4096
  buffer_load_dwordx4 v11, s[4:7], s37 offen sc1 lds
  s_add_u32 m0, m0, 4096
  s_add_u32 s37, s37, 4096
  buffer_load_dwordx4 v11, s[4:7], s37 offen sc1 lds
  s_add_u32 m0, m0, 4096
  s_add_u32 s37, s37, 4096
  buffer_load_dwordx4 v11, s[4:7], s37 offen sc1 lds
  s_add_u32 s26, s26, 114688
  s_cmp_ge_u32 s26, s52
  s_cselect_b32 s78, 917504, 0
  s_sub_u32 s26, s26, s78
  s_xor_b32 s36, s36, 32768
  s_add_u32 s29, s29, 1024
  s_add_u32 s38, s38, 1
  s_cmp_ge_u32 s38, 9
  s_cselect_b64 vcc, -1, 0
  v_cndmask_b32 v12, v12, v15, vcc
  s_waitcnt vmcnt(0)
  s_branch gtop_179
glast_180:
  s_waitcnt vmcnt(0)
  s_mov_b64 exec, 1
  ds_add_rtn_u32 v39, v37, v38
  s_waitcnt lgkmcnt(0)
  v_readfirstlane_b32 s31, v39
  s_mov_b64 exec, -1
  v_xor_b32 v37, 8, v37
  s_and_b32 s31, s31, 3
  s_cmp_lg_u32 s31, 3
  s_cbranch_scc1 agg_193
  s_mov_b64 exec, 1
  buffer_store_dword v14, off, s[4:7], s30 sc1
  s_mov_b64 exec, -1
agg_193:
  s_add_u32 s30, s30, 1024
  s_mov_b32 s34, 0
  s_branch mega_kernel_end
r_rl_19:
  s_lshl_b32 s25, s98, 13
  s_mov_b32 s26, s25
  s_lshr_b32 s41, s98, 2
  s_and_b32 s42, s98, 3
  s_mul_i32 s24, s41, 262144
  s_lshl_b32 s40, s42, 13
  s_add_u32 s24, s24, s40
  s_add_u32 s24, s24, 138412032
  s_lshl_b32 s40, s97, 24
  s_add_u32 s24, s24, s40
  s_lshl_b32 s27, s41, 15
  s_lshl_b32 s40, s42, 7
  s_add_u32 s27, s27, s40
  s_mov_b32 s28, 32
  s_lshl_b32 s41, s41, 10
  s_add_u32 s41, s41, s46
  s_add_u32 s29, s41, 393216
  s_lshl_b32 s40, s42, 2
  s_add_u32 s30, s41, s40
  s_add_u32 s30, s30, 524288
  s_cmp_eq_u32 s97, 1
  s_cbranch_scc1 rl_l1_194
  s_load_dwordx2 s[8:9], s[0:1], 0
  s_waitcnt lgkmcnt(0)
  s_mov_b32 s10, 2097152
  s_mov_b32 s11, 0x00020000
  s_add_u32 s26, s26, 12582912
  s_add_u32 s27, s27, 6291456
  s_add_u32 s52, s24, 2097152
  v_and_b32 v3, 7, v0
  v_lshrrev_b32 v4, 3, v0
  v_lshlrev_b32 v10, 4, v3
  s_lshl_b32 s31, s3, 2
  v_add_u32 v9, s31, v10
  v_lshlrev_b32 v7, 10, v3
  v_lshl_add_u32 v7, v4, 4, v7
  v_lshlrev_b32 v8, 9, v4
  v_lshl_add_u32 v8, v3, 4, v8
  v_lshrrev_b32 v5, 2, v3
  v_lshlrev_b32 v6, 12, v5
  v_lshl_add_u32 v6, v4, 6, v6
  v_and_b32 v5, 3, v3
  v_lshl_add_u32 v6, v5, 4, v6
  v_mov_b32 v13, 1
  s_mov_b32 s40, 0xffff0000
  v_min_u32 v11, 15, v2
  v_lshlrev_b32 v11, 2, v11
  v_mov_b32 v14, 163584
  v_mov_b32 v4, 0
  ds_write_b32 v14, v4
  ds_write_b32 v14, v4 offset:4
  ds_write_b32 v14, v4 offset:8
  s_waitcnt lgkmcnt(0)
  v_mov_b32 v4, 1
  v_mov_b32 v15, 163584
  s_mov_b32 s36, 1
  s_barrier
rwtop_195:
  buffer_load_dwordx4 v[72:75], v7, s[8:11], s25 offen offset:0
  buffer_load_dwordx4 v[76:79], v7, s[8:11], s25 offen offset:512
  s_cmp_lg_u32 s3, 0
  s_cbranch_scc1 wro_196
  s_mov_b32 s35, 0
poll_198:
  buffer_load_dword v12, v11, s[4:7], s29 offen sc1
  s_waitcnt vmcnt(0)
  v_cmp_ne_u32 vcc, 0, v12
  s_nop 0
  s_cmp_eq_u64 vcc, exec
  s_cbranch_scc1 polld_199
  s_sleep 3
  s_add_u32 s35, s35, 1
  s_cmp_lt_u32 s35, 131072
  s_cbranch_scc1 poll_198
  s_branch mega_kernel_end
polld_199:
  v_mov_b32 v12, s36
  ds_write_b32 v14, v12 offset:4
  s_waitcnt lgkmcnt(0)
  s_branch wrd_197
wro_196:
  s_mov_b32 s35, 0
wrl_200:
  ds_read_b32 v12, v14 offset:4
  s_add_u32 s35, s35, 1
  s_cmp_gt_u32 s35, 2097152
  s_cbranch_scc1 mega_kernel_end
  s_waitcnt lgkmcnt(0)
  v_readfirstlane_b32 s31, v12
  s_nop 0
  s_cmp_ge_u32 s31, s36
  s_nop 0
  s_cbranch_scc1 wrd_197
  s_sleep 1
  s_branch wrl_200
wrd_197:
  s_mov_b32 s31, s24
  buffer_load_dwordx4 v[80:83], v6, s[4:7], s31 offen offset:0 sc1
  buffer_load_dwordx4 v[84:87], v6, s[4:7], s31 offen offset:2048 sc1
  s_add_u32 s31, s31, 32768
  buffer_load_dwordx4 v[88:91], v6, s[4:7], s31 offen offset:0 sc1
  buffer_load_dwordx4 v[92:95], v6, s[4:7], s31 offen offset:2048 sc1
  s_add_u32 s31, s31, 32768
  buffer_load_dwordx4 v[96:99], v6, s[4:7], s31 offen offset:0 sc1
  buffer_load_dwordx4 v[100:103], v6, s[4:7], s31 offen offset:2048 sc1
  s_add_u32 s31, s31, 32768
  buffer_load_dwordx4 v[104:107], v6, s[4:7], s31 offen offset:0 sc1
  buffer_load_dwordx4 v[108:111], v6, s[4:7], s31 offen offset:2048 sc1
  s_add_u32 s31, s31, 32768
  buffer_load_dwordx4 v[112:115], v6, s[4:7], s31 offen offset:0 sc1
  buffer_load_dwordx4 v[116:119], v6, s[4:7], s31 offen offset:2048 sc1
  s_add_u32 s31, s31, 32768
  buffer_load_dwordx4 v[120:123], v6, s[4:7], s31 offen offset:0 sc1
  buffer_load_dwordx4 v[124:127], v6, s[4:7], s31 offen offset:2048 sc1
  s_add_u32 s31, s31, 32768
  buffer_load_dwordx4 v[128:131], v6, s[4:7], s31 offen offset:0 sc1
  buffer_load_dwordx4 v[132:135], v6, s[4:7], s31 offen offset:2048 sc1
  s_add_u32 s31, s31, 32768
  buffer_load_dwordx4 v[136:139], v6, s[4:7], s31 offen offset:0 sc1
  buffer_load_dwordx4 v[140:143], v6, s[4:7], s31 offen offset:2048 sc1
  s_add_u32 s24, s24, 524288
  s_cmp_ge_u32 s24, s52
  s_cselect_b32 s78, 2097152, 0
  s_sub_u32 s24, s24, s78
  s_add_u32 s25, s25, 65536
  s_add_u32 s29, s29, 2048
  s_add_u32 s36, s36, 1
  s_waitcnt vmcnt(14)
  v_lshlrev_b32 v40, 16, v80
  v_and_b32 v41, s40, v80
  v_lshlrev_b32 v42, 16, v81
  v_and_b32 v43, s40, v81
  v_lshlrev_b32 v44, 16, v82
  v_and_b32 v45, s40, v82
  v_lshlrev_b32 v46, 16, v83
  v_and_b32 v47, s40, v83
  v_lshlrev_b32 v48, 16, v84
  v_and_b32 v49, s40, v84
  v_lshlrev_b32 v50, 16, v85
  v_and_b32 v51, s40, v85
  v_lshlrev_b32 v52, 16, v86
  v_and_b32 v53, s40, v86
  v_lshlrev_b32 v54, 16, v87
  v_and_b32 v55, s40, v87
  s_waitcnt vmcnt(12)
  v_lshlrev_b32 v56, 16, v88
  v_and_b32 v57, s40, v88
  v_lshlrev_b32 v58, 16, v89
  v_and_b32 v59, s40, v89
  v_lshlrev_b32 v60, 16, v90
  v_and_b32 v61, s40, v90
  v_lshlrev_b32 v62, 16, v91
  v_and_b32 v63, s40, v91
  v_add_f32 v40, v40, v56
  v_add_f32 v41, v41, v57
  v_add_f32 v42, v42, v58
  v_add_f32 v43, v43, v59
  v_add_f32 v44, v44, v60
  v_add_f32 v45, v45, v61
  v_add_f32 v46, v46, v62
  v_add_f32 v47, v47, v63
  v_lshlrev_b32 v56, 16, v92
  v_and_b32 v57, s40, v92
  v_lshlrev_b32 v58, 16, v93
  v_and_b32 v59, s40, v93
  v_lshlrev_b32 v60, 16, v94
  v_and_b32 v61, s40, v94
  v_lshlrev_b32 v62, 16, v95
  v_and_b32 v63, s40, v95
  v_add_f32 v48, v48, v56
  v_add_f32 v49, v49, v57
  v_add_f32 v50, v50, v58
  v_add_f32 v51, v51, v59
  v_add_f32 v52, v52, v60
  v_add_f32 v53, v53, v61
  v_add_f32 v54, v54, v62
  v_add_f32 v55, v55, v63
  s_waitcnt vmcnt(10)
  v_lshlrev_b32 v56, 16, v96
  v_and_b32 v57, s40, v96
  v_lshlrev_b32 v58, 16, v97
  v_and_b32 v59, s40, v97
  v_lshlrev_b32 v60, 16, v98
  v_and_b32 v61, s40, v98
  v_lshlrev_b32 v62, 16, v99
  v_and_b32 v63, s40, v99
  v_add_f32 v40, v40, v56
  v_add_f32 v41, v41, v57
  v_add_f32 v42, v42, v58
  v_add_f32 v43, v43, v59
  v_add_f32 v44, v44, v60
  v_add_f32 v45, v45, v61
  v_add_f32 v46, v46, v62
  v_add_f32 v47, v47, v63
  v_lshlrev_b32 v56, 16, v100
  v_and_b32 v57, s40, v100
  v_lshlrev_b32 v58, 16, v101
  v_and_b32 v59, s40, v101
  v_lshlrev_b32 v60, 16, v102
  v_and_b32 v61, s40, v102
  v_lshlrev_b32 v62, 16, v103
  v_and_b32 v63, s40, v103
  v_add_f32 v48, v48, v56
  v_add_f32 v49, v49, v57
  v_add_f32 v50, v50, v58
  v_add_f32 v51, v51, v59
  v_add_f32 v52, v52, v60
  v_add_f32 v53, v53, v61
  v_add_f32 v54, v54, v62
  v_add_f32 v55, v55, v63
  s_waitcnt vmcnt(8)
  v_lshlrev_b32 v56, 16, v104
  v_and_b32 v57, s40, v104
  v_lshlrev_b32 v58, 16, v105
  v_and_b32 v59, s40, v105
  v_lshlrev_b32 v60, 16, v106
  v_and_b32 v61, s40, v106
  v_lshlrev_b32 v62, 16, v107
  v_and_b32 v63, s40, v107
  v_add_f32 v40, v40, v56
  v_add_f32 v41, v41, v57
  v_add_f32 v42, v42, v58
  v_add_f32 v43, v43, v59
  v_add_f32 v44, v44, v60
  v_add_f32 v45, v45, v61
  v_add_f32 v46, v46, v62
  v_add_f32 v47, v47, v63
  v_lshlrev_b32 v56, 16, v108
  v_and_b32 v57, s40, v108
  v_lshlrev_b32 v58, 16, v109
  v_and_b32 v59, s40, v109
  v_lshlrev_b32 v60, 16, v110
  v_and_b32 v61, s40, v110
  v_lshlrev_b32 v62, 16, v111
  v_and_b32 v63, s40, v111
  v_add_f32 v48, v48, v56
  v_add_f32 v49, v49, v57
  v_add_f32 v50, v50, v58
  v_add_f32 v51, v51, v59
  v_add_f32 v52, v52, v60
  v_add_f32 v53, v53, v61
  v_add_f32 v54, v54, v62
  v_add_f32 v55, v55, v63
  s_waitcnt vmcnt(6)
  v_lshlrev_b32 v56, 16, v112
  v_and_b32 v57, s40, v112
  v_lshlrev_b32 v58, 16, v113
  v_and_b32 v59, s40, v113
  v_lshlrev_b32 v60, 16, v114
  v_and_b32 v61, s40, v114
  v_lshlrev_b32 v62, 16, v115
  v_and_b32 v63, s40, v115
  v_add_f32 v40, v40, v56
  v_add_f32 v41, v41, v57
  v_add_f32 v42, v42, v58
  v_add_f32 v43, v43, v59
  v_add_f32 v44, v44, v60
  v_add_f32 v45, v45, v61
  v_add_f32 v46, v46, v62
  v_add_f32 v47, v47, v63
  v_lshlrev_b32 v56, 16, v116
  v_and_b32 v57, s40, v116
  v_lshlrev_b32 v58, 16, v117
  v_and_b32 v59, s40, v117
  v_lshlrev_b32 v60, 16, v118
  v_and_b32 v61, s40, v118
  v_lshlrev_b32 v62, 16, v119
  v_and_b32 v63, s40, v119
  v_add_f32 v48, v48, v56
  v_add_f32 v49, v49, v57
  v_add_f32 v50, v50, v58
  v_add_f32 v51, v51, v59
  v_add_f32 v52, v52, v60
  v_add_f32 v53, v53, v61
  v_add_f32 v54, v54, v62
  v_add_f32 v55, v55, v63
  s_waitcnt vmcnt(4)
  v_lshlrev_b32 v56, 16, v120
  v_and_b32 v57, s40, v120
  v_lshlrev_b32 v58, 16, v121
  v_and_b32 v59, s40, v121
  v_lshlrev_b32 v60, 16, v122
  v_and_b32 v61, s40, v122
  v_lshlrev_b32 v62, 16, v123
  v_and_b32 v63, s40, v123
  v_add_f32 v40, v40, v56
  v_add_f32 v41, v41, v57
  v_add_f32 v42, v42, v58
  v_add_f32 v43, v43, v59
  v_add_f32 v44, v44, v60
  v_add_f32 v45, v45, v61
  v_add_f32 v46, v46, v62
  v_add_f32 v47, v47, v63
  v_lshlrev_b32 v56, 16, v124
  v_and_b32 v57, s40, v124
  v_lshlrev_b32 v58, 16, v125
  v_and_b32 v59, s40, v125
  v_lshlrev_b32 v60, 16, v126
  v_and_b32 v61, s40, v126
  v_lshlrev_b32 v62, 16, v127
  v_and_b32 v63, s40, v127
  v_add_f32 v48, v48, v56
  v_add_f32 v49, v49, v57
  v_add_f32 v50, v50, v58
  v_add_f32 v51, v51, v59
  v_add_f32 v52, v52, v60
  v_add_f32 v53, v53, v61
  v_add_f32 v54, v54, v62
  v_add_f32 v55, v55, v63
  s_waitcnt vmcnt(2)
  v_lshlrev_b32 v56, 16, v128
  v_and_b32 v57, s40, v128
  v_lshlrev_b32 v58, 16, v129
  v_and_b32 v59, s40, v129
  v_lshlrev_b32 v60, 16, v130
  v_and_b32 v61, s40, v130
  v_lshlrev_b32 v62, 16, v131
  v_and_b32 v63, s40, v131
  v_add_f32 v40, v40, v56
  v_add_f32 v41, v41, v57
  v_add_f32 v42, v42, v58
  v_add_f32 v43, v43, v59
  v_add_f32 v44, v44, v60
  v_add_f32 v45, v45, v61
  v_add_f32 v46, v46, v62
  v_add_f32 v47, v47, v63
  v_lshlrev_b32 v56, 16, v132
  v_and_b32 v57, s40, v132
  v_lshlrev_b32 v58, 16, v133
  v_and_b32 v59, s40, v133
  v_lshlrev_b32 v60, 16, v134
  v_and_b32 v61, s40, v134
  v_lshlrev_b32 v62, 16, v135
  v_and_b32 v63, s40, v135
  v_add_f32 v48, v48, v56
  v_add_f32 v49, v49, v57
  v_add_f32 v50, v50, v58
  v_add_f32 v51, v51, v59
  v_add_f32 v52, v52, v60
  v_add_f32 v53, v53, v61
  v_add_f32 v54, v54, v62
  v_add_f32 v55, v55, v63
  s_waitcnt vmcnt(0)
  v_lshlrev_b32 v56, 16, v136
  v_and_b32 v57, s40, v136
  v_lshlrev_b32 v58, 16, v137
  v_and_b32 v59, s40, v137
  v_lshlrev_b32 v60, 16, v138
  v_and_b32 v61, s40, v138
  v_lshlrev_b32 v62, 16, v139
  v_and_b32 v63, s40, v139
  v_add_f32 v40, v40, v56
  v_add_f32 v41, v41, v57
  v_add_f32 v42, v42, v58
  v_add_f32 v43, v43, v59
  v_add_f32 v44, v44, v60
  v_add_f32 v45, v45, v61
  v_add_f32 v46, v46, v62
  v_add_f32 v47, v47, v63
  v_lshlrev_b32 v56, 16, v140
  v_and_b32 v57, s40, v140
  v_lshlrev_b32 v58, 16, v141
  v_and_b32 v59, s40, v141
  v_lshlrev_b32 v60, 16, v142
  v_and_b32 v61, s40, v142
  v_lshlrev_b32 v62, 16, v143
  v_and_b32 v63, s40, v143
  v_add_f32 v48, v48, v56
  v_add_f32 v49, v49, v57
  v_add_f32 v50, v50, v58
  v_add_f32 v51, v51, v59
  v_add_f32 v52, v52, v60
  v_add_f32 v53, v53, v61
  v_add_f32 v54, v54, v62
  v_add_f32 v55, v55, v63
  v_cvt_pk_bf16_f32 v64, v40, v41
  v_cvt_pk_bf16_f32 v65, v42, v43
  v_cvt_pk_bf16_f32 v66, v44, v45
  v_cvt_pk_bf16_f32 v67, v46, v47
  v_cvt_pk_bf16_f32 v68, v48, v49
  v_cvt_pk_bf16_f32 v69, v50, v51
  v_cvt_pk_bf16_f32 v70, v52, v53
  v_cvt_pk_bf16_f32 v71, v54, v55
  v_lshlrev_b32 v40, 16, v64
  v_and_b32 v41, s40, v64
  v_lshlrev_b32 v42, 16, v65
  v_and_b32 v43, s40, v65
  v_lshlrev_b32 v44, 16, v66
  v_and_b32 v45, s40, v66
  v_lshlrev_b32 v46, 16, v67
  v_and_b32 v47, s40, v67
  v_lshlrev_b32 v48, 16, v68
  v_and_b32 v49, s40, v68
  v_lshlrev_b32 v50, 16, v69
  v_and_b32 v51, s40, v69
  v_lshlrev_b32 v52, 16, v70
  v_and_b32 v53, s40, v70
  v_lshlrev_b32 v54, 16, v71
  v_and_b32 v55, s40, v71
  s_waitcnt vmcnt(0)
  v_lshlrev_b32 v24, 16, v72
  v_and_b32 v25, s40, v72
  v_lshlrev_b32 v26, 16, v73
  v_and_b32 v27, s40, v73
  v_lshlrev_b32 v28, 16, v74
  v_and_b32 v29, s40, v74
  v_lshlrev_b32 v30, 16, v75
  v_and_b32 v31, s40, v75
  v_lshlrev_b32 v32, 16, v76
  v_and_b32 v33, s40, v76
  v_lshlrev_b32 v34, 16, v77
  v_and_b32 v35, s40, v77
  v_lshlrev_b32 v36, 16, v78
  v_and_b32 v37, s40, v78
  v_lshlrev_b32 v38, 16, v79
  v_and_b32 v39, s40, v79
  v_add_f32 v24, v24, v40
  v_add_f32 v25, v25, v41
  v_add_f32 v26, v26, v42
  v_add_f32 v27, v27, v43
  v_add_f32 v28, v28, v44
  v_add_f32 v29, v29, v45
  v_add_f32 v30, v30, v46
  v_add_f32 v31, v31, v47
  v_add_f32 v32, v32, v48
  v_add_f32 v33, v33, v49
  v_add_f32 v34, v34, v50
  v_add_f32 v35, v35, v51
  v_add_f32 v36, v36, v52
  v_add_f32 v37, v37, v53
  v_add_f32 v38, v38, v54
  v_add_f32 v39, v39, v55
  v_cvt_pk_bf16_f32 v64, v24, v25
  v_cvt_pk_bf16_f32 v65, v26, v27
  v_cvt_pk_bf16_f32 v66, v28, v29
  v_cvt_pk_bf16_f32 v67, v30, v31
  v_cvt_pk_bf16_f32 v68, v32, v33
  v_cvt_pk_bf16_f32 v69, v34, v35
  v_cvt_pk_bf16_f32 v70, v36, v37
  v_cvt_pk_bf16_f32 v71, v38, v39
  buffer_store_dwordx4 v[64:67], v7, s[4:7], s26 offen offset:0 sc1
  buffer_store_dwordx4 v[68:71], v7, s[4:7], s26 offen offset:512 sc1
  v_lshlrev_b32 v24, 16, v64
  v_and_b32 v25, s40, v64
  v_lshlrev_b32 v26, 16, v65
  v_and_b32 v27, s40, v65
  v_lshlrev_b32 v28, 16, v66
  v_and_b32 v29, s40, v66
  v_lshlrev_b32 v30, 16, v67
  v_and_b32 v31, s40, v67
  v_lshlrev_b32 v32, 16, v68
  v_and_b32 v33, s40, v68
  v_lshlrev_b32 v34, 16, v69
  v_and_b32 v35, s40, v69
  v_lshlrev_b32 v36, 16, v70
  v_and_b32 v37, s40, v70
  v_lshlrev_b32 v38, 16, v71
  v_and_b32 v39, s40, v71
  v_add_f32 v16, v24, v25
  v_add_f32 v17, v26, v27
  v_add_f32 v16, v16, v28
  v_add_f32 v17, v17, v29
  v_add_f32 v16, v16, v30
  v_add_f32 v17, v17, v31
  v_add_f32 v16, v16, v32
  v_add_f32 v17, v17, v33
  v_add_f32 v16, v16, v34
  v_add_f32 v17, v17, v35
  v_add_f32 v16, v16, v36
  v_add_f32 v17, v17, v37
  v_add_f32 v16, v16, v38
  v_add_f32 v17, v17, v39
  v_add_f32 v16, v16, v17
  s_nop 1
  v_add_f32_dpp v16, v16, v16 row_ror:8 row_mask:0xf bank_mask:0xf
  v_mov_b32 v18, v16
  s_nop 1
  v_permlane16_swap_b32 v16, v18
  v_add_f32 v16, v16, v18
  v_mov_b32 v18, v16
  s_nop 1
  v_permlane32_swap_b32 v16, v18
  v_add_f32 v16, v16, v18
  ds_write_b32 v9, v16 offset:0
  s_waitcnt lgkmcnt(0)
  s_barrier
  ds_read_b128 v[56:59], v10 offset:0
  s_waitcnt lgkmcnt(0)
  v_add_f32 v56, v56, v57
  v_add_f32 v58, v58, v59
  v_add_f32 v16, v56, v58
  v_mul_f32 v16, 0x3b000000, v16
  v_sub_f32 v40, v24, v16
  v_sub_f32 v41, v25, v16
  v_sub_f32 v42, v26, v16
  v_sub_f32 v43, v27, v16
  v_sub_f32 v44, v28, v16
  v_sub_f32 v45, v29, v16
  v_sub_f32 v46, v30, v16
  v_sub_f32 v47, v31, v16
  v_sub_f32 v48, v32, v16
  v_sub_f32 v49, v33, v16
  v_sub_f32 v50, v34, v16
  v_sub_f32 v51, v35, v16
  v_sub_f32 v52, v36, v16
  v_sub_f32 v53, v37, v16
  v_sub_f32 v54, v38, v16
  v_sub_f32 v55, v39, v16
  v_mul_f32 v17, v40, v40
  v_mul_f32 v19, v41, v41
  v_fmac_f32 v17, v42, v42
  v_fmac_f32 v19, v43, v43
  v_fmac_f32 v17, v44, v44
  v_fmac_f32 v19, v45, v45
  v_fmac_f32 v17, v46, v46
  v_fmac_f32 v19, v47, v47
  v_fmac_f32 v17, v48, v48
  v_fmac_f32 v19, v49, v49
  v_fmac_f32 v17, v50, v50
  v_fmac_f32 v19, v51, v51
  v_fmac_f32 v17, v52, v52
  v_fmac_f32 v19, v53, v53
  v_fmac_f32 v17, v54, v54
  v_fmac_f32 v19, v55, v55
  v_add_f32 v17, v17, v19
  v_cvt_pk_bf16_f32 v16, v16, v16
  v_lshlrev_b32 v16, 16, v16
  v_add_f32_dpp v17, v17, v17 row_ror:8 row_mask:0xf bank_mask:0xf
  v_mov_b32 v18, v17
  s_nop 1
  v_permlane16_swap_b32 v17, v18
  v_add_f32 v17, v17, v18
  v_mov_b32 v18, v17
  s_nop 1
  v_permlane32_swap_b32 v17, v18
  v_add_f32 v17, v17, v18
  ds_write_b32 v9, v17 offset:128
  s_waitcnt lgkmcnt(0)
  s_barrier
  ds_read_b128 v[56:59], v10 offset:128
  s_waitcnt lgkmcnt(0)
  v_add_f32 v56, v56, v57
  v_add_f32 v58, v58, v59
  v_add_f32 v17, v56, v58
  v_sub_f32 v40, v24, v16
  v_sub_f32 v41, v25, v16
  v_sub_f32 v42, v26, v16
  v_sub_f32 v43, v27, v16
  v_sub_f32 v44, v28, v16
  v_sub_f32 v45, v29, v16
  v_sub_f32 v46, v30, v16
  v_sub_f32 v47, v31, v16
  v_sub_f32 v48, v32, v16
  v_sub_f32 v49, v33, v16
  v_sub_f32 v50, v34, v16
  v_sub_f32 v51, v35, v16
  v_sub_f32 v52, v36, v16
  v_sub_f32 v53, v37, v16
  v_sub_f32 v54, v38, v16
  v_sub_f32 v55, v39, v16
  v_mul_f32 v17, 0x3b000000, v17
  v_cvt_pk_bf16_f32 v17, v17, v17
  v_lshlrev_b32 v17, 16, v17
  v_add_f32 v17, 0x3727c5ac, v17
  v_cvt_pk_bf16_f32 v17, v17, v17
  v_lshlrev_b32 v17, 16, v17
  v_sqrt_f32 v17, v17
  s_nop 0
  v_cvt_pk_bf16_f32 v17, v17, v17
  v_lshlrev_b32 v17, 16, v17
  v_rcp_f32 v17, v17
  v_cvt_pk_bf16_f32 v72, v40, v41
  v_cvt_pk_bf16_f32 v73, v42, v43
  v_cvt_pk_bf16_f32 v74, v44, v45
  v_cvt_pk_bf16_f32 v75, v46, v47
  v_cvt_pk_bf16_f32 v76, v48, v49
  v_cvt_pk_bf16_f32 v77, v50, v51
  v_cvt_pk_bf16_f32 v78, v52, v53
  v_cvt_pk_bf16_f32 v79, v54, v55
  v_lshlrev_b32 v40, 16, v72
  v_and_b32 v41, s40, v72
  v_lshlrev_b32 v42, 16, v73
  v_and_b32 v43, s40, v73
  v_lshlrev_b32 v44, 16, v74
  v_and_b32 v45, s40, v74
  v_lshlrev_b32 v46, 16, v75
  v_and_b32 v47, s40, v75
  v_lshlrev_b32 v48, 16, v76
  v_and_b32 v49, s40, v76
  v_lshlrev_b32 v50, 16, v77
  v_and_b32 v51, s40, v77
  v_lshlrev_b32 v52, 16, v78
  v_and_b32 v53, s40, v78
  v_lshlrev_b32 v54, 16, v79
  v_and_b32 v55, s40, v79
  v_mul_f32 v40, v40, v17
  v_mul_f32 v41, v41, v17
  v_mul_f32 v42, v42, v17
  v_mul_f32 v43, v43, v17
  v_mul_f32 v44, v44, v17
  v_mul_f32 v45, v45, v17
  v_mul_f32 v46, v46, v17
  v_mul_f32 v47, v47, v17
  v_mul_f32 v48, v48, v17
  v_mul_f32 v49, v49, v17
  v_mul_f32 v50, v50, v17
  v_mul_f32 v51, v51, v17
  v_mul_f32 v52, v52, v17
  v_mul_f32 v53, v53, v17
  v_mul_f32 v54, v54, v17
  v_mul_f32 v55, v55, v17
  v_cvt_pk_bf16_f32 v72, v40, v41
  v_cvt_pk_bf16_f32 v73, v42, v43
  v_cvt_pk_bf16_f32 v74, v44, v45
  v_cvt_pk_bf16_f32 v75, v46, v47
  v_cvt_pk_bf16_f32 v76, v48, v49
  v_cvt_pk_bf16_f32 v77, v50, v51
  v_cvt_pk_bf16_f32 v78, v52, v53
  v_cvt_pk_bf16_f32 v79, v54, v55
  s_add_u32 s31, s27, 16384
  buffer_store_dwordx4 v[72:75], v8, s[4:7], s27 offen sc1
  buffer_store_dwordx4 v[76:79], v8, s[4:7], s31 offen sc1
  s_add_u32 s26, s26, 65536
  s_add_u32 s27, s27, 65536
  s_waitcnt vmcnt(0)
  s_mov_b64 exec, 1
  ds_add_rtn_u32 v5, v15, v4
  s_waitcnt lgkmcnt(0)
  v_readfirstlane_b32 s31, v5
  s_mov_b64 exec, -1
  v_xor_b32 v15, 8, v15
  s_and_b32 s31, s31, 3
  s_cmp_lg_u32 s31, 3
  s_cbranch_scc1 agg_201
  s_mov_b64 exec, 1
  buffer_store_dword v13, off, s[4:7], s30 sc1
  s_mov_b64 exec, -1
agg_201:
  s_add_u32 s30, s30, 2048
  s_barrier
  s_sub_u32 s28, s28, 1
  s_cmp_lg_u32 s28, 0
  s_cbranch_scc1 rwtop_195
  s_branch mega_kernel_end
rl_l1_194:
  s_add_u32 s25, s25, 14680064
  s_add_u32 s26, s26, 16777216
  s_add_u32 s27, s27, 10485760
  s_add_u32 s52, s24, 2097152
  v_and_b32 v3, 7, v0
  v_lshrrev_b32 v4, 3, v0
  v_lshlrev_b32 v10, 4, v3
  s_lshl_b32 s31, s3, 2
  v_add_u32 v9, s31, v10
  v_lshlrev_b32 v7, 10, v3
  v_lshl_add_u32 v7, v4, 4, v7
  v_lshlrev_b32 v8, 9, v4
  v_lshl_add_u32 v8, v3, 4, v8
  v_lshrrev_b32 v5, 2, v3
  v_lshlrev_b32 v6, 12, v5
  v_lshl_add_u32 v6, v4, 6, v6
  v_and_b32 v5, 3, v3
  v_lshl_add_u32 v6, v5, 4, v6
  v_mov_b32 v13, 1
  s_mov_b32 s40, 0xffff0000
  v_min_u32 v11, 15, v2
  v_lshlrev_b32 v11, 2, v11
  v_mov_b32 v14, 163584
  v_mov_b32 v4, 0
  ds_write_b32 v14, v4
  ds_write_b32 v14, v4 offset:4
  ds_write_b32 v14, v4 offset:8
  s_waitcnt lgkmcnt(0)
  v_mov_b32 v4, 1
  v_mov_b32 v15, 163584
  s_mov_b32 s36, 1
  s_barrier
rwtop_202:
  s_cmp_lg_u32 s3, 0
  s_cbranch_scc1 wro_203
  s_mov_b32 s35, 0
poll_205:
  buffer_load_dword v12, v11, s[4:7], s29 offen sc1
  s_waitcnt vmcnt(0)
  v_cmp_ne_u32 vcc, 0, v12
  s_nop 0
  s_cmp_eq_u64 vcc, exec
  s_cbranch_scc1 polld_206
  s_sleep 3
  s_add_u32 s35, s35, 1
  s_cmp_lt_u32 s35, 131072
  s_cbranch_scc1 poll_205
  s_branch mega_kernel_end
polld_206:
  v_mov_b32 v12, s36
  ds_write_b32 v14, v12 offset:4
  s_waitcnt lgkmcnt(0)
  s_branch wrd_204
wro_203:
  s_mov_b32 s35, 0
wrl_207:
  ds_read_b32 v12, v14 offset:4
  s_add_u32 s35, s35, 1
  s_cmp_gt_u32 s35, 2097152
  s_cbranch_scc1 mega_kernel_end
  s_waitcnt lgkmcnt(0)
  v_readfirstlane_b32 s31, v12
  s_nop 0
  s_cmp_ge_u32 s31, s36
  s_nop 0
  s_cbranch_scc1 wrd_204
  s_sleep 1
  s_branch wrl_207
wrd_204:
  s_mov_b32 s31, s24
  buffer_load_dwordx4 v[80:83], v6, s[4:7], s31 offen offset:0 sc1
  buffer_load_dwordx4 v[84:87], v6, s[4:7], s31 offen offset:2048 sc1
  s_add_u32 s31, s31, 32768
  buffer_load_dwordx4 v[88:91], v6, s[4:7], s31 offen offset:0 sc1
  buffer_load_dwordx4 v[92:95], v6, s[4:7], s31 offen offset:2048 sc1
  s_add_u32 s31, s31, 32768
  buffer_load_dwordx4 v[96:99], v6, s[4:7], s31 offen offset:0 sc1
  buffer_load_dwordx4 v[100:103], v6, s[4:7], s31 offen offset:2048 sc1
  s_add_u32 s31, s31, 32768
  buffer_load_dwordx4 v[104:107], v6, s[4:7], s31 offen offset:0 sc1
  buffer_load_dwordx4 v[108:111], v6, s[4:7], s31 offen offset:2048 sc1
  s_add_u32 s31, s31, 32768
  buffer_load_dwordx4 v[112:115], v6, s[4:7], s31 offen offset:0 sc1
  buffer_load_dwordx4 v[116:119], v6, s[4:7], s31 offen offset:2048 sc1
  s_add_u32 s31, s31, 32768
  buffer_load_dwordx4 v[120:123], v6, s[4:7], s31 offen offset:0 sc1
  buffer_load_dwordx4 v[124:127], v6, s[4:7], s31 offen offset:2048 sc1
  s_add_u32 s31, s31, 32768
  buffer_load_dwordx4 v[128:131], v6, s[4:7], s31 offen offset:0 sc1
  buffer_load_dwordx4 v[132:135], v6, s[4:7], s31 offen offset:2048 sc1
  s_add_u32 s31, s31, 32768
  buffer_load_dwordx4 v[136:139], v6, s[4:7], s31 offen offset:0 sc1
  buffer_load_dwordx4 v[140:143], v6, s[4:7], s31 offen offset:2048 sc1
  buffer_load_dwordx4 v[72:75], v7, s[4:7], s25 offen offset:0 sc1
  buffer_load_dwordx4 v[76:79], v7, s[4:7], s25 offen offset:512 sc1
  s_add_u32 s24, s24, 524288
  s_cmp_ge_u32 s24, s52
  s_cselect_b32 s78, 2097152, 0
  s_sub_u32 s24, s24, s78
  s_add_u32 s25, s25, 65536
  s_add_u32 s29, s29, 2048
  s_add_u32 s36, s36, 1
  s_waitcnt vmcnt(16)
  v_lshlrev_b32 v40, 16, v80
  v_and_b32 v41, s40, v80
  v_lshlrev_b32 v42, 16, v81
  v_and_b32 v43, s40, v81
  v_lshlrev_b32 v44, 16, v82
  v_and_b32 v45, s40, v82
  v_lshlrev_b32 v46, 16, v83
  v_and_b32 v47, s40, v83
  v_lshlrev_b32 v48, 16, v84
  v_and_b32 v49, s40, v84
  v_lshlrev_b32 v50, 16, v85
  v_and_b32 v51, s40, v85
  v_lshlrev_b32 v52, 16, v86
  v_and_b32 v53, s40, v86
  v_lshlrev_b32 v54, 16, v87
  v_and_b32 v55, s40, v87
  s_waitcnt vmcnt(14)
  v_lshlrev_b32 v56, 16, v88
  v_and_b32 v57, s40, v88
  v_lshlrev_b32 v58, 16, v89
  v_and_b32 v59, s40, v89
  v_lshlrev_b32 v60, 16, v90
  v_and_b32 v61, s40, v90
  v_lshlrev_b32 v62, 16, v91
  v_and_b32 v63, s40, v91
  v_add_f32 v40, v40, v56
  v_add_f32 v41, v41, v57
  v_add_f32 v42, v42, v58
  v_add_f32 v43, v43, v59
  v_add_f32 v44, v44, v60
  v_add_f32 v45, v45, v61
  v_add_f32 v46, v46, v62
  v_add_f32 v47, v47, v63
  v_lshlrev_b32 v56, 16, v92
  v_and_b32 v57, s40, v92
  v_lshlrev_b32 v58, 16, v93
  v_and_b32 v59, s40, v93
  v_lshlrev_b32 v60, 16, v94
  v_and_b32 v61, s40, v94
  v_lshlrev_b32 v62, 16, v95
  v_and_b32 v63, s40, v95
  v_add_f32 v48, v48, v56
  v_add_f32 v49, v49, v57
  v_add_f32 v50, v50, v58
  v_add_f32 v51, v51, v59
  v_add_f32 v52, v52, v60
  v_add_f32 v53, v53, v61
  v_add_f32 v54, v54, v62
  v_add_f32 v55, v55, v63
  s_waitcnt vmcnt(12)
  v_lshlrev_b32 v56, 16, v96
  v_and_b32 v57, s40, v96
  v_lshlrev_b32 v58, 16, v97
  v_and_b32 v59, s40, v97
  v_lshlrev_b32 v60, 16, v98
  v_and_b32 v61, s40, v98
  v_lshlrev_b32 v62, 16, v99
  v_and_b32 v63, s40, v99
  v_add_f32 v40, v40, v56
  v_add_f32 v41, v41, v57
  v_add_f32 v42, v42, v58
  v_add_f32 v43, v43, v59
  v_add_f32 v44, v44, v60
  v_add_f32 v45, v45, v61
  v_add_f32 v46, v46, v62
  v_add_f32 v47, v47, v63
  v_lshlrev_b32 v56, 16, v100
  v_and_b32 v57, s40, v100
  v_lshlrev_b32 v58, 16, v101
  v_and_b32 v59, s40, v101
  v_lshlrev_b32 v60, 16, v102
  v_and_b32 v61, s40, v102
  v_lshlrev_b32 v62, 16, v103
  v_and_b32 v63, s40, v103
  v_add_f32 v48, v48, v56
  v_add_f32 v49, v49, v57
  v_add_f32 v50, v50, v58
  v_add_f32 v51, v51, v59
  v_add_f32 v52, v52, v60
  v_add_f32 v53, v53, v61
  v_add_f32 v54, v54, v62
  v_add_f32 v55, v55, v63
  s_waitcnt vmcnt(10)
  v_lshlrev_b32 v56, 16, v104
  v_and_b32 v57, s40, v104
  v_lshlrev_b32 v58, 16, v105
  v_and_b32 v59, s40, v105
  v_lshlrev_b32 v60, 16, v106
  v_and_b32 v61, s40, v106
  v_lshlrev_b32 v62, 16, v107
  v_and_b32 v63, s40, v107
  v_add_f32 v40, v40, v56
  v_add_f32 v41, v41, v57
  v_add_f32 v42, v42, v58
  v_add_f32 v43, v43, v59
  v_add_f32 v44, v44, v60
  v_add_f32 v45, v45, v61
  v_add_f32 v46, v46, v62
  v_add_f32 v47, v47, v63
  v_lshlrev_b32 v56, 16, v108
  v_and_b32 v57, s40, v108
  v_lshlrev_b32 v58, 16, v109
  v_and_b32 v59, s40, v109
  v_lshlrev_b32 v60, 16, v110
  v_and_b32 v61, s40, v110
  v_lshlrev_b32 v62, 16, v111
  v_and_b32 v63, s40, v111
  v_add_f32 v48, v48, v56
  v_add_f32 v49, v49, v57
  v_add_f32 v50, v50, v58
  v_add_f32 v51, v51, v59
  v_add_f32 v52, v52, v60
  v_add_f32 v53, v53, v61
  v_add_f32 v54, v54, v62
  v_add_f32 v55, v55, v63
  s_waitcnt vmcnt(8)
  v_lshlrev_b32 v56, 16, v112
  v_and_b32 v57, s40, v112
  v_lshlrev_b32 v58, 16, v113
  v_and_b32 v59, s40, v113
  v_lshlrev_b32 v60, 16, v114
  v_and_b32 v61, s40, v114
  v_lshlrev_b32 v62, 16, v115
  v_and_b32 v63, s40, v115
  v_add_f32 v40, v40, v56
  v_add_f32 v41, v41, v57
  v_add_f32 v42, v42, v58
  v_add_f32 v43, v43, v59
  v_add_f32 v44, v44, v60
  v_add_f32 v45, v45, v61
  v_add_f32 v46, v46, v62
  v_add_f32 v47, v47, v63
  v_lshlrev_b32 v56, 16, v116
  v_and_b32 v57, s40, v116
  v_lshlrev_b32 v58, 16, v117
  v_and_b32 v59, s40, v117
  v_lshlrev_b32 v60, 16, v118
  v_and_b32 v61, s40, v118
  v_lshlrev_b32 v62, 16, v119
  v_and_b32 v63, s40, v119
  v_add_f32 v48, v48, v56
  v_add_f32 v49, v49, v57
  v_add_f32 v50, v50, v58
  v_add_f32 v51, v51, v59
  v_add_f32 v52, v52, v60
  v_add_f32 v53, v53, v61
  v_add_f32 v54, v54, v62
  v_add_f32 v55, v55, v63
  s_waitcnt vmcnt(6)
  v_lshlrev_b32 v56, 16, v120
  v_and_b32 v57, s40, v120
  v_lshlrev_b32 v58, 16, v121
  v_and_b32 v59, s40, v121
  v_lshlrev_b32 v60, 16, v122
  v_and_b32 v61, s40, v122
  v_lshlrev_b32 v62, 16, v123
  v_and_b32 v63, s40, v123
  v_add_f32 v40, v40, v56
  v_add_f32 v41, v41, v57
  v_add_f32 v42, v42, v58
  v_add_f32 v43, v43, v59
  v_add_f32 v44, v44, v60
  v_add_f32 v45, v45, v61
  v_add_f32 v46, v46, v62
  v_add_f32 v47, v47, v63
  v_lshlrev_b32 v56, 16, v124
  v_and_b32 v57, s40, v124
  v_lshlrev_b32 v58, 16, v125
  v_and_b32 v59, s40, v125
  v_lshlrev_b32 v60, 16, v126
  v_and_b32 v61, s40, v126
  v_lshlrev_b32 v62, 16, v127
  v_and_b32 v63, s40, v127
  v_add_f32 v48, v48, v56
  v_add_f32 v49, v49, v57
  v_add_f32 v50, v50, v58
  v_add_f32 v51, v51, v59
  v_add_f32 v52, v52, v60
  v_add_f32 v53, v53, v61
  v_add_f32 v54, v54, v62
  v_add_f32 v55, v55, v63
  s_waitcnt vmcnt(4)
  v_lshlrev_b32 v56, 16, v128
  v_and_b32 v57, s40, v128
  v_lshlrev_b32 v58, 16, v129
  v_and_b32 v59, s40, v129
  v_lshlrev_b32 v60, 16, v130
  v_and_b32 v61, s40, v130
  v_lshlrev_b32 v62, 16, v131
  v_and_b32 v63, s40, v131
  v_add_f32 v40, v40, v56
  v_add_f32 v41, v41, v57
  v_add_f32 v42, v42, v58
  v_add_f32 v43, v43, v59
  v_add_f32 v44, v44, v60
  v_add_f32 v45, v45, v61
  v_add_f32 v46, v46, v62
  v_add_f32 v47, v47, v63
  v_lshlrev_b32 v56, 16, v132
  v_and_b32 v57, s40, v132
  v_lshlrev_b32 v58, 16, v133
  v_and_b32 v59, s40, v133
  v_lshlrev_b32 v60, 16, v134
  v_and_b32 v61, s40, v134
  v_lshlrev_b32 v62, 16, v135
  v_and_b32 v63, s40, v135
  v_add_f32 v48, v48, v56
  v_add_f32 v49, v49, v57
  v_add_f32 v50, v50, v58
  v_add_f32 v51, v51, v59
  v_add_f32 v52, v52, v60
  v_add_f32 v53, v53, v61
  v_add_f32 v54, v54, v62
  v_add_f32 v55, v55, v63
  s_waitcnt vmcnt(2)
  v_lshlrev_b32 v56, 16, v136
  v_and_b32 v57, s40, v136
  v_lshlrev_b32 v58, 16, v137
  v_and_b32 v59, s40, v137
  v_lshlrev_b32 v60, 16, v138
  v_and_b32 v61, s40, v138
  v_lshlrev_b32 v62, 16, v139
  v_and_b32 v63, s40, v139
  v_add_f32 v40, v40, v56
  v_add_f32 v41, v41, v57
  v_add_f32 v42, v42, v58
  v_add_f32 v43, v43, v59
  v_add_f32 v44, v44, v60
  v_add_f32 v45, v45, v61
  v_add_f32 v46, v46, v62
  v_add_f32 v47, v47, v63
  v_lshlrev_b32 v56, 16, v140
  v_and_b32 v57, s40, v140
  v_lshlrev_b32 v58, 16, v141
  v_and_b32 v59, s40, v141
  v_lshlrev_b32 v60, 16, v142
  v_and_b32 v61, s40, v142
  v_lshlrev_b32 v62, 16, v143
  v_and_b32 v63, s40, v143
  v_add_f32 v48, v48, v56
  v_add_f32 v49, v49, v57
  v_add_f32 v50, v50, v58
  v_add_f32 v51, v51, v59
  v_add_f32 v52, v52, v60
  v_add_f32 v53, v53, v61
  v_add_f32 v54, v54, v62
  v_add_f32 v55, v55, v63
  v_cvt_pk_bf16_f32 v64, v40, v41
  v_cvt_pk_bf16_f32 v65, v42, v43
  v_cvt_pk_bf16_f32 v66, v44, v45
  v_cvt_pk_bf16_f32 v67, v46, v47
  v_cvt_pk_bf16_f32 v68, v48, v49
  v_cvt_pk_bf16_f32 v69, v50, v51
  v_cvt_pk_bf16_f32 v70, v52, v53
  v_cvt_pk_bf16_f32 v71, v54, v55
  v_lshlrev_b32 v40, 16, v64
  v_and_b32 v41, s40, v64
  v_lshlrev_b32 v42, 16, v65
  v_and_b32 v43, s40, v65
  v_lshlrev_b32 v44, 16, v66
  v_and_b32 v45, s40, v66
  v_lshlrev_b32 v46, 16, v67
  v_and_b32 v47, s40, v67
  v_lshlrev_b32 v48, 16, v68
  v_and_b32 v49, s40, v68
  v_lshlrev_b32 v50, 16, v69
  v_and_b32 v51, s40, v69
  v_lshlrev_b32 v52, 16, v70
  v_and_b32 v53, s40, v70
  v_lshlrev_b32 v54, 16, v71
  v_and_b32 v55, s40, v71
  s_waitcnt vmcnt(0)
  v_lshlrev_b32 v24, 16, v72
  v_and_b32 v25, s40, v72
  v_lshlrev_b32 v26, 16, v73
  v_and_b32 v27, s40, v73
  v_lshlrev_b32 v28, 16, v74
  v_and_b32 v29, s40, v74
  v_lshlrev_b32 v30, 16, v75
  v_and_b32 v31, s40, v75
  v_lshlrev_b32 v32, 16, v76
  v_and_b32 v33, s40, v76
  v_lshlrev_b32 v34, 16, v77
  v_and_b32 v35, s40, v77
  v_lshlrev_b32 v36, 16, v78
  v_and_b32 v37, s40, v78
  v_lshlrev_b32 v38, 16, v79
  v_and_b32 v39, s40, v79
  v_add_f32 v24, v24, v40
  v_add_f32 v25, v25, v41
  v_add_f32 v26, v26, v42
  v_add_f32 v27, v27, v43
  v_add_f32 v28, v28, v44
  v_add_f32 v29, v29, v45
  v_add_f32 v30, v30, v46
  v_add_f32 v31, v31, v47
  v_add_f32 v32, v32, v48
  v_add_f32 v33, v33, v49
  v_add_f32 v34, v34, v50
  v_add_f32 v35, v35, v51
  v_add_f32 v36, v36, v52
  v_add_f32 v37, v37, v53
  v_add_f32 v38, v38, v54
  v_add_f32 v39, v39, v55
  v_cvt_pk_bf16_f32 v64, v24, v25
  v_cvt_pk_bf16_f32 v65, v26, v27
  v_cvt_pk_bf16_f32 v66, v28, v29
  v_cvt_pk_bf16_f32 v67, v30, v31
  v_cvt_pk_bf16_f32 v68, v32, v33
  v_cvt_pk_bf16_f32 v69, v34, v35
  v_cvt_pk_bf16_f32 v70, v36, v37
  v_cvt_pk_bf16_f32 v71, v38, v39
  buffer_store_dwordx4 v[64:67], v7, s[4:7], s26 offen offset:0 sc1
  buffer_store_dwordx4 v[68:71], v7, s[4:7], s26 offen offset:512 sc1
  v_lshlrev_b32 v24, 16, v64
  v_and_b32 v25, s40, v64
  v_lshlrev_b32 v26, 16, v65
  v_and_b32 v27, s40, v65
  v_lshlrev_b32 v28, 16, v66
  v_and_b32 v29, s40, v66
  v_lshlrev_b32 v30, 16, v67
  v_and_b32 v31, s40, v67
  v_lshlrev_b32 v32, 16, v68
  v_and_b32 v33, s40, v68
  v_lshlrev_b32 v34, 16, v69
  v_and_b32 v35, s40, v69
  v_lshlrev_b32 v36, 16, v70
  v_and_b32 v37, s40, v70
  v_lshlrev_b32 v38, 16, v71
  v_and_b32 v39, s40, v71
  v_add_f32 v16, v24, v25
  v_add_f32 v17, v26, v27
  v_add_f32 v16, v16, v28
  v_add_f32 v17, v17, v29
  v_add_f32 v16, v16, v30
  v_add_f32 v17, v17, v31
  v_add_f32 v16, v16, v32
  v_add_f32 v17, v17, v33
  v_add_f32 v16, v16, v34
  v_add_f32 v17, v17, v35
  v_add_f32 v16, v16, v36
  v_add_f32 v17, v17, v37
  v_add_f32 v16, v16, v38
  v_add_f32 v17, v17, v39
  v_add_f32 v16, v16, v17
  s_nop 1
  v_add_f32_dpp v16, v16, v16 row_ror:8 row_mask:0xf bank_mask:0xf
  v_mov_b32 v18, v16
  s_nop 1
  v_permlane16_swap_b32 v16, v18
  v_add_f32 v16, v16, v18
  v_mov_b32 v18, v16
  s_nop 1
  v_permlane32_swap_b32 v16, v18
  v_add_f32 v16, v16, v18
  ds_write_b32 v9, v16 offset:0
  s_waitcnt lgkmcnt(0)
  s_barrier
  ds_read_b128 v[56:59], v10 offset:0
  s_waitcnt lgkmcnt(0)
  v_add_f32 v56, v56, v57
  v_add_f32 v58, v58, v59
  v_add_f32 v16, v56, v58
  v_mul_f32 v16, 0x3b000000, v16
  v_sub_f32 v40, v24, v16
  v_sub_f32 v41, v25, v16
  v_sub_f32 v42, v26, v16
  v_sub_f32 v43, v27, v16
  v_sub_f32 v44, v28, v16
  v_sub_f32 v45, v29, v16
  v_sub_f32 v46, v30, v16
  v_sub_f32 v47, v31, v16
  v_sub_f32 v48, v32, v16
  v_sub_f32 v49, v33, v16
  v_sub_f32 v50, v34, v16
  v_sub_f32 v51, v35, v16
  v_sub_f32 v52, v36, v16
  v_sub_f32 v53, v37, v16
  v_sub_f32 v54, v38, v16
  v_sub_f32 v55, v39, v16
  v_mul_f32 v17, v40, v40
  v_mul_f32 v19, v41, v41
  v_fmac_f32 v17, v42, v42
  v_fmac_f32 v19, v43, v43
  v_fmac_f32 v17, v44, v44
  v_fmac_f32 v19, v45, v45
  v_fmac_f32 v17, v46, v46
  v_fmac_f32 v19, v47, v47
  v_fmac_f32 v17, v48, v48
  v_fmac_f32 v19, v49, v49
  v_fmac_f32 v17, v50, v50
  v_fmac_f32 v19, v51, v51
  v_fmac_f32 v17, v52, v52
  v_fmac_f32 v19, v53, v53
  v_fmac_f32 v17, v54, v54
  v_fmac_f32 v19, v55, v55
  v_add_f32 v17, v17, v19
  v_cvt_pk_bf16_f32 v16, v16, v16
  v_lshlrev_b32 v16, 16, v16
  v_add_f32_dpp v17, v17, v17 row_ror:8 row_mask:0xf bank_mask:0xf
  v_mov_b32 v18, v17
  s_nop 1
  v_permlane16_swap_b32 v17, v18
  v_add_f32 v17, v17, v18
  v_mov_b32 v18, v17
  s_nop 1
  v_permlane32_swap_b32 v17, v18
  v_add_f32 v17, v17, v18
  ds_write_b32 v9, v17 offset:128
  s_waitcnt lgkmcnt(0)
  s_barrier
  ds_read_b128 v[56:59], v10 offset:128
  s_waitcnt lgkmcnt(0)
  v_add_f32 v56, v56, v57
  v_add_f32 v58, v58, v59
  v_add_f32 v17, v56, v58
  v_sub_f32 v40, v24, v16
  v_sub_f32 v41, v25, v16
  v_sub_f32 v42, v26, v16
  v_sub_f32 v43, v27, v16
  v_sub_f32 v44, v28, v16
  v_sub_f32 v45, v29, v16
  v_sub_f32 v46, v30, v16
  v_sub_f32 v47, v31, v16
  v_sub_f32 v48, v32, v16
  v_sub_f32 v49, v33, v16
  v_sub_f32 v50, v34, v16
  v_sub_f32 v51, v35, v16
  v_sub_f32 v52, v36, v16
  v_sub_f32 v53, v37, v16
  v_sub_f32 v54, v38, v16
  v_sub_f32 v55, v39, v16
  v_mul_f32 v17, 0x3b000000, v17
  v_cvt_pk_bf16_f32 v17, v17, v17
  v_lshlrev_b32 v17, 16, v17
  v_add_f32 v17, 0x3727c5ac, v17
  v_cvt_pk_bf16_f32 v17, v17, v17
  v_lshlrev_b32 v17, 16, v17
  v_sqrt_f32 v17, v17
  s_nop 0
  v_cvt_pk_bf16_f32 v17, v17, v17
  v_lshlrev_b32 v17, 16, v17
  v_rcp_f32 v17, v17
  v_cvt_pk_bf16_f32 v72, v40, v41
  v_cvt_pk_bf16_f32 v73, v42, v43
  v_cvt_pk_bf16_f32 v74, v44, v45
  v_cvt_pk_bf16_f32 v75, v46, v47
  v_cvt_pk_bf16_f32 v76, v48, v49
  v_cvt_pk_bf16_f32 v77, v50, v51
  v_cvt_pk_bf16_f32 v78, v52, v53
  v_cvt_pk_bf16_f32 v79, v54, v55
  v_lshlrev_b32 v40, 16, v72
  v_and_b32 v41, s40, v72
  v_lshlrev_b32 v42, 16, v73
  v_and_b32 v43, s40, v73
  v_lshlrev_b32 v44, 16, v74
  v_and_b32 v45, s40, v74
  v_lshlrev_b32 v46, 16, v75
  v_and_b32 v47, s40, v75
  v_lshlrev_b32 v48, 16, v76
  v_and_b32 v49, s40, v76
  v_lshlrev_b32 v50, 16, v77
  v_and_b32 v51, s40, v77
  v_lshlrev_b32 v52, 16, v78
  v_and_b32 v53, s40, v78
  v_lshlrev_b32 v54, 16, v79
  v_and_b32 v55, s40, v79
  v_mul_f32 v40, v40, v17
  v_mul_f32 v41, v41, v17
  v_mul_f32 v42, v42, v17
  v_mul_f32 v43, v43, v17
  v_mul_f32 v44, v44, v17
  v_mul_f32 v45, v45, v17
  v_mul_f32 v46, v46, v17
  v_mul_f32 v47, v47, v17
  v_mul_f32 v48, v48, v17
  v_mul_f32 v49, v49, v17
  v_mul_f32 v50, v50, v17
  v_mul_f32 v51, v51, v17
  v_mul_f32 v52, v52, v17
  v_mul_f32 v53, v53, v17
  v_mul_f32 v54, v54, v17
  v_mul_f32 v55, v55, v17
  v_cvt_pk_bf16_f32 v72, v40, v41
  v_cvt_pk_bf16_f32 v73, v42, v43
  v_cvt_pk_bf16_f32 v74, v44, v45
  v_cvt_pk_bf16_f32 v75, v46, v47
  v_cvt_pk_bf16_f32 v76, v48, v49
  v_cvt_pk_bf16_f32 v77, v50, v51
  v_cvt_pk_bf16_f32 v78, v52, v53
  v_cvt_pk_bf16_f32 v79, v54, v55
  s_add_u32 s31, s27, 16384
  buffer_store_dwordx4 v[72:75], v8, s[4:7], s27 offen sc1
  buffer_store_dwordx4 v[76:79], v8, s[4:7], s31 offen sc1
  s_add_u32 s26, s26, 65536
  s_add_u32 s27, s27, 65536
  s_waitcnt vmcnt(0)
  s_mov_b64 exec, 1
  ds_add_rtn_u32 v5, v15, v4
  s_waitcnt lgkmcnt(0)
  v_readfirstlane_b32 s31, v5
  s_mov_b64 exec, -1
  v_xor_b32 v15, 8, v15
  s_and_b32 s31, s31, 3
  s_cmp_lg_u32 s31, 3
  s_cbranch_scc1 agg_208
  s_mov_b64 exec, 1
  buffer_store_dword v13, off, s[4:7], s30 sc1
  s_mov_b64 exec, -1
agg_208:
  s_add_u32 s30, s30, 2048
  s_barrier
  s_sub_u32 s28, s28, 1
  s_cmp_lg_u32 s28, 0
  s_cbranch_scc1 rwtop_202
  s_branch mega_kernel_end
r_rl2_20:
  s_lshl_b32 s25, s98, 13
  s_mov_b32 s26, s25
  s_lshr_b32 s41, s98, 2
  s_and_b32 s42, s98, 3
  s_mul_i32 s24, s41, 131072
  s_lshl_b32 s40, s42, 13
  s_add_u32 s24, s24, s40
  s_add_u32 s24, s24, 188743680
  s_lshl_b32 s40, s97, 23
  s_add_u32 s24, s24, s40
  s_lshl_b32 s27, s41, 15
  s_lshl_b32 s40, s42, 7
  s_add_u32 s27, s27, s40
  s_mov_b32 s28, 32
  s_lshl_b32 s41, s41, 10
  s_add_u32 s41, s41, s46
  s_add_u32 s29, s41, 786432
  s_lshl_b32 s40, s42, 2
  s_add_u32 s30, s41, s40
  s_add_u32 s30, s30, 917504
  s_cmp_eq_u32 s97, 1
  s_cbranch_scc1 rl_l1_209
  s_add_u32 s25, s25, 12582912
  s_add_u32 s26, s26, 14680064
  s_add_u32 s27, s27, 8388608
  s_add_u32 s52, s24, 1048576
  v_and_b32 v3, 7, v0
  v_lshrrev_b32 v4, 3, v0
  v_lshlrev_b32 v10, 4, v3
  s_lshl_b32 s31, s3, 2
  v_add_u32 v9, s31, v10
  v_lshlrev_b32 v7, 10, v3
  v_lshl_add_u32 v7, v4, 4, v7
  v_lshlrev_b32 v8, 9, v4
  v_lshl_add_u32 v8, v3, 4, v8
  v_lshrrev_b32 v5, 2, v3
  v_lshlrev_b32 v6, 12, v5
  v_lshl_add_u32 v6, v4, 6, v6
  v_and_b32 v5, 3, v3
  v_lshl_add_u32 v6, v5, 4, v6
  v_mov_b32 v13, 1
  s_mov_b32 s40, 0xffff0000
  v_min_u32 v11, 7, v2
  v_lshlrev_b32 v11, 2, v11
  v_mov_b32 v14, 163584
  v_mov_b32 v4, 0
  ds_write_b32 v14, v4
  ds_write_b32 v14, v4 offset:4
  ds_write_b32 v14, v4 offset:8
  s_waitcnt lgkmcnt(0)
  v_mov_b32 v4, 1
  v_mov_b32 v15, 163584
  s_mov_b32 s36, 1
  s_barrier
rwtop_210:
  s_cmp_lg_u32 s3, 0
  s_cbranch_scc1 wro_211
  s_mov_b32 s35, 0
poll_213:
  buffer_load_dword v12, v11, s[4:7], s29 offen sc1
  s_waitcnt vmcnt(0)
  v_cmp_ne_u32 vcc, 0, v12
  s_nop 0
  s_cmp_eq_u64 vcc, exec
  s_cbranch_scc1 polld_214
  s_sleep 3
  s_add_u32 s35, s35, 1
  s_cmp_lt_u32 s35, 131072
  s_cbranch_scc1 poll_213
  s_branch mega_kernel_end
polld_214:
  v_mov_b32 v12, s36
  ds_write_b32 v14, v12 offset:4
  s_waitcnt lgkmcnt(0)
  s_branch wrd_212
wro_211:
  s_mov_b32 s35, 0
wrl_215:
  ds_read_b32 v12, v14 offset:4
  s_add_u32 s35, s35, 1
  s_cmp_gt_u32 s35, 2097152
  s_cbranch_scc1 mega_kernel_end
  s_waitcnt lgkmcnt(0)
  v_readfirstlane_b32 s31, v12
  s_nop 0
  s_cmp_ge_u32 s31, s36
  s_nop 0
  s_cbranch_scc1 wrd_212
  s_sleep 1
  s_branch wrl_215
wrd_212:
  s_mov_b32 s31, s24
  buffer_load_dwordx4 v[80:83], v6, s[4:7], s31 offen offset:0 sc1
  buffer_load_dwordx4 v[84:87], v6, s[4:7], s31 offen offset:2048 sc1
  s_add_u32 s31, s31, 32768
  buffer_load_dwordx4 v[88:91], v6, s[4:7], s31 offen offset:0 sc1
  buffer_load_dwordx4 v[92:95], v6, s[4:7], s31 offen offset:2048 sc1
  s_add_u32 s31, s31, 32768
  buffer_load_dwordx4 v[96:99], v6, s[4:7], s31 offen offset:0 sc1
  buffer_load_dwordx4 v[100:103], v6, s[4:7], s31 offen offset:2048 sc1
  s_add_u32 s31, s31, 32768
  buffer_load_dwordx4 v[104:107], v6, s[4:7], s31 offen offset:0 sc1
  buffer_load_dwordx4 v[108:111], v6, s[4:7], s31 offen offset:2048 sc1
  buffer_load_dwordx4 v[72:75], v7, s[4:7], s25 offen offset:0 sc1
  buffer_load_dwordx4 v[76:79], v7, s[4:7], s25 offen offset:512 sc1
  s_add_u32 s24, s24, 262144
  s_cmp_ge_u32 s24, s52
  s_cselect_b32 s78, 1048576, 0
  s_sub_u32 s24, s24, s78
  s_add_u32 s25, s25, 65536
  s_add_u32 s29, s29, 2048
  s_add_u32 s36, s36, 1
  s_waitcnt vmcnt(8)
  v_lshlrev_b32 v40, 16, v80
  v_and_b32 v41, s40, v80
  v_lshlrev_b32 v42, 16, v81
  v_and_b32 v43, s40, v81
  v_lshlrev_b32 v44, 16, v82
  v_and_b32 v45, s40, v82
  v_lshlrev_b32 v46, 16, v83
  v_and_b32 v47, s40, v83
  v_lshlrev_b32 v48, 16, v84
  v_and_b32 v49, s40, v84
  v_lshlrev_b32 v50, 16, v85
  v_and_b32 v51, s40, v85
  v_lshlrev_b32 v52, 16, v86
  v_and_b32 v53, s40, v86
  v_lshlrev_b32 v54, 16, v87
  v_and_b32 v55, s40, v87
  s_waitcnt vmcnt(6)
  v_lshlrev_b32 v56, 16, v88
  v_and_b32 v57, s40, v88
  v_lshlrev_b32 v58, 16, v89
  v_and_b32 v59, s40, v89
  v_lshlrev_b32 v60, 16, v90
  v_and_b32 v61, s40, v90
  v_lshlrev_b32 v62, 16, v91
  v_and_b32 v63, s40, v91
  v_add_f32 v40, v40, v56
  v_add_f32 v41, v41, v57
  v_add_f32 v42, v42, v58
  v_add_f32 v43, v43, v59
  v_add_f32 v44, v44, v60
  v_add_f32 v45, v45, v61
  v_add_f32 v46, v46, v62
  v_add_f32 v47, v47, v63
  v_lshlrev_b32 v56, 16, v92
  v_and_b32 v57, s40, v92
  v_lshlrev_b32 v58, 16, v93
  v_and_b32 v59, s40, v93
  v_lshlrev_b32 v60, 16, v94
  v_and_b32 v61, s40, v94
  v_lshlrev_b32 v62, 16, v95
  v_and_b32 v63, s40, v95
  v_add_f32 v48, v48, v56
  v_add_f32 v49, v49, v57
  v_add_f32 v50, v50, v58
  v_add_f32 v51, v51, v59
  v_add_f32 v52, v52, v60
  v_add_f32 v53, v53, v61
  v_add_f32 v54, v54, v62
  v_add_f32 v55, v55, v63
  s_waitcnt vmcnt(4)
  v_lshlrev_b32 v56, 16, v96
  v_and_b32 v57, s40, v96
  v_lshlrev_b32 v58, 16, v97
  v_and_b32 v59, s40, v97
  v_lshlrev_b32 v60, 16, v98
  v_and_b32 v61, s40, v98
  v_lshlrev_b32 v62, 16, v99
  v_and_b32 v63, s40, v99
  v_add_f32 v40, v40, v56
  v_add_f32 v41, v41, v57
  v_add_f32 v42, v42, v58
  v_add_f32 v43, v43, v59
  v_add_f32 v44, v44, v60
  v_add_f32 v45, v45, v61
  v_add_f32 v46, v46, v62
  v_add_f32 v47, v47, v63
  v_lshlrev_b32 v56, 16, v100
  v_and_b32 v57, s40, v100
  v_lshlrev_b32 v58, 16, v101
  v_and_b32 v59, s40, v101
  v_lshlrev_b32 v60, 16, v102
  v_and_b32 v61, s40, v102
  v_lshlrev_b32 v62, 16, v103
  v_and_b32 v63, s40, v103
  v_add_f32 v48, v48, v56
  v_add_f32 v49, v49, v57
  v_add_f32 v50, v50, v58
  v_add_f32 v51, v51, v59
  v_add_f32 v52, v52, v60
  v_add_f32 v53, v53, v61
  v_add_f32 v54, v54, v62
  v_add_f32 v55, v55, v63
  s_waitcnt vmcnt(2)
  v_lshlrev_b32 v56, 16, v104
  v_and_b32 v57, s40, v104
  v_lshlrev_b32 v58, 16, v105
  v_and_b32 v59, s40, v105
  v_lshlrev_b32 v60, 16, v106
  v_and_b32 v61, s40, v106
  v_lshlrev_b32 v62, 16, v107
  v_and_b32 v63, s40, v107
  v_add_f32 v40, v40, v56
  v_add_f32 v41, v41, v57
  v_add_f32 v42, v42, v58
  v_add_f32 v43, v43, v59
  v_add_f32 v44, v44, v60
  v_add_f32 v45, v45, v61
  v_add_f32 v46, v46, v62
  v_add_f32 v47, v47, v63
  v_lshlrev_b32 v56, 16, v108
  v_and_b32 v57, s40, v108
  v_lshlrev_b32 v58, 16, v109
  v_and_b32 v59, s40, v109
  v_lshlrev_b32 v60, 16, v110
  v_and_b32 v61, s40, v110
  v_lshlrev_b32 v62, 16, v111
  v_and_b32 v63, s40, v111
  v_add_f32 v48, v48, v56
  v_add_f32 v49, v49, v57
  v_add_f32 v50, v50, v58
  v_add_f32 v51, v51, v59
  v_add_f32 v52, v52, v60
  v_add_f32 v53, v53, v61
  v_add_f32 v54, v54, v62
  v_add_f32 v55, v55, v63
  v_cvt_pk_bf16_f32 v64, v40, v41
  v_cvt_pk_bf16_f32 v65, v42, v43
  v_cvt_pk_bf16_f32 v66, v44, v45
  v_cvt_pk_bf16_f32 v67, v46, v47
  v_cvt_pk_bf16_f32 v68, v48, v49
  v_cvt_pk_bf16_f32 v69, v50, v51
  v_cvt_pk_bf16_f32 v70, v52, v53
  v_cvt_pk_bf16_f32 v71, v54, v55
  v_lshlrev_b32 v40, 16, v64
  v_and_b32 v41, s40, v64
  v_lshlrev_b32 v42, 16, v65
  v_and_b32 v43, s40, v65
  v_lshlrev_b32 v44, 16, v66
  v_and_b32 v45, s40, v66
  v_lshlrev_b32 v46, 16, v67
  v_and_b32 v47, s40, v67
  v_lshlrev_b32 v48, 16, v68
  v_and_b32 v49, s40, v68
  v_lshlrev_b32 v50, 16, v69
  v_and_b32 v51, s40, v69
  v_lshlrev_b32 v52, 16, v70
  v_and_b32 v53, s40, v70
  v_lshlrev_b32 v54, 16, v71
  v_and_b32 v55, s40, v71
  s_waitcnt vmcnt(0)
  v_lshlrev_b32 v24, 16, v72
  v_and_b32 v25, s40, v72
  v_lshlrev_b32 v26, 16, v73
  v_and_b32 v27, s40, v73
  v_lshlrev_b32 v28, 16, v74
  v_and_b32 v29, s40, v74
  v_lshlrev_b32 v30, 16, v75
  v_and_b32 v31, s40, v75
  v_lshlrev_b32 v32, 16, v76
  v_and_b32 v33, s40, v76
  v_lshlrev_b32 v34, 16, v77
  v_and_b32 v35, s40, v77
  v_lshlrev_b32 v36, 16, v78
  v_and_b32 v37, s40, v78
  v_lshlrev_b32 v38, 16, v79
  v_and_b32 v39, s40, v79
  v_add_f32 v24, v24, v40
  v_add_f32 v25, v25, v41
  v_add_f32 v26, v26, v42
  v_add_f32 v27, v27, v43
  v_add_f32 v28, v28, v44
  v_add_f32 v29, v29, v45
  v_add_f32 v30, v30, v46
  v_add_f32 v31, v31, v47
  v_add_f32 v32, v32, v48
  v_add_f32 v33, v33, v49
  v_add_f32 v34, v34, v50
  v_add_f32 v35, v35, v51
  v_add_f32 v36, v36, v52
  v_add_f32 v37, v37, v53
  v_add_f32 v38, v38, v54
  v_add_f32 v39, v39, v55
  v_cvt_pk_bf16_f32 v64, v24, v25
  v_cvt_pk_bf16_f32 v65, v26, v27
  v_cvt_pk_bf16_f32 v66, v28, v29
  v_cvt_pk_bf16_f32 v67, v30, v31
  v_cvt_pk_bf16_f32 v68, v32, v33
  v_cvt_pk_bf16_f32 v69, v34, v35
  v_cvt_pk_bf16_f32 v70, v36, v37
  v_cvt_pk_bf16_f32 v71, v38, v39
  buffer_store_dwordx4 v[64:67], v7, s[4:7], s26 offen offset:0 sc1
  buffer_store_dwordx4 v[68:71], v7, s[4:7], s26 offen offset:512 sc1
  v_lshlrev_b32 v24, 16, v64
  v_and_b32 v25, s40, v64
  v_lshlrev_b32 v26, 16, v65
  v_and_b32 v27, s40, v65
  v_lshlrev_b32 v28, 16, v66
  v_and_b32 v29, s40, v66
  v_lshlrev_b32 v30, 16, v67
  v_and_b32 v31, s40, v67
  v_lshlrev_b32 v32, 16, v68
  v_and_b32 v33, s40, v68
  v_lshlrev_b32 v34, 16, v69
  v_and_b32 v35, s40, v69
  v_lshlrev_b32 v36, 16, v70
  v_and_b32 v37, s40, v70
  v_lshlrev_b32 v38, 16, v71
  v_and_b32 v39, s40, v71
  v_add_f32 v16, v24, v25
  v_add_f32 v17, v26, v27
  v_add_f32 v16, v16, v28
  v_add_f32 v17, v17, v29
  v_add_f32 v16, v16, v30
  v_add_f32 v17, v17, v31
  v_add_f32 v16, v16, v32
  v_add_f32 v17, v17, v33
  v_add_f32 v16, v16, v34
  v_add_f32 v17, v17, v35
  v_add_f32 v16, v16, v36
  v_add_f32 v17, v17, v37
  v_add_f32 v16, v16, v38
  v_add_f32 v17, v17, v39
  v_add_f32 v16, v16, v17
  s_nop 1
  v_add_f32_dpp v16, v16, v16 row_ror:8 row_mask:0xf bank_mask:0xf
  v_mov_b32 v18, v16
  s_nop 1
  v_permlane16_swap_b32 v16, v18
  v_add_f32 v16, v16, v18
  v_mov_b32 v18, v16
  s_nop 1
  v_permlane32_swap_b32 v16, v18
  v_add_f32 v16, v16, v18
  ds_write_b32 v9, v16 offset:0
  s_waitcnt lgkmcnt(0)
  s_barrier
  ds_read_b128 v[56:59], v10 offset:0
  s_waitcnt lgkmcnt(0)
  v_add_f32 v56, v56, v57
  v_add_f32 v58, v58, v59
  v_add_f32 v16, v56, v58
  v_mul_f32 v16, 0x3b000000, v16
  v_sub_f32 v40, v24, v16
  v_sub_f32 v41, v25, v16
  v_sub_f32 v42, v26, v16
  v_sub_f32 v43, v27, v16
  v_sub_f32 v44, v28, v16
  v_sub_f32 v45, v29, v16
  v_sub_f32 v46, v30, v16
  v_sub_f32 v47, v31, v16
  v_sub_f32 v48, v32, v16
  v_sub_f32 v49, v33, v16
  v_sub_f32 v50, v34, v16
  v_sub_f32 v51, v35, v16
  v_sub_f32 v52, v36, v16
  v_sub_f32 v53, v37, v16
  v_sub_f32 v54, v38, v16
  v_sub_f32 v55, v39, v16
  v_mul_f32 v17, v40, v40
  v_mul_f32 v19, v41, v41
  v_fmac_f32 v17, v42, v42
  v_fmac_f32 v19, v43, v43
  v_fmac_f32 v17, v44, v44
  v_fmac_f32 v19, v45, v45
  v_fmac_f32 v17, v46, v46
  v_fmac_f32 v19, v47, v47
  v_fmac_f32 v17, v48, v48
  v_fmac_f32 v19, v49, v49
  v_fmac_f32 v17, v50, v50
  v_fmac_f32 v19, v51, v51
  v_fmac_f32 v17, v52, v52
  v_fmac_f32 v19, v53, v53
  v_fmac_f32 v17, v54, v54
  v_fmac_f32 v19, v55, v55
  v_add_f32 v17, v17, v19
  v_cvt_pk_bf16_f32 v16, v16, v16
  v_lshlrev_b32 v16, 16, v16
  v_add_f32_dpp v17, v17, v17 row_ror:8 row_mask:0xf bank_mask:0xf
  v_mov_b32 v18, v17
  s_nop 1
  v_permlane16_swap_b32 v17, v18
  v_add_f32 v17, v17, v18
  v_mov_b32 v18, v17
  s_nop 1
  v_permlane32_swap_b32 v17, v18
  v_add_f32 v17, v17, v18
  ds_write_b32 v9, v17 offset:128
  s_waitcnt lgkmcnt(0)
  s_barrier
  ds_read_b128 v[56:59], v10 offset:128
  s_waitcnt lgkmcnt(0)
  v_add_f32 v56, v56, v57
  v_add_f32 v58, v58, v59
  v_add_f32 v17, v56, v58
  v_sub_f32 v40, v24, v16
  v_sub_f32 v41, v25, v16
  v_sub_f32 v42, v26, v16
  v_sub_f32 v43, v27, v16
  v_sub_f32 v44, v28, v16
  v_sub_f32 v45, v29, v16
  v_sub_f32 v46, v30, v16
  v_sub_f32 v47, v31, v16
  v_sub_f32 v48, v32, v16
  v_sub_f32 v49, v33, v16
  v_sub_f32 v50, v34, v16
  v_sub_f32 v51, v35, v16
  v_sub_f32 v52, v36, v16
  v_sub_f32 v53, v37, v16
  v_sub_f32 v54, v38, v16
  v_sub_f32 v55, v39, v16
  v_mul_f32 v17, 0x3b000000, v17
  v_cvt_pk_bf16_f32 v17, v17, v17
  v_lshlrev_b32 v17, 16, v17
  v_add_f32 v17, 0x3727c5ac, v17
  v_cvt_pk_bf16_f32 v17, v17, v17
  v_lshlrev_b32 v17, 16, v17
  v_sqrt_f32 v17, v17
  s_nop 0
  v_cvt_pk_bf16_f32 v17, v17, v17
  v_lshlrev_b32 v17, 16, v17
  v_rcp_f32 v17, v17
  v_cvt_pk_bf16_f32 v72, v40, v41
  v_cvt_pk_bf16_f32 v73, v42, v43
  v_cvt_pk_bf16_f32 v74, v44, v45
  v_cvt_pk_bf16_f32 v75, v46, v47
  v_cvt_pk_bf16_f32 v76, v48, v49
  v_cvt_pk_bf16_f32 v77, v50, v51
  v_cvt_pk_bf16_f32 v78, v52, v53
  v_cvt_pk_bf16_f32 v79, v54, v55
  v_lshlrev_b32 v40, 16, v72
  v_and_b32 v41, s40, v72
  v_lshlrev_b32 v42, 16, v73
  v_and_b32 v43, s40, v73
  v_lshlrev_b32 v44, 16, v74
  v_and_b32 v45, s40, v74
  v_lshlrev_b32 v46, 16, v75
  v_and_b32 v47, s40, v75
  v_lshlrev_b32 v48, 16, v76
  v_and_b32 v49, s40, v76
  v_lshlrev_b32 v50, 16, v77
  v_and_b32 v51, s40, v77
  v_lshlrev_b32 v52, 16, v78
  v_and_b32 v53, s40, v78
  v_lshlrev_b32 v54, 16, v79
  v_and_b32 v55, s40, v79
  v_mul_f32 v40, v40, v17
  v_mul_f32 v41, v41, v17
  v_mul_f32 v42, v42, v17
  v_mul_f32 v43, v43, v17
  v_mul_f32 v44, v44, v17
  v_mul_f32 v45, v45, v17
  v_mul_f32 v46, v46, v17
  v_mul_f32 v47, v47, v17
  v_mul_f32 v48, v48, v17
  v_mul_f32 v49, v49, v17
  v_mul_f32 v50, v50, v17
  v_mul_f32 v51, v51, v17
  v_mul_f32 v52, v52, v17
  v_mul_f32 v53, v53, v17
  v_mul_f32 v54, v54, v17
  v_mul_f32 v55, v55, v17
  v_cvt_pk_bf16_f32 v72, v40, v41
  v_cvt_pk_bf16_f32 v73, v42, v43
  v_cvt_pk_bf16_f32 v74, v44, v45
  v_cvt_pk_bf16_f32 v75, v46, v47
  v_cvt_pk_bf16_f32 v76, v48, v49
  v_cvt_pk_bf16_f32 v77, v50, v51
  v_cvt_pk_bf16_f32 v78, v52, v53
  v_cvt_pk_bf16_f32 v79, v54, v55
  s_add_u32 s31, s27, 16384
  buffer_store_dwordx4 v[72:75], v8, s[4:7], s27 offen sc1
  buffer_store_dwordx4 v[76:79], v8, s[4:7], s31 offen sc1
  s_add_u32 s26, s26, 65536
  s_add_u32 s27, s27, 65536
  s_waitcnt vmcnt(0)
  s_mov_b64 exec, 1
  ds_add_rtn_u32 v5, v15, v4
  s_waitcnt lgkmcnt(0)
  v_readfirstlane_b32 s31, v5
  s_mov_b64 exec, -1
  v_xor_b32 v15, 8, v15
  s_and_b32 s31, s31, 3
  s_cmp_lg_u32 s31, 3
  s_cbranch_scc1 agg_216
  s_mov_b64 exec, 1
  buffer_store_dword v13, off, s[4:7], s30 sc1
  s_mov_b64 exec, -1
agg_216:
  s_add_u32 s30, s30, 2048
  s_barrier
  s_sub_u32 s28, s28, 1
  s_cmp_lg_u32 s28, 0
  s_cbranch_scc1 rwtop_210
  s_branch mega_kernel_end
rl_l1_209:
  s_load_dwordx2 s[12:13], s[0:1], 88
  s_waitcnt lgkmcnt(0)
  s_mov_b32 s14, 2097152
  s_mov_b32 s15, 0x00020000
  s_add_u32 s25, s25, 16777216
  s_add_u32 s27, s27, 4194304
  s_add_u32 s52, s24, 1048576
  v_and_b32 v3, 7, v0
  v_lshrrev_b32 v4, 3, v0
  v_lshlrev_b32 v10, 4, v3
  s_lshl_b32 s31, s3, 2
  v_add_u32 v9, s31, v10
  v_lshlrev_b32 v7, 10, v3
  v_lshl_add_u32 v7, v4, 4, v7
  v_lshlrev_b32 v8, 9, v4
  v_lshl_add_u32 v8, v3, 4, v8
  v_lshrrev_b32 v5, 2, v3
  v_lshlrev_b32 v6, 12, v5
  v_lshl_add_u32 v6, v4, 6, v6
  v_and_b32 v5, 3, v3
  v_lshl_add_u32 v6, v5, 4, v6
  v_mov_b32 v13, 1
  s_mov_b32 s40, 0xffff0000
  v_min_u32 v11, 7, v2
  v_lshlrev_b32 v11, 2, v11
  v_mov_b32 v14, 163584
  v_mov_b32 v4, 0
  ds_write_b32 v14, v4
  ds_write_b32 v14, v4 offset:4
  ds_write_b32 v14, v4 offset:8
  s_waitcnt lgkmcnt(0)
  v_mov_b32 v4, 1
  v_mov_b32 v15, 163584
  s_mov_b32 s36, 1
  s_barrier
rwtop_217:
  s_cmp_lg_u32 s3, 0
  s_cbranch_scc1 wro_218
  s_mov_b32 s35, 0
poll_220:
  buffer_load_dword v12, v11, s[4:7], s29 offen sc1
  s_waitcnt vmcnt(0)
  v_cmp_ne_u32 vcc, 0, v12
  s_nop 0
  s_cmp_eq_u64 vcc, exec
  s_cbranch_scc1 polld_221
  s_sleep 3
  s_add_u32 s35, s35, 1
  s_cmp_lt_u32 s35, 131072
  s_cbranch_scc1 poll_220
  s_branch mega_kernel_end
polld_221:
  v_mov_b32 v12, s36
  ds_write_b32 v14, v12 offset:4
  s_waitcnt lgkmcnt(0)
  s_branch wrd_219
wro_218:
  s_mov_b32 s35, 0
wrl_222:
  ds_read_b32 v12, v14 offset:4
  s_add_u32 s35, s35, 1
  s_cmp_gt_u32 s35, 2097152
  s_cbranch_scc1 mega_kernel_end
  s_waitcnt lgkmcnt(0)
  v_readfirstlane_b32 s31, v12
  s_nop 0
  s_cmp_ge_u32 s31, s36
  s_nop 0
  s_cbranch_scc1 wrd_219
  s_sleep 1
  s_branch wrl_222
wrd_219:
  s_mov_b32 s31, s24
  buffer_load_dwordx4 v[80:83], v6, s[4:7], s31 offen offset:0 sc1
  buffer_load_dwordx4 v[84:87], v6, s[4:7], s31 offen offset:2048 sc1
  s_add_u32 s31, s31, 32768
  buffer_load_dwordx4 v[88:91], v6, s[4:7], s31 offen offset:0 sc1
  buffer_load_dwordx4 v[92:95], v6, s[4:7], s31 offen offset:2048 sc1
  s_add_u32 s31, s31, 32768
  buffer_load_dwordx4 v[96:99], v6, s[4:7], s31 offen offset:0 sc1
  buffer_load_dwordx4 v[100:103], v6, s[4:7], s31 offen offset:2048 sc1
  s_add_u32 s31, s31, 32768
  buffer_load_dwordx4 v[104:107], v6, s[4:7], s31 offen offset:0 sc1
  buffer_load_dwordx4 v[108:111], v6, s[4:7], s31 offen offset:2048 sc1
  buffer_load_dwordx4 v[72:75], v7, s[4:7], s25 offen offset:0 sc1
  buffer_load_dwordx4 v[76:79], v7, s[4:7], s25 offen offset:512 sc1
  s_add_u32 s24, s24, 262144
  s_cmp_ge_u32 s24, s52
  s_cselect_b32 s78, 1048576, 0
  s_sub_u32 s24, s24, s78
  s_add_u32 s25, s25, 65536
  s_add_u32 s29, s29, 2048
  s_add_u32 s36, s36, 1
  s_waitcnt vmcnt(8)
  v_lshlrev_b32 v40, 16, v80
  v_and_b32 v41, s40, v80
  v_lshlrev_b32 v42, 16, v81
  v_and_b32 v43, s40, v81
  v_lshlrev_b32 v44, 16, v82
  v_and_b32 v45, s40, v82
  v_lshlrev_b32 v46, 16, v83
  v_and_b32 v47, s40, v83
  v_lshlrev_b32 v48, 16, v84
  v_and_b32 v49, s40, v84
  v_lshlrev_b32 v50, 16, v85
  v_and_b32 v51, s40, v85
  v_lshlrev_b32 v52, 16, v86
  v_and_b32 v53, s40, v86
  v_lshlrev_b32 v54, 16, v87
  v_and_b32 v55, s40, v87
  s_waitcnt vmcnt(6)
  v_lshlrev_b32 v56, 16, v88
  v_and_b32 v57, s40, v88
  v_lshlrev_b32 v58, 16, v89
  v_and_b32 v59, s40, v89
  v_lshlrev_b32 v60, 16, v90
  v_and_b32 v61, s40, v90
  v_lshlrev_b32 v62, 16, v91
  v_and_b32 v63, s40, v91
  v_add_f32 v40, v40, v56
  v_add_f32 v41, v41, v57
  v_add_f32 v42, v42, v58
  v_add_f32 v43, v43, v59
  v_add_f32 v44, v44, v60
  v_add_f32 v45, v45, v61
  v_add_f32 v46, v46, v62
  v_add_f32 v47, v47, v63
  v_lshlrev_b32 v56, 16, v92
  v_and_b32 v57, s40, v92
  v_lshlrev_b32 v58, 16, v93
  v_and_b32 v59, s40, v93
  v_lshlrev_b32 v60, 16, v94
  v_and_b32 v61, s40, v94
  v_lshlrev_b32 v62, 16, v95
  v_and_b32 v63, s40, v95
  v_add_f32 v48, v48, v56
  v_add_f32 v49, v49, v57
  v_add_f32 v50, v50, v58
  v_add_f32 v51, v51, v59
  v_add_f32 v52, v52, v60
  v_add_f32 v53, v53, v61
  v_add_f32 v54, v54, v62
  v_add_f32 v55, v55, v63
  s_waitcnt vmcnt(4)
  v_lshlrev_b32 v56, 16, v96
  v_and_b32 v57, s40, v96
  v_lshlrev_b32 v58, 16, v97
  v_and_b32 v59, s40, v97
  v_lshlrev_b32 v60, 16, v98
  v_and_b32 v61, s40, v98
  v_lshlrev_b32 v62, 16, v99
  v_and_b32 v63, s40, v99
  v_add_f32 v40, v40, v56
  v_add_f32 v41, v41, v57
  v_add_f32 v42, v42, v58
  v_add_f32 v43, v43, v59
  v_add_f32 v44, v44, v60
  v_add_f32 v45, v45, v61
  v_add_f32 v46, v46, v62
  v_add_f32 v47, v47, v63
  v_lshlrev_b32 v56, 16, v100
  v_and_b32 v57, s40, v100
  v_lshlrev_b32 v58, 16, v101
  v_and_b32 v59, s40, v101
  v_lshlrev_b32 v60, 16, v102
  v_and_b32 v61, s40, v102
  v_lshlrev_b32 v62, 16, v103
  v_and_b32 v63, s40, v103
  v_add_f32 v48, v48, v56
  v_add_f32 v49, v49, v57
  v_add_f32 v50, v50, v58
  v_add_f32 v51, v51, v59
  v_add_f32 v52, v52, v60
  v_add_f32 v53, v53, v61
  v_add_f32 v54, v54, v62
  v_add_f32 v55, v55, v63
  s_waitcnt vmcnt(2)
  v_lshlrev_b32 v56, 16, v104
  v_and_b32 v57, s40, v104
  v_lshlrev_b32 v58, 16, v105
  v_and_b32 v59, s40, v105
  v_lshlrev_b32 v60, 16, v106
  v_and_b32 v61, s40, v106
  v_lshlrev_b32 v62, 16, v107
  v_and_b32 v63, s40, v107
  v_add_f32 v40, v40, v56
  v_add_f32 v41, v41, v57
  v_add_f32 v42, v42, v58
  v_add_f32 v43, v43, v59
  v_add_f32 v44, v44, v60
  v_add_f32 v45, v45, v61
  v_add_f32 v46, v46, v62
  v_add_f32 v47, v47, v63
  v_lshlrev_b32 v56, 16, v108
  v_and_b32 v57, s40, v108
  v_lshlrev_b32 v58, 16, v109
  v_and_b32 v59, s40, v109
  v_lshlrev_b32 v60, 16, v110
  v_and_b32 v61, s40, v110
  v_lshlrev_b32 v62, 16, v111
  v_and_b32 v63, s40, v111
  v_add_f32 v48, v48, v56
  v_add_f32 v49, v49, v57
  v_add_f32 v50, v50, v58
  v_add_f32 v51, v51, v59
  v_add_f32 v52, v52, v60
  v_add_f32 v53, v53, v61
  v_add_f32 v54, v54, v62
  v_add_f32 v55, v55, v63
  v_cvt_pk_bf16_f32 v64, v40, v41
  v_cvt_pk_bf16_f32 v65, v42, v43
  v_cvt_pk_bf16_f32 v66, v44, v45
  v_cvt_pk_bf16_f32 v67, v46, v47
  v_cvt_pk_bf16_f32 v68, v48, v49
  v_cvt_pk_bf16_f32 v69, v50, v51
  v_cvt_pk_bf16_f32 v70, v52, v53
  v_cvt_pk_bf16_f32 v71, v54, v55
  v_lshlrev_b32 v40, 16, v64
  v_and_b32 v41, s40, v64
  v_lshlrev_b32 v42, 16, v65
  v_and_b32 v43, s40, v65
  v_lshlrev_b32 v44, 16, v66
  v_and_b32 v45, s40, v66
  v_lshlrev_b32 v46, 16, v67
  v_and_b32 v47, s40, v67
  v_lshlrev_b32 v48, 16, v68
  v_and_b32 v49, s40, v68
  v_lshlrev_b32 v50, 16, v69
  v_and_b32 v51, s40, v69
  v_lshlrev_b32 v52, 16, v70
  v_and_b32 v53, s40, v70
  v_lshlrev_b32 v54, 16, v71
  v_and_b32 v55, s40, v71
  s_waitcnt vmcnt(0)
  v_lshlrev_b32 v24, 16, v72
  v_and_b32 v25, s40, v72
  v_lshlrev_b32 v26, 16, v73
  v_and_b32 v27, s40, v73
  v_lshlrev_b32 v28, 16, v74
  v_and_b32 v29, s40, v74
  v_lshlrev_b32 v30, 16, v75
  v_and_b32 v31, s40, v75
  v_lshlrev_b32 v32, 16, v76
  v_and_b32 v33, s40, v76
  v_lshlrev_b32 v34, 16, v77
  v_and_b32 v35, s40, v77
  v_lshlrev_b32 v36, 16, v78
  v_and_b32 v37, s40, v78
  v_lshlrev_b32 v38, 16, v79
  v_and_b32 v39, s40, v79
  v_add_f32 v24, v24, v40
  v_add_f32 v25, v25, v41
  v_add_f32 v26, v26, v42
  v_add_f32 v27, v27, v43
  v_add_f32 v28, v28, v44
  v_add_f32 v29, v29, v45
  v_add_f32 v30, v30, v46
  v_add_f32 v31, v31, v47
  v_add_f32 v32, v32, v48
  v_add_f32 v33, v33, v49
  v_add_f32 v34, v34, v50
  v_add_f32 v35, v35, v51
  v_add_f32 v36, v36, v52
  v_add_f32 v37, v37, v53
  v_add_f32 v38, v38, v54
  v_add_f32 v39, v39, v55
  v_cvt_pk_bf16_f32 v64, v24, v25
  v_cvt_pk_bf16_f32 v65, v26, v27
  v_cvt_pk_bf16_f32 v66, v28, v29
  v_cvt_pk_bf16_f32 v67, v30, v31
  v_cvt_pk_bf16_f32 v68, v32, v33
  v_cvt_pk_bf16_f32 v69, v34, v35
  v_cvt_pk_bf16_f32 v70, v36, v37
  v_cvt_pk_bf16_f32 v71, v38, v39
  buffer_store_dwordx4 v[64:67], v7, s[12:15], s26 offen offset:0
  buffer_store_dwordx4 v[68:71], v7, s[12:15], s26 offen offset:512
  s_add_u32 s26, s26, 65536
  s_add_u32 s27, s27, 65536
  s_waitcnt vmcnt(0)
  s_mov_b64 exec, 1
  ds_add_rtn_u32 v5, v15, v4
  s_waitcnt lgkmcnt(0)
  v_readfirstlane_b32 s31, v5
  s_mov_b64 exec, -1
  v_xor_b32 v15, 8, v15
  s_and_b32 s31, s31, 3
  s_cmp_lg_u32 s31, 3
  s_cbranch_scc1 agg_223
  s_mov_b64 exec, 1
  buffer_store_dword v13, off, s[4:7], s30 sc1
  s_mov_b64 exec, -1
agg_223:
  s_add_u32 s30, s30, 2048
  s_barrier
  s_sub_u32 s28, s28, 1
  s_cmp_lg_u32 s28, 0
  s_cbranch_scc1 rwtop_217
  s_branch mega_kernel_end
r_team_12:
  s_load_dwordx2 s[8:9], s[0:1], 16
  s_load_dwordx2 s[12:13], s[0:1], 24
  s_load_dwordx2 s[16:17], s[0:1], 32
  s_load_dwordx2 s[20:21], s[0:1], 40
  s_load_dwordx2 s[44:45], s[0:1], 8
  s_waitcnt lgkmcnt(0)
  s_mov_b32 s10, 4194304
  s_mov_b32 s11, 0x00020000
  s_mov_b32 s14, 4194304
  s_mov_b32 s15, 0x00020000
  s_mov_b32 s18, 4194304
  s_mov_b32 s19, 0x00020000
  s_mov_b32 s22, 4194304
  s_mov_b32 s23, 0x00020000
  s_mov_b32 s46, 8192
  s_mov_b32 s47, 0x00020000
  s_lshr_b32 s97, s96, 5
  s_and_b32 s24, s96, 31
  s_lshl_b32 s40, s24, 13
  s_mul_i32 s41, s97, 16777216
  s_add_u32 s40, s40, s41
  s_add_u32 s25, s40, 71303168
  s_add_u32 s26, s40, 104857600
  s_lshl_b32 s40, s24, 11
  s_mul_i32 s41, s97, 4194304
  s_add_u32 s40, s40, s41
  s_add_u32 s27, s40, 20971520
  s_add_u32 s28, s40, 29360128
  s_lshl_b32 s40, s97, 20
  s_add_u32 s29, s40, 1048576
  s_lshl_b32 s40, s97, 15
  s_add_u32 s30, s40, 3145728
  s_lshl_b32 s41, s97, 16
  s_lshr_b32 s40, s24, 1
  s_lshl_b32 s40, s40, 2
  s_add_u32 s40, s40, s41
  s_add_u32 s32, s40, 64
  s_lshl_b32 s40, s24, 4
  s_add_u32 s40, s40, s41
  s_add_u32 s33, s40, 131072
  v_bfe_u32 v32, v2, 2, 1
  v_bfe_u32 v20, v2, 5, 1
  v_lshl_add_u32 v32, v20, 1, v32
  v_bfe_u32 v20, v2, 4, 1
  v_lshl_add_u32 v32, v20, 2, v32
  v_bfe_u32 v33, v2, 3, 1
  v_and_b32 v34, 3, v2
  v_lshlrev_b32 v20, 1, v20
  v_xor_b32 v34, v34, v20
  v_lshl_add_u32 v21, v32, 4, v33
  v_lshlrev_b32 v35, 13, v21
  v_lshl_add_u32 v35, v34, 4, v35
  v_lshl_add_u32 v21, v33, 3, v32
  v_lshlrev_b32 v36, 10, v21
  v_lshl_add_u32 v36, v34, 4, v36
  v_bfe_u32 v20, v2, 2, 3
  v_bfe_u32 v21, v2, 5, 1
  v_lshl_add_u32 v20, v21, 4, v20
  v_lshlrev_b32 v37, 6, v20
  v_and_b32 v20, 3, v2
  v_lshl_add_u32 v37, v20, 3, v37
  v_bfe_u32 v21, v2, 4, 1
  v_lshl_add_u32 v37, v21, 5, v37
  s_lshl_b32 s35, s3, 15
  v_add_u32 v37, s35, v37
  v_xor_b32 v38, 32, v37
  v_add_u32 v4, s35, v1
  s_lshl_b32 s37, s24, 8
  s_lshl_b32 s35, s3, 6
  s_add_u32 s37, s37, s35
  s_lshl_b32 s36, s24, 17
  s_lshl_b32 s35, s3, 8
  s_add_u32 s36, s36, s35
  s_lshl_b32 s38, s3, 15
  s_lshl_b32 s34, s3, 13
  s_add_u32 s34, s34, 131072
  s_sub_u32 s35, s34, s38
  v_add_u32 v39, s35, v37
  v_xor_b32 v40, 32, v39
  s_and_b32 s40, s3, 1
  s_lshl_b32 s40, s40, 12
  s_and_b32 s41, s3, 2
  s_waitcnt vmcnt(0)
  s_xor_b32 s35, s40, 0
  s_add_u32 s35, s35, s38
  s_add_u32 m0, s35, 0
  s_xor_b32 s39, s41, 0
  s_lshl_b32 s39, s39, 20
  s_add_u32 s39, s39, s37
  s_add_u32 s35, s39, 0
  buffer_load_dwordx4 v35, s[8:11], s35 offen lds
  s_add_u32 m0, m0, 1024
  s_add_u32 s35, s39, 16384
  buffer_load_dwordx4 v35, s[8:11], s35 offen lds
  s_add_u32 m0, m0, 1024
  s_add_u32 s35, s39, 32768
  buffer_load_dwordx4 v35, s[8:11], s35 offen lds
  s_add_u32 m0, m0, 1024
  s_add_u32 s35, s39, 49152
  buffer_load_dwordx4 v35, s[8:11], s35 offen lds
  s_xor_b32 s35, s40, 4096
  s_add_u32 s35, s35, s38
  s_add_u32 m0, s35, 0
  s_xor_b32 s39, s41, 1
  s_lshl_b32 s39, s39, 20
  s_add_u32 s39, s39, s37
  s_add_u32 s35, s39, 0
  buffer_load_dwordx4 v35, s[8:11], s35 offen lds
  s_add_u32 m0, m0, 1024
  s_add_u32 s35, s39, 16384
  buffer_load_dwordx4 v35, s[8:11], s35 offen lds
  s_add_u32 m0, m0, 1024
  s_add_u32 s35, s39, 32768
  buffer_load_dwordx4 v35, s[8:11], s35 offen lds
  s_add_u32 m0, m0, 1024
  s_add_u32 s35, s39, 49152
  buffer_load_dwordx4 v35, s[8:11], s35 offen lds
  s_xor_b32 s35, s40, 0
  s_add_u32 s35, s35, s38
  s_add_u32 m0, s35, 8192
  s_xor_b32 s39, s41, 0
  s_lshl_b32 s39, s39, 20
  s_add_u32 s39, s39, s37
  s_add_u32 s35, s39, 65536
  buffer_load_dwordx4 v35, s[8:11], s35 offen lds
  s_add_u32 m0, m0, 1024
  s_add_u32 s35, s39, 81920
  buffer_load_dwordx4 v35, s[8:11], s35 offen lds
  s_add_u32 m0, m0, 1024
  s_add_u32 s35, s39, 98304
  buffer_load_dwordx4 v35, s[8:11], s35 offen lds
  s_add_u32 m0, m0, 1024
  s_add_u32 s35, s39, 114688
  buffer_load_dwordx4 v35, s[8:11], s35 offen lds
  s_xor_b32 s35, s40, 4096
  s_add_u32 s35, s35, s38
  s_add_u32 m0, s35, 8192
  s_xor_b32 s39, s41, 1
  s_lshl_b32 s39, s39, 20
  s_add_u32 s39, s39, s37
  s_add_u32 s35, s39, 65536
  buffer_load_dwordx4 v35, s[8:11], s35 offen lds
  s_add_u32 m0, m0, 1024
  s_add_u32 s35, s39, 81920
  buffer_load_dwordx4 v35, s[8:11], s35 offen lds
  s_add_u32 m0, m0, 1024
  s_add_u32 s35, s39, 98304
  buffer_load_dwordx4 v35, s[8:11], s35 offen lds
  s_add_u32 m0, m0, 1024
  s_add_u32 s35, s39, 114688
  buffer_load_dwordx4 v35, s[8:11], s35 offen lds
  s_xor_b32 s35, s40, 0
  s_add_u32 s35, s35, s38
  s_add_u32 m0, s35, 16384
  s_xor_b32 s39, s41, 2
  s_lshl_b32 s39, s39, 20
  s_add_u32 s39, s39, s37
  s_add_u32 s35, s39, 65536
  buffer_load_dwordx4 v35, s[8:11], s35 offen lds
  s_add_u32 m0, m0, 1024
  s_add_u32 s35, s39, 81920
  buffer_load_dwordx4 v35, s[8:11], s35 offen lds
  s_add_u32 m0, m0, 1024
  s_add_u32 s35, s39, 98304
  buffer_load_dwordx4 v35, s[8:11], s35 offen lds
  s_add_u32 m0, m0, 1024
  s_add_u32 s35, s39, 114688
  buffer_load_dwordx4 v35, s[8:11], s35 offen lds
  s_xor_b32 s35, s40, 4096
  s_add_u32 s35, s35, s38
  s_add_u32 m0, s35, 16384
  s_xor_b32 s39, s41, 3
  s_lshl_b32 s39, s39, 20
  s_add_u32 s39, s39, s37
  s_add_u32 s35, s39, 65536
  buffer_load_dwordx4 v35, s[8:11], s35 offen lds
  s_add_u32 m0, m0, 1024
  s_add_u32 s35, s39, 81920
  buffer_load_dwordx4 v35, s[8:11], s35 offen lds
  s_add_u32 m0, m0, 1024
  s_add_u32 s35, s39, 98304
  buffer_load_dwordx4 v35, s[8:11], s35 offen lds
  s_add_u32 m0, m0, 1024
  s_add_u32 s35, s39, 114688
  buffer_load_dwordx4 v35, s[8:11], s35 offen lds
  s_xor_b32 s35, s40, 0
  s_add_u32 s35, s35, s38
  s_add_u32 m0, s35, 24576
  s_xor_b32 s39, s41, 0
  s_lshl_b32 s39, s39, 20
  s_add_u32 s39, s39, s37
  s_add_u32 s35, s39, 0
  buffer_load_dwordx4 v35, s[12:15], s35 offen lds
  s_add_u32 m0, m0, 1024
  s_add_u32 s35, s39, 16384
  buffer_load_dwordx4 v35, s[12:15], s35 offen lds
  s_add_u32 m0, m0, 1024
  s_add_u32 s35, s39, 32768
  buffer_load_dwordx4 v35, s[12:15], s35 offen lds
  s_add_u32 m0, m0, 1024
  s_add_u32 s35, s39, 49152
  buffer_load_dwordx4 v35, s[12:15], s35 offen lds
  s_xor_b32 s35, s40, 4096
  s_add_u32 s35, s35, s38
  s_add_u32 m0, s35, 24576
  s_xor_b32 s39, s41, 1
  s_lshl_b32 s39, s39, 20
  s_add_u32 s39, s39, s37
  s_add_u32 s35, s39, 0
  buffer_load_dwordx4 v35, s[12:15], s35 offen lds
  s_add_u32 m0, m0, 1024
  s_add_u32 s35, s39, 16384
  buffer_load_dwordx4 v35, s[12:15], s35 offen lds
  s_add_u32 m0, m0, 1024
  s_add_u32 s35, s39, 32768
  buffer_load_dwordx4 v35, s[12:15], s35 offen lds
  s_add_u32 m0, m0, 1024
  s_add_u32 s35, s39, 49152
  buffer_load_dwordx4 v35, s[12:15], s35 offen lds
  s_xor_b32 s35, s40, 0
  s_add_u32 s35, s35, s34
  s_add_u32 m0, s35, 0
  s_xor_b32 s39, s41, 0
  s_lshl_b32 s39, s39, 20
  s_add_u32 s39, s39, s37
  s_add_u32 s35, s39, 65536
  buffer_load_dwordx4 v35, s[12:15], s35 offen lds
  s_add_u32 m0, m0, 1024
  s_add_u32 s35, s39, 81920
  buffer_load_dwordx4 v35, s[12:15], s35 offen lds
  s_add_u32 m0, m0, 1024
  s_add_u32 s35, s39, 98304
  buffer_load_dwordx4 v35, s[12:15], s35 offen lds
  s_add_u32 m0, m0, 1024
  s_add_u32 s35, s39, 114688
  buffer_load_dwordx4 v35, s[12:15], s35 offen lds
  s_xor_b32 s35, s40, 4096
  s_add_u32 s35, s35, s34
  s_add_u32 m0, s35, 0
  s_xor_b32 s39, s41, 1
  s_lshl_b32 s39, s39, 20
  s_add_u32 s39, s39, s37
  s_add_u32 s35, s39, 65536
  buffer_load_dwordx4 v35, s[12:15], s35 offen lds
  s_add_u32 m0, m0, 1024
  s_add_u32 s35, s39, 81920
  buffer_load_dwordx4 v35, s[12:15], s35 offen lds
  s_add_u32 m0, m0, 1024
  s_add_u32 s35, s39, 98304
  buffer_load_dwordx4 v35, s[12:15], s35 offen lds
  s_add_u32 m0, m0, 1024
  s_add_u32 s35, s39, 114688
  buffer_load_dwordx4 v35, s[12:15], s35 offen lds
  s_mov_b64 s[60:61], s[36:37]
  v_and_b32 v44, 15, v2
  v_lshrrev_b32 v45, 4, v2
  v_and_b32 v46, 1, v2
  v_lshrrev_b32 v47, 1, v44
  v_cmp_eq_u32 s[52:53], 1, v46
  v_mov_b32 v20, 0x4444
  v_mov_b32 v21, 0xeeee
  v_cndmask_b32 v3, v20, v21, s[52:53]
  v_add_u32 v5, 131072, v1
  s_lshl_b32 s35, s3, 11
  v_add_u32 v18, s35, v5
  s_add_u32 s55, s35, 139264
  v_lshlrev_b32 v17, 11, v45
  v_lshl_add_u32 v17, v44, 4, v17
  s_lshl_b32 s35, s3, 9
  v_add_u32 v17, s35, v17
  s_lshl_b32 s35, s3, 10
  s_add_u32 s35, s35, 155648
  v_add_u32 v19, s35, v1
  s_cmp_ge_u32 s3, 2
  s_cselect_b32 s51, s27, s28
  s_and_b32 s35, s3, 1
  s_lshl_b32 s35, s35, 10
  s_add_u32 s51, s51, s35
  v_lshrrev_b32 v20, 3, v44
  v_lshlrev_b32 v6, 7, v20
  v_lshl_add_u32 v6, v45, 5, v6
  v_and_b32 v20, 7, v44
  v_lshl_add_u32 v6, v20, 1, v6
  s_lshl_b32 s35, s3, 9
  s_add_u32 s35, s35, 155648
  v_add_u32 v6, s35, v6
  v_lshl_add_u32 v20, v45, 3, v47
  v_lshlrev_b32 v7, 4, v20
  v_add_u32 v7, 155648, v7
  v_lshrrev_b32 v20, 2, v44
  v_lshl_add_u32 v20, v20, 1, v46
  v_lshl_add_u32 v21, v45, 3, v20
  v_lshlrev_b32 v8, 4, v21
  v_add_u32 v8, 157696, v8
  v_lshlrev_b32 v9, 8, v46
  v_lshl_add_u32 v9, v47, 5, v9
  v_lshl_add_u32 v9, v45, 3, v9
  s_lshl_b32 s35, s3, 9
  s_add_u32 s35, s35, 159744
  v_add_u32 v9, s35, v9
  v_lshrrev_b32 v20, 2, v44
  v_lshlrev_b32 v10, 14, v20
  v_lshrrev_b32 v20, 1, v45
  v_lshl_add_u32 v10, v20, 13, v10
  v_and_b32 v20, 1, v45
  v_lshl_add_u32 v10, v20, 11, v10
  v_and_b32 v20, 3, v44
  v_lshl_add_u32 v10, v20, 4, v10
  s_lshl_b32 s35, s3, 16
  v_add_u32 v10, s35, v10
  v_bfe_u32 v20, v44, 1, 1
  v_lshlrev_b32 v11, 8, v20
  v_lshl_add_u32 v11, v46, 4, v11
  v_and_b32 v20, 1, v45
  v_lshl_add_u32 v11, v20, 5, v11
  s_lshr_b32 s35, s24, 1
  s_lshl_b32 s35, s35, 9
  s_and_b32 s36, s24, 1
  s_lshl_b32 s36, s36, 7
  s_add_u32 s35, s35, s36
  s_and_b32 s36, s3, 1
  s_lshl_b32 s36, s36, 6
  s_add_u32 s35, s35, s36
  s_lshr_b32 s36, s3, 1
  s_lshl_b32 s36, s36, 3
  s_add_u32 s35, s35, s36
  v_add_u32 v11, s35, v11
  s_mov_b32 s48, 0x000f000f
  s_mov_b32 s49, 0
  v_lshrrev_b32 v20, 2, v44
  v_lshlrev_b32 v12, 7, v20
  v_and_b32 v20, 3, v44
  v_lshl_add_u32 v12, v20, 4, v12
  v_lshl_add_u32 v12, v45, 9, v12
  s_lshl_b32 s35, s3, 11
  v_add_u32 v12, s35, v12
  v_lshrrev_b32 v20, 1, v45
  v_lshlrev_b32 v13, 10, v20
  v_lshl_add_u32 v13, v44, 3, v13
  v_and_b32 v20, 1, v45
  v_lshl_add_u32 v13, v20, 2, v13
  s_lshl_b32 s35, s3, 8
  s_add_u32 s35, s35, 155648
  v_add_u32 v13, s35, v13
  v_lshlrev_b32 v15, 7, v44
  s_lshl_b32 s35, s3, 11
  s_add_u32 s35, s35, 262144
  v_add_u32 v15, s35, v15
  v_and_b32 v20, 1, v45
  v_lshl_add_u32 v15, v20, 25, v15
  v_cmp_eq_u32 vcc, 0, v44
  v_mov_b32 v20, 0x3f80
  s_nop 0
  v_cndmask_b32 v48, 0, v20, vcc
  v_cmp_eq_u32 vcc, 1, v44
  v_mov_b32 v20, 0x3f800000
  s_nop 0
  v_cndmask_b32 v48, v48, v20, vcc
  v_mov_b32 v124, 0x3f803f80
  v_cmp_eq_u32 vcc, 2, v44
  v_mov_b32 v20, 0x3f80
  s_nop 0
  v_cndmask_b32 v49, 0, v20, vcc
  v_cmp_eq_u32 vcc, 3, v44
  v_mov_b32 v20, 0x3f800000
  s_nop 0
  v_cndmask_b32 v49, v49, v20, vcc
  v_mov_b32 v125, 0x3f803f80
  v_cmp_eq_u32 vcc, 4, v44
  v_mov_b32 v20, 0x3f80
  s_nop 0
  v_cndmask_b32 v50, 0, v20, vcc
  v_cmp_eq_u32 vcc, 5, v44
  v_mov_b32 v20, 0x3f800000
  s_nop 0
  v_cndmask_b32 v50, v50, v20, vcc
  v_mov_b32 v126, 0x3f803f80
  v_cmp_eq_u32 vcc, 6, v44
  v_mov_b32 v20, 0x3f80
  s_nop 0
  v_cndmask_b32 v51, 0, v20, vcc
  v_cmp_eq_u32 vcc, 7, v44
  v_mov_b32 v20, 0x3f800000
  s_nop 0
  v_cndmask_b32 v51, v51, v20, vcc
  v_mov_b32 v127, 0x3f803f80
  s_mov_b32 s54, 0x3e0293ee
  v_lshlrev_b32 v14, 6, v46
  v_lshlrev_b32 v22, 10, v47
  v_lshl_add_u32 v20, v45, 1, v46
  v_lshl_add_u32 v22, v20, 1, v22
  s_lshl_b32 s35, s3, 8
  v_add_u32 v22, s35, v22
  buffer_load_ushort v96, v22, s[44:47], 0 offen offset:0
  buffer_load_ushort v97, v22, s[44:47], 0 offen offset:32
  buffer_load_ushort v98, v22, s[44:47], 0 offen offset:64
  buffer_load_ushort v99, v22, s[44:47], 0 offen offset:96
  buffer_load_ushort v100, v22, s[44:47], 0 offen offset:128
  buffer_load_ushort v101, v22, s[44:47], 0 offen offset:160
  buffer_load_ushort v102, v22, s[44:47], 0 offen offset:192
  buffer_load_ushort v103, v22, s[44:47], 0 offen offset:224
  buffer_load_ushort v104, v22, s[44:47], 0 offen offset:16
  buffer_load_ushort v105, v22, s[44:47], 0 offen offset:48
  buffer_load_ushort v106, v22, s[44:47], 0 offen offset:80
  buffer_load_ushort v107, v22, s[44:47], 0 offen offset:112
  buffer_load_ushort v108, v22, s[44:47], 0 offen offset:144
  buffer_load_ushort v109, v22, s[44:47], 0 offen offset:176
  buffer_load_ushort v110, v22, s[44:47], 0 offen offset:208
  buffer_load_ushort v111, v22, s[44:47], 0 offen offset:240
  s_mov_b64 s[36:37], s[60:61]
  s_waitcnt vmcnt(48)
  ds_read_b64_tr_b16 a[0:1], v37 offset:0
  ds_read_b64_tr_b16 a[2:3], v37 offset:512
  ds_read_b64_tr_b16 a[4:5], v37 offset:2048
  ds_read_b64_tr_b16 a[6:7], v37 offset:2560
  ds_read_b64_tr_b16 a[8:9], v38 offset:0
  ds_read_b64_tr_b16 a[10:11], v38 offset:512
  ds_read_b64_tr_b16 a[12:13], v38 offset:2048
  ds_read_b64_tr_b16 a[14:15], v38 offset:2560
  s_waitcnt lgkmcnt(0)
  ds_read_b64_tr_b16 a[16:17], v37 offset:4096
  ds_read_b64_tr_b16 a[18:19], v37 offset:4608
  ds_read_b64_tr_b16 a[20:21], v37 offset:6144
  ds_read_b64_tr_b16 a[22:23], v37 offset:6656
  ds_read_b64_tr_b16 a[24:25], v38 offset:4096
  ds_read_b64_tr_b16 a[26:27], v38 offset:4608
  ds_read_b64_tr_b16 a[28:29], v38 offset:6144
  ds_read_b64_tr_b16 a[30:31], v38 offset:6656
  s_waitcnt lgkmcnt(0)
  s_xor_b32 s35, s40, 0
  s_add_u32 s35, s35, s38
  s_add_u32 m0, s35, 0
  s_xor_b32 s39, s41, 2
  s_lshl_b32 s39, s39, 20
  s_add_u32 s39, s39, s37
  s_add_u32 s35, s39, 65536
  buffer_load_dwordx4 v35, s[12:15], s35 offen lds
  s_add_u32 m0, m0, 1024
  s_add_u32 s35, s39, 81920
  buffer_load_dwordx4 v35, s[12:15], s35 offen lds
  s_add_u32 m0, m0, 1024
  s_add_u32 s35, s39, 98304
  buffer_load_dwordx4 v35, s[12:15], s35 offen lds
  s_add_u32 m0, m0, 1024
  s_add_u32 s35, s39, 114688
  buffer_load_dwordx4 v35, s[12:15], s35 offen lds
  s_xor_b32 s35, s40, 4096
  s_add_u32 s35, s35, s38
  s_add_u32 m0, s35, 0
  s_xor_b32 s39, s41, 3
  s_lshl_b32 s39, s39, 20
  s_add_u32 s39, s39, s37
  s_add_u32 s35, s39, 65536
  buffer_load_dwordx4 v35, s[12:15], s35 offen lds
  s_add_u32 m0, m0, 1024
  s_add_u32 s35, s39, 81920
  buffer_load_dwordx4 v35, s[12:15], s35 offen lds
  s_add_u32 m0, m0, 1024
  s_add_u32 s35, s39, 98304
  buffer_load_dwordx4 v35, s[12:15], s35 offen lds
  s_add_u32 m0, m0, 1024
  s_add_u32 s35, s39, 114688
  buffer_load_dwordx4 v35, s[12:15], s35 offen lds
  s_waitcnt vmcnt(48)
  ds_read_b64_tr_b16 a[32:33], v37 offset:8192
  ds_read_b64_tr_b16 a[34:35], v37 offset:8704
  ds_read_b64_tr_b16 a[36:37], v37 offset:10240
  ds_read_b64_tr_b16 a[38:39], v37 offset:10752
  ds_read_b64_tr_b16 a[40:41], v38 offset:8192
  ds_read_b64_tr_b16 a[42:43], v38 offset:8704
  ds_read_b64_tr_b16 a[44:45], v38 offset:10240
  ds_read_b64_tr_b16 a[46:47], v38 offset:10752
  s_waitcnt lgkmcnt(0)
  ds_read_b64_tr_b16 a[48:49], v37 offset:12288
  ds_read_b64_tr_b16 a[50:51], v37 offset:12800
  ds_read_b64_tr_b16 a[52:53], v37 offset:14336
  ds_read_b64_tr_b16 a[54:55], v37 offset:14848
  ds_read_b64_tr_b16 a[56:57], v38 offset:12288
  ds_read_b64_tr_b16 a[58:59], v38 offset:12800
  ds_read_b64_tr_b16 a[60:61], v38 offset:14336
  ds_read_b64_tr_b16 a[62:63], v38 offset:14848
  s_waitcnt lgkmcnt(0)
  s_xor_b32 s35, s40, 0
  s_add_u32 s35, s35, s38
  s_add_u32 m0, s35, 8192
  s_xor_b32 s39, s41, 0
  s_lshl_b32 s39, s39, 20
  s_add_u32 s39, s39, s37
  s_add_u32 s35, s39, 0
  buffer_load_dwordx4 v35, s[16:19], s35 offen lds
  s_add_u32 m0, m0, 1024
  s_add_u32 s35, s39, 16384
  buffer_load_dwordx4 v35, s[16:19], s35 offen lds
  s_add_u32 m0, m0, 1024
  s_add_u32 s35, s39, 32768
  buffer_load_dwordx4 v35, s[16:19], s35 offen lds
  s_add_u32 m0, m0, 1024
  s_add_u32 s35, s39, 49152
  buffer_load_dwordx4 v35, s[16:19], s35 offen lds
  s_xor_b32 s35, s40, 4096
  s_add_u32 s35, s35, s38
  s_add_u32 m0, s35, 8192
  s_xor_b32 s39, s41, 1
  s_lshl_b32 s39, s39, 20
  s_add_u32 s39, s39, s37
  s_add_u32 s35, s39, 0
  buffer_load_dwordx4 v35, s[16:19], s35 offen lds
  s_add_u32 m0, m0, 1024
  s_add_u32 s35, s39, 16384
  buffer_load_dwordx4 v35, s[16:19], s35 offen lds
  s_add_u32 m0, m0, 1024
  s_add_u32 s35, s39, 32768
  buffer_load_dwordx4 v35, s[16:19], s35 offen lds
  s_add_u32 m0, m0, 1024
  s_add_u32 s35, s39, 49152
  buffer_load_dwordx4 v35, s[16:19], s35 offen lds
  s_waitcnt vmcnt(48)
  ds_read_b64_tr_b16 a[64:65], v37 offset:16384
  ds_read_b64_tr_b16 a[66:67], v37 offset:16896
  ds_read_b64_tr_b16 a[68:69], v37 offset:18432
  ds_read_b64_tr_b16 a[70:71], v37 offset:18944
  ds_read_b64_tr_b16 a[72:73], v38 offset:16384
  ds_read_b64_tr_b16 a[74:75], v38 offset:16896
  ds_read_b64_tr_b16 a[76:77], v38 offset:18432
  ds_read_b64_tr_b16 a[78:79], v38 offset:18944
  s_waitcnt lgkmcnt(0)
  ds_read_b64_tr_b16 a[80:81], v37 offset:20480
  ds_read_b64_tr_b16 a[82:83], v37 offset:20992
  ds_read_b64_tr_b16 a[84:85], v37 offset:22528
  ds_read_b64_tr_b16 a[86:87], v37 offset:23040
  ds_read_b64_tr_b16 a[88:89], v38 offset:20480
  ds_read_b64_tr_b16 a[90:91], v38 offset:20992
  ds_read_b64_tr_b16 a[92:93], v38 offset:22528
  ds_read_b64_tr_b16 a[94:95], v38 offset:23040
  s_waitcnt lgkmcnt(0)
  s_xor_b32 s35, s40, 0
  s_add_u32 s35, s35, s38
  s_add_u32 m0, s35, 16384
  s_xor_b32 s39, s41, 0
  s_lshl_b32 s39, s39, 20
  s_add_u32 s39, s39, s37
  s_add_u32 s35, s39, 65536
  buffer_load_dwordx4 v35, s[16:19], s35 offen lds
  s_add_u32 m0, m0, 1024
  s_add_u32 s35, s39, 81920
  buffer_load_dwordx4 v35, s[16:19], s35 offen lds
  s_add_u32 m0, m0, 1024
  s_add_u32 s35, s39, 98304
  buffer_load_dwordx4 v35, s[16:19], s35 offen lds
  s_add_u32 m0, m0, 1024
  s_add_u32 s35, s39, 114688
  buffer_load_dwordx4 v35, s[16:19], s35 offen lds
  s_xor_b32 s35, s40, 4096
  s_add_u32 s35, s35, s38
  s_add_u32 m0, s35, 16384
  s_xor_b32 s39, s41, 1
  s_lshl_b32 s39, s39, 20
  s_add_u32 s39, s39, s37
  s_add_u32 s35, s39, 65536
  buffer_load_dwordx4 v35, s[16:19], s35 offen lds
  s_add_u32 m0, m0, 1024
  s_add_u32 s35, s39, 81920
  buffer_load_dwordx4 v35, s[16:19], s35 offen lds
  s_add_u32 m0, m0, 1024
  s_add_u32 s35, s39, 98304
  buffer_load_dwordx4 v35, s[16:19], s35 offen lds
  s_add_u32 m0, m0, 1024
  s_add_u32 s35, s39, 114688
  buffer_load_dwordx4 v35, s[16:19], s35 offen lds
  s_waitcnt vmcnt(48)
  ds_read_b64_tr_b16 a[96:97], v37 offset:24576
  ds_read_b64_tr_b16 a[98:99], v37 offset:25088
  ds_read_b64_tr_b16 a[100:101], v37 offset:26624
  ds_read_b64_tr_b16 a[102:103], v37 offset:27136
  ds_read_b64_tr_b16 a[104:105], v38 offset:24576
  ds_read_b64_tr_b16 a[106:107], v38 offset:25088
  ds_read_b64_tr_b16 a[108:109], v38 offset:26624
  ds_read_b64_tr_b16 a[110:111], v38 offset:27136
  s_waitcnt lgkmcnt(0)
  ds_read_b64_tr_b16 a[112:113], v37 offset:28672
  ds_read_b64_tr_b16 a[114:115], v37 offset:29184
  ds_read_b64_tr_b16 a[116:117], v37 offset:30720
  ds_read_b64_tr_b16 a[118:119], v37 offset:31232
  ds_read_b64_tr_b16 a[120:121], v38 offset:28672
  ds_read_b64_tr_b16 a[122:123], v38 offset:29184
  ds_read_b64_tr_b16 a[124:125], v38 offset:30720
  ds_read_b64_tr_b16 a[126:127], v38 offset:31232
  s_waitcnt lgkmcnt(0)
  s_xor_b32 s35, s40, 0
  s_add_u32 s35, s35, s38
  s_add_u32 m0, s35, 24576
  s_xor_b32 s39, s41, 2
  s_lshl_b32 s39, s39, 20
  s_add_u32 s39, s39, s37
  s_add_u32 s35, s39, 0
  buffer_load_dwordx4 v35, s[16:19], s35 offen lds
  s_add_u32 m0, m0, 1024
  s_add_u32 s35, s39, 16384
  buffer_load_dwordx4 v35, s[16:19], s35 offen lds
  s_add_u32 m0, m0, 1024
  s_add_u32 s35, s39, 32768
  buffer_load_dwordx4 v35, s[16:19], s35 offen lds
  s_add_u32 m0, m0, 1024
  s_add_u32 s35, s39, 49152
  buffer_load_dwordx4 v35, s[16:19], s35 offen lds
  s_xor_b32 s35, s40, 4096
  s_add_u32 s35, s35, s38
  s_add_u32 m0, s35, 24576
  s_xor_b32 s39, s41, 3
  s_lshl_b32 s39, s39, 20
  s_add_u32 s39, s39, s37
  s_add_u32 s35, s39, 0
  buffer_load_dwordx4 v35, s[16:19], s35 offen lds
  s_add_u32 m0, m0, 1024
  s_add_u32 s35, s39, 16384
  buffer_load_dwordx4 v35, s[16:19], s35 offen lds
  s_add_u32 m0, m0, 1024
  s_add_u32 s35, s39, 32768
  buffer_load_dwordx4 v35, s[16:19], s35 offen lds
  s_add_u32 m0, m0, 1024
  s_add_u32 s35, s39, 49152
  buffer_load_dwordx4 v35, s[16:19], s35 offen lds
  s_waitcnt vmcnt(48)
  ds_read_b64_tr_b16 a[128:129], v39 offset:0
  ds_read_b64_tr_b16 a[130:131], v39 offset:512
  ds_read_b64_tr_b16 a[132:133], v39 offset:2048
  ds_read_b64_tr_b16 a[134:135], v39 offset:2560
  ds_read_b64_tr_b16 a[136:137], v40 offset:0
  ds_read_b64_tr_b16 a[138:139], v40 offset:512
  ds_read_b64_tr_b16 a[140:141], v40 offset:2048
  ds_read_b64_tr_b16 a[142:143], v40 offset:2560
  s_waitcnt lgkmcnt(0)
  ds_read_b64_tr_b16 a[144:145], v39 offset:4096
  ds_read_b64_tr_b16 a[146:147], v39 offset:4608
  ds_read_b64_tr_b16 a[148:149], v39 offset:6144
  ds_read_b64_tr_b16 a[150:151], v39 offset:6656
  ds_read_b64_tr_b16 a[152:153], v40 offset:4096
  ds_read_b64_tr_b16 a[154:155], v40 offset:4608
  ds_read_b64_tr_b16 a[156:157], v40 offset:6144
  ds_read_b64_tr_b16 a[158:159], v40 offset:6656
  s_waitcnt lgkmcnt(0)
  s_xor_b32 s35, s40, 0
  s_add_u32 s35, s35, s34
  s_add_u32 m0, s35, 0
  s_xor_b32 s39, s41, 2
  s_lshl_b32 s39, s39, 20
  s_add_u32 s39, s39, s37
  s_add_u32 s35, s39, 65536
  buffer_load_dwordx4 v35, s[16:19], s35 offen lds
  s_add_u32 m0, m0, 1024
  s_add_u32 s35, s39, 81920
  buffer_load_dwordx4 v35, s[16:19], s35 offen lds
  s_add_u32 m0, m0, 1024
  s_add_u32 s35, s39, 98304
  buffer_load_dwordx4 v35, s[16:19], s35 offen lds
  s_add_u32 m0, m0, 1024
  s_add_u32 s35, s39, 114688
  buffer_load_dwordx4 v35, s[16:19], s35 offen lds
  s_xor_b32 s35, s40, 4096
  s_add_u32 s35, s35, s34
  s_add_u32 m0, s35, 0
  s_xor_b32 s39, s41, 3
  s_lshl_b32 s39, s39, 20
  s_add_u32 s39, s39, s37
  s_add_u32 s35, s39, 65536
  buffer_load_dwordx4 v35, s[16:19], s35 offen lds
  s_add_u32 m0, m0, 1024
  s_add_u32 s35, s39, 81920
  buffer_load_dwordx4 v35, s[16:19], s35 offen lds
  s_add_u32 m0, m0, 1024
  s_add_u32 s35, s39, 98304
  buffer_load_dwordx4 v35, s[16:19], s35 offen lds
  s_add_u32 m0, m0, 1024
  s_add_u32 s35, s39, 114688
  buffer_load_dwordx4 v35, s[16:19], s35 offen lds
  s_waitcnt vmcnt(32)
  ds_read_b64_tr_b16 a[160:161], v37 offset:0
  ds_read_b64_tr_b16 a[162:163], v37 offset:512
  ds_read_b64_tr_b16 a[164:165], v37 offset:2048
  ds_read_b64_tr_b16 a[166:167], v37 offset:2560
  ds_read_b64_tr_b16 a[168:169], v38 offset:0
  ds_read_b64_tr_b16 a[170:171], v38 offset:512
  ds_read_b64_tr_b16 a[172:173], v38 offset:2048
  ds_read_b64_tr_b16 a[174:175], v38 offset:2560
  s_waitcnt lgkmcnt(0)
  ds_read_b64_tr_b16 a[176:177], v37 offset:4096
  ds_read_b64_tr_b16 a[178:179], v37 offset:4608
  ds_read_b64_tr_b16 a[180:181], v37 offset:6144
  ds_read_b64_tr_b16 a[182:183], v37 offset:6656
  ds_read_b64_tr_b16 a[184:185], v38 offset:4096
  ds_read_b64_tr_b16 a[186:187], v38 offset:4608
  ds_read_b64_tr_b16 a[188:189], v38 offset:6144
  ds_read_b64_tr_b16 a[190:191], v38 offset:6656
  s_waitcnt lgkmcnt(0)
  s_add_u32 m0, s38, 0
  s_add_u32 s35, s36, 64
  buffer_load_dwordx4 v36, s[20:23], s35 offen lds
  s_add_u32 m0, m0, 1024
  s_add_u32 s35, s36, 16448
  buffer_load_dwordx4 v36, s[20:23], s35 offen lds
  s_add_u32 m0, m0, 1024
  s_add_u32 s35, s36, 32832
  buffer_load_dwordx4 v36, s[20:23], s35 offen lds
  s_add_u32 m0, m0, 1024
  s_add_u32 s35, s36, 49216
  buffer_load_dwordx4 v36, s[20:23], s35 offen lds
  s_add_u32 m0, s38, 4096
  s_add_u32 s35, s36, 65600
  buffer_load_dwordx4 v36, s[20:23], s35 offen lds
  s_add_u32 m0, m0, 1024
  s_add_u32 s35, s36, 81984
  buffer_load_dwordx4 v36, s[20:23], s35 offen lds
  s_add_u32 m0, m0, 1024
  s_add_u32 s35, s36, 98368
  buffer_load_dwordx4 v36, s[20:23], s35 offen lds
  s_add_u32 m0, m0, 1024
  s_add_u32 s35, s36, 114752
  buffer_load_dwordx4 v36, s[20:23], s35 offen lds
  s_waitcnt vmcnt(32)
  ds_read_b64_tr_b16 a[192:193], v37 offset:8192
  ds_read_b64_tr_b16 a[194:195], v37 offset:8704
  ds_read_b64_tr_b16 a[196:197], v37 offset:10240
  ds_read_b64_tr_b16 a[198:199], v37 offset:10752
  ds_read_b64_tr_b16 a[200:201], v38 offset:8192
  ds_read_b64_tr_b16 a[202:203], v38 offset:8704
  ds_read_b64_tr_b16 a[204:205], v38 offset:10240
  ds_read_b64_tr_b16 a[206:207], v38 offset:10752
  s_waitcnt lgkmcnt(0)
  ds_read_b64_tr_b16 a[208:209], v37 offset:12288
  ds_read_b64_tr_b16 a[210:211], v37 offset:12800
  ds_read_b64_tr_b16 a[212:213], v37 offset:14336
  ds_read_b64_tr_b16 a[214:215], v37 offset:14848
  ds_read_b64_tr_b16 a[216:217], v38 offset:12288
  ds_read_b64_tr_b16 a[218:219], v38 offset:12800
  ds_read_b64_tr_b16 a[220:221], v38 offset:14336
  ds_read_b64_tr_b16 a[222:223], v38 offset:14848
  s_waitcnt lgkmcnt(0)
  s_add_u32 m0, s38, 8192
  s_add_u32 s35, s36, 128
  buffer_load_dwordx4 v36, s[20:23], s35 offen lds
  s_add_u32 m0, m0, 1024
  s_add_u32 s35, s36, 16512
  buffer_load_dwordx4 v36, s[20:23], s35 offen lds
  s_add_u32 m0, m0, 1024
  s_add_u32 s35, s36, 32896
  buffer_load_dwordx4 v36, s[20:23], s35 offen lds
  s_add_u32 m0, m0, 1024
  s_add_u32 s35, s36, 49280
  buffer_load_dwordx4 v36, s[20:23], s35 offen lds
  s_add_u32 m0, s38, 12288
  s_add_u32 s35, s36, 65664
  buffer_load_dwordx4 v36, s[20:23], s35 offen lds
  s_add_u32 m0, m0, 1024
  s_add_u32 s35, s36, 82048
  buffer_load_dwordx4 v36, s[20:23], s35 offen lds
  s_add_u32 m0, m0, 1024
  s_add_u32 s35, s36, 98432
  buffer_load_dwordx4 v36, s[20:23], s35 offen lds
  s_add_u32 m0, m0, 1024
  s_add_u32 s35, s36, 114816
  buffer_load_dwordx4 v36, s[20:23], s35 offen lds
  s_waitcnt vmcnt(32)
  ds_read_b64_tr_b16 a[224:225], v37 offset:16384
  ds_read_b64_tr_b16 a[226:227], v37 offset:16896
  ds_read_b64_tr_b16 a[228:229], v37 offset:18432
  ds_read_b64_tr_b16 a[230:231], v37 offset:18944
  ds_read_b64_tr_b16 a[232:233], v38 offset:16384
  ds_read_b64_tr_b16 a[234:235], v38 offset:16896
  ds_read_b64_tr_b16 a[236:237], v38 offset:18432
  ds_read_b64_tr_b16 a[238:239], v38 offset:18944
  s_waitcnt lgkmcnt(0)
  ds_read_b64_tr_b16 a[240:241], v37 offset:20480
  ds_read_b64_tr_b16 a[242:243], v37 offset:20992
  ds_read_b64_tr_b16 a[244:245], v37 offset:22528
  ds_read_b64_tr_b16 a[246:247], v37 offset:23040
  ds_read_b64_tr_b16 a[248:249], v38 offset:20480
  ds_read_b64_tr_b16 a[250:251], v38 offset:20992
  ds_read_b64_tr_b16 a[252:253], v38 offset:22528
  ds_read_b64_tr_b16 a[254:255], v38 offset:23040
  s_waitcnt lgkmcnt(0)
  s_add_u32 m0, s38, 16384
  s_add_u32 s35, s36, 0
  buffer_load_dwordx4 v36, s[20:23], s35 offen lds
  s_add_u32 m0, m0, 1024
  s_add_u32 s35, s36, 16384
  buffer_load_dwordx4 v36, s[20:23], s35 offen lds
  s_add_u32 m0, m0, 1024
  s_add_u32 s35, s36, 32768
  buffer_load_dwordx4 v36, s[20:23], s35 offen lds
  s_add_u32 m0, m0, 1024
  s_add_u32 s35, s36, 49152
  buffer_load_dwordx4 v36, s[20:23], s35 offen lds
  s_add_u32 m0, s38, 20480
  s_add_u32 s35, s36, 65536
  buffer_load_dwordx4 v36, s[20:23], s35 offen lds
  s_add_u32 m0, m0, 1024
  s_add_u32 s35, s36, 81920
  buffer_load_dwordx4 v36, s[20:23], s35 offen lds
  s_add_u32 m0, m0, 1024
  s_add_u32 s35, s36, 98304
  buffer_load_dwordx4 v36, s[20:23], s35 offen lds
  s_add_u32 m0, m0, 1024
  s_add_u32 s35, s36, 114688
  buffer_load_dwordx4 v36, s[20:23], s35 offen lds
  s_waitcnt vmcnt(32)
  ds_read_b64_tr_b16 v[128:129], v37 offset:24576
  ds_read_b64_tr_b16 v[130:131], v37 offset:25088
  ds_read_b64_tr_b16 v[132:133], v37 offset:26624
  ds_read_b64_tr_b16 v[134:135], v37 offset:27136
  ds_read_b64_tr_b16 v[136:137], v38 offset:24576
  ds_read_b64_tr_b16 v[138:139], v38 offset:25088
  ds_read_b64_tr_b16 v[140:141], v38 offset:26624
  ds_read_b64_tr_b16 v[142:143], v38 offset:27136
  s_waitcnt lgkmcnt(0)
  ds_read_b64_tr_b16 v[144:145], v37 offset:28672
  ds_read_b64_tr_b16 v[146:147], v37 offset:29184
  ds_read_b64_tr_b16 v[148:149], v37 offset:30720
  ds_read_b64_tr_b16 v[150:151], v37 offset:31232
  ds_read_b64_tr_b16 v[152:153], v38 offset:28672
  ds_read_b64_tr_b16 v[154:155], v38 offset:29184
  ds_read_b64_tr_b16 v[156:157], v38 offset:30720
  ds_read_b64_tr_b16 v[158:159], v38 offset:31232
  s_waitcnt lgkmcnt(0)
  s_add_u32 m0, s38, 24576
  s_add_u32 s35, s36, 192
  buffer_load_dwordx4 v36, s[20:23], s35 offen lds
  s_add_u32 m0, m0, 1024
  s_add_u32 s35, s36, 16576
  buffer_load_dwordx4 v36, s[20:23], s35 offen lds
  s_add_u32 m0, m0, 1024
  s_add_u32 s35, s36, 32960
  buffer_load_dwordx4 v36, s[20:23], s35 offen lds
  s_add_u32 m0, m0, 1024
  s_add_u32 s35, s36, 49344
  buffer_load_dwordx4 v36, s[20:23], s35 offen lds
  s_add_u32 m0, s38, 28672
  s_add_u32 s35, s36, 65728
  buffer_load_dwordx4 v36, s[20:23], s35 offen lds
  s_add_u32 m0, m0, 1024
  s_add_u32 s35, s36, 82112
  buffer_load_dwordx4 v36, s[20:23], s35 offen lds
  s_add_u32 m0, m0, 1024
  s_add_u32 s35, s36, 98496
  buffer_load_dwordx4 v36, s[20:23], s35 offen lds
  s_add_u32 m0, m0, 1024
  s_add_u32 s35, s36, 114880
  buffer_load_dwordx4 v36, s[20:23], s35 offen lds
  s_waitcnt vmcnt(32)
  ds_read_b64_tr_b16 v[160:161], v39 offset:0
  ds_read_b64_tr_b16 v[162:163], v39 offset:512
  ds_read_b64_tr_b16 v[164:165], v39 offset:2048
  ds_read_b64_tr_b16 v[166:167], v39 offset:2560
  ds_read_b64_tr_b16 v[168:169], v40 offset:0
  ds_read_b64_tr_b16 v[170:171], v40 offset:512
  ds_read_b64_tr_b16 v[172:173], v40 offset:2048
  ds_read_b64_tr_b16 v[174:175], v40 offset:2560
  s_waitcnt lgkmcnt(0)
  ds_read_b64_tr_b16 v[176:177], v39 offset:4096
  ds_read_b64_tr_b16 v[178:179], v39 offset:4608
  ds_read_b64_tr_b16 v[180:181], v39 offset:6144
  ds_read_b64_tr_b16 v[182:183], v39 offset:6656
  ds_read_b64_tr_b16 v[184:185], v40 offset:4096
  ds_read_b64_tr_b16 v[186:187], v40 offset:4608
  ds_read_b64_tr_b16 v[188:189], v40 offset:6144
  ds_read_b64_tr_b16 v[190:191], v40 offset:6656
  s_waitcnt lgkmcnt(0)
  s_waitcnt vmcnt(24)
  ds_read_b64_tr_b16 v[192:193], v37 offset:0
  ds_read_b64_tr_b16 v[194:195], v37 offset:512
  ds_read_b64_tr_b16 v[196:197], v37 offset:2048
  ds_read_b64_tr_b16 v[198:199], v37 offset:2560
  ds_read_b64_tr_b16 v[200:201], v38 offset:0
  ds_read_b64_tr_b16 v[202:203], v38 offset:512
  ds_read_b64_tr_b16 v[204:205], v38 offset:2048
  ds_read_b64_tr_b16 v[206:207], v38 offset:2560
  s_waitcnt lgkmcnt(0)
  ds_read_b64_tr_b16 v[208:209], v37 offset:4096
  ds_read_b64_tr_b16 v[210:211], v37 offset:4608
  ds_read_b64_tr_b16 v[212:213], v37 offset:6144
  ds_read_b64_tr_b16 v[214:215], v37 offset:6656
  ds_read_b64_tr_b16 v[216:217], v38 offset:4096
  ds_read_b64_tr_b16 v[218:219], v38 offset:4608
  ds_read_b64_tr_b16 v[220:221], v38 offset:6144
  ds_read_b64_tr_b16 v[222:223], v38 offset:6656
  s_waitcnt lgkmcnt(0)
  s_xor_b32 s35, s40, 0
  s_add_u32 s35, s35, s38
  s_add_u32 m0, s35, 0
  s_xor_b32 s39, s41, 2
  s_lshl_b32 s39, s39, 20
  s_add_u32 s39, s39, s37
  s_add_u32 s35, s39, 0
  buffer_load_dwordx4 v35, s[8:11], s35 offen lds
  s_add_u32 m0, m0, 1024
  s_add_u32 s35, s39, 16384
  buffer_load_dwordx4 v35, s[8:11], s35 offen lds
  s_add_u32 m0, m0, 1024
  s_add_u32 s35, s39, 32768
  buffer_load_dwordx4 v35, s[8:11], s35 offen lds
  s_add_u32 m0, m0, 1024
  s_add_u32 s35, s39, 49152
  buffer_load_dwordx4 v35, s[8:11], s35 offen lds
  s_xor_b32 s35, s40, 4096
  s_add_u32 s35, s35, s38
  s_add_u32 m0, s35, 0
  s_xor_b32 s39, s41, 3
  s_lshl_b32 s39, s39, 20
  s_add_u32 s39, s39, s37
  s_add_u32 s35, s39, 0
  buffer_load_dwordx4 v35, s[8:11], s35 offen lds
  s_add_u32 m0, m0, 1024
  s_add_u32 s35, s39, 16384
  buffer_load_dwordx4 v35, s[8:11], s35 offen lds
  s_add_u32 m0, m0, 1024
  s_add_u32 s35, s39, 32768
  buffer_load_dwordx4 v35, s[8:11], s35 offen lds
  s_add_u32 m0, m0, 1024
  s_add_u32 s35, s39, 49152
  buffer_load_dwordx4 v35, s[8:11], s35 offen lds
  s_waitcnt vmcnt(24)
  ds_read_b64_tr_b16 v[224:225], v37 offset:8192
  ds_read_b64_tr_b16 v[226:227], v37 offset:8704
  ds_read_b64_tr_b16 v[228:229], v37 offset:10240
  ds_read_b64_tr_b16 v[230:231], v37 offset:10752
  ds_read_b64_tr_b16 v[232:233], v38 offset:8192
  ds_read_b64_tr_b16 v[234:235], v38 offset:8704
  ds_read_b64_tr_b16 v[236:237], v38 offset:10240
  ds_read_b64_tr_b16 v[238:239], v38 offset:10752
  s_waitcnt lgkmcnt(0)
  ds_read_b64_tr_b16 v[240:241], v37 offset:12288
  ds_read_b64_tr_b16 v[242:243], v37 offset:12800
  ds_read_b64_tr_b16 v[244:245], v37 offset:14336
  ds_read_b64_tr_b16 v[246:247], v37 offset:14848
  ds_read_b64_tr_b16 v[248:249], v38 offset:12288
  ds_read_b64_tr_b16 v[250:251], v38 offset:12800
  ds_read_b64_tr_b16 v[252:253], v38 offset:14336
  ds_read_b64_tr_b16 v[254:255], v38 offset:14848
  s_waitcnt lgkmcnt(0)
  s_xor_b32 s35, s40, 0
  s_add_u32 s35, s35, s38
  s_add_u32 m0, s35, 8192
  s_xor_b32 s39, s41, 2
  s_lshl_b32 s39, s39, 20
  s_add_u32 s39, s39, s37
  s_add_u32 s35, s39, 0
  buffer_load_dwordx4 v35, s[12:15], s35 offen lds
  s_add_u32 m0, m0, 1024
  s_add_u32 s35, s39, 16384
  buffer_load_dwordx4 v35, s[12:15], s35 offen lds
  s_add_u32 m0, m0, 1024
  s_add_u32 s35, s39, 32768
  buffer_load_dwordx4 v35, s[12:15], s35 offen lds
  s_add_u32 m0, m0, 1024
  s_add_u32 s35, s39, 49152
  buffer_load_dwordx4 v35, s[12:15], s35 offen lds
  s_xor_b32 s35, s40, 4096
  s_add_u32 s35, s35, s38
  s_add_u32 m0, s35, 8192
  s_xor_b32 s39, s41, 3
  s_lshl_b32 s39, s39, 20
  s_add_u32 s39, s39, s37
  s_add_u32 s35, s39, 0
  buffer_load_dwordx4 v35, s[12:15], s35 offen lds
  s_add_u32 m0, m0, 1024
  s_add_u32 s35, s39, 16384
  buffer_load_dwordx4 v35, s[12:15], s35 offen lds
  s_add_u32 m0, m0, 1024
  s_add_u32 s35, s39, 32768
  buffer_load_dwordx4 v35, s[12:15], s35 offen lds
  s_add_u32 m0, m0, 1024
  s_add_u32 s35, s39, 49152
  buffer_load_dwordx4 v35, s[12:15], s35 offen lds
  s_waitcnt vmcnt(24)
  ds_read_b64_tr_b16 v[64:65], v37 offset:16384
  ds_read_b64_tr_b16 v[66:67], v37 offset:16896
  ds_read_b64_tr_b16 v[68:69], v37 offset:18432
  ds_read_b64_tr_b16 v[70:71], v37 offset:18944
  ds_read_b64_tr_b16 v[72:73], v38 offset:16384
  ds_read_b64_tr_b16 v[74:75], v38 offset:16896
  ds_read_b64_tr_b16 v[76:77], v38 offset:18432
  ds_read_b64_tr_b16 v[78:79], v38 offset:18944
  s_waitcnt lgkmcnt(0)
  ds_write_b128 v4, v[64:67] offset:16384
  ds_write_b128 v4, v[68:71] offset:17408
  ds_write_b128 v4, v[72:75] offset:18432
  ds_write_b128 v4, v[76:79] offset:19456
  s_waitcnt lgkmcnt(0)
  ds_read_b64_tr_b16 v[64:65], v37 offset:20480
  ds_read_b64_tr_b16 v[66:67], v37 offset:20992
  ds_read_b64_tr_b16 v[68:69], v37 offset:22528
  ds_read_b64_tr_b16 v[70:71], v37 offset:23040
  ds_read_b64_tr_b16 v[72:73], v38 offset:20480
  ds_read_b64_tr_b16 v[74:75], v38 offset:20992
  ds_read_b64_tr_b16 v[76:77], v38 offset:22528
  ds_read_b64_tr_b16 v[78:79], v38 offset:23040
  s_waitcnt lgkmcnt(0)
  ds_write_b128 v4, v[64:67] offset:20480
  ds_write_b128 v4, v[68:71] offset:21504
  ds_write_b128 v4, v[72:75] offset:22528
  ds_write_b128 v4, v[76:79] offset:23552
  s_waitcnt lgkmcnt(0)
  s_waitcnt vmcnt(16)
  ds_read_b64_tr_b16 v[64:65], v37 offset:24576
  ds_read_b64_tr_b16 v[66:67], v37 offset:25088
  ds_read_b64_tr_b16 v[68:69], v37 offset:26624
  ds_read_b64_tr_b16 v[70:71], v37 offset:27136
  ds_read_b64_tr_b16 v[72:73], v38 offset:24576
  ds_read_b64_tr_b16 v[74:75], v38 offset:25088
  ds_read_b64_tr_b16 v[76:77], v38 offset:26624
  ds_read_b64_tr_b16 v[78:79], v38 offset:27136
  s_waitcnt lgkmcnt(0)
  ds_write_b128 v4, v[64:67] offset:24576
  ds_write_b128 v4, v[68:71] offset:25600
  ds_write_b128 v4, v[72:75] offset:26624
  ds_write_b128 v4, v[76:79] offset:27648
  s_waitcnt lgkmcnt(0)
  ds_read_b64_tr_b16 v[64:65], v37 offset:28672
  ds_read_b64_tr_b16 v[66:67], v37 offset:29184
  ds_read_b64_tr_b16 v[68:69], v37 offset:30720
  ds_read_b64_tr_b16 v[70:71], v37 offset:31232
  ds_read_b64_tr_b16 v[72:73], v38 offset:28672
  ds_read_b64_tr_b16 v[74:75], v38 offset:29184
  ds_read_b64_tr_b16 v[76:77], v38 offset:30720
  ds_read_b64_tr_b16 v[78:79], v38 offset:31232
  s_waitcnt lgkmcnt(0)
  ds_write_b128 v4, v[64:67] offset:28672
  ds_write_b128 v4, v[68:71] offset:29696
  ds_write_b128 v4, v[72:75] offset:30720
  ds_write_b128 v4, v[76:79] offset:31744
  s_waitcnt lgkmcnt(0)
  s_waitcnt vmcnt(8)
  ds_read_b64_tr_b16 v[64:65], v37 offset:0
  ds_read_b64_tr_b16 v[66:67], v37 offset:512
  ds_read_b64_tr_b16 v[68:69], v37 offset:2048
  ds_read_b64_tr_b16 v[70:71], v37 offset:2560
  ds_read_b64_tr_b16 v[72:73], v38 offset:0
  ds_read_b64_tr_b16 v[74:75], v38 offset:512
  ds_read_b64_tr_b16 v[76:77], v38 offset:2048
  ds_read_b64_tr_b16 v[78:79], v38 offset:2560
  s_waitcnt lgkmcnt(0)
  ds_write_b128 v4, v[64:67] offset:0
  ds_write_b128 v4, v[68:71] offset:1024
  ds_write_b128 v4, v[72:75] offset:2048
  ds_write_b128 v4, v[76:79] offset:3072
  s_waitcnt lgkmcnt(0)
  ds_read_b64_tr_b16 v[64:65], v37 offset:4096
  ds_read_b64_tr_b16 v[66:67], v37 offset:4608
  ds_read_b64_tr_b16 v[68:69], v37 offset:6144
  ds_read_b64_tr_b16 v[70:71], v37 offset:6656
  ds_read_b64_tr_b16 v[72:73], v38 offset:4096
  ds_read_b64_tr_b16 v[74:75], v38 offset:4608
  ds_read_b64_tr_b16 v[76:77], v38 offset:6144
  ds_read_b64_tr_b16 v[78:79], v38 offset:6656
  s_waitcnt lgkmcnt(0)
  ds_write_b128 v4, v[64:67] offset:4096
  ds_write_b128 v4, v[68:71] offset:5120
  ds_write_b128 v4, v[72:75] offset:6144
  ds_write_b128 v4, v[76:79] offset:7168
  s_waitcnt lgkmcnt(0)
  s_waitcnt vmcnt(0)
  ds_read_b64_tr_b16 v[64:65], v37 offset:8192
  ds_read_b64_tr_b16 v[66:67], v37 offset:8704
  ds_read_b64_tr_b16 v[68:69], v37 offset:10240
  ds_read_b64_tr_b16 v[70:71], v37 offset:10752
  ds_read_b64_tr_b16 v[72:73], v38 offset:8192
  ds_read_b64_tr_b16 v[74:75], v38 offset:8704
  ds_read_b64_tr_b16 v[76:77], v38 offset:10240
  ds_read_b64_tr_b16 v[78:79], v38 offset:10752
  s_waitcnt lgkmcnt(0)
  ds_write_b128 v4, v[64:67] offset:8192
  ds_write_b128 v4, v[68:71] offset:9216
  ds_write_b128 v4, v[72:75] offset:10240
  ds_write_b128 v4, v[76:79] offset:11264
  s_waitcnt lgkmcnt(0)
  ds_read_b64_tr_b16 v[64:65], v37 offset:12288
  ds_read_b64_tr_b16 v[66:67], v37 offset:12800
  ds_read_b64_tr_b16 v[68:69], v37 offset:14336
  ds_read_b64_tr_b16 v[70:71], v37 offset:14848
  ds_read_b64_tr_b16 v[72:73], v38 offset:12288
  ds_read_b64_tr_b16 v[74:75], v38 offset:12800
  ds_read_b64_tr_b16 v[76:77], v38 offset:14336
  ds_read_b64_tr_b16 v[78:79], v38 offset:14848
  s_waitcnt lgkmcnt(0)
  ds_write_b128 v4, v[64:67] offset:12288
  ds_write_b128 v4, v[68:71] offset:13312
  ds_write_b128 v4, v[72:75] offset:14336
  ds_write_b128 v4, v[76:79] offset:15360
  s_waitcnt lgkmcnt(0)
  s_barrier
  s_mov_b32 s90, 0
pur_224:
  s_add_u32 s90, s90, 1
  s_cmp_gt_u32 s90, 131072
  s_cbranch_scc1 mega_kernel_end
  v_and_b32 v21, 7, v2
  v_lshlrev_b32 v21, 2, v21
  v_cmp_ne_u32 vcc, 0, v21
  v_add_u32 v20, 128, v21
  s_nop 0
  v_cndmask_b32 v21, 0, v20, vcc
  buffer_load_dword v20, v21, s[92:95], 0 offen sc1
  s_waitcnt vmcnt(0)
  v_readlane_b32 s80, v20, 0
  v_readlane_b32 s81, v20, 1
  v_readlane_b32 s82, v20, 2
  v_readlane_b32 s83, v20, 3
  v_readlane_b32 s84, v20, 4
  v_readlane_b32 s85, v20, 5
  v_readlane_b32 s86, v20, 6
  v_readlane_b32 s87, v20, 7
  s_add_u32 s88, s80, s81
  s_add_u32 s88, s88, s82
  s_add_u32 s88, s88, s83
  s_add_u32 s88, s88, s84
  s_add_u32 s88, s88, s85
  s_add_u32 s88, s88, s86
  s_add_u32 s88, s88, s87
  s_lshr_b32 s89, s96, 5
  v_readlane_b32 s89, v20, s89
  s_mov_b32 s59, 1
  s_cmp_ge_u32 s89, 32
  s_cbranch_scc1 purd_225
  s_mov_b32 s59, 0
  s_cmp_lt_u32 s88, 256
  s_cbranch_scc1 pur_224
purd_225:
  v_and_b32 v20, 1, v2
  v_lshlrev_b32 v20, 7, v20
  s_mov_b32 s89, 0
wi_226:
  buffer_load_dword v21, v20, s[92:95], 0 offen offset:64 sc1
  s_waitcnt vmcnt(0)
  v_readlane_b32 s80, v21, 0
  v_readlane_b32 s81, v21, 1
  s_nop 0
  s_add_u32 s80, s80, s81
  s_cmp_ge_u32 s80, 64
  s_cbranch_scc1 wid_227
  s_sleep 8
  s_add_u32 s89, s89, 1
  s_cmp_lt_u32 s89, 131072
  s_cbranch_scc1 wi_226
  s_branch mega_kernel_end
wid_227:
  v_lshlrev_b32 v20, 7, v2
  s_lshl_b32 s40, s24, 13
  s_lshl_b32 s41, s3, 18
  s_add_u32 s40, s40, s41
  s_add_u32 s40, s40, s29
  buffer_load_dword v21, v20, s[4:7], s40 offen sc1
  s_lshl_b32 s41, s3, 13
  s_add_u32 s40, s41, s30
  buffer_load_dword v41, v20, s[4:7], s40 offen sc1
  s_waitcnt vmcnt(0)
  ds_write_b128 v5, v[48:51] offset:30720
  v_lshl_or_b32 v32, v97, 16, v96
  v_lshl_or_b32 v33, v99, 16, v98
  v_lshl_or_b32 v34, v101, 16, v100
  v_lshl_or_b32 v35, v103, 16, v102
  v_lshl_or_b32 v36, v105, 16, v104
  v_lshl_or_b32 v37, v107, 16, v106
  v_lshl_or_b32 v38, v109, 16, v108
  v_lshl_or_b32 v39, v111, 16, v110
  s_lshl_b32 s35, s3, 11
  v_add_u32 v22, s35, v5
  ds_write_b128 v22, v[32:35]
  ds_write_b128 v22, v[36:39] offset:1024
  v_lshlrev_b32 v23, 2, v2
  v_and_b32 v23, 127, v23
  v_mov_b32 v0, 1
  v_mov_b32 v16, 0
  s_mov_b32 s34, 0
  s_cmp_eq_u32 s59, 1
  s_cbranch_scc0 tslow_228
  s_mov_b32 s91, 2146435072
  s_mov_b32 s28, 2146435072
  s_mov_b32 s57, 2146435072
  s_mov_b32 s31, 0
  s_mov_b32 s90, 2146435072
  s_mov_b32 s27, 2146435072
  s_mov_b32 m0, s55
  s_cmp_lg_u32 s3, 3
  s_cbranch_scc1 tfok_230
  v_cmp_ne_u32 vcc, 0, v16
  s_nop 0
  s_cmp_eq_u64 vcc, exec
  s_cbranch_scc1 tfok_230
  s_mov_b32 s38, 0
poll_231:
  buffer_load_dword v16, v14, s[4:7], s32 offen sc1
  s_waitcnt vmcnt(0)
  v_cmp_ne_u32 vcc, 0, v16
  s_nop 0
  s_cmp_eq_u64 vcc, exec
  s_cbranch_scc1 polld_232
  s_sleep 4
  s_add_u32 s38, s38, 1
  s_cmp_lt_u32 s38, 131072
  s_cbranch_scc1 poll_231
  s_branch mega_kernel_end
polld_232:
tfok_230:
  s_add_u32 s32, s32, 1024
  s_cmp_eq_u32 s3, 3
  s_cselect_b32 s58, s32, 2146435072
  v_mov_b64 v[72:73], 0
  v_mov_b64 v[74:75], 0
  v_mov_b64 v[76:77], 0
  v_mov_b64 v[78:79], 0
  v_mov_b64 v[80:81], 0
  v_mov_b64 v[82:83], 0
  v_mov_b64 v[84:85], 0
  v_mov_b64 v[86:87], 0
  ds_read_b128 v[88:91], v4 offset:0
  ds_read_b128 v[92:95], v4 offset:1024
  ds_read_b128 v[96:99], v4 offset:2048
  ds_read_b128 v[100:103], v4 offset:3072
  ds_read_b128 v[104:107], v4 offset:4096
  ds_read_b128 v[108:111], v4 offset:5120
  ds_read_b128 v[112:115], v4 offset:6144
  ds_read_b128 v[116:119], v4 offset:7168
  v_mov_b64 v[64:65], 0
  v_mov_b64 v[66:67], 0
  v_mov_b64 v[68:69], 0
  v_mov_b64 v[70:71], 0
  s_and_b32 s37, s34, 3
  s_lshl_b32 s37, s37, 18
  s_add_u32 s37, s37, s29
  s_lshl_b32 s36, s24, 6
  s_add_u32 s39, s37, s36
  s_add_u32 s56, s39, 4096
  s_lshl_b32 s36, s24, 13
  s_add_u32 s37, s37, s36
  s_lshl_b32 s36, s3, 11
  s_add_u32 s37, s37, s36
  s_sub_u32 s50, s25, 960
  s_mov_b32 s40, s37
  s_add_u32 s35, s34, 1
  s_and_b32 s35, s35, 3
  s_lshl_b32 s35, s35, 13
  s_add_u32 s41, s35, s30
  s_xor_b32 s42, s41, 16384
  s_branch ttop_229
tp2_233:
  buffer_load_dwordx4 v[32:35], v1, s[4:7], s43 offen offset:0 sc1
  buffer_load_dwordx4 v[36:39], v1, s[4:7], s43 offen offset:1024 sc1
  s_mov_b64 exec, -1
  s_add_u32 s38, s38, 1
  s_cmp_gt_u32 s38, 524288
  s_cbranch_scc1 mega_kernel_end
tp2b_234:
  s_waitcnt vmcnt(1)
  ds_write_b128 v18, v[32:35] offset:0
  v_max3_u32 v24, v32, v33, v34
  v_max_u32 v24, v24, v35
  s_waitcnt vmcnt(0)
  ds_write_b128 v18, v[36:39] offset:1024
  v_max3_u32 v24, v24, v36, v37
  v_max3_u32 v24, v24, v38, v39
  v_cmp_eq_u32 vcc, -1, v24
  s_nop 0
  s_mov_b64 exec, vcc
  s_cbranch_vccnz tp2_233
  s_mov_b64 exec, -1
  s_cmp_eq_u32 s59, 0
  s_cbranch_scc1 tfslow_235
ttop_229:
  v_smfmac_f32_16x16x64_bf16 v[64:67], v[32:35], a[0:7], v3
  v_xor_b32 v24, 2048, v18
  v_smfmac_f32_16x16x64_bf16 v[68:71], v[32:35], a[8:15], v3
  v_xor_b32 v25, 4096, v18
  v_xor_b32 v26, 6144, v18
  s_waitcnt lgkmcnt(0)
  s_barrier
  ds_read_b128 v[48:51], v25 offset:0
  ds_read_b128 v[56:59], v26 offset:0
  ds_read_b128 v[40:43], v24 offset:0
  ds_read_b128 v[44:47], v24 offset:1024
  ds_read_b128 v[52:55], v25 offset:1024
  ds_read_b128 v[60:63], v26 offset:1024
  v_smfmac_f32_16x16x64_bf16 v[64:67], v[36:39], a[32:39], v3
  buffer_load_dwordx4 v12, s[4:7], s25 offen sc1 lds
  v_smfmac_f32_16x16x64_bf16 v[68:71], v[36:39], a[40:47], v3
  v_smfmac_f32_16x16x64_bf16 v[72:75], v[32:35], a[96:103], v3
  v_smfmac_f32_16x16x64_bf16 v[76:79], v[32:35], a[104:111], v3
  buffer_load_dwordx4 v12, s[4:7], s50 offen offset:1024 sc1 lds
  v_smfmac_f32_16x16x64_bf16 v[72:75], v[36:39], a[128:135], v3
  v_smfmac_f32_16x16x64_bf16 v[76:79], v[36:39], a[136:143], v3
  v_smfmac_f32_16x16x64_bf16 v[80:83], v[32:35], a[192:199], v3
  buffer_store_dwordx4 v[20:23], v1, s[4:7], s27 offen sc1
  v_smfmac_f32_16x16x64_bf16 v[84:87], v[32:35], a[200:207], v3
  v_smfmac_f32_16x16x64_bf16 v[80:83], v[36:39], a[224:231], v3
  v_smfmac_f32_16x16x64_bf16 v[84:87], v[36:39], a[232:239], v3
  s_waitcnt lgkmcnt(5)
  v_smfmac_f32_16x16x64_bf16 v[64:67], v[48:51], v[88:95], v3
  v_smfmac_f32_16x16x64_bf16 v[68:71], v[48:51], v[96:103], v3
  s_waitcnt lgkmcnt(4)
  v_smfmac_f32_16x16x64_bf16 v[64:67], v[56:59], v[104:111], v3
  ds_read_b128 v[88:91], v4 offset:8192
  ds_read_b128 v[92:95], v4 offset:9216
  v_smfmac_f32_16x16x64_bf16 v[68:71], v[56:59], v[112:119], v3
  ds_read_b128 v[96:99], v4 offset:10240
  ds_read_b128 v[100:103], v4 offset:11264
  buffer_load_dwordx4 v[24:27], v17, s[4:7], s26 offen sc1
  s_waitcnt lgkmcnt(7)
  v_smfmac_f32_16x16x64_bf16 v[64:67], v[40:43], a[16:23], v3
  ds_read_b128 v[104:107], v4 offset:12288
  ds_read_b128 v[108:111], v4 offset:13312
  v_smfmac_f32_16x16x64_bf16 v[68:71], v[40:43], a[24:31], v3
  ds_read_b128 v[112:115], v4 offset:14336
  ds_read_b128 v[116:119], v4 offset:15360
  s_waitcnt lgkmcnt(10)
  v_smfmac_f32_16x16x64_bf16 v[64:67], v[44:47], a[48:55], v3
  v_smfmac_f32_16x16x64_bf16 v[68:71], v[44:47], a[56:63], v3
  buffer_load_dwordx4 v[28:31], v17, s[4:7], s26 offen offset:256 sc1
  s_waitcnt lgkmcnt(9)
  v_smfmac_f32_16x16x64_bf16 v[64:67], v[52:55], a[64:71], v3
  v_smfmac_f32_16x16x64_bf16 v[68:71], v[52:55], a[72:79], v3
  s_waitcnt lgkmcnt(8)
  v_smfmac_f32_16x16x64_bf16 v[64:67], v[60:63], a[80:87], v3
  v_smfmac_f32_16x16x64_bf16 v[68:71], v[60:63], a[88:95], v3
  buffer_load_dword v2, v15, s[4:7], s25 offen sc1
  v_smfmac_f32_16x16x64_bf16 v[72:75], v[40:43], a[112:119], v3
  v_smfmac_f32_16x16x64_bf16 v[76:79], v[40:43], a[120:127], v3
  v_smfmac_f32_16x16x64_bf16 v[72:75], v[44:47], a[144:151], v3
  buffer_load_dword v16, v14, s[4:7], s58 offen sc1
  v_smfmac_f32_16x16x64_bf16 v[76:79], v[44:47], a[152:159], v3
  s_waitcnt lgkmcnt(0)
  v_smfmac_f32_16x16x64_bf16 v[72:75], v[48:51], v[88:95], v3
  v_add_f32 v64, v64, v65
  v_smfmac_f32_16x16x64_bf16 v[76:79], v[48:51], v[96:103], v3
  v_add_f32 v66, v66, v67
  v_smfmac_f32_16x16x64_bf16 v[72:75], v[56:59], v[104:111], v3
  v_cvt_pk_bf16_f32 v64, v64, v66
  ds_write_b16 v6, v64 offset:0
  ds_write_b16_d16_hi v6, v64 offset:16
  v_smfmac_f32_16x16x64_bf16 v[76:79], v[56:59], v[112:119], v3
  v_add_f32 v68, v68, v69
  v_smfmac_f32_16x16x64_bf16 v[72:75], v[52:55], a[160:167], v3
  v_add_f32 v70, v70, v71
  v_smfmac_f32_16x16x64_bf16 v[76:79], v[52:55], a[168:175], v3
  v_cvt_pk_bf16_f32 v68, v68, v70
  ds_write_b16 v6, v68 offset:256
  ds_write_b16_d16_hi v6, v68 offset:272
  v_smfmac_f32_16x16x64_bf16 v[72:75], v[60:63], a[176:183], v3
  s_waitcnt vmcnt(5) lgkmcnt(0)
  s_barrier
  ds_read_b128 v[104:107], v7
  ds_read_b128 v[88:91], v5 offset:8192
  v_smfmac_f32_16x16x64_bf16 v[76:79], v[60:63], a[184:191], v3
  ds_read_b128 v[92:95], v5 offset:9216
  ds_read_b128 v[108:111], v7 offset:512
  v_smfmac_f32_16x16x64_bf16 v[80:83], v[40:43], a[208:215], v3
  ds_read_b128 v[96:99], v5 offset:10240
  ds_read_b128 v[100:103], v5 offset:11264
  v_smfmac_f32_16x16x64_bf16 v[84:87], v[40:43], a[216:223], v3
  ds_read_b128 v[112:115], v7 offset:1024
  ds_read_b128 v[116:119], v7 offset:1536
  v_smfmac_f32_16x16x64_bf16 v[80:83], v[44:47], a[240:247], v3
  buffer_store_dwordx4 v[120:123], v1, s[4:7], s90 offen offset:1024
  v_smfmac_f32_16x16x64_bf16 v[84:87], v[44:47], a[248:255], v3
  s_waitcnt lgkmcnt(2)
  v_mfma_f32_16x16x32_bf16 v[64:67], v[88:91], v[104:107], 0
  v_add_f32 v72, v72, v73
  v_add_f32 v74, v74, v75
  v_mfma_f32_16x16x32_bf16 v[68:71], v[92:95], v[104:107], 0
  v_cvt_pk_bf16_f32 v72, v72, v74
  ds_write_b16 v6, v72 offset:2048
  ds_write_b16_d16_hi v6, v72 offset:2064
  v_add_f32 v76, v76, v77
  ds_read_b128 v[88:91], v5 offset:12288
  ds_read_b128 v[92:95], v5 offset:13312
  v_mfma_f32_16x16x32_bf16 v[64:67], v[96:99], v[108:111], v[64:67]
  v_add_f32 v78, v78, v79
  v_cvt_pk_bf16_f32 v76, v76, v78
  ds_write_b16 v6, v76 offset:2304
  ds_write_b16_d16_hi v6, v76 offset:2320
  v_mfma_f32_16x16x32_bf16 v[68:71], v[100:103], v[108:111], v[68:71]
  ds_read_b128 v[96:99], v5 offset:14336
  ds_read_b128 v[100:103], v5 offset:15360
  v_smfmac_f32_16x16x64_bf16 v[80:83], v[48:51], v[128:135], v3
  v_smfmac_f32_16x16x64_bf16 v[84:87], v[48:51], v[136:143], v3
  s_waitcnt vmcnt(5) lgkmcnt(2)
  s_barrier
  ds_read_b128 v[32:35], v8 offset:0
  ds_read_b128 v[36:39], v8 offset:512
  v_mfma_f32_16x16x32_bf16 v[64:67], v[88:91], v[112:115], v[64:67]
  ds_read_b128 v[40:43], v8 offset:1024
  ds_read_b128 v[44:47], v8 offset:1536
  v_mfma_f32_16x16x32_bf16 v[68:71], v[92:95], v[112:115], v[68:71]
  s_mov_b64 exec, 1
  buffer_store_dword v0, off, s[4:7], s91 sc1
  s_mov_b64 exec, -1
  s_waitcnt lgkmcnt(4)
  v_mfma_f32_16x16x32_bf16 v[64:67], v[96:99], v[116:119], v[64:67]
  buffer_store_dwordx4 v[120:123], v1, s[4:7], s90 offen
  v_mfma_f32_16x16x32_bf16 v[68:71], v[100:103], v[116:119], v[68:71]
  v_smfmac_f32_16x16x64_bf16 v[80:83], v[52:55], v[160:167], v3
  s_waitcnt lgkmcnt(0)
  v_mfma_f32_16x16x32_bf16 v[120:123], v[32:35], v[104:107], 0
  v_mfma_f32_16x16x32_bf16 v[120:123], v[36:39], v[108:111], v[120:123]
  v_mfma_f32_16x16x32_bf16 v[120:123], v[40:43], v[112:115], v[120:123]
  v_mfma_f32_16x16x32_bf16 v[120:123], v[44:47], v[116:119], v[120:123]
  v_max3_f32 v20, v64, v65, v66
  s_nop 0
  v_max3_f32 v21, v67, v68, v69
  v_smfmac_f32_16x16x64_bf16 v[84:87], v[52:55], v[168:175], v3
  v_max3_f32 v20, v20, v70, v71
  ds_read_b128 v[88:91], v4 offset:16384
  ds_read_b128 v[92:95], v4 offset:17408
  ds_read_b128 v[104:107], v4 offset:18432
  ds_read_b128 v[108:111], v4 offset:19456
  v_smfmac_f32_16x16x64_bf16 v[80:83], v[56:59], v[144:151], v3
  v_max3_f32 v21, v21, v120, v121
  v_max_f32 v20, v20, v21
  v_mov_b32 v21, v20
  v_smfmac_f32_16x16x64_bf16 v[84:87], v[56:59], v[152:159], v3
  ds_read_b128 v[96:99], v4 offset:20480
  ds_read_b128 v[100:103], v4 offset:21504
  v_permlane16_swap_b32 v20, v21
  v_max_f32 v20, v20, v21
  v_mov_b32 v21, v20
  v_smfmac_f32_16x16x64_bf16 v[80:83], v[60:63], v[176:183], v3
  ds_read_b128 v[112:115], v4 offset:22528
  ds_read_b128 v[116:119], v4 offset:23552
  v_permlane32_swap_b32 v20, v21
  v_max_f32 v20, v20, v21
  v_smfmac_f32_16x16x64_bf16 v[84:87], v[60:63], v[184:191], v3
  v_mul_f32 v20, s54, v20
  v_fma_f32 v64, v64, s54, -v20
  v_fma_f32 v65, v65, s54, -v20
  v_fma_f32 v66, v66, s54, -v20
  v_fma_f32 v67, v67, s54, -v20
  v_fma_f32 v68, v68, s54, -v20
  v_fma_f32 v69, v69, s54, -v20
  v_fma_f32 v70, v70, s54, -v20
  v_fma_f32 v71, v71, s54, -v20
  v_exp_f32 v64, v64
  v_exp_f32 v65, v65
  v_exp_f32 v66, v66
  v_exp_f32 v67, v67
  v_exp_f32 v68, v68
  v_exp_f32 v69, v69
  v_exp_f32 v70, v70
  v_exp_f32 v71, v71
  v_fma_f32 v120, v120, s54, -v20
  v_cvt_pk_bf16_f32 v72, v64, v65
  v_cvt_pk_bf16_f32 v73, v66, v67
  v_cvt_pk_bf16_f32 v74, v68, v69
  v_cvt_pk_bf16_f32 v75, v70, v71
  v_fma_f32 v121, v121, s54, -v20
  v_exp_f32 v120, v120
  s_waitcnt vmcnt(5)
  v_mfma_f32_16x16x32_bf16 v[76:79], v[124:127], v[72:75], 0
  v_exp_f32 v121, v121
  v_mfma_f32_16x16x32_bf16 v[64:67], v[24:27], v[72:75], 0
  v_cvt_pk_bf16_f32 v22, v120, v121
  v_add_f32 v80, v80, v81
  v_mfma_f32_16x16x32_bf16 v[68:71], v[28:31], v[72:75], 0
  v_cndmask_b32 v122, v22, 0, s[52:53]
  v_cndmask_b32 v123, 0, v22, s[52:53]
  v_add_f32 v82, v82, v83
  v_add_f32 v84, v84, v85
  v_mfma_f32_16x16x16_bf16 v[76:79], v[124:125], v[122:123], v[76:79]
  v_add_f32 v86, v86, v87
  v_cvt_pk_bf16_f32 v80, v80, v82
  v_cvt_pk_bf16_f32 v81, v84, v86
  ds_write_b32 v13, v80 offset:0
  ds_write_b32 v13, v81 offset:128
  v_mfma_f32_16x16x16_bf16 v[64:67], v[80:81], v[122:123], v[64:67]
  v_mfma_f32_16x16x16_bf16 v[68:71], v[80:81], v[122:123], v[68:71]
  s_nop 0
  v_rcp_f32 v76, v76
  ds_read_b128 v[32:35], v4 offset:24576
  ds_read_b128 v[36:39], v4 offset:25600
  ds_read_b128 v[40:43], v4 offset:28672
  ds_read_b128 v[44:47], v4 offset:29696
  v_mov_b64 v[48:49], 0
  v_mov_b64 v[50:51], 0
  v_mov_b64 v[52:53], 0
  v_cndmask_b32 v64, v64, v68, s[52:53]
  v_cndmask_b32 v65, v65, v69, s[52:53]
  v_cndmask_b32 v66, v66, v70, s[52:53]
  v_cndmask_b32 v67, v67, v71, s[52:53]
  v_mul_f32 v64, v64, v76
  v_mul_f32 v65, v65, v76
  v_mul_f32 v66, v66, v76
  v_mul_f32 v67, v67, v76
  v_cvt_pk_bf16_f32 v22, v64, v65
  v_cvt_pk_bf16_f32 v23, v66, v67
  ds_write_b64 v9, v[22:23]
  v_mov_b64 v[72:73], 0
  v_mov_b64 v[74:75], 0
  v_mov_b64 v[76:77], 0
  v_mov_b64 v[78:79], 0
  v_mov_b64 v[80:81], 0
  v_mov_b64 v[82:83], 0
  v_mov_b64 v[84:85], 0
  v_mov_b64 v[86:87], 0
  s_waitcnt lgkmcnt(0)
  s_barrier
  ds_read_b128 v[24:27], v5 offset:28672
  ds_read_b128 v[28:31], v5 offset:29696
  s_cmp_ge_u32 s34, 63
  s_cbranch_scc1 tdone_238
  v_mov_b64 v[54:55], 0
  v_mov_b64 v[56:57], 0
  v_mov_b64 v[58:59], 0
  v_mov_b64 v[60:61], 0
  v_mov_b64 v[62:63], 0
  s_waitcnt lgkmcnt(1)
  v_smfmac_f32_16x16x64_bf16 v[72:75], v[24:27], v[88:95], v3
  s_waitcnt lgkmcnt(0)
  v_smfmac_f32_16x16x64_bf16 v[72:75], v[28:31], v[96:103], v3
  v_smfmac_f32_16x16x64_bf16 v[76:79], v[24:27], v[104:111], v3
  ds_read_b128 v[88:91], v4 offset:26624
  ds_read_b128 v[92:95], v4 offset:27648
  v_smfmac_f32_16x16x64_bf16 v[76:79], v[28:31], v[112:119], v3
  ds_read_b128 v[96:99], v4 offset:30720
  ds_read_b128 v[100:103], v4 offset:31744
  v_smfmac_f32_16x16x64_bf16 v[80:83], v[24:27], v[192:199], v3
  v_smfmac_f32_16x16x64_bf16 v[80:83], v[28:31], v[208:215], v3
  v_add_f32 v72, v72, v73
  v_add_f32 v74, v74, v75
  v_smfmac_f32_16x16x64_bf16 v[84:87], v[24:27], v[200:207], v3
  s_nop 0
  v_add_f32 v76, v76, v77
  v_add_f32 v78, v78, v79
  v_smfmac_f32_16x16x64_bf16 v[84:87], v[28:31], v[216:223], v3
  v_cvt_pk_bf16_f32 v64, v72, v76
  v_cvt_pk_bf16_f32 v66, v74, v78
  v_smfmac_f32_16x16x64_bf16 v[48:51], v[24:27], v[224:231], v3
  v_min_u32 v64, -2, v64
  v_min_u32 v66, -2, v66
  v_smfmac_f32_16x16x64_bf16 v[48:51], v[28:31], v[240:247], v3
  v_add_f32 v80, v80, v81
  v_add_f32 v82, v82, v83
  v_smfmac_f32_16x16x64_bf16 v[52:55], v[24:27], v[232:239], v3
  v_add_f32 v84, v84, v85
  v_add_f32 v86, v86, v87
  v_smfmac_f32_16x16x64_bf16 v[52:55], v[28:31], v[248:255], v3
  v_cvt_pk_bf16_f32 v65, v80, v84
  v_cvt_pk_bf16_f32 v67, v82, v86
  v_smfmac_f32_16x16x64_bf16 v[56:59], v[24:27], v[32:39], v3
  v_min_u32 v65, -2, v65
  v_min_u32 v67, -2, v67
  v_smfmac_f32_16x16x64_bf16 v[56:59], v[28:31], v[40:47], v3
  buffer_store_dwordx4 v[64:67], v10, s[4:7], s39 offen
  v_add_f32 v48, v48, v49
  s_waitcnt lgkmcnt(0)
  ds_read_b128 v[44:47], v5 offset:30720
  v_smfmac_f32_16x16x64_bf16 v[60:63], v[24:27], v[88:95], v3
  v_add_f32 v50, v50, v51
  v_add_f32 v52, v52, v53
  v_smfmac_f32_16x16x64_bf16 v[60:63], v[28:31], v[96:103], v3
  v_add_f32 v54, v54, v55
  v_cvt_pk_bf16_f32 v68, v48, v52
  v_cvt_pk_bf16_f32 v70, v50, v54
  v_min_u32 v68, -2, v68
  v_min_u32 v70, -2, v70
  v_add_f32 v56, v56, v57
  v_add_f32 v58, v58, v59
  s_nop 0
  v_add_f32 v60, v60, v61
  v_add_f32 v62, v62, v63
  v_cvt_pk_bf16_f32 v69, v56, v60
  v_cvt_pk_bf16_f32 v71, v58, v62
  v_min_u32 v69, -2, v69
  v_min_u32 v71, -2, v71
  buffer_store_dwordx4 v[68:71], v10, s[4:7], s56 offen
  v_mov_b64 v[120:121], -1
  v_mov_b64 v[122:123], -1
  s_add_u32 s34, s34, 1
  s_lshl_b32 s36, s3, 11
  s_add_u32 s43, s41, s36
  s_cmp_eq_u32 s3, 2
  s_cselect_b32 s91, s33, 2146435072
  s_add_u32 s33, s33, 1024
  s_mov_b32 s27, s51
  s_add_u32 s51, s51, 65536
  s_mov_b32 s90, s40
  s_add_u32 s25, s25, 262144
  s_add_u32 s26, s26, 262144
  v_mov_b64 v[72:73], 0
  v_mov_b64 v[74:75], 0
  v_mov_b64 v[76:77], 0
  v_mov_b64 v[78:79], 0
  v_mov_b64 v[80:81], 0
  v_mov_b64 v[82:83], 0
  v_mov_b64 v[84:85], 0
  v_mov_b64 v[86:87], 0
  ds_read_b128 v[88:91], v4 offset:0
  ds_read_b128 v[92:95], v4 offset:1024
  ds_read_b128 v[96:99], v4 offset:2048
  ds_read_b128 v[100:103], v4 offset:3072
  ds_read_b128 v[104:107], v4 offset:4096
  ds_read_b128 v[108:111], v4 offset:5120
  ds_read_b128 v[112:115], v4 offset:6144
  ds_read_b128 v[116:119], v4 offset:7168
  v_mov_b64 v[64:65], 0
  v_mov_b64 v[66:67], 0
  v_mov_b64 v[68:69], 0
  v_mov_b64 v[70:71], 0
  s_and_b32 s37, s34, 3
  s_lshl_b32 s37, s37, 18
  s_add_u32 s37, s37, s29
  s_lshl_b32 s36, s24, 6
  s_add_u32 s39, s37, s36
  s_add_u32 s56, s39, 4096
  s_lshl_b32 s36, s24, 13
  s_add_u32 s37, s37, s36
  s_lshl_b32 s36, s3, 11
  s_add_u32 s37, s37, s36
  s_sub_u32 s50, s25, 960
  s_mov_b32 s38, 0
tp1_239:
  buffer_load_dwordx4 v[32:35], v1, s[4:7], s40 offen sc1
  buffer_load_dwordx4 v[36:39], v1, s[4:7], s40 offen offset:1024 sc1
  s_mov_b64 exec, -1
  s_add_u32 s38, s38, 1
  s_cmp_gt_u32 s38, 524288
  s_cbranch_scc1 mega_kernel_end
  s_waitcnt vmcnt(0) lgkmcnt(8)
  v_mfma_f32_16x16x32_bf16 v[40:43], v[44:47], v[32:35], 0
  v_max3_u32 v20, v32, v33, v34
  v_max3_u32 v21, v35, v36, v37
  v_mfma_f32_16x16x32_bf16 v[40:43], v[44:47], v[36:39], v[40:43]
  v_max3_u32 v20, v20, v38, v39
  v_max_u32 v20, v20, v21
  v_cmp_eq_u32 vcc, -1, v20
  s_nop 0
  s_mov_b64 exec, vcc
  s_cbranch_vccnz tp1_239
  s_mov_b64 exec, -1
  s_nop 0
  v_add_f32_dpp v40, v40, v40 row_ror:4 row_mask:0xf bank_mask:0xf
  v_add_f32_dpp v41, v41, v41 row_ror:4 row_mask:0xf bank_mask:0xf
  v_add_f32_dpp v42, v42, v42 row_ror:4 row_mask:0xf bank_mask:0xf
  v_add_f32_dpp v43, v43, v43 row_ror:4 row_mask:0xf bank_mask:0xf
  v_add_f32_dpp v40, v40, v40 row_ror:8 row_mask:0xf bank_mask:0xf
  v_add_f32_dpp v41, v41, v41 row_ror:8 row_mask:0xf bank_mask:0xf
  v_add_f32_dpp v42, v42, v42 row_ror:8 row_mask:0xf bank_mask:0xf
  v_add_f32_dpp v43, v43, v43 row_ror:8 row_mask:0xf bank_mask:0xf
  v_cvt_pk_bf16_f32 v20, v40, v41
  v_cvt_pk_bf16_f32 v21, v42, v43
  v_min_u32 v20, -2, v20
  v_min_u32 v21, -2, v21
  s_mov_b64 exec, s[48:49]
  buffer_store_dwordx2 v[20:21], v11, s[4:7], s41 offen
  buffer_store_dwordx2 v[120:121], v11, s[4:7], s42 offen
  s_mov_b64 exec, -1
  s_mov_b32 s38, 0
  ds_read_b128 v[20:23], v19
  s_mov_b32 s40, s37
  s_add_u32 s35, s34, 1
  s_and_b32 s35, s35, 3
  s_lshl_b32 s35, s35, 13
  s_add_u32 s41, s35, s30
  s_xor_b32 s42, s41, 16384
  v_cmp_ne_u32 vcc, 0, v16
  s_nop 0
  s_cmp_eq_u64 vcc, exec
  s_cselect_b32 s59, 1, 0
  s_cmp_lg_u32 s3, 3
  s_cselect_b32 s59, 1, s59
  s_add_u32 s58, s32, 1024
  s_cselect_b32 s35, 0, 0
  s_cmp_eq_u32 s3, 3
  s_cselect_b32 s58, s58, 2146435072
  s_add_u32 s32, s32, 1024
  s_barrier
  buffer_load_dwordx4 v[32:35], v1, s[4:7], s43 offen offset:0 sc1
  buffer_load_dwordx4 v[36:39], v1, s[4:7], s43 offen offset:1024 sc1
  s_branch tp2b_234
tfslow_235:
  s_sub_u32 s37, s32, 1024
  s_mov_b32 s38, 0
poll_242:
  buffer_load_dword v16, v14, s[4:7], s37 offen sc1
  s_waitcnt vmcnt(0)
  v_cmp_ne_u32 vcc, 0, v16
  s_nop 0
  s_cmp_eq_u64 vcc, exec
  s_cbranch_scc1 polld_243
  s_sleep 4
  s_add_u32 s38, s38, 1
  s_cmp_lt_u32 s38, 131072
  s_cbranch_scc1 poll_242
  s_branch mega_kernel_end
polld_243:
  s_branch ttop_229
tdone_238:
  ds_read_b128 v[20:23], v19
  s_waitcnt lgkmcnt(0)
  buffer_store_dwordx4 v[20:23], v1, s[4:7], s51 offen sc1
  s_waitcnt vmcnt(0)
  s_barrier
  s_cmp_lg_u32 s3, 2
  s_cbranch_scc1 mega_kernel_end
  s_mov_b64 exec, 1
  buffer_store_dword v0, off, s[4:7], s33 sc1
  s_mov_b64 exec, -1
  s_branch mega_kernel_end
tslow_228:
  s_mov_b32 s91, 2146435072
  s_mov_b32 s28, 2146435072
  s_mov_b32 s57, 2146435072
  s_mov_b32 s31, 0
  s_mov_b32 s90, 2146435072
  s_mov_b32 s27, 2146435072
  s_mov_b32 m0, s55
  s_cmp_lg_u32 s3, 3
  s_cbranch_scc1 tfok_245
  v_cmp_ne_u32 vcc, 0, v16
  s_nop 0
  s_cmp_eq_u64 vcc, exec
  s_cbranch_scc1 tfok_245
  s_mov_b32 s38, 0
poll_246:
  buffer_load_dword v16, v14, s[4:7], s32 offen sc1
  s_waitcnt vmcnt(0)
  v_cmp_ne_u32 vcc, 0, v16
  s_nop 0
  s_cmp_eq_u64 vcc, exec
  s_cbranch_scc1 polld_247
  s_sleep 4
  s_add_u32 s38, s38, 1
  s_cmp_lt_u32 s38, 131072
  s_cbranch_scc1 poll_246
  s_branch mega_kernel_end
polld_247:
tfok_245:
  s_add_u32 s32, s32, 1024
  s_cmp_eq_u32 s3, 3
  s_cselect_b32 s58, s32, 2146435072
  v_mov_b64 v[72:73], 0
  v_mov_b64 v[74:75], 0
  v_mov_b64 v[76:77], 0
  v_mov_b64 v[78:79], 0
  v_mov_b64 v[80:81], 0
  v_mov_b64 v[82:83], 0
  v_mov_b64 v[84:85], 0
  v_mov_b64 v[86:87], 0
  ds_read_b128 v[88:91], v4 offset:0
  ds_read_b128 v[92:95], v4 offset:1024
  ds_read_b128 v[96:99], v4 offset:2048
  ds_read_b128 v[100:103], v4 offset:3072
  ds_read_b128 v[104:107], v4 offset:4096
  ds_read_b128 v[108:111], v4 offset:5120
  ds_read_b128 v[112:115], v4 offset:6144
  ds_read_b128 v[116:119], v4 offset:7168
  v_mov_b64 v[64:65], 0
  v_mov_b64 v[66:67], 0
  v_mov_b64 v[68:69], 0
  v_mov_b64 v[70:71], 0
  s_and_b32 s37, s34, 3
  s_lshl_b32 s37, s37, 18
  s_add_u32 s37, s37, s29
  s_lshl_b32 s36, s24, 6
  s_add_u32 s39, s37, s36
  s_add_u32 s56, s39, 4096
  s_lshl_b32 s36, s24, 13
  s_add_u32 s37, s37, s36
  s_lshl_b32 s36, s3, 11
  s_add_u32 s37, s37, s36
  s_sub_u32 s50, s25, 960
  s_mov_b32 s40, s37
  s_add_u32 s35, s34, 1
  s_and_b32 s35, s35, 3
  s_lshl_b32 s35, s35, 13
  s_add_u32 s41, s35, s30
  s_xor_b32 s42, s41, 16384
  s_branch ttop_244
tp2_248:
  buffer_load_dwordx4 v[32:35], v1, s[4:7], s43 offen offset:0 sc1
  buffer_load_dwordx4 v[36:39], v1, s[4:7], s43 offen offset:1024 sc1
  s_mov_b64 exec, -1
  s_add_u32 s38, s38, 1
  s_cmp_gt_u32 s38, 524288
  s_cbranch_scc1 mega_kernel_end
tp2b_249:
  s_waitcnt vmcnt(1)
  ds_write_b128 v18, v[32:35] offset:0
  v_max3_u32 v24, v32, v33, v34
  v_max_u32 v24, v24, v35
  s_waitcnt vmcnt(0)
  ds_write_b128 v18, v[36:39] offset:1024
  v_max3_u32 v24, v24, v36, v37
  v_max3_u32 v24, v24, v38, v39
  v_cmp_eq_u32 vcc, -1, v24
  s_nop 0
  s_mov_b64 exec, vcc
  s_cbranch_vccnz tp2_248
  s_mov_b64 exec, -1
  s_cmp_eq_u32 s59, 0
  s_cbranch_scc1 tfslow_250
ttop_244:
  v_smfmac_f32_16x16x64_bf16 v[64:67], v[32:35], a[0:7], v3
  v_xor_b32 v24, 2048, v18
  v_smfmac_f32_16x16x64_bf16 v[68:71], v[32:35], a[8:15], v3
  v_xor_b32 v25, 4096, v18
  v_xor_b32 v26, 6144, v18
  s_waitcnt lgkmcnt(0)
  s_barrier
  ds_read_b128 v[48:51], v25 offset:0
  ds_read_b128 v[56:59], v26 offset:0
  ds_read_b128 v[40:43], v24 offset:0
  ds_read_b128 v[44:47], v24 offset:1024
  ds_read_b128 v[52:55], v25 offset:1024
  ds_read_b128 v[60:63], v26 offset:1024
  v_smfmac_f32_16x16x64_bf16 v[64:67], v[36:39], a[32:39], v3
  buffer_load_dwordx4 v12, s[4:7], s25 offen sc1 lds
  v_smfmac_f32_16x16x64_bf16 v[68:71], v[36:39], a[40:47], v3
  v_smfmac_f32_16x16x64_bf16 v[72:75], v[32:35], a[96:103], v3
  v_smfmac_f32_16x16x64_bf16 v[76:79], v[32:35], a[104:111], v3
  buffer_load_dwordx4 v12, s[4:7], s50 offen offset:1024 sc1 lds
  v_smfmac_f32_16x16x64_bf16 v[72:75], v[36:39], a[128:135], v3
  v_smfmac_f32_16x16x64_bf16 v[76:79], v[36:39], a[136:143], v3
  v_smfmac_f32_16x16x64_bf16 v[80:83], v[32:35], a[192:199], v3
  buffer_store_dwordx4 v[20:23], v1, s[4:7], s27 offen sc1
  v_smfmac_f32_16x16x64_bf16 v[84:87], v[32:35], a[200:207], v3
  v_smfmac_f32_16x16x64_bf16 v[80:83], v[36:39], a[224:231], v3
  v_smfmac_f32_16x16x64_bf16 v[84:87], v[36:39], a[232:239], v3
  s_waitcnt lgkmcnt(5)
  v_smfmac_f32_16x16x64_bf16 v[64:67], v[48:51], v[88:95], v3
  v_smfmac_f32_16x16x64_bf16 v[68:71], v[48:51], v[96:103], v3
  s_waitcnt lgkmcnt(4)
  v_smfmac_f32_16x16x64_bf16 v[64:67], v[56:59], v[104:111], v3
  ds_read_b128 v[88:91], v4 offset:8192
  ds_read_b128 v[92:95], v4 offset:9216
  v_smfmac_f32_16x16x64_bf16 v[68:71], v[56:59], v[112:119], v3
  ds_read_b128 v[96:99], v4 offset:10240
  ds_read_b128 v[100:103], v4 offset:11264
  buffer_load_dwordx4 v[24:27], v17, s[4:7], s26 offen sc1
  s_waitcnt lgkmcnt(7)
  v_smfmac_f32_16x16x64_bf16 v[64:67], v[40:43], a[16:23], v3
  ds_read_b128 v[104:107], v4 offset:12288
  ds_read_b128 v[108:111], v4 offset:13312
  v_smfmac_f32_16x16x64_bf16 v[68:71], v[40:43], a[24:31], v3
  ds_read_b128 v[112:115], v4 offset:14336
  ds_read_b128 v[116:119], v4 offset:15360
  s_waitcnt lgkmcnt(10)
  v_smfmac_f32_16x16x64_bf16 v[64:67], v[44:47], a[48:55], v3
  v_smfmac_f32_16x16x64_bf16 v[68:71], v[44:47], a[56:63], v3
  buffer_load_dwordx4 v[28:31], v17, s[4:7], s26 offen offset:256 sc1
  s_waitcnt lgkmcnt(9)
  v_smfmac_f32_16x16x64_bf16 v[64:67], v[52:55], a[64:71], v3
  v_smfmac_f32_16x16x64_bf16 v[68:71], v[52:55], a[72:79], v3
  s_waitcnt lgkmcnt(8)
  v_smfmac_f32_16x16x64_bf16 v[64:67], v[60:63], a[80:87], v3
  v_smfmac_f32_16x16x64_bf16 v[68:71], v[60:63], a[88:95], v3
  buffer_load_dword v2, v15, s[4:7], s25 offen sc1
  v_smfmac_f32_16x16x64_bf16 v[72:75], v[40:43], a[112:119], v3
  v_smfmac_f32_16x16x64_bf16 v[76:79], v[40:43], a[120:127], v3
  v_smfmac_f32_16x16x64_bf16 v[72:75], v[44:47], a[144:151], v3
  buffer_load_dword v16, v14, s[4:7], s58 offen sc1
  v_smfmac_f32_16x16x64_bf16 v[76:79], v[44:47], a[152:159], v3
  s_waitcnt lgkmcnt(0)
  v_smfmac_f32_16x16x64_bf16 v[72:75], v[48:51], v[88:95], v3
  v_add_f32 v64, v64, v65
  v_smfmac_f32_16x16x64_bf16 v[76:79], v[48:51], v[96:103], v3
  v_add_f32 v66, v66, v67
  v_smfmac_f32_16x16x64_bf16 v[72:75], v[56:59], v[104:111], v3
  v_cvt_pk_bf16_f32 v64, v64, v66
  ds_write_b16 v6, v64 offset:0
  ds_write_b16_d16_hi v6, v64 offset:16
  v_smfmac_f32_16x16x64_bf16 v[76:79], v[56:59], v[112:119], v3
  v_add_f32 v68, v68, v69
  v_smfmac_f32_16x16x64_bf16 v[72:75], v[52:55], a[160:167], v3
  v_add_f32 v70, v70, v71
  v_smfmac_f32_16x16x64_bf16 v[76:79], v[52:55], a[168:175], v3
  v_cvt_pk_bf16_f32 v68, v68, v70
  ds_write_b16 v6, v68 offset:256
  ds_write_b16_d16_hi v6, v68 offset:272
  v_smfmac_f32_16x16x64_bf16 v[72:75], v[60:63], a[176:183], v3
  s_waitcnt vmcnt(5) lgkmcnt(0)
  s_barrier
  ds_read_b128 v[104:107], v7
  ds_read_b128 v[88:91], v5 offset:8192
  v_smfmac_f32_16x16x64_bf16 v[76:79], v[60:63], a[184:191], v3
  ds_read_b128 v[92:95], v5 offset:9216
  ds_read_b128 v[108:111], v7 offset:512
  v_smfmac_f32_16x16x64_bf16 v[80:83], v[40:43], a[208:215], v3
  ds_read_b128 v[96:99], v5 offset:10240
  ds_read_b128 v[100:103], v5 offset:11264
  v_smfmac_f32_16x16x64_bf16 v[84:87], v[40:43], a[216:223], v3
  ds_read_b128 v[112:115], v7 offset:1024
  ds_read_b128 v[116:119], v7 offset:1536
  v_smfmac_f32_16x16x64_bf16 v[80:83], v[44:47], a[240:247], v3
  buffer_store_dwordx4 v[120:123], v1, s[4:7], s90 offen offset:1024 sc1
  v_smfmac_f32_16x16x64_bf16 v[84:87], v[44:47], a[248:255], v3
  s_waitcnt lgkmcnt(2)
  v_mfma_f32_16x16x32_bf16 v[64:67], v[88:91], v[104:107], 0
  v_add_f32 v72, v72, v73
  v_add_f32 v74, v74, v75
  v_mfma_f32_16x16x32_bf16 v[68:71], v[92:95], v[104:107], 0
  v_cvt_pk_bf16_f32 v72, v72, v74
  ds_write_b16 v6, v72 offset:2048
  ds_write_b16_d16_hi v6, v72 offset:2064
  v_add_f32 v76, v76, v77
  ds_read_b128 v[88:91], v5 offset:12288
  ds_read_b128 v[92:95], v5 offset:13312
  v_mfma_f32_16x16x32_bf16 v[64:67], v[96:99], v[108:111], v[64:67]
  v_add_f32 v78, v78, v79
  v_cvt_pk_bf16_f32 v76, v76, v78
  ds_write_b16 v6, v76 offset:2304
  ds_write_b16_d16_hi v6, v76 offset:2320
  v_mfma_f32_16x16x32_bf16 v[68:71], v[100:103], v[108:111], v[68:71]
  ds_read_b128 v[96:99], v5 offset:14336
  ds_read_b128 v[100:103], v5 offset:15360
  v_smfmac_f32_16x16x64_bf16 v[80:83], v[48:51], v[128:135], v3
  v_smfmac_f32_16x16x64_bf16 v[84:87], v[48:51], v[136:143], v3
  s_waitcnt vmcnt(5) lgkmcnt(2)
  s_barrier
  ds_read_b128 v[32:35], v8 offset:0
  ds_read_b128 v[36:39], v8 offset:512
  v_mfma_f32_16x16x32_bf16 v[64:67], v[88:91], v[112:115], v[64:67]
  ds_read_b128 v[40:43], v8 offset:1024
  ds_read_b128 v[44:47], v8 offset:1536
  v_mfma_f32_16x16x32_bf16 v[68:71], v[92:95], v[112:115], v[68:71]
  s_mov_b64 exec, 1
  buffer_store_dword v0, off, s[4:7], s91 sc1
  s_mov_b64 exec, -1
  s_waitcnt lgkmcnt(4)
  v_mfma_f32_16x16x32_bf16 v[64:67], v[96:99], v[116:119], v[64:67]
  buffer_store_dwordx4 v[120:123], v1, s[4:7], s90 offen sc1
  v_mfma_f32_16x16x32_bf16 v[68:71], v[100:103], v[116:119], v[68:71]
  v_smfmac_f32_16x16x64_bf16 v[80:83], v[52:55], v[160:167], v3
  s_waitcnt lgkmcnt(0)
  v_mfma_f32_16x16x32_bf16 v[120:123], v[32:35], v[104:107], 0
  v_mfma_f32_16x16x32_bf16 v[120:123], v[36:39], v[108:111], v[120:123]
  v_mfma_f32_16x16x32_bf16 v[120:123], v[40:43], v[112:115], v[120:123]
  v_mfma_f32_16x16x32_bf16 v[120:123], v[44:47], v[116:119], v[120:123]
  v_max3_f32 v20, v64, v65, v66
  s_nop 0
  v_max3_f32 v21, v67, v68, v69
  v_smfmac_f32_16x16x64_bf16 v[84:87], v[52:55], v[168:175], v3
  v_max3_f32 v20, v20, v70, v71
  ds_read_b128 v[88:91], v4 offset:16384
  ds_read_b128 v[92:95], v4 offset:17408
  ds_read_b128 v[104:107], v4 offset:18432
  ds_read_b128 v[108:111], v4 offset:19456
  v_smfmac_f32_16x16x64_bf16 v[80:83], v[56:59], v[144:151], v3
  v_max3_f32 v21, v21, v120, v121
  v_max_f32 v20, v20, v21
  v_mov_b32 v21, v20
  v_smfmac_f32_16x16x64_bf16 v[84:87], v[56:59], v[152:159], v3
  ds_read_b128 v[96:99], v4 offset:20480
  ds_read_b128 v[100:103], v4 offset:21504
  v_permlane16_swap_b32 v20, v21
  v_max_f32 v20, v20, v21
  v_mov_b32 v21, v20
  v_smfmac_f32_16x16x64_bf16 v[80:83], v[60:63], v[176:183], v3
  ds_read_b128 v[112:115], v4 offset:22528
  ds_read_b128 v[116:119], v4 offset:23552
  v_permlane32_swap_b32 v20, v21
  v_max_f32 v20, v20, v21
  v_smfmac_f32_16x16x64_bf16 v[84:87], v[60:63], v[184:191], v3
  v_mul_f32 v20, s54, v20
  v_fma_f32 v64, v64, s54, -v20
  v_fma_f32 v65, v65, s54, -v20
  v_fma_f32 v66, v66, s54, -v20
  v_fma_f32 v67, v67, s54, -v20
  v_fma_f32 v68, v68, s54, -v20
  v_fma_f32 v69, v69, s54, -v20
  v_fma_f32 v70, v70, s54, -v20
  v_fma_f32 v71, v71, s54, -v20
  v_exp_f32 v64, v64
  v_exp_f32 v65, v65
  v_exp_f32 v66, v66
  v_exp_f32 v67, v67
  v_exp_f32 v68, v68
  v_exp_f32 v69, v69
  v_exp_f32 v70, v70
  v_exp_f32 v71, v71
  v_fma_f32 v120, v120, s54, -v20
  v_cvt_pk_bf16_f32 v72, v64, v65
  v_cvt_pk_bf16_f32 v73, v66, v67
  v_cvt_pk_bf16_f32 v74, v68, v69
  v_cvt_pk_bf16_f32 v75, v70, v71
  v_fma_f32 v121, v121, s54, -v20
  v_exp_f32 v120, v120
  s_waitcnt vmcnt(5)
  v_mfma_f32_16x16x32_bf16 v[76:79], v[124:127], v[72:75], 0
  v_exp_f32 v121, v121
  v_mfma_f32_16x16x32_bf16 v[64:67], v[24:27], v[72:75], 0
  v_cvt_pk_bf16_f32 v22, v120, v121
  v_add_f32 v80, v80, v81
  v_mfma_f32_16x16x32_bf16 v[68:71], v[28:31], v[72:75], 0
  v_cndmask_b32 v122, v22, 0, s[52:53]
  v_cndmask_b32 v123, 0, v22, s[52:53]
  v_add_f32 v82, v82, v83
  v_add_f32 v84, v84, v85
  v_mfma_f32_16x16x16_bf16 v[76:79], v[124:125], v[122:123], v[76:79]
  v_add_f32 v86, v86, v87
  v_cvt_pk_bf16_f32 v80, v80, v82
  v_cvt_pk_bf16_f32 v81, v84, v86
  ds_write_b32 v13, v80 offset:0
  ds_write_b32 v13, v81 offset:128
  v_mfma_f32_16x16x16_bf16 v[64:67], v[80:81], v[122:123], v[64:67]
  v_mfma_f32_16x16x16_bf16 v[68:71], v[80:81], v[122:123], v[68:71]
  s_nop 0
  v_rcp_f32 v76, v76
  ds_read_b128 v[32:35], v4 offset:24576
  ds_read_b128 v[36:39], v4 offset:25600
  ds_read_b128 v[40:43], v4 offset:28672
  ds_read_b128 v[44:47], v4 offset:29696
  v_mov_b64 v[48:49], 0
  v_mov_b64 v[50:51], 0
  v_mov_b64 v[52:53], 0
  v_cndmask_b32 v64, v64, v68, s[52:53]
  v_cndmask_b32 v65, v65, v69, s[52:53]
  v_cndmask_b32 v66, v66, v70, s[52:53]
  v_cndmask_b32 v67, v67, v71, s[52:53]
  v_mul_f32 v64, v64, v76
  v_mul_f32 v65, v65, v76
  v_mul_f32 v66, v66, v76
  v_mul_f32 v67, v67, v76
  v_cvt_pk_bf16_f32 v22, v64, v65
  v_cvt_pk_bf16_f32 v23, v66, v67
  ds_write_b64 v9, v[22:23]
  v_mov_b64 v[72:73], 0
  v_mov_b64 v[74:75], 0
  v_mov_b64 v[76:77], 0
  v_mov_b64 v[78:79], 0
  v_mov_b64 v[80:81], 0
  v_mov_b64 v[82:83], 0
  v_mov_b64 v[84:85], 0
  v_mov_b64 v[86:87], 0
  s_waitcnt lgkmcnt(0)
  s_barrier
  ds_read_b128 v[24:27], v5 offset:28672
  ds_read_b128 v[28:31], v5 offset:29696
  s_cmp_ge_u32 s34, 63
  s_cbranch_scc1 tdone_253
  v_mov_b64 v[54:55], 0
  v_mov_b64 v[56:57], 0
  v_mov_b64 v[58:59], 0
  v_mov_b64 v[60:61], 0
  v_mov_b64 v[62:63], 0
  s_waitcnt lgkmcnt(1)
  v_smfmac_f32_16x16x64_bf16 v[72:75], v[24:27], v[88:95], v3
  s_waitcnt lgkmcnt(0)
  v_smfmac_f32_16x16x64_bf16 v[72:75], v[28:31], v[96:103], v3
  v_smfmac_f32_16x16x64_bf16 v[76:79], v[24:27], v[104:111], v3
  ds_read_b128 v[88:91], v4 offset:26624
  ds_read_b128 v[92:95], v4 offset:27648
  v_smfmac_f32_16x16x64_bf16 v[76:79], v[28:31], v[112:119], v3
  ds_read_b128 v[96:99], v4 offset:30720
  ds_read_b128 v[100:103], v4 offset:31744
  v_smfmac_f32_16x16x64_bf16 v[80:83], v[24:27], v[192:199], v3
  v_smfmac_f32_16x16x64_bf16 v[80:83], v[28:31], v[208:215], v3
  v_add_f32 v72, v72, v73
  v_add_f32 v74, v74, v75
  v_smfmac_f32_16x16x64_bf16 v[84:87], v[24:27], v[200:207], v3
  s_nop 0
  v_add_f32 v76, v76, v77
  v_add_f32 v78, v78, v79
  v_smfmac_f32_16x16x64_bf16 v[84:87], v[28:31], v[216:223], v3
  v_cvt_pk_bf16_f32 v64, v72, v76
  v_cvt_pk_bf16_f32 v66, v74, v78
  v_smfmac_f32_16x16x64_bf16 v[48:51], v[24:27], v[224:231], v3
  v_min_u32 v64, -2, v64
  v_min_u32 v66, -2, v66
  v_smfmac_f32_16x16x64_bf16 v[48:51], v[28:31], v[240:247], v3
  v_add_f32 v80, v80, v81
  v_add_f32 v82, v82, v83
  v_smfmac_f32_16x16x64_bf16 v[52:55], v[24:27], v[232:239], v3
  v_add_f32 v84, v84, v85
  v_add_f32 v86, v86, v87
  v_smfmac_f32_16x16x64_bf16 v[52:55], v[28:31], v[248:255], v3
  v_cvt_pk_bf16_f32 v65, v80, v84
  v_cvt_pk_bf16_f32 v67, v82, v86
  v_smfmac_f32_16x16x64_bf16 v[56:59], v[24:27], v[32:39], v3
  v_min_u32 v65, -2, v65
  v_min_u32 v67, -2, v67
  v_smfmac_f32_16x16x64_bf16 v[56:59], v[28:31], v[40:47], v3
  buffer_store_dwordx4 v[64:67], v10, s[4:7], s39 offen sc1
  v_add_f32 v48, v48, v49
  s_waitcnt lgkmcnt(0)
  ds_read_b128 v[44:47], v5 offset:30720
  v_smfmac_f32_16x16x64_bf16 v[60:63], v[24:27], v[88:95], v3
  v_add_f32 v50, v50, v51
  v_add_f32 v52, v52, v53
  v_smfmac_f32_16x16x64_bf16 v[60:63], v[28:31], v[96:103], v3
  v_add_f32 v54, v54, v55
  v_cvt_pk_bf16_f32 v68, v48, v52
  v_cvt_pk_bf16_f32 v70, v50, v54
  v_min_u32 v68, -2, v68
  v_min_u32 v70, -2, v70
  v_add_f32 v56, v56, v57
  v_add_f32 v58, v58, v59
  s_nop 0
  v_add_f32 v60, v60, v61
  v_add_f32 v62, v62, v63
  v_cvt_pk_bf16_f32 v69, v56, v60
  v_cvt_pk_bf16_f32 v71, v58, v62
  v_min_u32 v69, -2, v69
  v_min_u32 v71, -2, v71
  buffer_store_dwordx4 v[68:71], v10, s[4:7], s56 offen sc1
  v_mov_b64 v[120:121], -1
  v_mov_b64 v[122:123], -1
  s_add_u32 s34, s34, 1
  s_lshl_b32 s36, s3, 11
  s_add_u32 s43, s41, s36
  s_cmp_eq_u32 s3, 2
  s_cselect_b32 s91, s33, 2146435072
  s_add_u32 s33, s33, 1024
  s_mov_b32 s27, s51
  s_add_u32 s51, s51, 65536
  s_mov_b32 s90, s40
  s_add_u32 s25, s25, 262144
  s_add_u32 s26, s26, 262144
  v_mov_b64 v[72:73], 0
  v_mov_b64 v[74:75], 0
  v_mov_b64 v[76:77], 0
  v_mov_b64 v[78:79], 0
  v_mov_b64 v[80:81], 0
  v_mov_b64 v[82:83], 0
  v_mov_b64 v[84:85], 0
  v_mov_b64 v[86:87], 0
  ds_read_b128 v[88:91], v4 offset:0
  ds_read_b128 v[92:95], v4 offset:1024
  ds_read_b128 v[96:99], v4 offset:2048
  ds_read_b128 v[100:103], v4 offset:3072
  ds_read_b128 v[104:107], v4 offset:4096
  ds_read_b128 v[108:111], v4 offset:5120
  ds_read_b128 v[112:115], v4 offset:6144
  ds_read_b128 v[116:119], v4 offset:7168
  v_mov_b64 v[64:65], 0
  v_mov_b64 v[66:67], 0
  v_mov_b64 v[68:69], 0
  v_mov_b64 v[70:71], 0
  s_and_b32 s37, s34, 3
  s_lshl_b32 s37, s37, 18
  s_add_u32 s37, s37, s29
  s_lshl_b32 s36, s24, 6
  s_add_u32 s39, s37, s36
  s_add_u32 s56, s39, 4096
  s_lshl_b32 s36, s24, 13
  s_add_u32 s37, s37, s36
  s_lshl_b32 s36, s3, 11
  s_add_u32 s37, s37, s36
  s_sub_u32 s50, s25, 960
  s_mov_b32 s38, 0
tp1_254:
  buffer_load_dwordx4 v[32:35], v1, s[4:7], s40 offen sc1
  buffer_load_dwordx4 v[36:39], v1, s[4:7], s40 offen offset:1024 sc1
  s_mov_b64 exec, -1
  s_add_u32 s38, s38, 1
  s_cmp_gt_u32 s38, 524288
  s_cbranch_scc1 mega_kernel_end
  s_waitcnt vmcnt(0) lgkmcnt(8)
  v_mfma_f32_16x16x32_bf16 v[40:43], v[44:47], v[32:35], 0
  v_max3_u32 v20, v32, v33, v34
  v_max3_u32 v21, v35, v36, v37
  v_mfma_f32_16x16x32_bf16 v[40:43], v[44:47], v[36:39], v[40:43]
  v_max3_u32 v20, v20, v38, v39
  v_max_u32 v20, v20, v21
  v_cmp_eq_u32 vcc, -1, v20
  s_nop 0
  s_mov_b64 exec, vcc
  s_cbranch_vccnz tp1_254
  s_mov_b64 exec, -1
  s_nop 0
  v_add_f32_dpp v40, v40, v40 row_ror:4 row_mask:0xf bank_mask:0xf
  v_add_f32_dpp v41, v41, v41 row_ror:4 row_mask:0xf bank_mask:0xf
  v_add_f32_dpp v42, v42, v42 row_ror:4 row_mask:0xf bank_mask:0xf
  v_add_f32_dpp v43, v43, v43 row_ror:4 row_mask:0xf bank_mask:0xf
  v_add_f32_dpp v40, v40, v40 row_ror:8 row_mask:0xf bank_mask:0xf
  v_add_f32_dpp v41, v41, v41 row_ror:8 row_mask:0xf bank_mask:0xf
  v_add_f32_dpp v42, v42, v42 row_ror:8 row_mask:0xf bank_mask:0xf
  v_add_f32_dpp v43, v43, v43 row_ror:8 row_mask:0xf bank_mask:0xf
  v_cvt_pk_bf16_f32 v20, v40, v41
  v_cvt_pk_bf16_f32 v21, v42, v43
  v_min_u32 v20, -2, v20
  v_min_u32 v21, -2, v21
  s_mov_b64 exec, s[48:49]
  buffer_store_dwordx2 v[20:21], v11, s[4:7], s41 offen sc1
  buffer_store_dwordx2 v[120:121], v11, s[4:7], s42 offen sc1
  s_mov_b64 exec, -1
  s_mov_b32 s38, 0
  ds_read_b128 v[20:23], v19
  s_mov_b32 s40, s37
  s_add_u32 s35, s34, 1
  s_and_b32 s35, s35, 3
  s_lshl_b32 s35, s35, 13
  s_add_u32 s41, s35, s30
  s_xor_b32 s42, s41, 16384
  v_cmp_ne_u32 vcc, 0, v16
  s_nop 0
  s_cmp_eq_u64 vcc, exec
  s_cselect_b32 s59, 1, 0
  s_cmp_lg_u32 s3, 3
  s_cselect_b32 s59, 1, s59
  s_add_u32 s58, s32, 1024
  s_cselect_b32 s35, 0, 0
  s_cmp_eq_u32 s3, 3
  s_cselect_b32 s58, s58, 2146435072
  s_add_u32 s32, s32, 1024
  s_barrier
  buffer_load_dwordx4 v[32:35], v1, s[4:7], s43 offen offset:0 sc1
  buffer_load_dwordx4 v[36:39], v1, s[4:7], s43 offen offset:1024 sc1
  s_branch tp2b_249
tfslow_250:
  s_sub_u32 s37, s32, 1024
  s_mov_b32 s38, 0
poll_257:
  buffer_load_dword v16, v14, s[4:7], s37 offen sc1
  s_waitcnt vmcnt(0)
  v_cmp_ne_u32 vcc, 0, v16
  s_nop 0
  s_cmp_eq_u64 vcc, exec
  s_cbranch_scc1 polld_258
  s_sleep 4
  s_add_u32 s38, s38, 1
  s_cmp_lt_u32 s38, 131072
  s_cbranch_scc1 poll_257
  s_branch mega_kernel_end
polld_258:
  s_branch ttop_244
tdone_253:
  ds_read_b128 v[20:23], v19
  s_waitcnt lgkmcnt(0)
  buffer_store_dwordx4 v[20:23], v1, s[4:7], s51 offen sc1
  s_waitcnt vmcnt(0)
  s_barrier
  s_cmp_lg_u32 s3, 2
  s_cbranch_scc1 mega_kernel_end
  s_mov_b64 exec, 1
  buffer_store_dword v0, off, s[4:7], s33 sc1
  s_mov_b64 exec, -1
  s_branch mega_kernel_end
mega_kernel_end:
  s_endpgm

.section .rodata,"a"
.p2align 6
.amdhsa_kernel mega_kernel
  .amdhsa_next_free_vgpr 512
  .amdhsa_next_free_sgpr 102
  .amdhsa_accum_offset 256
  .amdhsa_group_segment_fixed_size 0
  .amdhsa_kernarg_size 112
  .amdhsa_user_sgpr_count 2
  .amdhsa_user_sgpr_kernarg_segment_ptr 1
  .amdhsa_system_sgpr_workgroup_id_x 1
.end_amdhsa_kernel
```
